```python
import torch

def _softmax(x, axis=-1):
    return torch.softmax(x, dim=axis)
def _gelu(x):
    return torch.nn.functional.gelu(x, approximate="tanh")
def _silu(x):
    return torch.nn.functional.silu(x)
def _sigmoid(x):
    return torch.sigmoid(x)
def _layernorm(x, axis=-1, eps=1e-5):
    m = x.mean(dim=axis, keepdim=True)
    v = x.var(dim=axis, keepdim=True, unbiased=False)
    return (x - m) / torch.sqrt(v + eps)
def _scatter_add(tgt, idx, src, axis=0):
    return tgt.clone().index_add_(axis, idx, src)
def _segment_sum(src, seg, n):
    out = torch.zeros((n,) + src.shape[1:], dtype=src.dtype)
    return out.index_add_(0, seg, src)
def _pad(x, pw):
    flat = tuple(v for pair in reversed(pw) for v in pair)
    return torch.nn.functional.pad(x, flat)

kernel_name = 'concat_heads__gqa_block_cached__gqa_block_cached__near_ridge'

def setup_inputs():

    _w = (lambda a: (lambda t: t.to(torch.bfloat16) if t.is_floating_point() else t)(torch.as_tensor(a)))
    def _A_setup():
        B, Sq, D = 16, 32, 512
        Hq, Hkv, Sk, Dh = 32, 8, 1024, 128
        assert Hq % Hkv == 0, (Hq, Hkv)
        return {
            "x": _w((lambda *s: torch.randn(*s, dtype=torch.bfloat16) * 0.8)(B, Sq, D)),
            "k_cache": _w((lambda *s: torch.randn(*s, dtype=torch.bfloat16) * 0.8)(B, Hkv, Sk, Dh)),
            "v_cache": _w((lambda *s: torch.randn(*s, dtype=torch.bfloat16) * 0.05)(B, Hkv, Sk, Dh)),
            "wq": _w((lambda *s: torch.randn(*s, dtype=torch.bfloat16) * 0.8)(D, Hq * Dh) * (D ** -0.5)),
            "wo": _w((lambda *s: torch.randn(*s, dtype=torch.bfloat16) * 0.05)(Hq * Dh, D) * ((Hq * Dh) ** -0.5)),
        }
    _A_in = _A_setup()

    def _B_setup():
        B, Sq, D = 16, 32, 512
        Hq, Hkv, Sk, Dh = 32, 8, 1024, 128
        assert Hq % Hkv == 0, (Hq, Hkv)
        return {
            "x": _w((lambda *s: torch.randn(*s, dtype=torch.bfloat16) * 0.8)(B, Sq, D)),
            "k_cache": _w((lambda *s: torch.randn(*s, dtype=torch.bfloat16) * 0.8)(B, Hkv, Sk, Dh)),
            "v_cache": _w((lambda *s: torch.randn(*s, dtype=torch.bfloat16) * 0.05)(B, Hkv, Sk, Dh)),
            "wq": _w((lambda *s: torch.randn(*s, dtype=torch.bfloat16) * 0.8)(D, Hq * Dh) * (D ** -0.5)),
            "wo": _w((lambda *s: torch.randn(*s, dtype=torch.bfloat16) * 0.05)(Hq * Dh, D) * ((Hq * Dh) ** -0.5)),
        }
    _B_in = _B_setup()

    return {
        "A_x": _A_in["x"],
        "A_k_cache": _A_in["k_cache"],
        "A_v_cache": _A_in["v_cache"],
        "A_wq": _A_in["wq"],
        "A_wo": _A_in["wo"],
        "B_x": _B_in["x"],
        "B_k_cache": _B_in["k_cache"],
        "B_v_cache": _B_in["v_cache"],
        "B_wq": _B_in["wq"],
        "B_wo": _B_in["wo"],
    }

def reference(A_x, A_k_cache, A_v_cache, A_wq, A_wo, B_x, B_k_cache, B_v_cache, B_wq, B_wo):
    def _A_ref(x, k_cache, v_cache, wq, wo):
        B, Sq, D = x.shape
        Hq, Dh = 32, 128
        Hkv = k_cache.shape[1]
        rep = Hq // Hkv
        q = (lambda x, *d: x.permute(*d))((x @ wq).reshape(B, Sq, Hq, Dh), 0, 2, 1, 3)
        k = (lambda x, n, axis: torch.repeat_interleave(x, n, dim=axis))(k_cache, rep, axis=1)
        v = (lambda x, n, axis: torch.repeat_interleave(x, n, dim=axis))(v_cache, rep, axis=1)
        scores = torch.einsum("bhqd,bhkd->bhqk", q, k) * (Dh ** -0.5)
        p = _softmax(scores, axis=-1)
        o = torch.einsum("bhqk,bhkd->bhqd", p, v)
        return (lambda x, *d: x.permute(*d))(o, 0, 2, 1, 3).reshape(B, Sq, Hq * Dh) @ wo

    def _B_ref(x, k_cache, v_cache, wq, wo):
        B, Sq, D = x.shape
        Hq, Dh = 32, 128
        Hkv = k_cache.shape[1]
        rep = Hq // Hkv
        q = (lambda x, *d: x.permute(*d))((x @ wq).reshape(B, Sq, Hq, Dh), 0, 2, 1, 3)
        k = (lambda x, n, axis: torch.repeat_interleave(x, n, dim=axis))(k_cache, rep, axis=1)
        v = (lambda x, n, axis: torch.repeat_interleave(x, n, dim=axis))(v_cache, rep, axis=1)
        scores = torch.einsum("bhqd,bhkd->bhqk", q, k) * (Dh ** -0.5)
        p = _softmax(scores, axis=-1)
        o = torch.einsum("bhqk,bhkd->bhqd", p, v)
        return (lambda x, *d: x.permute(*d))(o, 0, 2, 1, 3).reshape(B, Sq, Hq * Dh) @ wo

    a = _A_ref(A_x, A_k_cache, A_v_cache, A_wq, A_wo)
    b = _B_ref(B_x, B_k_cache, B_v_cache, B_wq, B_wo)
    return torch.concatenate([a, b], axis=-1)
```

```asm
; @launch grid=(256,1,1) block=(256,1,1) lds=163840
.amdgcn_target "amdgcn-amd-amdhsa--gfx950"
.text
.globl concat_heads__gqa_block_cached__gqa_block_cached__near_ridge_kernel
.p2align 8
.type concat_heads__gqa_block_cached__gqa_block_cached__near_ridge_kernel,@function
concat_heads__gqa_block_cached__gqa_block_cached__near_ridge_kernel:
    s_cmp_ge_u32 s2, 128
    s_cbranch_scc1 LB_top
    s_cmp_ge_u32 s2, 256
    s_cbranch_scc1 LA_end
    s_mov_b32 s100, 0
LA_again:
    s_load_dwordx16 s[16:31], s[0:1], 0
    s_load_dwordx8 s[32:39], s[0:1], 64
    s_load_dwordx2 s[40:41], s[0:1], 96
    s_getpc_b64 s[12:13]
LA_pc:
    s_bfe_u32 s10, s2, 0x40003
    s_lshl_b32 s10, s10, 12
    v_lshl_add_u32 v6, v0, 4, s10
    v_min_u32 v6, 0xa818, v6
    global_load_dwordx4 v[48:51], v6, s[12:13]
    v_lshrrev_b32 v2, 6, v0
    v_and_b32 v1, 63, v0
    v_readfirstlane_b32 s3, v2
    s_and_b32 s4, s2, 7
    s_lshr_b32 s7, s2, 3
    s_and_b32 s5, s7, 15
    s_lshr_b32 s6, s7, 4
    v_lshrrev_b32 v3, 4, v1
    v_and_b32 v4, 15, v1
    s_lshl_b32 s13, s4, 10
    s_lshl_b32 s14, s3, 8
    s_add_u32 s13, s13, s14
    v_lshlrev_b32 v11, 16, v3
    v_lshl_add_u32 v11, v4, 4, v11
    v_add_u32 v11, s13, v11
    s_mov_b32 s54, 4194304
    s_mov_b32 s55, 0x20000
    s_cmp_eq_u32 s6, 1
    s_waitcnt lgkmcnt(0)
    s_cselect_b32 s52, s32, s22
    s_cselect_b32 s53, s33, s23
    s_cselect_b32 s16, s26, s16
    s_cselect_b32 s17, s27, s17
    s_cselect_b32 s18, s28, s18
    s_cselect_b32 s19, s29, s19
    s_cselect_b32 s20, s30, s20
    s_cselect_b32 s21, s31, s21
    s_cselect_b32 s24, s34, s24
    s_cselect_b32 s25, s35, s25
    s_lshl_b32 s10, s5, 15
    s_add_u32 s60, s16, s10
    s_addc_u32 s61, s17, 0
    s_mov_b32 s62, 32768
    s_mov_b32 s63, 0x20000
    s_and_b32 s8, s3, 1
    s_lshl_b32 s8, s8, 3
    s_lshl_b32 s11, s5, 2
    s_lshl_b32 s12, s3, 13
    s_add_u32 s15, s12, 131072
    v_xor_b32 v5, s8, v1
    v_xor_b32 v32, 0, v5
    v_add_u32 v32, s11, v32
    v_and_b32 v32, 63, v32
    v_lshl_add_u32 v32, v32, 4, s12
    v_xor_b32 v33, 1, v5
    v_add_u32 v33, s11, v33
    v_and_b32 v33, 63, v33
    v_lshl_add_u32 v33, v33, 4, s12
    v_xor_b32 v34, 2, v5
    v_add_u32 v34, s11, v34
    v_and_b32 v34, 63, v34
    v_lshl_add_u32 v34, v34, 4, s12
    v_xor_b32 v35, 3, v5
    v_add_u32 v35, s11, v35
    v_and_b32 v35, 63, v35
    v_lshl_add_u32 v35, v35, 4, s12
    v_xor_b32 v36, 4, v5
    v_add_u32 v36, s11, v36
    v_and_b32 v36, 63, v36
    v_lshl_add_u32 v36, v36, 4, s12
    v_xor_b32 v37, 5, v5
    v_add_u32 v37, s11, v37
    v_and_b32 v37, 63, v37
    v_lshl_add_u32 v37, v37, 4, s12
    v_xor_b32 v38, 6, v5
    v_add_u32 v38, s11, v38
    v_and_b32 v38, 63, v38
    v_lshl_add_u32 v38, v38, 4, s12
    v_xor_b32 v39, 7, v5
    v_add_u32 v39, s11, v39
    v_and_b32 v39, 63, v39
    v_lshl_add_u32 v39, v39, 4, s12
    s_and_b32 s10, s2, 127
    s_lshl_b32 s10, s10, 18
    s_add_u32 s44, s18, s10
    s_addc_u32 s45, s19, 0
    s_mov_b32 s46, 262144
    s_mov_b32 s47, 0x20000
    s_add_u32 s48, s20, s10
    s_addc_u32 s49, s21, 0
    s_mov_b32 s50, 262144
    s_mov_b32 s51, 0x20000
    s_lshl_b32 s10, s4, 19
    s_add_u32 s56, s24, s10
    s_addc_u32 s57, s25, 0
    s_mov_b32 s58, 524288
    s_mov_b32 s59, 0x20000
    s_mov_b32 s64, s40
    s_mov_b32 s65, s41
    s_mov_b32 s66, 0x10000000
    s_mov_b32 s67, 0x20000
    s_mov_b32 s68, s36
    s_mov_b32 s69, s37
    s_mov_b32 s70, 1048576
    s_mov_b32 s71, 0x20000
    s_mov_b32 s92, s38
    s_mov_b32 s93, s39
    s_mov_b32 s94, 256
    s_mov_b32 s95, 0x20000
    s_lshl_b32 s75, s7, 20
    v_mov_b32 v56, 270336
    s_xor_b32 s10, s2, 128
    s_or_b32 s10, s10, s3
    s_cbranch_scc1 LA_ne0
    buffer_load_dword v57, v56, s[64:67], 0 offen sc1
LA_ne0:
    s_mov_b32 s72, 0x05040100
    s_mov_b32 s73, 0x07060302
    s_mov_b32 s74, 1040356334
    s_lshl_b32 s78, s3, 11
    s_lshl_b32 s79, s3, 12
    s_lshl_b32 s81, s5, 15
    s_and_b32 s83, s5, 1
    s_mul_i32 s10, s3, 2048
    v_lshl_add_u32 v6, v3, 8, s10
    v_add_u32 v7, s8, v3
    v_xor_b32 v7, v7, v4
    v_lshl_add_u32 v8, v7, 4, v6
    v_xor_b32 v9, 192, v8
    v_lshlrev_b32 v7, 1, v3
    v_xor_b32 v7, v7, v4
    v_lshl_add_u32 v10, v7, 4, v6
    v_lshlrev_b32 v7, 2, v3
    v_xor_b32 v7, v7, v4
    v_lshlrev_b32 v7, 4, v7
    v_lshl_add_u32 v7, v3, 10, v7
    v_add_u32 v60, s14, v7
    v_add_u32 v61, 3072, v60
    v_add_u32 v62, 14336, v60
    v_add_u32 v63, 17408, v60
    v_and_b32 v7, 4, v4
    v_lshlrev_b32 v7, 1, v7
    v_xor_b32 v7, v7, v4
    v_lshlrev_b32 v5, 2, v3
    v_xor_b32 v7, v7, v5
    v_lshlrev_b32 v7, 4, v7
    v_lshl_add_u32 v16, v4, 8, v7
    v_xor_b32 v17, 16, v16
    v_xor_b32 v18, 32, v16
    v_xor_b32 v19, 48, v16
    v_lshrrev_b32 v5, 2, v1
    v_and_b32 v6, 7, v5
    v_lshlrev_b32 v7, 8, v5
    v_lshl_add_u32 v7, v6, 5, v7
    v_and_b32 v5, 3, v1
    v_lshl_add_u32 v7, v5, 3, v7
    v_add_u32 v20, 65536, v7
    v_xor_b32 v21, 32, v20
    v_xor_b32 v22, 64, v20
    v_xor_b32 v23, 96, v20
    v_xor_b32 v24, 128, v20
    v_xor_b32 v25, 160, v20
    v_xor_b32 v26, 192, v20
    v_xor_b32 v27, 224, v20
    v_lshrrev_b32 v6, 5, v1
    v_bfe_u32 v5, v1, 2, 2
    v_lshl_add_u32 v7, v6, 2, v5
    v_lshlrev_b32 v7, 8, v7
    v_lshl_add_u32 v7, v5, 6, v7
    v_and_b32 v5, 1, v3
    v_lshl_add_u32 v7, v5, 5, v7
    v_and_b32 v5, 3, v1
    v_lshl_add_u32 v7, v5, 3, v7
    v_add_u32 v28, s79, v7
    v_xor_b32 v29, 64, v28
    v_xor_b32 v30, 128, v28
    v_xor_b32 v31, 192, v28
    v_xor_b32 v5, v3, v4
    v_lshlrev_b32 v5, 4, v5
    v_lshl_add_u32 v5, v4, 10, v5
    v_add_u32 v44, 131072, v5
    v_xor_b32 v45, 64, v44
    v_xor_b32 v46, 128, v44
    v_xor_b32 v47, 192, v44
    v_xor_b32 v5, 128, v10
    s_add_u32 m0, s78, 0
    s_mov_b32 s9, 0
    buffer_load_dwordx4 v8, s[44:47], s9 offen nt lds
    buffer_load_dwordx4 v9, s[44:47], s9 offen offset:1024 nt lds
    s_add_u32 m0, s78, 8192
    s_mov_b32 s9, 8192
    buffer_load_dwordx4 v8, s[44:47], s9 offen nt lds
    buffer_load_dwordx4 v9, s[44:47], s9 offen offset:1024 nt lds
    s_add_u32 m0, s78, 65536
    s_mov_b32 s9, 0
    buffer_load_dwordx4 v10, s[48:51], s9 offen nt lds
    buffer_load_dwordx4 v5, s[48:51], s9 offen offset:1024 nt lds
    s_add_u32 m0, s78, 16384
    s_mov_b32 s9, 16384
    buffer_load_dwordx4 v8, s[44:47], s9 offen nt lds
    buffer_load_dwordx4 v9, s[44:47], s9 offen offset:1024 nt lds
    s_add_u32 m0, s78, 73728
    s_mov_b32 s9, 8192
    buffer_load_dwordx4 v10, s[48:51], s9 offen nt lds
    buffer_load_dwordx4 v5, s[48:51], s9 offen offset:1024 nt lds
    s_add_u32 m0, s78, 24576
    s_mov_b32 s9, 24576
    buffer_load_dwordx4 v8, s[44:47], s9 offen nt lds
    buffer_load_dwordx4 v9, s[44:47], s9 offen offset:1024 nt lds
    s_add_u32 m0, s78, 81920
    s_mov_b32 s9, 16384
    buffer_load_dwordx4 v10, s[48:51], s9 offen nt lds
    buffer_load_dwordx4 v5, s[48:51], s9 offen offset:1024 nt lds
    s_add_u32 m0, s78, 32768
    s_mov_b32 s9, 32768
    buffer_load_dwordx4 v8, s[44:47], s9 offen nt lds
    buffer_load_dwordx4 v9, s[44:47], s9 offen offset:1024 nt lds
    s_add_u32 m0, s78, 90112
    s_mov_b32 s9, 24576
    buffer_load_dwordx4 v10, s[48:51], s9 offen nt lds
    buffer_load_dwordx4 v5, s[48:51], s9 offen offset:1024 nt lds
    s_add_u32 m0, s78, 40960
    s_mov_b32 s9, 40960
    buffer_load_dwordx4 v8, s[44:47], s9 offen nt lds
    buffer_load_dwordx4 v9, s[44:47], s9 offen offset:1024 nt lds
    s_add_u32 m0, s78, 98304
    s_mov_b32 s9, 32768
    buffer_load_dwordx4 v10, s[48:51], s9 offen nt lds
    buffer_load_dwordx4 v5, s[48:51], s9 offen offset:1024 nt lds
    s_add_u32 m0, s78, 49152
    s_mov_b32 s9, 49152
    buffer_load_dwordx4 v8, s[44:47], s9 offen nt lds
    buffer_load_dwordx4 v9, s[44:47], s9 offen offset:1024 nt lds
    s_add_u32 s80, s5, 0
    s_and_b32 s80, s80, 15
    s_lshl_b32 s80, s80, 18
    buffer_load_dwordx4 v[160:163], v11, s[52:55], s80 offen
    s_add_u32 s80, s80, 8192
    buffer_load_dwordx4 v[164:167], v11, s[52:55], s80 offen
    s_add_u32 s80, s80, 8192
    buffer_load_dwordx4 v[168:171], v11, s[52:55], s80 offen
    s_add_u32 s80, s80, 8192
    buffer_load_dwordx4 v[172:175], v11, s[52:55], s80 offen
    s_add_u32 s80, s80, 8192
    buffer_load_dwordx4 v[176:179], v11, s[52:55], s80 offen
    s_add_u32 s80, s80, 8192
    buffer_load_dwordx4 v[180:183], v11, s[52:55], s80 offen
    s_add_u32 s80, s80, 8192
    buffer_load_dwordx4 v[184:187], v11, s[52:55], s80 offen
    s_add_u32 s80, s80, 8192
    buffer_load_dwordx4 v[188:191], v11, s[52:55], s80 offen
    s_mov_b32 m0, s15
    s_movk_i32 s10, 0x1000
    buffer_load_dwordx4 v32, s[60:63], 0 offen lds
    buffer_load_dwordx4 v33, s[60:63], 0 offen offset:1024 lds
    buffer_load_dwordx4 v34, s[60:63], 0 offen offset:2048 lds
    buffer_load_dwordx4 v35, s[60:63], 0 offen offset:3072 lds
    s_add_u32 m0, s15, 4096
    s_nop 0
    buffer_load_dwordx4 v36, s[60:63], s10 offen lds
    buffer_load_dwordx4 v37, s[60:63], s10 offen offset:1024 lds
    buffer_load_dwordx4 v38, s[60:63], s10 offen offset:2048 lds
    buffer_load_dwordx4 v39, s[60:63], s10 offen offset:3072 lds
    s_add_u32 s80, s5, 1
    s_and_b32 s80, s80, 15
    s_lshl_b32 s80, s80, 18
    buffer_load_dwordx4 v[192:195], v11, s[52:55], s80 offen
    s_add_u32 s80, s80, 8192
    buffer_load_dwordx4 v[196:199], v11, s[52:55], s80 offen
    s_add_u32 s80, s80, 8192
    buffer_load_dwordx4 v[200:203], v11, s[52:55], s80 offen
    s_add_u32 s80, s80, 8192
    buffer_load_dwordx4 v[204:207], v11, s[52:55], s80 offen
    s_add_u32 s80, s80, 8192
    buffer_load_dwordx4 v[208:211], v11, s[52:55], s80 offen
    s_add_u32 s80, s80, 8192
    buffer_load_dwordx4 v[212:215], v11, s[52:55], s80 offen
    s_add_u32 s80, s80, 8192
    buffer_load_dwordx4 v[216:219], v11, s[52:55], s80 offen
    s_add_u32 s80, s80, 8192
    buffer_load_dwordx4 v[220:223], v11, s[52:55], s80 offen
    s_waitcnt vmcnt(8)
    s_barrier
    ds_read_b128 a[0:3], v44 offset:0
    ds_read_b128 a[4:7], v44 offset:16384
    ds_read_b128 a[8:11], v45 offset:0
    ds_read_b128 a[12:15], v45 offset:16384
    ds_read_b128 a[16:19], v46 offset:0
    ds_read_b128 a[20:23], v46 offset:16384
    ds_read_b128 a[24:27], v47 offset:0
    ds_read_b128 a[28:31], v47 offset:16384
    ds_read_b128 a[32:35], v44 offset:256
    ds_read_b128 a[36:39], v44 offset:16640
    ds_read_b128 a[40:43], v45 offset:256
    ds_read_b128 a[44:47], v45 offset:16640
    ds_read_b128 a[48:51], v46 offset:256
    ds_read_b128 a[52:55], v46 offset:16640
    ds_read_b128 a[56:59], v47 offset:256
    ds_read_b128 a[60:63], v47 offset:16640
    ds_read_b128 a[64:67], v44 offset:512
    ds_read_b128 a[68:71], v44 offset:16896
    s_add_u32 s80, s5, 2
    s_and_b32 s80, s80, 15
    s_lshl_b32 s80, s80, 18
    buffer_load_dwordx4 v[224:227], v11, s[52:55], s80 offen
    ds_read_b128 a[72:75], v45 offset:512
    ds_read_b128 a[76:79], v45 offset:16896
    s_add_u32 s80, s80, 8192
    buffer_load_dwordx4 v[228:231], v11, s[52:55], s80 offen
    ds_read_b128 a[80:83], v46 offset:512
    ds_read_b128 a[84:87], v46 offset:16896
    s_add_u32 s80, s80, 8192
    buffer_load_dwordx4 v[232:235], v11, s[52:55], s80 offen
    ds_read_b128 a[88:91], v47 offset:512
    ds_read_b128 a[92:95], v47 offset:16896
    s_add_u32 s80, s80, 8192
    buffer_load_dwordx4 v[236:239], v11, s[52:55], s80 offen
    ds_read_b128 a[96:99], v44 offset:768
    ds_read_b128 a[100:103], v44 offset:17152
    s_add_u32 s80, s80, 8192
    buffer_load_dwordx4 v[240:243], v11, s[52:55], s80 offen
    ds_read_b128 a[104:107], v45 offset:768
    ds_read_b128 a[108:111], v45 offset:17152
    s_add_u32 s80, s80, 8192
    buffer_load_dwordx4 v[244:247], v11, s[52:55], s80 offen
    ds_read_b128 a[112:115], v46 offset:768
    ds_read_b128 a[116:119], v46 offset:17152
    s_add_u32 s80, s80, 8192
    buffer_load_dwordx4 v[248:251], v11, s[52:55], s80 offen
    ds_read_b128 a[120:123], v47 offset:768
    ds_read_b128 a[124:127], v47 offset:17152
    s_add_u32 s80, s80, 8192
    buffer_load_dwordx4 v[252:255], v11, s[52:55], s80 offen
    v_perm_b32 v32, v164, v160, s72
    v_perm_b32 v33, v172, v168, s72
    v_perm_b32 v34, v180, v176, s72
    v_perm_b32 v35, v188, v184, s72
    v_perm_b32 v36, v164, v160, s73
    v_perm_b32 v37, v172, v168, s73
    v_perm_b32 v38, v180, v176, s73
    v_perm_b32 v39, v188, v184, s73
    s_waitcnt lgkmcnt(15)
    v_mfma_f32_16x16x32_bf16 v[96:99], v[32:35], a[0:3], 0
    v_mfma_f32_16x16x32_bf16 v[100:103], v[32:35], a[4:7], 0
    s_add_u32 s80, s5, 3
    s_and_b32 s80, s80, 15
    s_lshl_b32 s80, s80, 18
    buffer_load_dwordx4 v[64:67], v11, s[52:55], s80 offen
    v_perm_b32 v40, v165, v161, s72
    v_perm_b32 v41, v173, v169, s72
    v_perm_b32 v42, v181, v177, s72
    v_perm_b32 v43, v189, v185, s72
    v_mfma_f32_16x16x32_bf16 v[104:107], v[36:39], a[0:3], 0
    v_mfma_f32_16x16x32_bf16 v[108:111], v[36:39], a[4:7], 0
    s_add_u32 s80, s80, 8192
    buffer_load_dwordx4 v[68:71], v11, s[52:55], s80 offen
    v_perm_b32 v32, v165, v161, s73
    v_perm_b32 v33, v173, v169, s73
    v_perm_b32 v34, v181, v177, s73
    v_perm_b32 v35, v189, v185, s73
    v_mfma_f32_16x16x32_bf16 v[112:115], v[40:43], a[0:3], 0
    v_mfma_f32_16x16x32_bf16 v[116:119], v[40:43], a[4:7], 0
    s_add_u32 s80, s80, 8192
    buffer_load_dwordx4 v[72:75], v11, s[52:55], s80 offen
    v_perm_b32 v36, v166, v162, s72
    v_perm_b32 v37, v174, v170, s72
    v_perm_b32 v38, v182, v178, s72
    v_perm_b32 v39, v190, v186, s72
    v_mfma_f32_16x16x32_bf16 v[120:123], v[32:35], a[0:3], 0
    v_mfma_f32_16x16x32_bf16 v[124:127], v[32:35], a[4:7], 0
    s_add_u32 s80, s80, 8192
    buffer_load_dwordx4 v[76:79], v11, s[52:55], s80 offen
    v_perm_b32 v40, v166, v162, s73
    v_perm_b32 v41, v174, v170, s73
    v_perm_b32 v42, v182, v178, s73
    v_perm_b32 v43, v190, v186, s73
    v_mfma_f32_16x16x32_bf16 v[128:131], v[36:39], a[0:3], 0
    v_mfma_f32_16x16x32_bf16 v[132:135], v[36:39], a[4:7], 0
    s_add_u32 s80, s80, 8192
    buffer_load_dwordx4 v[80:83], v11, s[52:55], s80 offen
    v_perm_b32 v32, v167, v163, s72
    v_perm_b32 v33, v175, v171, s72
    v_perm_b32 v34, v183, v179, s72
    v_perm_b32 v35, v191, v187, s72
    v_mfma_f32_16x16x32_bf16 v[136:139], v[40:43], a[0:3], 0
    v_mfma_f32_16x16x32_bf16 v[140:143], v[40:43], a[4:7], 0
    s_add_u32 s80, s80, 8192
    buffer_load_dwordx4 v[84:87], v11, s[52:55], s80 offen
    v_perm_b32 v36, v167, v163, s73
    v_perm_b32 v37, v175, v171, s73
    v_perm_b32 v38, v183, v179, s73
    v_perm_b32 v39, v191, v187, s73
    v_mfma_f32_16x16x32_bf16 v[144:147], v[32:35], a[0:3], 0
    v_mfma_f32_16x16x32_bf16 v[148:151], v[32:35], a[4:7], 0
    s_add_u32 s80, s80, 8192
    buffer_load_dwordx4 v[88:91], v11, s[52:55], s80 offen
    v_mfma_f32_16x16x32_bf16 v[152:155], v[36:39], a[0:3], 0
    v_mfma_f32_16x16x32_bf16 v[156:159], v[36:39], a[4:7], 0
    s_add_u32 s80, s80, 8192
    buffer_load_dwordx4 v[92:95], v11, s[52:55], s80 offen
    s_waitcnt lgkmcnt(0)
    s_cmp_lg_u32 s83, 0
    s_cbranch_scc1 LA_nb0_0
    s_barrier
    s_add_u32 m0, s79, 131072
    s_add_u32 s82, s81, 0
    s_and_b32 s82, s82, 0x7ffff
    buffer_load_dwordx4 v60, s[56:59], s82 offen lds
    buffer_load_dwordx4 v61, s[56:59], s82 offen offset:1024 lds
    buffer_load_dwordx4 v62, s[56:59], s82 offen offset:2048 lds
    buffer_load_dwordx4 v63, s[56:59], s82 offen offset:3072 lds
    s_add_u32 m0, s79, 147456
    s_add_u32 s82, s81, 8192
    s_and_b32 s82, s82, 0x7ffff
    buffer_load_dwordx4 v60, s[56:59], s82 offen lds
    buffer_load_dwordx4 v61, s[56:59], s82 offen offset:1024 lds
    buffer_load_dwordx4 v62, s[56:59], s82 offen offset:2048 lds
    buffer_load_dwordx4 v63, s[56:59], s82 offen offset:3072 lds
LA_nb0_0:
    s_cmp_lg_u32 s83, 1
    s_cbranch_scc1 LA_nb0_1
    s_barrier
    s_add_u32 m0, s79, 131072
    s_add_u32 s82, s81, 0
    s_and_b32 s82, s82, 0x7ffff
    buffer_load_dwordx4 v60, s[56:59], s82 offen lds
    buffer_load_dwordx4 v61, s[56:59], s82 offen offset:1024 lds
    buffer_load_dwordx4 v62, s[56:59], s82 offen offset:2048 lds
    buffer_load_dwordx4 v63, s[56:59], s82 offen offset:3072 lds
    s_add_u32 m0, s79, 147456
    s_add_u32 s82, s81, 8192
    s_and_b32 s82, s82, 0x7ffff
    buffer_load_dwordx4 v60, s[56:59], s82 offen lds
    buffer_load_dwordx4 v61, s[56:59], s82 offen offset:1024 lds
    buffer_load_dwordx4 v62, s[56:59], s82 offen offset:2048 lds
    buffer_load_dwordx4 v63, s[56:59], s82 offen offset:3072 lds
LA_nb0_1:
    s_waitcnt vmcnt(16)
    v_perm_b32 v40, v196, v192, s72
    v_perm_b32 v41, v204, v200, s72
    v_perm_b32 v42, v212, v208, s72
    v_perm_b32 v43, v220, v216, s72
    v_perm_b32 v32, v196, v192, s73
    v_perm_b32 v33, v204, v200, s73
    v_perm_b32 v34, v212, v208, s73
    v_perm_b32 v35, v220, v216, s73
    v_mfma_f32_16x16x32_bf16 v[96:99], v[40:43], a[8:11], v[96:99]
    v_mfma_f32_16x16x32_bf16 v[100:103], v[40:43], a[12:15], v[100:103]
    s_add_u32 s80, s5, 4
    s_and_b32 s80, s80, 15
    s_lshl_b32 s80, s80, 18
    buffer_load_dwordx4 v[160:163], v11, s[52:55], s80 offen
    v_perm_b32 v36, v197, v193, s72
    v_perm_b32 v37, v205, v201, s72
    v_perm_b32 v38, v213, v209, s72
    v_perm_b32 v39, v221, v217, s72
    v_mfma_f32_16x16x32_bf16 v[104:107], v[32:35], a[8:11], v[104:107]
    v_mfma_f32_16x16x32_bf16 v[108:111], v[32:35], a[12:15], v[108:111]
    s_add_u32 s80, s80, 8192
    buffer_load_dwordx4 v[164:167], v11, s[52:55], s80 offen
    v_perm_b32 v40, v197, v193, s73
    v_perm_b32 v41, v205, v201, s73
    v_perm_b32 v42, v213, v209, s73
    v_perm_b32 v43, v221, v217, s73
    v_mfma_f32_16x16x32_bf16 v[112:115], v[36:39], a[8:11], v[112:115]
    v_mfma_f32_16x16x32_bf16 v[116:119], v[36:39], a[12:15], v[116:119]
    s_add_u32 s80, s80, 8192
    buffer_load_dwordx4 v[168:171], v11, s[52:55], s80 offen
    v_perm_b32 v32, v198, v194, s72
    v_perm_b32 v33, v206, v202, s72
    v_perm_b32 v34, v214, v210, s72
    v_perm_b32 v35, v222, v218, s72
    v_mfma_f32_16x16x32_bf16 v[120:123], v[40:43], a[8:11], v[120:123]
    v_mfma_f32_16x16x32_bf16 v[124:127], v[40:43], a[12:15], v[124:127]
    s_add_u32 s80, s80, 8192
    buffer_load_dwordx4 v[172:175], v11, s[52:55], s80 offen
    v_perm_b32 v36, v198, v194, s73
    v_perm_b32 v37, v206, v202, s73
    v_perm_b32 v38, v214, v210, s73
    v_perm_b32 v39, v222, v218, s73
    v_mfma_f32_16x16x32_bf16 v[128:131], v[32:35], a[8:11], v[128:131]
    v_mfma_f32_16x16x32_bf16 v[132:135], v[32:35], a[12:15], v[132:135]
    s_add_u32 s80, s80, 8192
    buffer_load_dwordx4 v[176:179], v11, s[52:55], s80 offen
    v_perm_b32 v40, v199, v195, s72
    v_perm_b32 v41, v207, v203, s72
    v_perm_b32 v42, v215, v211, s72
    v_perm_b32 v43, v223, v219, s72
    v_mfma_f32_16x16x32_bf16 v[136:139], v[36:39], a[8:11], v[136:139]
    v_mfma_f32_16x16x32_bf16 v[140:143], v[36:39], a[12:15], v[140:143]
    s_add_u32 s80, s80, 8192
    buffer_load_dwordx4 v[180:183], v11, s[52:55], s80 offen
    v_perm_b32 v32, v199, v195, s73
    v_perm_b32 v33, v207, v203, s73
    v_perm_b32 v34, v215, v211, s73
    v_perm_b32 v35, v223, v219, s73
    v_mfma_f32_16x16x32_bf16 v[144:147], v[40:43], a[8:11], v[144:147]
    v_mfma_f32_16x16x32_bf16 v[148:151], v[40:43], a[12:15], v[148:151]
    s_add_u32 s80, s80, 8192
    buffer_load_dwordx4 v[184:187], v11, s[52:55], s80 offen
    v_mfma_f32_16x16x32_bf16 v[152:155], v[32:35], a[8:11], v[152:155]
    v_mfma_f32_16x16x32_bf16 v[156:159], v[32:35], a[12:15], v[156:159]
    s_add_u32 s80, s80, 8192
    buffer_load_dwordx4 v[188:191], v11, s[52:55], s80 offen
    s_waitcnt vmcnt(16)
    v_perm_b32 v36, v228, v224, s72
    v_perm_b32 v37, v236, v232, s72
    v_perm_b32 v38, v244, v240, s72
    v_perm_b32 v39, v252, v248, s72
    v_perm_b32 v40, v228, v224, s73
    v_perm_b32 v41, v236, v232, s73
    v_perm_b32 v42, v244, v240, s73
    v_perm_b32 v43, v252, v248, s73
    v_mfma_f32_16x16x32_bf16 v[96:99], v[36:39], a[16:19], v[96:99]
    v_mfma_f32_16x16x32_bf16 v[100:103], v[36:39], a[20:23], v[100:103]
    s_add_u32 s80, s5, 5
    s_and_b32 s80, s80, 15
    s_lshl_b32 s80, s80, 18
    buffer_load_dwordx4 v[192:195], v11, s[52:55], s80 offen
    v_perm_b32 v32, v229, v225, s72
    v_perm_b32 v33, v237, v233, s72
    v_perm_b32 v34, v245, v241, s72
    v_perm_b32 v35, v253, v249, s72
    v_mfma_f32_16x16x32_bf16 v[104:107], v[40:43], a[16:19], v[104:107]
    v_mfma_f32_16x16x32_bf16 v[108:111], v[40:43], a[20:23], v[108:111]
    s_add_u32 s80, s80, 8192
    buffer_load_dwordx4 v[196:199], v11, s[52:55], s80 offen
    v_perm_b32 v36, v229, v225, s73
    v_perm_b32 v37, v237, v233, s73
    v_perm_b32 v38, v245, v241, s73
    v_perm_b32 v39, v253, v249, s73
    v_mfma_f32_16x16x32_bf16 v[112:115], v[32:35], a[16:19], v[112:115]
    v_mfma_f32_16x16x32_bf16 v[116:119], v[32:35], a[20:23], v[116:119]
    s_add_u32 s80, s80, 8192
    buffer_load_dwordx4 v[200:203], v11, s[52:55], s80 offen
    v_perm_b32 v40, v230, v226, s72
    v_perm_b32 v41, v238, v234, s72
    v_perm_b32 v42, v246, v242, s72
    v_perm_b32 v43, v254, v250, s72
    v_mfma_f32_16x16x32_bf16 v[120:123], v[36:39], a[16:19], v[120:123]
    v_mfma_f32_16x16x32_bf16 v[124:127], v[36:39], a[20:23], v[124:127]
    s_add_u32 s80, s80, 8192
    buffer_load_dwordx4 v[204:207], v11, s[52:55], s80 offen
    v_perm_b32 v32, v230, v226, s73
    v_perm_b32 v33, v238, v234, s73
    v_perm_b32 v34, v246, v242, s73
    v_perm_b32 v35, v254, v250, s73
    v_mfma_f32_16x16x32_bf16 v[128:131], v[40:43], a[16:19], v[128:131]
    v_mfma_f32_16x16x32_bf16 v[132:135], v[40:43], a[20:23], v[132:135]
    s_add_u32 s80, s80, 8192
    buffer_load_dwordx4 v[208:211], v11, s[52:55], s80 offen
    v_perm_b32 v36, v231, v227, s72
    v_perm_b32 v37, v239, v235, s72
    v_perm_b32 v38, v247, v243, s72
    v_perm_b32 v39, v255, v251, s72
    v_mfma_f32_16x16x32_bf16 v[136:139], v[32:35], a[16:19], v[136:139]
    v_mfma_f32_16x16x32_bf16 v[140:143], v[32:35], a[20:23], v[140:143]
    s_add_u32 s80, s80, 8192
    buffer_load_dwordx4 v[212:215], v11, s[52:55], s80 offen
    v_perm_b32 v40, v231, v227, s73
    v_perm_b32 v41, v239, v235, s73
    v_perm_b32 v42, v247, v243, s73
    v_perm_b32 v43, v255, v251, s73
    v_mfma_f32_16x16x32_bf16 v[144:147], v[36:39], a[16:19], v[144:147]
    v_mfma_f32_16x16x32_bf16 v[148:151], v[36:39], a[20:23], v[148:151]
    s_add_u32 s80, s80, 8192
    buffer_load_dwordx4 v[216:219], v11, s[52:55], s80 offen
    v_mfma_f32_16x16x32_bf16 v[152:155], v[40:43], a[16:19], v[152:155]
    v_mfma_f32_16x16x32_bf16 v[156:159], v[40:43], a[20:23], v[156:159]
    s_add_u32 s80, s80, 8192
    buffer_load_dwordx4 v[220:223], v11, s[52:55], s80 offen
    s_xor_b32 s10, s2, 128
    s_or_b32 s10, s10, s3
    s_cbranch_scc1 LA_ne1
    v_add_u32 v57, 1, v57
    v_mov_b32 v2, 0
    v_max_u32 v57, 1, v57
    s_mov_b64 exec, 1
    buffer_store_dword v57, v56, s[64:67], 0 offen sc1
    buffer_store_dword v57, v2, s[92:95], 0 offen sc1
    s_mov_b64 exec, -1
LA_ne1:
    s_waitcnt vmcnt(16)
    v_perm_b32 v32, v68, v64, s72
    v_perm_b32 v33, v76, v72, s72
    v_perm_b32 v34, v84, v80, s72
    v_perm_b32 v35, v92, v88, s72
    v_perm_b32 v36, v68, v64, s73
    v_perm_b32 v37, v76, v72, s73
    v_perm_b32 v38, v84, v80, s73
    v_perm_b32 v39, v92, v88, s73
    v_mfma_f32_16x16x32_bf16 v[96:99], v[32:35], a[24:27], v[96:99]
    v_mfma_f32_16x16x32_bf16 v[100:103], v[32:35], a[28:31], v[100:103]
    s_add_u32 s80, s5, 6
    s_and_b32 s80, s80, 15
    s_lshl_b32 s80, s80, 18
    buffer_load_dwordx4 v[224:227], v11, s[52:55], s80 offen
    v_perm_b32 v40, v69, v65, s72
    v_perm_b32 v41, v77, v73, s72
    v_perm_b32 v42, v85, v81, s72
    v_perm_b32 v43, v93, v89, s72
    v_mfma_f32_16x16x32_bf16 v[104:107], v[36:39], a[24:27], v[104:107]
    v_mfma_f32_16x16x32_bf16 v[108:111], v[36:39], a[28:31], v[108:111]
    s_add_u32 s80, s80, 8192
    buffer_load_dwordx4 v[228:231], v11, s[52:55], s80 offen
    v_perm_b32 v32, v69, v65, s73
    v_perm_b32 v33, v77, v73, s73
    v_perm_b32 v34, v85, v81, s73
    v_perm_b32 v35, v93, v89, s73
    v_mfma_f32_16x16x32_bf16 v[112:115], v[40:43], a[24:27], v[112:115]
    v_mfma_f32_16x16x32_bf16 v[116:119], v[40:43], a[28:31], v[116:119]
    s_add_u32 s80, s80, 8192
    buffer_load_dwordx4 v[232:235], v11, s[52:55], s80 offen
    v_perm_b32 v36, v70, v66, s72
    v_perm_b32 v37, v78, v74, s72
    v_perm_b32 v38, v86, v82, s72
    v_perm_b32 v39, v94, v90, s72
    v_mfma_f32_16x16x32_bf16 v[120:123], v[32:35], a[24:27], v[120:123]
    v_mfma_f32_16x16x32_bf16 v[124:127], v[32:35], a[28:31], v[124:127]
    s_add_u32 s80, s80, 8192
    buffer_load_dwordx4 v[236:239], v11, s[52:55], s80 offen
    v_perm_b32 v40, v70, v66, s73
    v_perm_b32 v41, v78, v74, s73
    v_perm_b32 v42, v86, v82, s73
    v_perm_b32 v43, v94, v90, s73
    v_mfma_f32_16x16x32_bf16 v[128:131], v[36:39], a[24:27], v[128:131]
    v_mfma_f32_16x16x32_bf16 v[132:135], v[36:39], a[28:31], v[132:135]
    s_add_u32 s80, s80, 8192
    buffer_load_dwordx4 v[240:243], v11, s[52:55], s80 offen
    v_perm_b32 v32, v71, v67, s72
    v_perm_b32 v33, v79, v75, s72
    v_perm_b32 v34, v87, v83, s72
    v_perm_b32 v35, v95, v91, s72
    v_mfma_f32_16x16x32_bf16 v[136:139], v[40:43], a[24:27], v[136:139]
    v_mfma_f32_16x16x32_bf16 v[140:143], v[40:43], a[28:31], v[140:143]
    s_add_u32 s80, s80, 8192
    buffer_load_dwordx4 v[244:247], v11, s[52:55], s80 offen
    v_perm_b32 v36, v71, v67, s73
    v_perm_b32 v37, v79, v75, s73
    v_perm_b32 v38, v87, v83, s73
    v_perm_b32 v39, v95, v91, s73
    v_mfma_f32_16x16x32_bf16 v[144:147], v[32:35], a[24:27], v[144:147]
    v_mfma_f32_16x16x32_bf16 v[148:151], v[32:35], a[28:31], v[148:151]
    s_add_u32 s80, s80, 8192
    buffer_load_dwordx4 v[248:251], v11, s[52:55], s80 offen
    v_mfma_f32_16x16x32_bf16 v[152:155], v[36:39], a[24:27], v[152:155]
    v_mfma_f32_16x16x32_bf16 v[156:159], v[36:39], a[28:31], v[156:159]
    s_add_u32 s80, s80, 8192
    buffer_load_dwordx4 v[252:255], v11, s[52:55], s80 offen
    s_waitcnt vmcnt(16)
    v_perm_b32 v40, v164, v160, s72
    v_perm_b32 v41, v172, v168, s72
    v_perm_b32 v42, v180, v176, s72
    v_perm_b32 v43, v188, v184, s72
    v_perm_b32 v32, v164, v160, s73
    v_perm_b32 v33, v172, v168, s73
    v_perm_b32 v34, v180, v176, s73
    v_perm_b32 v35, v188, v184, s73
    v_mfma_f32_16x16x32_bf16 v[96:99], v[40:43], a[32:35], v[96:99]
    v_mfma_f32_16x16x32_bf16 v[100:103], v[40:43], a[36:39], v[100:103]
    s_add_u32 s80, s5, 7
    s_and_b32 s80, s80, 15
    s_lshl_b32 s80, s80, 18
    buffer_load_dwordx4 v[64:67], v11, s[52:55], s80 offen
    v_perm_b32 v36, v165, v161, s72
    v_perm_b32 v37, v173, v169, s72
    v_perm_b32 v38, v181, v177, s72
    v_perm_b32 v39, v189, v185, s72
    v_mfma_f32_16x16x32_bf16 v[104:107], v[32:35], a[32:35], v[104:107]
    v_mfma_f32_16x16x32_bf16 v[108:111], v[32:35], a[36:39], v[108:111]
    s_add_u32 s80, s80, 8192
    buffer_load_dwordx4 v[68:71], v11, s[52:55], s80 offen
    v_perm_b32 v40, v165, v161, s73
    v_perm_b32 v41, v173, v169, s73
    v_perm_b32 v42, v181, v177, s73
    v_perm_b32 v43, v189, v185, s73
    v_mfma_f32_16x16x32_bf16 v[112:115], v[36:39], a[32:35], v[112:115]
    v_mfma_f32_16x16x32_bf16 v[116:119], v[36:39], a[36:39], v[116:119]
    s_add_u32 s80, s80, 8192
    buffer_load_dwordx4 v[72:75], v11, s[52:55], s80 offen
    v_perm_b32 v32, v166, v162, s72
    v_perm_b32 v33, v174, v170, s72
    v_perm_b32 v34, v182, v178, s72
    v_perm_b32 v35, v190, v186, s72
    v_mfma_f32_16x16x32_bf16 v[120:123], v[40:43], a[32:35], v[120:123]
    v_mfma_f32_16x16x32_bf16 v[124:127], v[40:43], a[36:39], v[124:127]
    s_add_u32 s80, s80, 8192
    buffer_load_dwordx4 v[76:79], v11, s[52:55], s80 offen
    v_perm_b32 v36, v166, v162, s73
    v_perm_b32 v37, v174, v170, s73
    v_perm_b32 v38, v182, v178, s73
    v_perm_b32 v39, v190, v186, s73
    v_mfma_f32_16x16x32_bf16 v[128:131], v[32:35], a[32:35], v[128:131]
    v_mfma_f32_16x16x32_bf16 v[132:135], v[32:35], a[36:39], v[132:135]
    s_add_u32 s80, s80, 8192
    buffer_load_dwordx4 v[80:83], v11, s[52:55], s80 offen
    v_perm_b32 v40, v167, v163, s72
    v_perm_b32 v41, v175, v171, s72
    v_perm_b32 v42, v183, v179, s72
    v_perm_b32 v43, v191, v187, s72
    v_mfma_f32_16x16x32_bf16 v[136:139], v[36:39], a[32:35], v[136:139]
    v_mfma_f32_16x16x32_bf16 v[140:143], v[36:39], a[36:39], v[140:143]
    s_add_u32 s80, s80, 8192
    buffer_load_dwordx4 v[84:87], v11, s[52:55], s80 offen
    v_perm_b32 v32, v167, v163, s73
    v_perm_b32 v33, v175, v171, s73
    v_perm_b32 v34, v183, v179, s73
    v_perm_b32 v35, v191, v187, s73
    v_mfma_f32_16x16x32_bf16 v[144:147], v[40:43], a[32:35], v[144:147]
    v_mfma_f32_16x16x32_bf16 v[148:151], v[40:43], a[36:39], v[148:151]
    s_add_u32 s80, s80, 8192
    buffer_load_dwordx4 v[88:91], v11, s[52:55], s80 offen
    v_mfma_f32_16x16x32_bf16 v[152:155], v[32:35], a[32:35], v[152:155]
    v_mfma_f32_16x16x32_bf16 v[156:159], v[32:35], a[36:39], v[156:159]
    s_add_u32 s80, s80, 8192
    buffer_load_dwordx4 v[92:95], v11, s[52:55], s80 offen
    s_waitcnt vmcnt(16)
    v_perm_b32 v36, v196, v192, s72
    v_perm_b32 v37, v204, v200, s72
    v_perm_b32 v38, v212, v208, s72
    v_perm_b32 v39, v220, v216, s72
    v_perm_b32 v40, v196, v192, s73
    v_perm_b32 v41, v204, v200, s73
    v_perm_b32 v42, v212, v208, s73
    v_perm_b32 v43, v220, v216, s73
    v_mfma_f32_16x16x32_bf16 v[96:99], v[36:39], a[40:43], v[96:99]
    v_mfma_f32_16x16x32_bf16 v[100:103], v[36:39], a[44:47], v[100:103]
    s_add_u32 s80, s5, 8
    s_and_b32 s80, s80, 15
    s_lshl_b32 s80, s80, 18
    buffer_load_dwordx4 v[160:163], v11, s[52:55], s80 offen
    v_perm_b32 v32, v197, v193, s72
    v_perm_b32 v33, v205, v201, s72
    v_perm_b32 v34, v213, v209, s72
    v_perm_b32 v35, v221, v217, s72
    v_mfma_f32_16x16x32_bf16 v[104:107], v[40:43], a[40:43], v[104:107]
    v_mfma_f32_16x16x32_bf16 v[108:111], v[40:43], a[44:47], v[108:111]
    s_add_u32 s80, s80, 8192
    buffer_load_dwordx4 v[164:167], v11, s[52:55], s80 offen
    v_perm_b32 v36, v197, v193, s73
    v_perm_b32 v37, v205, v201, s73
    v_perm_b32 v38, v213, v209, s73
    v_perm_b32 v39, v221, v217, s73
    v_mfma_f32_16x16x32_bf16 v[112:115], v[32:35], a[40:43], v[112:115]
    v_mfma_f32_16x16x32_bf16 v[116:119], v[32:35], a[44:47], v[116:119]
    s_add_u32 s80, s80, 8192
    buffer_load_dwordx4 v[168:171], v11, s[52:55], s80 offen
    v_perm_b32 v40, v198, v194, s72
    v_perm_b32 v41, v206, v202, s72
    v_perm_b32 v42, v214, v210, s72
    v_perm_b32 v43, v222, v218, s72
    v_mfma_f32_16x16x32_bf16 v[120:123], v[36:39], a[40:43], v[120:123]
    v_mfma_f32_16x16x32_bf16 v[124:127], v[36:39], a[44:47], v[124:127]
    s_add_u32 s80, s80, 8192
    buffer_load_dwordx4 v[172:175], v11, s[52:55], s80 offen
    v_perm_b32 v32, v198, v194, s73
    v_perm_b32 v33, v206, v202, s73
    v_perm_b32 v34, v214, v210, s73
    v_perm_b32 v35, v222, v218, s73
    v_mfma_f32_16x16x32_bf16 v[128:131], v[40:43], a[40:43], v[128:131]
    v_mfma_f32_16x16x32_bf16 v[132:135], v[40:43], a[44:47], v[132:135]
    s_add_u32 s80, s80, 8192
    buffer_load_dwordx4 v[176:179], v11, s[52:55], s80 offen
    v_perm_b32 v36, v199, v195, s72
    v_perm_b32 v37, v207, v203, s72
    v_perm_b32 v38, v215, v211, s72
    v_perm_b32 v39, v223, v219, s72
    v_mfma_f32_16x16x32_bf16 v[136:139], v[32:35], a[40:43], v[136:139]
    v_mfma_f32_16x16x32_bf16 v[140:143], v[32:35], a[44:47], v[140:143]
    s_add_u32 s80, s80, 8192
    buffer_load_dwordx4 v[180:183], v11, s[52:55], s80 offen
    v_perm_b32 v40, v199, v195, s73
    v_perm_b32 v41, v207, v203, s73
    v_perm_b32 v42, v215, v211, s73
    v_perm_b32 v43, v223, v219, s73
    v_mfma_f32_16x16x32_bf16 v[144:147], v[36:39], a[40:43], v[144:147]
    v_mfma_f32_16x16x32_bf16 v[148:151], v[36:39], a[44:47], v[148:151]
    s_add_u32 s80, s80, 8192
    buffer_load_dwordx4 v[184:187], v11, s[52:55], s80 offen
    v_mfma_f32_16x16x32_bf16 v[152:155], v[40:43], a[40:43], v[152:155]
    v_mfma_f32_16x16x32_bf16 v[156:159], v[40:43], a[44:47], v[156:159]
    s_add_u32 s80, s80, 8192
    buffer_load_dwordx4 v[188:191], v11, s[52:55], s80 offen
    s_waitcnt vmcnt(16)
    v_perm_b32 v32, v228, v224, s72
    v_perm_b32 v33, v236, v232, s72
    v_perm_b32 v34, v244, v240, s72
    v_perm_b32 v35, v252, v248, s72
    v_perm_b32 v36, v228, v224, s73
    v_perm_b32 v37, v236, v232, s73
    v_perm_b32 v38, v244, v240, s73
    v_perm_b32 v39, v252, v248, s73
    v_mfma_f32_16x16x32_bf16 v[96:99], v[32:35], a[48:51], v[96:99]
    v_mfma_f32_16x16x32_bf16 v[100:103], v[32:35], a[52:55], v[100:103]
    s_add_u32 s80, s5, 9
    s_and_b32 s80, s80, 15
    s_lshl_b32 s80, s80, 18
    buffer_load_dwordx4 v[192:195], v11, s[52:55], s80 offen
    v_perm_b32 v40, v229, v225, s72
    v_perm_b32 v41, v237, v233, s72
    v_perm_b32 v42, v245, v241, s72
    v_perm_b32 v43, v253, v249, s72
    v_mfma_f32_16x16x32_bf16 v[104:107], v[36:39], a[48:51], v[104:107]
    v_mfma_f32_16x16x32_bf16 v[108:111], v[36:39], a[52:55], v[108:111]
    s_add_u32 s80, s80, 8192
    buffer_load_dwordx4 v[196:199], v11, s[52:55], s80 offen
    v_perm_b32 v32, v229, v225, s73
    v_perm_b32 v33, v237, v233, s73
    v_perm_b32 v34, v245, v241, s73
    v_perm_b32 v35, v253, v249, s73
    v_mfma_f32_16x16x32_bf16 v[112:115], v[40:43], a[48:51], v[112:115]
    v_mfma_f32_16x16x32_bf16 v[116:119], v[40:43], a[52:55], v[116:119]
    s_add_u32 s80, s80, 8192
    buffer_load_dwordx4 v[200:203], v11, s[52:55], s80 offen
    v_perm_b32 v36, v230, v226, s72
    v_perm_b32 v37, v238, v234, s72
    v_perm_b32 v38, v246, v242, s72
    v_perm_b32 v39, v254, v250, s72
    v_mfma_f32_16x16x32_bf16 v[120:123], v[32:35], a[48:51], v[120:123]
    v_mfma_f32_16x16x32_bf16 v[124:127], v[32:35], a[52:55], v[124:127]
    s_add_u32 s80, s80, 8192
    buffer_load_dwordx4 v[204:207], v11, s[52:55], s80 offen
    v_perm_b32 v40, v230, v226, s73
    v_perm_b32 v41, v238, v234, s73
    v_perm_b32 v42, v246, v242, s73
    v_perm_b32 v43, v254, v250, s73
    v_mfma_f32_16x16x32_bf16 v[128:131], v[36:39], a[48:51], v[128:131]
    v_mfma_f32_16x16x32_bf16 v[132:135], v[36:39], a[52:55], v[132:135]
    s_add_u32 s80, s80, 8192
    buffer_load_dwordx4 v[208:211], v11, s[52:55], s80 offen
    v_perm_b32 v32, v231, v227, s72
    v_perm_b32 v33, v239, v235, s72
    v_perm_b32 v34, v247, v243, s72
    v_perm_b32 v35, v255, v251, s72
    v_mfma_f32_16x16x32_bf16 v[136:139], v[40:43], a[48:51], v[136:139]
    v_mfma_f32_16x16x32_bf16 v[140:143], v[40:43], a[52:55], v[140:143]
    s_add_u32 s80, s80, 8192
    buffer_load_dwordx4 v[212:215], v11, s[52:55], s80 offen
    v_perm_b32 v36, v231, v227, s73
    v_perm_b32 v37, v239, v235, s73
    v_perm_b32 v38, v247, v243, s73
    v_perm_b32 v39, v255, v251, s73
    v_mfma_f32_16x16x32_bf16 v[144:147], v[32:35], a[48:51], v[144:147]
    v_mfma_f32_16x16x32_bf16 v[148:151], v[32:35], a[52:55], v[148:151]
    s_add_u32 s80, s80, 8192
    buffer_load_dwordx4 v[216:219], v11, s[52:55], s80 offen
    v_mfma_f32_16x16x32_bf16 v[152:155], v[36:39], a[48:51], v[152:155]
    v_mfma_f32_16x16x32_bf16 v[156:159], v[36:39], a[52:55], v[156:159]
    s_add_u32 s80, s80, 8192
    buffer_load_dwordx4 v[220:223], v11, s[52:55], s80 offen
    s_waitcnt vmcnt(16)
    v_perm_b32 v40, v68, v64, s72
    v_perm_b32 v41, v76, v72, s72
    v_perm_b32 v42, v84, v80, s72
    v_perm_b32 v43, v92, v88, s72
    v_perm_b32 v32, v68, v64, s73
    v_perm_b32 v33, v76, v72, s73
    v_perm_b32 v34, v84, v80, s73
    v_perm_b32 v35, v92, v88, s73
    v_mfma_f32_16x16x32_bf16 v[96:99], v[40:43], a[56:59], v[96:99]
    v_mfma_f32_16x16x32_bf16 v[100:103], v[40:43], a[60:63], v[100:103]
    s_add_u32 s80, s5, 10
    s_and_b32 s80, s80, 15
    s_lshl_b32 s80, s80, 18
    buffer_load_dwordx4 v[224:227], v11, s[52:55], s80 offen
    v_perm_b32 v36, v69, v65, s72
    v_perm_b32 v37, v77, v73, s72
    v_perm_b32 v38, v85, v81, s72
    v_perm_b32 v39, v93, v89, s72
    v_mfma_f32_16x16x32_bf16 v[104:107], v[32:35], a[56:59], v[104:107]
    v_mfma_f32_16x16x32_bf16 v[108:111], v[32:35], a[60:63], v[108:111]
    s_add_u32 s80, s80, 8192
    buffer_load_dwordx4 v[228:231], v11, s[52:55], s80 offen
    v_perm_b32 v40, v69, v65, s73
    v_perm_b32 v41, v77, v73, s73
    v_perm_b32 v42, v85, v81, s73
    v_perm_b32 v43, v93, v89, s73
    v_mfma_f32_16x16x32_bf16 v[112:115], v[36:39], a[56:59], v[112:115]
    v_mfma_f32_16x16x32_bf16 v[116:119], v[36:39], a[60:63], v[116:119]
    s_add_u32 s80, s80, 8192
    buffer_load_dwordx4 v[232:235], v11, s[52:55], s80 offen
    v_perm_b32 v32, v70, v66, s72
    v_perm_b32 v33, v78, v74, s72
    v_perm_b32 v34, v86, v82, s72
    v_perm_b32 v35, v94, v90, s72
    v_mfma_f32_16x16x32_bf16 v[120:123], v[40:43], a[56:59], v[120:123]
    v_mfma_f32_16x16x32_bf16 v[124:127], v[40:43], a[60:63], v[124:127]
    s_add_u32 s80, s80, 8192
    buffer_load_dwordx4 v[236:239], v11, s[52:55], s80 offen
    v_perm_b32 v36, v70, v66, s73
    v_perm_b32 v37, v78, v74, s73
    v_perm_b32 v38, v86, v82, s73
    v_perm_b32 v39, v94, v90, s73
    v_mfma_f32_16x16x32_bf16 v[128:131], v[32:35], a[56:59], v[128:131]
    v_mfma_f32_16x16x32_bf16 v[132:135], v[32:35], a[60:63], v[132:135]
    s_add_u32 s80, s80, 8192
    buffer_load_dwordx4 v[240:243], v11, s[52:55], s80 offen
    v_perm_b32 v40, v71, v67, s72
    v_perm_b32 v41, v79, v75, s72
    v_perm_b32 v42, v87, v83, s72
    v_perm_b32 v43, v95, v91, s72
    v_mfma_f32_16x16x32_bf16 v[136:139], v[36:39], a[56:59], v[136:139]
    v_mfma_f32_16x16x32_bf16 v[140:143], v[36:39], a[60:63], v[140:143]
    s_add_u32 s80, s80, 8192
    buffer_load_dwordx4 v[244:247], v11, s[52:55], s80 offen
    v_perm_b32 v32, v71, v67, s73
    v_perm_b32 v33, v79, v75, s73
    v_perm_b32 v34, v87, v83, s73
    v_perm_b32 v35, v95, v91, s73
    v_mfma_f32_16x16x32_bf16 v[144:147], v[40:43], a[56:59], v[144:147]
    v_mfma_f32_16x16x32_bf16 v[148:151], v[40:43], a[60:63], v[148:151]
    s_add_u32 s80, s80, 8192
    buffer_load_dwordx4 v[248:251], v11, s[52:55], s80 offen
    v_mfma_f32_16x16x32_bf16 v[152:155], v[32:35], a[56:59], v[152:155]
    v_mfma_f32_16x16x32_bf16 v[156:159], v[32:35], a[60:63], v[156:159]
    s_add_u32 s80, s80, 8192
    buffer_load_dwordx4 v[252:255], v11, s[52:55], s80 offen
    s_waitcnt vmcnt(16)
    v_perm_b32 v36, v164, v160, s72
    v_perm_b32 v37, v172, v168, s72
    v_perm_b32 v38, v180, v176, s72
    v_perm_b32 v39, v188, v184, s72
    v_perm_b32 v40, v164, v160, s73
    v_perm_b32 v41, v172, v168, s73
    v_perm_b32 v42, v180, v176, s73
    v_perm_b32 v43, v188, v184, s73
    v_mfma_f32_16x16x32_bf16 v[96:99], v[36:39], a[64:67], v[96:99]
    v_mfma_f32_16x16x32_bf16 v[100:103], v[36:39], a[68:71], v[100:103]
    s_add_u32 s80, s5, 11
    s_and_b32 s80, s80, 15
    s_lshl_b32 s80, s80, 18
    buffer_load_dwordx4 v[64:67], v11, s[52:55], s80 offen
    v_perm_b32 v32, v165, v161, s72
    v_perm_b32 v33, v173, v169, s72
    v_perm_b32 v34, v181, v177, s72
    v_perm_b32 v35, v189, v185, s72
    v_mfma_f32_16x16x32_bf16 v[104:107], v[40:43], a[64:67], v[104:107]
    v_mfma_f32_16x16x32_bf16 v[108:111], v[40:43], a[68:71], v[108:111]
    s_add_u32 s80, s80, 8192
    buffer_load_dwordx4 v[68:71], v11, s[52:55], s80 offen
    v_perm_b32 v36, v165, v161, s73
    v_perm_b32 v37, v173, v169, s73
    v_perm_b32 v38, v181, v177, s73
    v_perm_b32 v39, v189, v185, s73
    v_mfma_f32_16x16x32_bf16 v[112:115], v[32:35], a[64:67], v[112:115]
    v_mfma_f32_16x16x32_bf16 v[116:119], v[32:35], a[68:71], v[116:119]
    s_add_u32 s80, s80, 8192
    buffer_load_dwordx4 v[72:75], v11, s[52:55], s80 offen
    v_perm_b32 v40, v166, v162, s72
    v_perm_b32 v41, v174, v170, s72
    v_perm_b32 v42, v182, v178, s72
    v_perm_b32 v43, v190, v186, s72
    v_mfma_f32_16x16x32_bf16 v[120:123], v[36:39], a[64:67], v[120:123]
    v_mfma_f32_16x16x32_bf16 v[124:127], v[36:39], a[68:71], v[124:127]
    s_add_u32 s80, s80, 8192
    buffer_load_dwordx4 v[76:79], v11, s[52:55], s80 offen
    v_perm_b32 v32, v166, v162, s73
    v_perm_b32 v33, v174, v170, s73
    v_perm_b32 v34, v182, v178, s73
    v_perm_b32 v35, v190, v186, s73
    v_mfma_f32_16x16x32_bf16 v[128:131], v[40:43], a[64:67], v[128:131]
    v_mfma_f32_16x16x32_bf16 v[132:135], v[40:43], a[68:71], v[132:135]
    s_add_u32 s80, s80, 8192
    buffer_load_dwordx4 v[80:83], v11, s[52:55], s80 offen
    v_perm_b32 v36, v167, v163, s72
    v_perm_b32 v37, v175, v171, s72
    v_perm_b32 v38, v183, v179, s72
    v_perm_b32 v39, v191, v187, s72
    v_mfma_f32_16x16x32_bf16 v[136:139], v[32:35], a[64:67], v[136:139]
    v_mfma_f32_16x16x32_bf16 v[140:143], v[32:35], a[68:71], v[140:143]
    s_add_u32 s80, s80, 8192
    buffer_load_dwordx4 v[84:87], v11, s[52:55], s80 offen
    v_perm_b32 v40, v167, v163, s73
    v_perm_b32 v41, v175, v171, s73
    v_perm_b32 v42, v183, v179, s73
    v_perm_b32 v43, v191, v187, s73
    v_mfma_f32_16x16x32_bf16 v[144:147], v[36:39], a[64:67], v[144:147]
    v_mfma_f32_16x16x32_bf16 v[148:151], v[36:39], a[68:71], v[148:151]
    s_add_u32 s80, s80, 8192
    buffer_load_dwordx4 v[88:91], v11, s[52:55], s80 offen
    v_mfma_f32_16x16x32_bf16 v[152:155], v[40:43], a[64:67], v[152:155]
    v_mfma_f32_16x16x32_bf16 v[156:159], v[40:43], a[68:71], v[156:159]
    s_add_u32 s80, s80, 8192
    buffer_load_dwordx4 v[92:95], v11, s[52:55], s80 offen
    s_waitcnt vmcnt(16)
    v_perm_b32 v32, v196, v192, s72
    v_perm_b32 v33, v204, v200, s72
    v_perm_b32 v34, v212, v208, s72
    v_perm_b32 v35, v220, v216, s72
    v_perm_b32 v36, v196, v192, s73
    v_perm_b32 v37, v204, v200, s73
    v_perm_b32 v38, v212, v208, s73
    v_perm_b32 v39, v220, v216, s73
    v_mfma_f32_16x16x32_bf16 v[96:99], v[32:35], a[72:75], v[96:99]
    v_mfma_f32_16x16x32_bf16 v[100:103], v[32:35], a[76:79], v[100:103]
    s_add_u32 s80, s5, 12
    s_and_b32 s80, s80, 15
    s_lshl_b32 s80, s80, 18
    buffer_load_dwordx4 v[160:163], v11, s[52:55], s80 offen
    v_perm_b32 v40, v197, v193, s72
    v_perm_b32 v41, v205, v201, s72
    v_perm_b32 v42, v213, v209, s72
    v_perm_b32 v43, v221, v217, s72
    v_mfma_f32_16x16x32_bf16 v[104:107], v[36:39], a[72:75], v[104:107]
    v_mfma_f32_16x16x32_bf16 v[108:111], v[36:39], a[76:79], v[108:111]
    s_add_u32 s80, s80, 8192
    buffer_load_dwordx4 v[164:167], v11, s[52:55], s80 offen
    v_perm_b32 v32, v197, v193, s73
    v_perm_b32 v33, v205, v201, s73
    v_perm_b32 v34, v213, v209, s73
    v_perm_b32 v35, v221, v217, s73
    v_mfma_f32_16x16x32_bf16 v[112:115], v[40:43], a[72:75], v[112:115]
    v_mfma_f32_16x16x32_bf16 v[116:119], v[40:43], a[76:79], v[116:119]
    s_add_u32 s80, s80, 8192
    buffer_load_dwordx4 v[168:171], v11, s[52:55], s80 offen
    v_perm_b32 v36, v198, v194, s72
    v_perm_b32 v37, v206, v202, s72
    v_perm_b32 v38, v214, v210, s72
    v_perm_b32 v39, v222, v218, s72
    v_mfma_f32_16x16x32_bf16 v[120:123], v[32:35], a[72:75], v[120:123]
    v_mfma_f32_16x16x32_bf16 v[124:127], v[32:35], a[76:79], v[124:127]
    s_add_u32 s80, s80, 8192
    buffer_load_dwordx4 v[172:175], v11, s[52:55], s80 offen
    v_perm_b32 v40, v198, v194, s73
    v_perm_b32 v41, v206, v202, s73
    v_perm_b32 v42, v214, v210, s73
    v_perm_b32 v43, v222, v218, s73
    v_mfma_f32_16x16x32_bf16 v[128:131], v[36:39], a[72:75], v[128:131]
    v_mfma_f32_16x16x32_bf16 v[132:135], v[36:39], a[76:79], v[132:135]
    s_add_u32 s80, s80, 8192
    buffer_load_dwordx4 v[176:179], v11, s[52:55], s80 offen
    v_perm_b32 v32, v199, v195, s72
    v_perm_b32 v33, v207, v203, s72
    v_perm_b32 v34, v215, v211, s72
    v_perm_b32 v35, v223, v219, s72
    v_mfma_f32_16x16x32_bf16 v[136:139], v[40:43], a[72:75], v[136:139]
    v_mfma_f32_16x16x32_bf16 v[140:143], v[40:43], a[76:79], v[140:143]
    s_add_u32 s80, s80, 8192
    buffer_load_dwordx4 v[180:183], v11, s[52:55], s80 offen
    v_perm_b32 v36, v199, v195, s73
    v_perm_b32 v37, v207, v203, s73
    v_perm_b32 v38, v215, v211, s73
    v_perm_b32 v39, v223, v219, s73
    v_mfma_f32_16x16x32_bf16 v[144:147], v[32:35], a[72:75], v[144:147]
    v_mfma_f32_16x16x32_bf16 v[148:151], v[32:35], a[76:79], v[148:151]
    s_add_u32 s80, s80, 8192
    buffer_load_dwordx4 v[184:187], v11, s[52:55], s80 offen
    v_mfma_f32_16x16x32_bf16 v[152:155], v[36:39], a[72:75], v[152:155]
    v_mfma_f32_16x16x32_bf16 v[156:159], v[36:39], a[76:79], v[156:159]
    s_add_u32 s80, s80, 8192
    buffer_load_dwordx4 v[188:191], v11, s[52:55], s80 offen
    s_waitcnt vmcnt(16)
    v_perm_b32 v40, v228, v224, s72
    v_perm_b32 v41, v236, v232, s72
    v_perm_b32 v42, v244, v240, s72
    v_perm_b32 v43, v252, v248, s72
    v_perm_b32 v32, v228, v224, s73
    v_perm_b32 v33, v236, v232, s73
    v_perm_b32 v34, v244, v240, s73
    v_perm_b32 v35, v252, v248, s73
    v_mfma_f32_16x16x32_bf16 v[96:99], v[40:43], a[80:83], v[96:99]
    v_mfma_f32_16x16x32_bf16 v[100:103], v[40:43], a[84:87], v[100:103]
    s_add_u32 s80, s5, 13
    s_and_b32 s80, s80, 15
    s_lshl_b32 s80, s80, 18
    buffer_load_dwordx4 v[192:195], v11, s[52:55], s80 offen
    v_perm_b32 v36, v229, v225, s72
    v_perm_b32 v37, v237, v233, s72
    v_perm_b32 v38, v245, v241, s72
    v_perm_b32 v39, v253, v249, s72
    v_mfma_f32_16x16x32_bf16 v[104:107], v[32:35], a[80:83], v[104:107]
    v_mfma_f32_16x16x32_bf16 v[108:111], v[32:35], a[84:87], v[108:111]
    s_add_u32 s80, s80, 8192
    buffer_load_dwordx4 v[196:199], v11, s[52:55], s80 offen
    v_perm_b32 v40, v229, v225, s73
    v_perm_b32 v41, v237, v233, s73
    v_perm_b32 v42, v245, v241, s73
    v_perm_b32 v43, v253, v249, s73
    v_mfma_f32_16x16x32_bf16 v[112:115], v[36:39], a[80:83], v[112:115]
    v_mfma_f32_16x16x32_bf16 v[116:119], v[36:39], a[84:87], v[116:119]
    s_add_u32 s80, s80, 8192
    buffer_load_dwordx4 v[200:203], v11, s[52:55], s80 offen
    v_perm_b32 v32, v230, v226, s72
    v_perm_b32 v33, v238, v234, s72
    v_perm_b32 v34, v246, v242, s72
    v_perm_b32 v35, v254, v250, s72
    v_mfma_f32_16x16x32_bf16 v[120:123], v[40:43], a[80:83], v[120:123]
    v_mfma_f32_16x16x32_bf16 v[124:127], v[40:43], a[84:87], v[124:127]
    s_add_u32 s80, s80, 8192
    buffer_load_dwordx4 v[204:207], v11, s[52:55], s80 offen
    v_perm_b32 v36, v230, v226, s73
    v_perm_b32 v37, v238, v234, s73
    v_perm_b32 v38, v246, v242, s73
    v_perm_b32 v39, v254, v250, s73
    v_mfma_f32_16x16x32_bf16 v[128:131], v[32:35], a[80:83], v[128:131]
    v_mfma_f32_16x16x32_bf16 v[132:135], v[32:35], a[84:87], v[132:135]
    s_add_u32 s80, s80, 8192
    buffer_load_dwordx4 v[208:211], v11, s[52:55], s80 offen
    v_perm_b32 v40, v231, v227, s72
    v_perm_b32 v41, v239, v235, s72
    v_perm_b32 v42, v247, v243, s72
    v_perm_b32 v43, v255, v251, s72
    v_mfma_f32_16x16x32_bf16 v[136:139], v[36:39], a[80:83], v[136:139]
    v_mfma_f32_16x16x32_bf16 v[140:143], v[36:39], a[84:87], v[140:143]
    s_add_u32 s80, s80, 8192
    buffer_load_dwordx4 v[212:215], v11, s[52:55], s80 offen
    v_perm_b32 v32, v231, v227, s73
    v_perm_b32 v33, v239, v235, s73
    v_perm_b32 v34, v247, v243, s73
    v_perm_b32 v35, v255, v251, s73
    v_mfma_f32_16x16x32_bf16 v[144:147], v[40:43], a[80:83], v[144:147]
    v_mfma_f32_16x16x32_bf16 v[148:151], v[40:43], a[84:87], v[148:151]
    s_add_u32 s80, s80, 8192
    buffer_load_dwordx4 v[216:219], v11, s[52:55], s80 offen
    v_mfma_f32_16x16x32_bf16 v[152:155], v[32:35], a[80:83], v[152:155]
    v_mfma_f32_16x16x32_bf16 v[156:159], v[32:35], a[84:87], v[156:159]
    s_add_u32 s80, s80, 8192
    buffer_load_dwordx4 v[220:223], v11, s[52:55], s80 offen
    v_mov_b32 v2, 0x3f803f80
    v_accvgpr_write_b32 a76, v2
    v_accvgpr_write_b32 a77, v2
    v_accvgpr_write_b32 a78, v2
    v_accvgpr_write_b32 a79, v2
    s_waitcnt vmcnt(16)
    v_perm_b32 v36, v68, v64, s72
    v_perm_b32 v37, v76, v72, s72
    v_perm_b32 v38, v84, v80, s72
    v_perm_b32 v39, v92, v88, s72
    v_perm_b32 v40, v68, v64, s73
    v_perm_b32 v41, v76, v72, s73
    v_perm_b32 v42, v84, v80, s73
    v_perm_b32 v43, v92, v88, s73
    v_mfma_f32_16x16x32_bf16 v[96:99], v[36:39], a[88:91], v[96:99]
    v_mfma_f32_16x16x32_bf16 v[100:103], v[36:39], a[92:95], v[100:103]
    s_add_u32 s80, s5, 14
    s_and_b32 s80, s80, 15
    s_lshl_b32 s80, s80, 18
    buffer_load_dwordx4 v[224:227], v11, s[52:55], s80 offen
    v_perm_b32 v32, v69, v65, s72
    v_perm_b32 v33, v77, v73, s72
    v_perm_b32 v34, v85, v81, s72
    v_perm_b32 v35, v93, v89, s72
    v_mfma_f32_16x16x32_bf16 v[104:107], v[40:43], a[88:91], v[104:107]
    v_mfma_f32_16x16x32_bf16 v[108:111], v[40:43], a[92:95], v[108:111]
    s_add_u32 s80, s80, 8192
    buffer_load_dwordx4 v[228:231], v11, s[52:55], s80 offen
    v_perm_b32 v36, v69, v65, s73
    v_perm_b32 v37, v77, v73, s73
    v_perm_b32 v38, v85, v81, s73
    v_perm_b32 v39, v93, v89, s73
    v_mfma_f32_16x16x32_bf16 v[112:115], v[32:35], a[88:91], v[112:115]
    v_mfma_f32_16x16x32_bf16 v[116:119], v[32:35], a[92:95], v[116:119]
    s_add_u32 s80, s80, 8192
    buffer_load_dwordx4 v[232:235], v11, s[52:55], s80 offen
    v_perm_b32 v40, v70, v66, s72
    v_perm_b32 v41, v78, v74, s72
    v_perm_b32 v42, v86, v82, s72
    v_perm_b32 v43, v94, v90, s72
    v_mfma_f32_16x16x32_bf16 v[120:123], v[36:39], a[88:91], v[120:123]
    v_mfma_f32_16x16x32_bf16 v[124:127], v[36:39], a[92:95], v[124:127]
    s_add_u32 s80, s80, 8192
    buffer_load_dwordx4 v[236:239], v11, s[52:55], s80 offen
    v_perm_b32 v32, v70, v66, s73
    v_perm_b32 v33, v78, v74, s73
    v_perm_b32 v34, v86, v82, s73
    v_perm_b32 v35, v94, v90, s73
    v_mfma_f32_16x16x32_bf16 v[128:131], v[40:43], a[88:91], v[128:131]
    v_mfma_f32_16x16x32_bf16 v[132:135], v[40:43], a[92:95], v[132:135]
    s_add_u32 s80, s80, 8192
    buffer_load_dwordx4 v[240:243], v11, s[52:55], s80 offen
    v_perm_b32 v36, v71, v67, s72
    v_perm_b32 v37, v79, v75, s72
    v_perm_b32 v38, v87, v83, s72
    v_perm_b32 v39, v95, v91, s72
    v_mfma_f32_16x16x32_bf16 v[136:139], v[32:35], a[88:91], v[136:139]
    v_mfma_f32_16x16x32_bf16 v[140:143], v[32:35], a[92:95], v[140:143]
    s_add_u32 s80, s80, 8192
    buffer_load_dwordx4 v[244:247], v11, s[52:55], s80 offen
    v_perm_b32 v40, v71, v67, s73
    v_perm_b32 v41, v79, v75, s73
    v_perm_b32 v42, v87, v83, s73
    v_perm_b32 v43, v95, v91, s73
    v_mfma_f32_16x16x32_bf16 v[144:147], v[36:39], a[88:91], v[144:147]
    v_mfma_f32_16x16x32_bf16 v[148:151], v[36:39], a[92:95], v[148:151]
    s_add_u32 s80, s80, 8192
    buffer_load_dwordx4 v[248:251], v11, s[52:55], s80 offen
    v_mfma_f32_16x16x32_bf16 v[152:155], v[40:43], a[88:91], v[152:155]
    v_mfma_f32_16x16x32_bf16 v[156:159], v[40:43], a[92:95], v[156:159]
    s_add_u32 s80, s80, 8192
    buffer_load_dwordx4 v[252:255], v11, s[52:55], s80 offen
    s_load_dword s42, s[92:93], 0
    s_waitcnt vmcnt(16)
    v_perm_b32 v32, v164, v160, s72
    v_perm_b32 v33, v172, v168, s72
    v_perm_b32 v34, v180, v176, s72
    v_perm_b32 v35, v188, v184, s72
    v_perm_b32 v36, v164, v160, s73
    v_perm_b32 v37, v172, v168, s73
    v_perm_b32 v38, v180, v176, s73
    v_perm_b32 v39, v188, v184, s73
    v_mfma_f32_16x16x32_bf16 v[96:99], v[32:35], a[96:99], v[96:99]
    v_mfma_f32_16x16x32_bf16 v[100:103], v[32:35], a[100:103], v[100:103]
    s_add_u32 s80, s5, 15
    s_and_b32 s80, s80, 15
    s_lshl_b32 s80, s80, 18
    buffer_load_dwordx4 v[64:67], v11, s[52:55], s80 offen
    v_perm_b32 v40, v165, v161, s72
    v_perm_b32 v41, v173, v169, s72
    v_perm_b32 v42, v181, v177, s72
    v_perm_b32 v43, v189, v185, s72
    v_mfma_f32_16x16x32_bf16 v[104:107], v[36:39], a[96:99], v[104:107]
    v_mfma_f32_16x16x32_bf16 v[108:111], v[36:39], a[100:103], v[108:111]
    s_add_u32 s80, s80, 8192
    buffer_load_dwordx4 v[68:71], v11, s[52:55], s80 offen
    v_perm_b32 v32, v165, v161, s73
    v_perm_b32 v33, v173, v169, s73
    v_perm_b32 v34, v181, v177, s73
    v_perm_b32 v35, v189, v185, s73
    v_mfma_f32_16x16x32_bf16 v[112:115], v[40:43], a[96:99], v[112:115]
    v_mfma_f32_16x16x32_bf16 v[116:119], v[40:43], a[100:103], v[116:119]
    s_add_u32 s80, s80, 8192
    buffer_load_dwordx4 v[72:75], v11, s[52:55], s80 offen
    v_perm_b32 v36, v166, v162, s72
    v_perm_b32 v37, v174, v170, s72
    v_perm_b32 v38, v182, v178, s72
    v_perm_b32 v39, v190, v186, s72
    v_mfma_f32_16x16x32_bf16 v[120:123], v[32:35], a[96:99], v[120:123]
    v_mfma_f32_16x16x32_bf16 v[124:127], v[32:35], a[100:103], v[124:127]
    s_add_u32 s80, s80, 8192
    buffer_load_dwordx4 v[76:79], v11, s[52:55], s80 offen
    v_perm_b32 v40, v166, v162, s73
    v_perm_b32 v41, v174, v170, s73
    v_perm_b32 v42, v182, v178, s73
    v_perm_b32 v43, v190, v186, s73
    v_mfma_f32_16x16x32_bf16 v[128:131], v[36:39], a[96:99], v[128:131]
    v_mfma_f32_16x16x32_bf16 v[132:135], v[36:39], a[100:103], v[132:135]
    s_add_u32 s80, s80, 8192
    buffer_load_dwordx4 v[80:83], v11, s[52:55], s80 offen
    v_perm_b32 v32, v167, v163, s72
    v_perm_b32 v33, v175, v171, s72
    v_perm_b32 v34, v183, v179, s72
    v_perm_b32 v35, v191, v187, s72
    v_mfma_f32_16x16x32_bf16 v[136:139], v[40:43], a[96:99], v[136:139]
    v_mfma_f32_16x16x32_bf16 v[140:143], v[40:43], a[100:103], v[140:143]
    s_add_u32 s80, s80, 8192
    buffer_load_dwordx4 v[84:87], v11, s[52:55], s80 offen
    v_perm_b32 v36, v167, v163, s73
    v_perm_b32 v37, v175, v171, s73
    v_perm_b32 v38, v183, v179, s73
    v_perm_b32 v39, v191, v187, s73
    v_mfma_f32_16x16x32_bf16 v[144:147], v[32:35], a[96:99], v[144:147]
    v_mfma_f32_16x16x32_bf16 v[148:151], v[32:35], a[100:103], v[148:151]
    s_add_u32 s80, s80, 8192
    buffer_load_dwordx4 v[88:91], v11, s[52:55], s80 offen
    v_mfma_f32_16x16x32_bf16 v[152:155], v[36:39], a[96:99], v[152:155]
    v_mfma_f32_16x16x32_bf16 v[156:159], v[36:39], a[100:103], v[156:159]
    s_add_u32 s80, s80, 8192
    buffer_load_dwordx4 v[92:95], v11, s[52:55], s80 offen
    s_waitcnt vmcnt(16)
    v_perm_b32 v40, v196, v192, s72
    v_perm_b32 v41, v204, v200, s72
    v_perm_b32 v42, v212, v208, s72
    v_perm_b32 v43, v220, v216, s72
    v_perm_b32 v32, v196, v192, s73
    v_perm_b32 v33, v204, v200, s73
    v_perm_b32 v34, v212, v208, s73
    v_perm_b32 v35, v220, v216, s73
    v_mfma_f32_16x16x32_bf16 v[96:99], v[40:43], a[104:107], v[96:99]
    v_mfma_f32_16x16x32_bf16 v[100:103], v[40:43], a[108:111], v[100:103]
    v_perm_b32 v36, v197, v193, s72
    v_perm_b32 v37, v205, v201, s72
    v_perm_b32 v38, v213, v209, s72
    v_perm_b32 v39, v221, v217, s72
    v_mfma_f32_16x16x32_bf16 v[104:107], v[32:35], a[104:107], v[104:107]
    v_mfma_f32_16x16x32_bf16 v[108:111], v[32:35], a[108:111], v[108:111]
    v_perm_b32 v40, v197, v193, s73
    v_perm_b32 v41, v205, v201, s73
    v_perm_b32 v42, v213, v209, s73
    v_perm_b32 v43, v221, v217, s73
    v_mfma_f32_16x16x32_bf16 v[112:115], v[36:39], a[104:107], v[112:115]
    v_mfma_f32_16x16x32_bf16 v[116:119], v[36:39], a[108:111], v[116:119]
    v_perm_b32 v32, v198, v194, s72
    v_perm_b32 v33, v206, v202, s72
    v_perm_b32 v34, v214, v210, s72
    v_perm_b32 v35, v222, v218, s72
    v_mfma_f32_16x16x32_bf16 v[120:123], v[40:43], a[104:107], v[120:123]
    v_mfma_f32_16x16x32_bf16 v[124:127], v[40:43], a[108:111], v[124:127]
    v_perm_b32 v36, v198, v194, s73
    v_perm_b32 v37, v206, v202, s73
    v_perm_b32 v38, v214, v210, s73
    v_perm_b32 v39, v222, v218, s73
    v_mfma_f32_16x16x32_bf16 v[128:131], v[32:35], a[104:107], v[128:131]
    v_mfma_f32_16x16x32_bf16 v[132:135], v[32:35], a[108:111], v[132:135]
    v_perm_b32 v40, v199, v195, s72
    v_perm_b32 v41, v207, v203, s72
    v_perm_b32 v42, v215, v211, s72
    v_perm_b32 v43, v223, v219, s72
    v_mfma_f32_16x16x32_bf16 v[136:139], v[36:39], a[104:107], v[136:139]
    v_mfma_f32_16x16x32_bf16 v[140:143], v[36:39], a[108:111], v[140:143]
    v_perm_b32 v32, v199, v195, s73
    v_perm_b32 v33, v207, v203, s73
    v_perm_b32 v34, v215, v211, s73
    v_perm_b32 v35, v223, v219, s73
    v_mfma_f32_16x16x32_bf16 v[144:147], v[40:43], a[104:107], v[144:147]
    v_mfma_f32_16x16x32_bf16 v[148:151], v[40:43], a[108:111], v[148:151]
    v_mfma_f32_16x16x32_bf16 v[152:155], v[32:35], a[104:107], v[152:155]
    v_mfma_f32_16x16x32_bf16 v[156:159], v[32:35], a[108:111], v[156:159]
    s_waitcnt lgkmcnt(0)
    s_cmp_eq_u32 s42, 0
    s_cbranch_scc1 LA_nononce
LA_nonce:
    s_waitcnt vmcnt(8)
    v_perm_b32 v36, v228, v224, s72
    v_perm_b32 v37, v236, v232, s72
    v_perm_b32 v38, v244, v240, s72
    v_perm_b32 v39, v252, v248, s72
    v_perm_b32 v40, v228, v224, s73
    v_perm_b32 v41, v236, v232, s73
    v_perm_b32 v42, v244, v240, s73
    v_perm_b32 v43, v252, v248, s73
    v_mfma_f32_16x16x32_bf16 v[96:99], v[36:39], a[112:115], v[96:99]
    v_mfma_f32_16x16x32_bf16 v[100:103], v[36:39], a[116:119], v[100:103]
    v_perm_b32 v32, v229, v225, s72
    v_perm_b32 v33, v237, v233, s72
    v_perm_b32 v34, v245, v241, s72
    v_perm_b32 v35, v253, v249, s72
    v_mfma_f32_16x16x32_bf16 v[104:107], v[40:43], a[112:115], v[104:107]
    v_mfma_f32_16x16x32_bf16 v[108:111], v[40:43], a[116:119], v[108:111]
    v_perm_b32 v36, v229, v225, s73
    v_perm_b32 v37, v237, v233, s73
    v_perm_b32 v38, v245, v241, s73
    v_perm_b32 v39, v253, v249, s73
    v_mfma_f32_16x16x32_bf16 v[112:115], v[32:35], a[112:115], v[112:115]
    v_mfma_f32_16x16x32_bf16 v[116:119], v[32:35], a[116:119], v[116:119]
    v_perm_b32 v40, v230, v226, s72
    v_perm_b32 v41, v238, v234, s72
    v_perm_b32 v42, v246, v242, s72
    v_perm_b32 v43, v254, v250, s72
    v_mfma_f32_16x16x32_bf16 v[120:123], v[36:39], a[112:115], v[120:123]
    v_mfma_f32_16x16x32_bf16 v[124:127], v[36:39], a[116:119], v[124:127]
    v_perm_b32 v32, v230, v226, s73
    v_perm_b32 v33, v238, v234, s73
    v_perm_b32 v34, v246, v242, s73
    v_perm_b32 v35, v254, v250, s73
    v_mfma_f32_16x16x32_bf16 v[128:131], v[40:43], a[112:115], v[128:131]
    v_mfma_f32_16x16x32_bf16 v[132:135], v[40:43], a[116:119], v[132:135]
    v_perm_b32 v36, v231, v227, s72
    v_perm_b32 v37, v239, v235, s72
    v_perm_b32 v38, v247, v243, s72
    v_perm_b32 v39, v255, v251, s72
    v_mfma_f32_16x16x32_bf16 v[136:139], v[32:35], a[112:115], v[136:139]
    v_mfma_f32_16x16x32_bf16 v[140:143], v[32:35], a[116:119], v[140:143]
    v_perm_b32 v40, v231, v227, s73
    v_perm_b32 v41, v239, v235, s73
    v_perm_b32 v42, v247, v243, s73
    v_perm_b32 v43, v255, v251, s73
    v_mfma_f32_16x16x32_bf16 v[144:147], v[36:39], a[112:115], v[144:147]
    v_mfma_f32_16x16x32_bf16 v[148:151], v[36:39], a[116:119], v[148:151]
    v_mfma_f32_16x16x32_bf16 v[152:155], v[40:43], a[112:115], v[152:155]
    v_mfma_f32_16x16x32_bf16 v[156:159], v[40:43], a[116:119], v[156:159]
    s_add_u32 m0, s78, 106496
    s_mov_b32 s9, 40960
    buffer_load_dwordx4 v10, s[48:51], s9 offen nt lds
    buffer_load_dwordx4 v5, s[48:51], s9 offen offset:1024 nt lds
    s_add_u32 m0, s78, 57344
    s_mov_b32 s9, 57344
    buffer_load_dwordx4 v8, s[44:47], s9 offen nt lds
    buffer_load_dwordx4 v9, s[44:47], s9 offen offset:1024 nt lds
    s_add_u32 m0, s78, 114688
    s_mov_b32 s9, 49152
    buffer_load_dwordx4 v10, s[48:51], s9 offen nt lds
    buffer_load_dwordx4 v5, s[48:51], s9 offen offset:1024 nt lds
    s_barrier
    v_mov_b32 v252, v60
    v_mov_b32 v253, v61
    v_mov_b32 v254, v62
    v_mov_b32 v255, v63
    s_waitcnt vmcnt(6)
    v_perm_b32 v32, v68, v64, s72
    v_perm_b32 v33, v76, v72, s72
    v_perm_b32 v34, v84, v80, s72
    v_perm_b32 v35, v92, v88, s72
    ds_read_b128 a[32:35], v16 offset:0
    v_perm_b32 v36, v68, v64, s73
    v_perm_b32 v37, v76, v72, s73
    v_perm_b32 v38, v84, v80, s73
    v_perm_b32 v39, v92, v88, s73
    v_mfma_f32_16x16x32_bf16 v[96:99], v[32:35], a[120:123], v[96:99]
    v_mfma_f32_16x16x32_bf16 v[100:103], v[32:35], a[124:127], v[100:103]
    ds_read_b128 a[36:39], v17 offset:0
    v_perm_b32 v40, v69, v65, s72
    v_perm_b32 v41, v77, v73, s72
    v_perm_b32 v42, v85, v81, s72
    v_perm_b32 v43, v93, v89, s72
    v_mfma_f32_16x16x32_bf16 v[104:107], v[36:39], a[120:123], v[104:107]
    v_mfma_f32_16x16x32_bf16 v[108:111], v[36:39], a[124:127], v[108:111]
    ds_read_b128 a[40:43], v18 offset:0
    v_perm_b32 v32, v69, v65, s73
    v_perm_b32 v33, v77, v73, s73
    v_perm_b32 v34, v85, v81, s73
    v_perm_b32 v35, v93, v89, s73
    v_mfma_f32_16x16x32_bf16 v[112:115], v[40:43], a[120:123], v[112:115]
    v_mfma_f32_16x16x32_bf16 v[116:119], v[40:43], a[124:127], v[116:119]
    ds_read_b128 a[44:47], v19 offset:0
    v_perm_b32 v36, v70, v66, s72
    v_perm_b32 v37, v78, v74, s72
    v_perm_b32 v38, v86, v82, s72
    v_perm_b32 v39, v94, v90, s72
    v_mfma_f32_16x16x32_bf16 v[120:123], v[32:35], a[120:123], v[120:123]
    v_mfma_f32_16x16x32_bf16 v[124:127], v[32:35], a[124:127], v[124:127]
    ds_read_b128 a[48:51], v16 offset:4096
    v_perm_b32 v40, v70, v66, s73
    v_perm_b32 v41, v78, v74, s73
    v_perm_b32 v42, v86, v82, s73
    v_perm_b32 v43, v94, v90, s73
    v_mfma_f32_16x16x32_bf16 v[128:131], v[36:39], a[120:123], v[128:131]
    v_mfma_f32_16x16x32_bf16 v[132:135], v[36:39], a[124:127], v[132:135]
    ds_read_b128 a[52:55], v17 offset:4096
    v_perm_b32 v32, v71, v67, s72
    v_perm_b32 v33, v79, v75, s72
    v_perm_b32 v34, v87, v83, s72
    v_perm_b32 v35, v95, v91, s72
    v_mfma_f32_16x16x32_bf16 v[136:139], v[40:43], a[120:123], v[136:139]
    v_mfma_f32_16x16x32_bf16 v[140:143], v[40:43], a[124:127], v[140:143]
    ds_read_b128 a[56:59], v18 offset:4096
    v_perm_b32 v36, v71, v67, s73
    v_perm_b32 v37, v79, v75, s73
    v_perm_b32 v38, v87, v83, s73
    v_perm_b32 v39, v95, v91, s73
    v_mfma_f32_16x16x32_bf16 v[144:147], v[32:35], a[120:123], v[144:147]
    v_mfma_f32_16x16x32_bf16 v[148:151], v[32:35], a[124:127], v[148:151]
    ds_read_b128 a[60:63], v19 offset:4096
    v_mfma_f32_16x16x32_bf16 v[152:155], v[36:39], a[120:123], v[152:155]
    v_mfma_f32_16x16x32_bf16 v[156:159], v[36:39], a[124:127], v[156:159]
    s_mov_b32 s14, s74
    s_mov_b32 s15, s74
    v_pk_mul_f32 v[96:97], v[96:97], s[14:15]
    v_pk_mul_f32 v[104:105], v[104:105], s[14:15]
    v_pk_mul_f32 v[112:113], v[112:113], s[14:15]
    v_pk_mul_f32 v[120:121], v[120:121], s[14:15]
    v_pk_mul_f32 v[128:129], v[128:129], s[14:15]
    v_pk_mul_f32 v[136:137], v[136:137], s[14:15]
    v_pk_mul_f32 v[144:145], v[144:145], s[14:15]
    v_pk_mul_f32 v[152:153], v[152:153], s[14:15]
    v_cvt_pk_bf16_f32 v160, v96, v104
    v_cvt_pk_bf16_f32 v161, v112, v120
    v_cvt_pk_bf16_f32 v162, v128, v136
    v_cvt_pk_bf16_f32 v163, v144, v152
    v_cvt_pk_bf16_f32 v164, v97, v105
    v_cvt_pk_bf16_f32 v165, v113, v121
    v_cvt_pk_bf16_f32 v166, v129, v137
    v_cvt_pk_bf16_f32 v167, v145, v153
    v_pk_mul_f32 v[98:99], v[98:99], s[14:15]
    v_pk_mul_f32 v[106:107], v[106:107], s[14:15]
    v_pk_mul_f32 v[114:115], v[114:115], s[14:15]
    v_pk_mul_f32 v[122:123], v[122:123], s[14:15]
    v_pk_mul_f32 v[130:131], v[130:131], s[14:15]
    v_pk_mul_f32 v[138:139], v[138:139], s[14:15]
    v_pk_mul_f32 v[146:147], v[146:147], s[14:15]
    v_pk_mul_f32 v[154:155], v[154:155], s[14:15]
    v_cvt_pk_bf16_f32 v168, v98, v106
    v_cvt_pk_bf16_f32 v169, v114, v122
    v_cvt_pk_bf16_f32 v170, v130, v138
    v_cvt_pk_bf16_f32 v171, v146, v154
    v_cvt_pk_bf16_f32 v172, v99, v107
    v_cvt_pk_bf16_f32 v173, v115, v123
    v_cvt_pk_bf16_f32 v174, v131, v139
    v_cvt_pk_bf16_f32 v175, v147, v155
    s_waitcnt lgkmcnt(0)
    v_mfma_f32_16x16x32_bf16 v[32:35], a[32:35], v[160:163], 0
    v_pk_mul_f32 v[100:101], v[100:101], s[14:15]
    v_pk_mul_f32 v[108:109], v[108:109], s[14:15]
    v_pk_mul_f32 v[116:117], v[116:117], s[14:15]
    v_pk_mul_f32 v[124:125], v[124:125], s[14:15]
    v_mfma_f32_16x16x32_bf16 v[32:35], a[36:39], v[164:167], v[32:35]
    v_pk_mul_f32 v[132:133], v[132:133], s[14:15]
    v_pk_mul_f32 v[140:141], v[140:141], s[14:15]
    v_pk_mul_f32 v[148:149], v[148:149], s[14:15]
    v_pk_mul_f32 v[156:157], v[156:157], s[14:15]
    v_mfma_f32_16x16x32_bf16 v[32:35], a[40:43], v[168:171], v[32:35]
    v_cvt_pk_bf16_f32 v176, v100, v108
    v_cvt_pk_bf16_f32 v177, v116, v124
    v_cvt_pk_bf16_f32 v178, v132, v140
    v_cvt_pk_bf16_f32 v179, v148, v156
    v_mfma_f32_16x16x32_bf16 v[32:35], a[44:47], v[172:175], v[32:35]
    v_cvt_pk_bf16_f32 v180, v101, v109
    v_cvt_pk_bf16_f32 v181, v117, v125
    v_cvt_pk_bf16_f32 v182, v133, v141
    v_cvt_pk_bf16_f32 v183, v149, v157
    v_mfma_f32_16x16x32_bf16 v[36:39], a[48:51], v[160:163], 0
    v_pk_mul_f32 v[102:103], v[102:103], s[14:15]
    v_pk_mul_f32 v[110:111], v[110:111], s[14:15]
    v_pk_mul_f32 v[118:119], v[118:119], s[14:15]
    v_pk_mul_f32 v[126:127], v[126:127], s[14:15]
    v_mfma_f32_16x16x32_bf16 v[36:39], a[52:55], v[164:167], v[36:39]
    v_pk_mul_f32 v[134:135], v[134:135], s[14:15]
    v_pk_mul_f32 v[142:143], v[142:143], s[14:15]
    v_pk_mul_f32 v[150:151], v[150:151], s[14:15]
    v_pk_mul_f32 v[158:159], v[158:159], s[14:15]
    v_mfma_f32_16x16x32_bf16 v[36:39], a[56:59], v[168:171], v[36:39]
    v_cvt_pk_bf16_f32 v184, v102, v110
    v_cvt_pk_bf16_f32 v185, v118, v126
    v_cvt_pk_bf16_f32 v186, v134, v142
    v_cvt_pk_bf16_f32 v187, v150, v158
    v_mfma_f32_16x16x32_bf16 v[36:39], a[60:63], v[172:175], v[36:39]
    v_cvt_pk_bf16_f32 v188, v103, v111
    v_cvt_pk_bf16_f32 v189, v119, v127
    v_cvt_pk_bf16_f32 v190, v135, v143
    v_cvt_pk_bf16_f32 v191, v151, v159
    v_mfma_f32_16x16x32_bf16 v[40:43], a[32:35], v[176:179], 0
    v_mfma_f32_16x16x32_bf16 v[40:43], a[36:39], v[180:183], v[40:43]
    v_mfma_f32_16x16x32_bf16 v[40:43], a[40:43], v[184:187], v[40:43]
    v_mfma_f32_16x16x32_bf16 v[40:43], a[44:47], v[188:191], v[40:43]
    v_mfma_f32_16x16x32_bf16 v[44:47], a[48:51], v[176:179], 0
    v_mfma_f32_16x16x32_bf16 v[44:47], a[52:55], v[180:183], v[44:47]
    v_mfma_f32_16x16x32_bf16 v[44:47], a[56:59], v[184:187], v[44:47]
    v_mfma_f32_16x16x32_bf16 v[44:47], a[60:63], v[188:191], v[44:47]
    s_mov_b32 s72, 0x40004000
    s_barrier
    ds_read_b128 a[64:67], v16 offset:8192
    ds_read_b128 a[68:71], v17 offset:8192
    ds_read_b128 a[72:75], v18 offset:8192
    s_add_u32 m0, s78, 0
    s_mov_b32 s9, 65536
    buffer_load_dwordx4 v8, s[44:47], s9 offen nt lds
    ds_read_b128 a[32:35], v19 offset:8192
    buffer_load_dwordx4 v9, s[44:47], s9 offen offset:1024 nt lds
    v_add_u32 v28, 98304, v28
    v_add_u32 v29, 98304, v29
    v_add_u32 v30, 98304, v30
    v_add_u32 v31, 98304, v31
    ds_read_b64_tr_b16 a[80:81], v28 offset:32768
    v_max3_f32 v14, v32, v33, v34
    v_max3_f32 v14, v14, v35, v36
    v_max3_f32 v14, v14, v37, v38
    v_max_f32 v14, v14, v39
    v_max3_f32 v73, v40, v41, v42
    v_max3_f32 v73, v73, v43, v44
    v_max3_f32 v73, v73, v45, v46
    v_max_f32 v73, v73, v47
    v_mov_b32 v74, v14
    v_mov_b32 v75, v73
    s_nop 0
    v_permlane16_swap_b32 v74, v14
    v_permlane16_swap_b32 v75, v73
    v_max_f32 v14, v14, v74
    v_max_f32 v73, v73, v75
    v_mov_b32 v74, v14
    v_mov_b32 v75, v73
    s_nop 0
    v_permlane32_swap_b32 v74, v14
    v_permlane32_swap_b32 v75, v73
    v_max_f32 v14, v14, v74
    v_max_f32 v73, v73, v75
    v_add_f32 v14, 1088421888, v14
    v_add_f32 v73, 1088421888, v73
    v_sub_f32 v32, v32, v14
    v_sub_f32 v33, v33, v14
    v_sub_f32 v34, v34, v14
    v_sub_f32 v35, v35, v14
    v_sub_f32 v36, v36, v14
    v_sub_f32 v37, v37, v14
    v_sub_f32 v38, v38, v14
    v_sub_f32 v39, v39, v14
    v_sub_f32 v40, v40, v73
    v_sub_f32 v41, v41, v73
    v_sub_f32 v42, v42, v73
    v_sub_f32 v43, v43, v73
    v_sub_f32 v44, v44, v73
    v_sub_f32 v45, v45, v73
    v_sub_f32 v46, v46, v73
    v_sub_f32 v47, v47, v73
    v_sub_f32 v64, 0, v14
    v_sub_f32 v65, 0, v14
    v_sub_f32 v66, 0, v14
    v_sub_f32 v67, 0, v14
    v_sub_f32 v68, 0, v73
    v_sub_f32 v69, 0, v73
    v_sub_f32 v70, 0, v73
    v_sub_f32 v71, 0, v73
    ds_read_b128 a[36:39], v16 offset:12288
    v_exp_f32 v244, v32
    s_add_u32 m0, s78, 122880
    s_mov_b32 s9, 57344
    buffer_load_dwordx4 v10, s[48:51], s9 offen nt lds
    ds_read_b64_tr_b16 a[82:83], v28 offset:34816
    ds_read_b128 a[40:43], v17 offset:12288
    v_exp_f32 v245, v33
    buffer_load_dwordx4 v5, s[48:51], s9 offen offset:1024 nt lds
    ds_read_b64_tr_b16 a[84:85], v29 offset:32768
    ds_read_b64_tr_b16 a[86:87], v29 offset:34816
    ds_read_b128 a[44:47], v18 offset:12288
    v_exp_f32 v246, v34
    ds_read_b64_tr_b16 a[88:89], v30 offset:32768
    ds_read_b64_tr_b16 a[90:91], v30 offset:34816
    ds_read_b128 a[48:51], v19 offset:12288
    v_cvt_pk_bf16_f32 v80, v244, v245
    ds_read_b64_tr_b16 a[92:93], v31 offset:32768
    ds_read_b64_tr_b16 a[94:95], v31 offset:34816
    ds_read_b64_tr_b16 a[52:53], v20 offset:0
    ds_read_b64_tr_b16 a[54:55], v20 offset:4096
    v_exp_f32 v247, v35
    ds_read_b64_tr_b16 a[56:57], v21 offset:0
    ds_read_b64_tr_b16 a[58:59], v21 offset:4096
    v_exp_f32 v244, v36
    ds_read_b64_tr_b16 a[60:61], v22 offset:0
    ds_read_b64_tr_b16 a[62:63], v22 offset:4096
    v_cvt_pk_bf16_f32 v81, v246, v247
    v_exp_f32 v245, v37
    v_exp_f32 v246, v38
    s_waitcnt lgkmcnt(15)
    v_mfma_f32_16x16x32_bf16 v[48:51], a[64:67], v[160:163], v[64:67]
    v_cvt_pk_bf16_f32 v82, v244, v245
    v_exp_f32 v247, v39
    v_mfma_f32_16x16x32_bf16 v[48:51], a[68:71], v[164:167], v[48:51]
    v_exp_f32 v244, v40
    v_mfma_f32_16x16x32_bf16 v[48:51], a[72:75], v[168:171], v[48:51]
    v_cvt_pk_bf16_f32 v83, v246, v247
    v_exp_f32 v245, v41
    v_mfma_f32_16x16x32_bf16 v[48:51], a[32:35], v[172:175], v[48:51]
    v_exp_f32 v246, v42
    v_mfma_f32_16x16x32_bf16 v[56:59], a[64:67], v[176:179], v[68:71]
    ds_read_b64_tr_b16 a[64:65], v23 offset:0
    ds_read_b64_tr_b16 a[66:67], v23 offset:4096
    v_mfma_f32_16x16x32_bf16 v[56:59], a[68:71], v[180:183], v[56:59]
    v_cvt_pk_bf16_f32 v84, v244, v245
    v_exp_f32 v247, v43
    v_mfma_f32_16x16x32_bf16 v[56:59], a[72:75], v[184:187], v[56:59]
    ds_read_b64_tr_b16 a[68:69], v24 offset:0
    ds_read_b64_tr_b16 a[70:71], v24 offset:4096
    v_mfma_f32_16x16x32_bf16 v[56:59], a[32:35], v[188:191], v[56:59]
    v_exp_f32 v244, v44
    v_mfma_f32_16x16x32_bf16 v[52:55], a[36:39], v[160:163], v[64:67]
    ds_read_b64_tr_b16 a[72:73], v25 offset:0
    ds_read_b64_tr_b16 a[74:75], v25 offset:4096
    s_waitcnt lgkmcnt(15)
    v_mfma_f32_16x16x32_bf16 v[52:55], a[40:43], v[164:167], v[52:55]
    v_cvt_pk_bf16_f32 v85, v246, v247
    v_exp_f32 v245, v45
    v_mfma_f32_16x16x32_bf16 v[52:55], a[44:47], v[168:171], v[52:55]
    ds_read_b64_tr_b16 a[32:33], v26 offset:0
    ds_read_b64_tr_b16 a[34:35], v26 offset:4096
    s_waitcnt lgkmcnt(15)
    v_mfma_f32_16x16x32_bf16 v[52:55], a[48:51], v[172:175], v[52:55]
    v_exp_f32 v246, v46
    v_mfma_f32_16x16x32_bf16 v[60:63], a[36:39], v[176:179], v[68:71]
    ds_read_b64_tr_b16 a[36:37], v27 offset:0
    ds_read_b64_tr_b16 a[38:39], v27 offset:4096
    v_mfma_f32_16x16x32_bf16 v[60:63], a[40:43], v[180:183], v[60:63]
    v_cvt_pk_bf16_f32 v86, v244, v245
    v_exp_f32 v247, v47
    v_mfma_f32_16x16x32_bf16 v[60:63], a[44:47], v[184:187], v[60:63]
    v_cvt_pk_bf16_f32 v87, v246, v247
    v_mfma_f32_16x16x32_bf16 v[60:63], a[48:51], v[188:191], v[60:63]
    s_waitcnt lgkmcnt(0)
    s_barrier
    v_mfma_f32_16x16x32_bf16 v[96:99], a[52:55], v[80:83], 0
    ds_read_b128 a[40:43], v16 offset:16384
    ds_read_b128 a[44:47], v17 offset:16384
    ds_read_b128 a[48:51], v18 offset:16384
    s_add_u32 m0, s78, 8192
    s_mov_b32 s9, 73728
    buffer_load_dwordx4 v8, s[44:47], s9 offen nt lds
    v_mfma_f32_16x16x32_bf16 v[100:103], a[52:55], v[84:87], 0
    ds_read_b128 a[52:55], v19 offset:16384
    v_mfma_f32_16x16x32_bf16 v[104:107], a[56:59], v[80:83], 0
    buffer_load_dwordx4 v9, s[44:47], s9 offen offset:1024 nt lds
    ds_read_b64_tr_b16 a[96:97], v28 offset:49152
    v_mfma_f32_16x16x32_bf16 v[108:111], a[56:59], v[84:87], 0
    ds_read_b128 a[56:59], v16 offset:20480
    v_exp_f32 v244, v48
    v_mfma_f32_16x16x32_bf16 v[112:115], a[60:63], v[80:83], 0
    s_add_u32 m0, s78, 65536
    s_mov_b32 s9, 65536
    buffer_load_dwordx4 v10, s[48:51], s9 offen nt lds
    ds_read_b64_tr_b16 a[98:99], v28 offset:51200
    v_mfma_f32_16x16x32_bf16 v[116:119], a[60:63], v[84:87], 0
    ds_read_b128 a[60:63], v17 offset:20480
    v_exp_f32 v245, v49
    v_mfma_f32_16x16x32_bf16 v[120:123], a[64:67], v[80:83], 0
    buffer_load_dwordx4 v5, s[48:51], s9 offen offset:1024 nt lds
    ds_read_b64_tr_b16 a[100:101], v29 offset:49152
    ds_read_b64_tr_b16 a[102:103], v29 offset:51200
    v_mfma_f32_16x16x32_bf16 v[124:127], a[64:67], v[84:87], 0
    ds_read_b128 a[64:67], v18 offset:20480
    v_exp_f32 v246, v50
    v_mfma_f32_16x16x32_bf16 v[128:131], a[68:71], v[80:83], 0
    ds_read_b64_tr_b16 a[104:105], v30 offset:49152
    ds_read_b64_tr_b16 a[106:107], v30 offset:51200
    v_cvt_pk_bf16_f32 v88, v244, v245
    v_mfma_f32_16x16x32_bf16 v[132:135], a[68:71], v[84:87], 0
    ds_read_b128 a[68:71], v19 offset:20480
    v_exp_f32 v247, v51
    v_mfma_f32_16x16x32_bf16 v[136:139], a[72:75], v[80:83], 0
    ds_read_b64_tr_b16 a[108:109], v31 offset:49152
    ds_read_b64_tr_b16 a[110:111], v31 offset:51200
    v_mfma_f32_16x16x32_bf16 v[140:143], a[72:75], v[84:87], 0
    ds_read_b64_tr_b16 a[72:73], v20 offset:8192
    ds_read_b64_tr_b16 a[74:75], v20 offset:12288
    v_mfma_f32_16x16x32_bf16 v[144:147], a[32:35], v[80:83], 0
    v_exp_f32 v244, v52
    v_cvt_pk_bf16_f32 v89, v246, v247
    v_mfma_f32_16x16x32_bf16 v[148:151], a[32:35], v[84:87], 0
    ds_read_b64_tr_b16 a[32:33], v21 offset:8192
    ds_read_b64_tr_b16 a[34:35], v21 offset:12288
    v_mfma_f32_16x16x32_bf16 v[152:155], a[36:39], v[80:83], 0
    v_exp_f32 v245, v53
    v_mfma_f32_16x16x32_bf16 v[156:159], a[36:39], v[84:87], 0
    ds_read_b64_tr_b16 a[36:37], v22 offset:8192
    ds_read_b64_tr_b16 a[38:39], v22 offset:12288
    v_mfma_f32_16x16x32_bf16 v[76:79], a[76:79], v[80:83], 0
    v_exp_f32 v246, v54
    v_cvt_pk_bf16_f32 v90, v244, v245
    v_mfma_f32_16x16x32_bf16 v[240:243], a[76:79], v[84:87], 0
    v_exp_f32 v247, v55
    s_waitcnt lgkmcnt(8)
    v_mfma_f32_16x16x32_bf16 v[32:35], a[40:43], v[160:163], v[64:67]
    v_exp_f32 v244, v56
    v_cvt_pk_bf16_f32 v91, v246, v247
    v_mfma_f32_16x16x32_bf16 v[32:35], a[44:47], v[164:167], v[32:35]
    v_exp_f32 v245, v57
    v_mfma_f32_16x16x32_bf16 v[32:35], a[48:51], v[168:171], v[32:35]
    v_exp_f32 v246, v58
    v_cvt_pk_bf16_f32 v92, v244, v245
    v_mfma_f32_16x16x32_bf16 v[32:35], a[52:55], v[172:175], v[32:35]
    v_exp_f32 v247, v59
    v_mfma_f32_16x16x32_bf16 v[40:43], a[40:43], v[176:179], v[68:71]
    ds_read_b64_tr_b16 a[40:41], v23 offset:8192
    ds_read_b64_tr_b16 a[42:43], v23 offset:12288
    v_mfma_f32_16x16x32_bf16 v[40:43], a[44:47], v[180:183], v[40:43]
    v_exp_f32 v244, v60
    v_cvt_pk_bf16_f32 v93, v246, v247
    v_mfma_f32_16x16x32_bf16 v[40:43], a[48:51], v[184:187], v[40:43]
    ds_read_b64_tr_b16 a[44:45], v24 offset:8192
    ds_read_b64_tr_b16 a[46:47], v24 offset:12288
    v_mfma_f32_16x16x32_bf16 v[40:43], a[52:55], v[188:191], v[40:43]
    v_exp_f32 v245, v61
    v_exp_f32 v246, v62
    v_mfma_f32_16x16x32_bf16 v[36:39], a[56:59], v[160:163], v[64:67]
    ds_read_b64_tr_b16 a[48:49], v25 offset:8192
    ds_read_b64_tr_b16 a[50:51], v25 offset:12288
    v_cvt_pk_bf16_f32 v94, v244, v245
    v_mfma_f32_16x16x32_bf16 v[36:39], a[60:63], v[164:167], v[36:39]
    v_exp_f32 v247, v63
    v_or3_b32 v14, v88, v89, v90
    v_mfma_f32_16x16x32_bf16 v[36:39], a[64:67], v[168:171], v[36:39]
    ds_read_b64_tr_b16 a[52:53], v26 offset:8192
    ds_read_b64_tr_b16 a[54:55], v26 offset:12288
    v_cvt_pk_bf16_f32 v95, v246, v247
    v_mfma_f32_16x16x32_bf16 v[36:39], a[68:71], v[172:175], v[36:39]
    v_or3_b32 v14, v14, v91, v92
    v_or3_b32 v14, v14, v93, v94
    v_bitop3_b32 v14, v14, v95, s72 bitop3:0xa8
    v_mfma_f32_16x16x32_bf16 v[44:47], a[56:59], v[176:179], v[68:71]
    ds_read_b64_tr_b16 a[56:57], v27 offset:8192
    ds_read_b64_tr_b16 a[58:59], v27 offset:12288
    s_add_u32 m0, s79, 131072
    s_add_u32 s82, s81, 32768
    s_and_b32 s82, s82, 0x7ffff
    buffer_load_dwordx4 v252, s[56:59], s82 offen lds
    v_mfma_f32_16x16x32_bf16 v[44:47], a[60:63], v[180:183], v[44:47]
    buffer_load_dwordx4 v253, s[56:59], s82 offen offset:1024 lds
    v_mfma_f32_16x16x32_bf16 v[44:47], a[64:67], v[184:187], v[44:47]
    v_cmp_ne_u32 vcc, 0, v14
    v_mfma_f32_16x16x32_bf16 v[44:47], a[68:71], v[188:191], v[44:47]
    s_cbranch_vccnz LA_r1_1
LA_b1_1:
    s_waitcnt lgkmcnt(0)
    s_barrier
    s_lshl_b32 s13, s4, 15
    s_add_u32 s13, s13, s75
    v_lshl_add_u32 v12, v0, 4, s13
    s_lshl_b32 s13, s5, 16
    s_lshl_b32 s12, s6, 10
    s_add_u32 s13, s13, s12
    s_lshl_b32 s12, s4, 7
    s_add_u32 s13, s13, s12
    v_and_b32 v13, 31, v0
    v_lshlrev_b32 v13, 11, v13
    v_lshrrev_b32 v2, 5, v0
    v_lshl_add_u32 v13, v2, 4, v13
    v_add_u32 v13, s13, v13
    s_lshl_b32 s10, s4, 8
    s_add_u32 s10, s10, s75
    s_add_u32 s10, s10, 262144
    v_and_b32 v2, 7, v1
    v_lshl_add_u32 v248, v2, 2, s10
    s_lshl_b32 s10, s3, 1
    v_add_u32 v249, s10, v1
    s_lshl_b32 s11, s4, 2
    s_add_u32 s11, s11, s75
    s_add_u32 s11, s11, 262144
    v_lshl_add_u32 v249, v249, 8, s11
    v_mov_b32 v250, s42
    v_mfma_f32_16x16x32_bf16 v[96:99], a[72:75], v[88:91], v[96:99]
    ds_read_b128 a[60:63], v16 offset:24576
    ds_read_b128 a[64:67], v17 offset:24576
    ds_read_b128 a[68:71], v18 offset:24576
    s_add_u32 m0, s78, 16384
    s_mov_b32 s9, 81920
    buffer_load_dwordx4 v8, s[44:47], s9 offen nt lds
    v_mfma_f32_16x16x32_bf16 v[100:103], a[72:75], v[92:95], v[100:103]
    ds_read_b128 a[72:75], v19 offset:24576
    v_mfma_f32_16x16x32_bf16 v[104:107], a[32:35], v[88:91], v[104:107]
    buffer_load_dwordx4 v9, s[44:47], s9 offen offset:1024 nt lds
    v_exp_f32 v244, v32
    v_mfma_f32_16x16x32_bf16 v[108:111], a[32:35], v[92:95], v[108:111]
    ds_read_b128 a[32:35], v16 offset:28672
    v_exp_f32 v245, v33
    v_mfma_f32_16x16x32_bf16 v[112:115], a[36:39], v[88:91], v[112:115]
    s_add_u32 m0, s79, 131072
    s_nop 0
    buffer_load_dwordx4 v254, s[56:59], s82 offen offset:2048 lds
    v_mfma_f32_16x16x32_bf16 v[116:119], a[36:39], v[92:95], v[116:119]
    ds_read_b128 a[36:39], v17 offset:28672
    v_exp_f32 v246, v34
    v_mfma_f32_16x16x32_bf16 v[120:123], a[40:43], v[88:91], v[120:123]
    buffer_load_dwordx4 v255, s[56:59], s82 offen offset:3072 lds
    v_cvt_pk_bf16_f32 v80, v244, v245
    v_mfma_f32_16x16x32_bf16 v[124:127], a[40:43], v[92:95], v[124:127]
    ds_read_b128 a[40:43], v18 offset:28672
    v_exp_f32 v247, v35
    v_mfma_f32_16x16x32_bf16 v[128:131], a[44:47], v[88:91], v[128:131]
    v_exp_f32 v244, v36
    v_mfma_f32_16x16x32_bf16 v[132:135], a[44:47], v[92:95], v[132:135]
    ds_read_b128 a[44:47], v19 offset:28672
    v_cvt_pk_bf16_f32 v81, v246, v247
    v_mfma_f32_16x16x32_bf16 v[136:139], a[48:51], v[88:91], v[136:139]
    v_exp_f32 v245, v37
    v_mfma_f32_16x16x32_bf16 v[140:143], a[48:51], v[92:95], v[140:143]
    ds_read_b64_tr_b16 a[48:49], v20 offset:16384
    ds_read_b64_tr_b16 a[50:51], v20 offset:20480
    v_mfma_f32_16x16x32_bf16 v[144:147], a[52:55], v[88:91], v[144:147]
    v_exp_f32 v246, v38
    v_mfma_f32_16x16x32_bf16 v[148:151], a[52:55], v[92:95], v[148:151]
    ds_read_b64_tr_b16 a[52:53], v21 offset:16384
    ds_read_b64_tr_b16 a[54:55], v21 offset:20480
    v_mfma_f32_16x16x32_bf16 v[152:155], a[56:59], v[88:91], v[152:155]
    v_cvt_pk_bf16_f32 v82, v244, v245
    v_exp_f32 v247, v39
    v_mfma_f32_16x16x32_bf16 v[156:159], a[56:59], v[92:95], v[156:159]
    ds_read_b64_tr_b16 a[56:57], v22 offset:16384
    ds_read_b64_tr_b16 a[58:59], v22 offset:20480
    v_mfma_f32_16x16x32_bf16 v[76:79], a[76:79], v[88:91], v[76:79]
    v_exp_f32 v244, v40
    v_mfma_f32_16x16x32_bf16 v[240:243], a[76:79], v[92:95], v[240:243]
    v_cvt_pk_bf16_f32 v83, v246, v247
    v_exp_f32 v245, v41
    s_waitcnt lgkmcnt(6)
    v_mfma_f32_16x16x32_bf16 v[48:51], a[60:63], v[160:163], v[64:67]
    v_exp_f32 v246, v42
    v_mfma_f32_16x16x32_bf16 v[48:51], a[64:67], v[164:167], v[48:51]
    v_cvt_pk_bf16_f32 v84, v244, v245
    v_exp_f32 v247, v43
    v_mfma_f32_16x16x32_bf16 v[48:51], a[68:71], v[168:171], v[48:51]
    v_exp_f32 v244, v44
    v_mfma_f32_16x16x32_bf16 v[48:51], a[72:75], v[172:175], v[48:51]
    v_cvt_pk_bf16_f32 v85, v246, v247
    v_exp_f32 v245, v45
    v_mfma_f32_16x16x32_bf16 v[56:59], a[60:63], v[176:179], v[68:71]
    ds_read_b64_tr_b16 a[60:61], v23 offset:16384
    ds_read_b64_tr_b16 a[62:63], v23 offset:20480
    v_mfma_f32_16x16x32_bf16 v[56:59], a[64:67], v[180:183], v[56:59]
    v_exp_f32 v246, v46
    v_mfma_f32_16x16x32_bf16 v[56:59], a[68:71], v[184:187], v[56:59]
    ds_read_b64_tr_b16 a[64:65], v24 offset:16384
    ds_read_b64_tr_b16 a[66:67], v24 offset:20480
    v_mfma_f32_16x16x32_bf16 v[56:59], a[72:75], v[188:191], v[56:59]
    v_cvt_pk_bf16_f32 v86, v244, v245
    v_mfma_f32_16x16x32_bf16 v[52:55], a[32:35], v[160:163], v[64:67]
    ds_read_b64_tr_b16 a[68:69], v25 offset:16384
    ds_read_b64_tr_b16 a[70:71], v25 offset:20480
    v_mfma_f32_16x16x32_bf16 v[52:55], a[36:39], v[164:167], v[52:55]
    v_exp_f32 v247, v47
    v_mfma_f32_16x16x32_bf16 v[52:55], a[40:43], v[168:171], v[52:55]
    ds_read_b64_tr_b16 a[72:73], v26 offset:16384
    ds_read_b64_tr_b16 a[74:75], v26 offset:20480
    v_mfma_f32_16x16x32_bf16 v[52:55], a[44:47], v[172:175], v[52:55]
    v_or3_b32 v14, v80, v81, v82
    v_cvt_pk_bf16_f32 v87, v246, v247
    v_mfma_f32_16x16x32_bf16 v[60:63], a[32:35], v[176:179], v[68:71]
    ds_read_b64_tr_b16 a[32:33], v27 offset:16384
    ds_read_b64_tr_b16 a[34:35], v27 offset:20480
    v_mfma_f32_16x16x32_bf16 v[60:63], a[36:39], v[180:183], v[60:63]
    v_or3_b32 v14, v14, v83, v84
    v_or3_b32 v14, v14, v85, v86
    v_mfma_f32_16x16x32_bf16 v[60:63], a[40:43], v[184:187], v[60:63]
    v_bitop3_b32 v14, v14, v87, s72 bitop3:0xa8
    v_cmp_ne_u32 vcc, 0, v14
    v_mfma_f32_16x16x32_bf16 v[60:63], a[44:47], v[188:191], v[60:63]
    s_cbranch_vccnz LA_r1_2
LA_b1_2:
    s_waitcnt lgkmcnt(0)
    s_barrier
    v_mfma_f32_16x16x32_bf16 v[96:99], a[48:51], v[80:83], v[96:99]
    ds_read_b128 a[36:39], v16 offset:32768
    ds_read_b128 a[40:43], v17 offset:32768
    ds_read_b128 a[44:47], v18 offset:32768
    s_add_u32 m0, s78, 73728
    s_mov_b32 s9, 73728
    buffer_load_dwordx4 v10, s[48:51], s9 offen nt lds
    v_mfma_f32_16x16x32_bf16 v[100:103], a[48:51], v[84:87], v[100:103]
    ds_read_b128 a[48:51], v19 offset:32768
    v_mfma_f32_16x16x32_bf16 v[104:107], a[52:55], v[80:83], v[104:107]
    buffer_load_dwordx4 v5, s[48:51], s9 offen offset:1024 nt lds
    v_exp_f32 v244, v48
    v_mfma_f32_16x16x32_bf16 v[108:111], a[52:55], v[84:87], v[108:111]
    ds_read_b128 a[52:55], v16 offset:36864
    v_exp_f32 v245, v49
    v_mfma_f32_16x16x32_bf16 v[112:115], a[56:59], v[80:83], v[112:115]
    s_add_u32 m0, s78, 24576
    s_mov_b32 s9, 90112
    buffer_load_dwordx4 v8, s[44:47], s9 offen nt lds
    v_mfma_f32_16x16x32_bf16 v[116:119], a[56:59], v[84:87], v[116:119]
    ds_read_b128 a[56:59], v17 offset:36864
    v_exp_f32 v246, v50
    v_mfma_f32_16x16x32_bf16 v[120:123], a[60:63], v[80:83], v[120:123]
    buffer_load_dwordx4 v9, s[44:47], s9 offen offset:1024 nt lds
    v_cvt_pk_bf16_f32 v88, v244, v245
    v_mfma_f32_16x16x32_bf16 v[124:127], a[60:63], v[84:87], v[124:127]
    ds_read_b128 a[60:63], v18 offset:36864
    v_exp_f32 v247, v51
    v_mfma_f32_16x16x32_bf16 v[128:131], a[64:67], v[80:83], v[128:131]
    v_exp_f32 v244, v52
    v_mfma_f32_16x16x32_bf16 v[132:135], a[64:67], v[84:87], v[132:135]
    ds_read_b128 a[64:67], v19 offset:36864
    v_cvt_pk_bf16_f32 v89, v246, v247
    v_mfma_f32_16x16x32_bf16 v[136:139], a[68:71], v[80:83], v[136:139]
    v_exp_f32 v245, v53
    v_mfma_f32_16x16x32_bf16 v[140:143], a[68:71], v[84:87], v[140:143]
    ds_read_b64_tr_b16 a[68:69], v20 offset:24576
    ds_read_b64_tr_b16 a[70:71], v20 offset:28672
    v_mfma_f32_16x16x32_bf16 v[144:147], a[72:75], v[80:83], v[144:147]
    v_exp_f32 v246, v54
    v_mfma_f32_16x16x32_bf16 v[148:151], a[72:75], v[84:87], v[148:151]
    ds_read_b64_tr_b16 a[72:73], v21 offset:24576
    ds_read_b64_tr_b16 a[74:75], v21 offset:28672
    v_mfma_f32_16x16x32_bf16 v[152:155], a[32:35], v[80:83], v[152:155]
    v_cvt_pk_bf16_f32 v90, v244, v245
    v_exp_f32 v247, v55
    v_mfma_f32_16x16x32_bf16 v[156:159], a[32:35], v[84:87], v[156:159]
    ds_read_b64_tr_b16 a[32:33], v22 offset:24576
    ds_read_b64_tr_b16 a[34:35], v22 offset:28672
    v_mfma_f32_16x16x32_bf16 v[76:79], a[76:79], v[80:83], v[76:79]
    v_exp_f32 v244, v56
    v_mfma_f32_16x16x32_bf16 v[240:243], a[76:79], v[84:87], v[240:243]
    v_cvt_pk_bf16_f32 v91, v246, v247
    v_exp_f32 v245, v57
    s_waitcnt lgkmcnt(6)
    v_mfma_f32_16x16x32_bf16 v[32:35], a[36:39], v[160:163], v[64:67]
    v_exp_f32 v246, v58
    v_mfma_f32_16x16x32_bf16 v[32:35], a[40:43], v[164:167], v[32:35]
    v_cvt_pk_bf16_f32 v92, v244, v245
    v_exp_f32 v247, v59
    v_mfma_f32_16x16x32_bf16 v[32:35], a[44:47], v[168:171], v[32:35]
    v_exp_f32 v244, v60
    v_mfma_f32_16x16x32_bf16 v[32:35], a[48:51], v[172:175], v[32:35]
    v_cvt_pk_bf16_f32 v93, v246, v247
    v_exp_f32 v245, v61
    v_mfma_f32_16x16x32_bf16 v[40:43], a[36:39], v[176:179], v[68:71]
    ds_read_b64_tr_b16 a[36:37], v23 offset:24576
    ds_read_b64_tr_b16 a[38:39], v23 offset:28672
    v_mfma_f32_16x16x32_bf16 v[40:43], a[40:43], v[180:183], v[40:43]
    v_exp_f32 v246, v62
    v_mfma_f32_16x16x32_bf16 v[40:43], a[44:47], v[184:187], v[40:43]
    ds_read_b64_tr_b16 a[40:41], v24 offset:24576
    ds_read_b64_tr_b16 a[42:43], v24 offset:28672
    v_cvt_pk_bf16_f32 v94, v244, v245
    v_mfma_f32_16x16x32_bf16 v[40:43], a[48:51], v[188:191], v[40:43]
    v_exp_f32 v247, v63
    v_mfma_f32_16x16x32_bf16 v[36:39], a[52:55], v[160:163], v[64:67]
    ds_read_b64_tr_b16 a[44:45], v25 offset:24576
    ds_read_b64_tr_b16 a[46:47], v25 offset:28672
    v_or3_b32 v14, v88, v89, v90
    v_mfma_f32_16x16x32_bf16 v[36:39], a[56:59], v[164:167], v[36:39]
    v_cvt_pk_bf16_f32 v95, v246, v247
    v_or3_b32 v14, v14, v91, v92
    v_mfma_f32_16x16x32_bf16 v[36:39], a[60:63], v[168:171], v[36:39]
    ds_read_b64_tr_b16 a[48:49], v26 offset:24576
    ds_read_b64_tr_b16 a[50:51], v26 offset:28672
    v_or3_b32 v14, v14, v93, v94
    v_mfma_f32_16x16x32_bf16 v[36:39], a[64:67], v[172:175], v[36:39]
    v_bitop3_b32 v14, v14, v95, s72 bitop3:0xa8
    v_cmp_ne_u32 vcc, 0, v14
    v_mfma_f32_16x16x32_bf16 v[44:47], a[52:55], v[176:179], v[68:71]
    ds_read_b64_tr_b16 a[52:53], v27 offset:24576
    ds_read_b64_tr_b16 a[54:55], v27 offset:28672
    s_add_u32 m0, s79, 147456
    s_add_u32 s82, s81, 40960
    s_and_b32 s82, s82, 0x7ffff
    buffer_load_dwordx4 v252, s[56:59], s82 offen lds
    v_mfma_f32_16x16x32_bf16 v[44:47], a[56:59], v[180:183], v[44:47]
    buffer_load_dwordx4 v253, s[56:59], s82 offen offset:1024 lds
    v_mfma_f32_16x16x32_bf16 v[44:47], a[60:63], v[184:187], v[44:47]
    v_mfma_f32_16x16x32_bf16 v[44:47], a[64:67], v[188:191], v[44:47]
    s_cbranch_vccnz LA_r1_3
LA_b1_3:
    s_waitcnt lgkmcnt(0)
    s_barrier
    buffer_load_dword v6, v248, s[64:67], 0 offen sc1
    v_mfma_f32_16x16x32_bf16 v[96:99], a[68:71], v[88:91], v[96:99]
    ds_read_b128 a[56:59], v16 offset:40960
    ds_read_b128 a[60:63], v17 offset:40960
    ds_read_b128 a[64:67], v18 offset:40960
    s_add_u32 m0, s78, 81920
    s_mov_b32 s9, 81920
    buffer_load_dwordx4 v10, s[48:51], s9 offen nt lds
    v_mfma_f32_16x16x32_bf16 v[100:103], a[68:71], v[92:95], v[100:103]
    ds_read_b128 a[68:71], v19 offset:40960
    v_mfma_f32_16x16x32_bf16 v[104:107], a[72:75], v[88:91], v[104:107]
    buffer_load_dwordx4 v5, s[48:51], s9 offen offset:1024 nt lds
    s_waitcnt vmcnt(9)
    ds_read_b64_tr_b16 a[112:113], v28 offset:32768
    v_mfma_f32_16x16x32_bf16 v[108:111], a[72:75], v[92:95], v[108:111]
    ds_read_b128 a[72:75], v16 offset:45056
    v_exp_f32 v244, v32
    v_mfma_f32_16x16x32_bf16 v[112:115], a[32:35], v[88:91], v[112:115]
    s_add_u32 m0, s78, 32768
    s_mov_b32 s9, 98304
    buffer_load_dwordx4 v8, s[44:47], s9 offen nt lds
    ds_read_b64_tr_b16 a[114:115], v28 offset:34816
    v_mfma_f32_16x16x32_bf16 v[116:119], a[32:35], v[92:95], v[116:119]
    ds_read_b128 a[32:35], v17 offset:45056
    v_exp_f32 v245, v33
    v_mfma_f32_16x16x32_bf16 v[120:123], a[36:39], v[88:91], v[120:123]
    buffer_load_dwordx4 v9, s[44:47], s9 offen offset:1024 nt lds
    ds_read_b64_tr_b16 a[116:117], v29 offset:32768
    ds_read_b64_tr_b16 a[118:119], v29 offset:34816
    v_mfma_f32_16x16x32_bf16 v[124:127], a[36:39], v[92:95], v[124:127]
    ds_read_b128 a[36:39], v18 offset:45056
    v_exp_f32 v246, v34
    v_mfma_f32_16x16x32_bf16 v[128:131], a[40:43], v[88:91], v[128:131]
    ds_read_b64_tr_b16 a[120:121], v30 offset:32768
    ds_read_b64_tr_b16 a[122:123], v30 offset:34816
    v_cvt_pk_bf16_f32 v80, v244, v245
    v_mfma_f32_16x16x32_bf16 v[132:135], a[40:43], v[92:95], v[132:135]
    ds_read_b128 a[40:43], v19 offset:45056
    v_exp_f32 v247, v35
    v_mfma_f32_16x16x32_bf16 v[136:139], a[44:47], v[88:91], v[136:139]
    ds_read_b64_tr_b16 a[124:125], v31 offset:32768
    ds_read_b64_tr_b16 a[126:127], v31 offset:34816
    v_mfma_f32_16x16x32_bf16 v[140:143], a[44:47], v[92:95], v[140:143]
    ds_read_b64_tr_b16 a[44:45], v20 offset:32768
    ds_read_b64_tr_b16 a[46:47], v20 offset:36864
    v_mfma_f32_16x16x32_bf16 v[144:147], a[48:51], v[88:91], v[144:147]
    v_exp_f32 v244, v36
    v_cvt_pk_bf16_f32 v81, v246, v247
    v_mfma_f32_16x16x32_bf16 v[148:151], a[48:51], v[92:95], v[148:151]
    ds_read_b64_tr_b16 a[48:49], v21 offset:32768
    ds_read_b64_tr_b16 a[50:51], v21 offset:36864
    v_mfma_f32_16x16x32_bf16 v[152:155], a[52:55], v[88:91], v[152:155]
    v_exp_f32 v245, v37
    v_mfma_f32_16x16x32_bf16 v[156:159], a[52:55], v[92:95], v[156:159]
    ds_read_b64_tr_b16 a[52:53], v22 offset:32768
    ds_read_b64_tr_b16 a[54:55], v22 offset:36864
    v_mfma_f32_16x16x32_bf16 v[76:79], a[76:79], v[88:91], v[76:79]
    v_exp_f32 v246, v38
    v_cvt_pk_bf16_f32 v82, v244, v245
    v_mfma_f32_16x16x32_bf16 v[240:243], a[76:79], v[92:95], v[240:243]
    v_exp_f32 v247, v39
    s_waitcnt lgkmcnt(8)
    v_mfma_f32_16x16x32_bf16 v[48:51], a[56:59], v[160:163], v[64:67]
    v_exp_f32 v244, v40
    v_cvt_pk_bf16_f32 v83, v246, v247
    v_mfma_f32_16x16x32_bf16 v[48:51], a[60:63], v[164:167], v[48:51]
    v_exp_f32 v245, v41
    v_mfma_f32_16x16x32_bf16 v[48:51], a[64:67], v[168:171], v[48:51]
    v_exp_f32 v246, v42
    v_cvt_pk_bf16_f32 v84, v244, v245
    v_mfma_f32_16x16x32_bf16 v[48:51], a[68:71], v[172:175], v[48:51]
    v_exp_f32 v247, v43
    v_mfma_f32_16x16x32_bf16 v[56:59], a[56:59], v[176:179], v[68:71]
    ds_read_b64_tr_b16 a[56:57], v23 offset:32768
    ds_read_b64_tr_b16 a[58:59], v23 offset:36864
    v_mfma_f32_16x16x32_bf16 v[56:59], a[60:63], v[180:183], v[56:59]
    v_exp_f32 v244, v44
    v_cvt_pk_bf16_f32 v85, v246, v247
    v_mfma_f32_16x16x32_bf16 v[56:59], a[64:67], v[184:187], v[56:59]
    ds_read_b64_tr_b16 a[60:61], v24 offset:32768
    ds_read_b64_tr_b16 a[62:63], v24 offset:36864
    v_mfma_f32_16x16x32_bf16 v[56:59], a[68:71], v[188:191], v[56:59]
    v_exp_f32 v245, v45
    v_mfma_f32_16x16x32_bf16 v[52:55], a[72:75], v[160:163], v[64:67]
    ds_read_b64_tr_b16 a[64:65], v25 offset:32768
    ds_read_b64_tr_b16 a[66:67], v25 offset:36864
    v_mfma_f32_16x16x32_bf16 v[52:55], a[32:35], v[164:167], v[52:55]
    v_exp_f32 v246, v46
    v_cvt_pk_bf16_f32 v86, v244, v245
    v_mfma_f32_16x16x32_bf16 v[52:55], a[36:39], v[168:171], v[52:55]
    ds_read_b64_tr_b16 a[68:69], v26 offset:32768
    ds_read_b64_tr_b16 a[70:71], v26 offset:36864
    v_exp_f32 v247, v47
    v_mfma_f32_16x16x32_bf16 v[52:55], a[40:43], v[172:175], v[52:55]
    v_or3_b32 v14, v80, v81, v82
    v_cvt_pk_bf16_f32 v87, v246, v247
    v_or3_b32 v14, v14, v83, v84
    v_mfma_f32_16x16x32_bf16 v[60:63], a[72:75], v[176:179], v[68:71]
    ds_read_b64_tr_b16 a[72:73], v27 offset:32768
    ds_read_b64_tr_b16 a[74:75], v27 offset:36864
    s_add_u32 m0, s79, 147456
    s_nop 0
    buffer_load_dwordx4 v254, s[56:59], s82 offen offset:2048 lds
    v_mfma_f32_16x16x32_bf16 v[60:63], a[32:35], v[180:183], v[60:63]
    buffer_load_dwordx4 v255, s[56:59], s82 offen offset:3072 lds
    v_or3_b32 v14, v14, v85, v86
    v_mfma_f32_16x16x32_bf16 v[60:63], a[36:39], v[184:187], v[60:63]
    v_bitop3_b32 v14, v14, v87, s72 bitop3:0xa8
    v_cmp_ne_u32 vcc, 0, v14
    v_mfma_f32_16x16x32_bf16 v[60:63], a[40:43], v[188:191], v[60:63]
    s_cbranch_vccnz LA_r1_4
LA_b1_4:
    s_waitcnt lgkmcnt(0)
    s_barrier
    v_mfma_f32_16x16x32_bf16 v[96:99], a[44:47], v[80:83], v[96:99]
    ds_read_b128 a[32:35], v16 offset:49152
    ds_read_b128 a[36:39], v17 offset:49152
    ds_read_b128 a[40:43], v18 offset:49152
    s_add_u32 m0, s78, 90112
    s_mov_b32 s9, 90112
    buffer_load_dwordx4 v10, s[48:51], s9 offen nt lds
    v_mfma_f32_16x16x32_bf16 v[100:103], a[44:47], v[84:87], v[100:103]
    ds_read_b128 a[44:47], v19 offset:49152
    v_mfma_f32_16x16x32_bf16 v[104:107], a[48:51], v[80:83], v[104:107]
    buffer_load_dwordx4 v5, s[48:51], s9 offen offset:1024 nt lds
    v_exp_f32 v244, v48
    v_mfma_f32_16x16x32_bf16 v[108:111], a[48:51], v[84:87], v[108:111]
    ds_read_b128 a[48:51], v16 offset:53248
    v_exp_f32 v245, v49
    v_mfma_f32_16x16x32_bf16 v[112:115], a[52:55], v[80:83], v[112:115]
    s_add_u32 m0, s79, 131072
    s_add_u32 s82, s81, 65536
    s_and_b32 s82, s82, 0x7ffff
    buffer_load_dwordx4 v252, s[56:59], s82 offen lds
    v_mfma_f32_16x16x32_bf16 v[116:119], a[52:55], v[84:87], v[116:119]
    ds_read_b128 a[52:55], v17 offset:53248
    v_exp_f32 v246, v50
    v_mfma_f32_16x16x32_bf16 v[120:123], a[56:59], v[80:83], v[120:123]
    buffer_load_dwordx4 v253, s[56:59], s82 offen offset:1024 lds
    v_cvt_pk_bf16_f32 v88, v244, v245
    v_mfma_f32_16x16x32_bf16 v[124:127], a[56:59], v[84:87], v[124:127]
    ds_read_b128 a[56:59], v18 offset:53248
    v_exp_f32 v247, v51
    v_mfma_f32_16x16x32_bf16 v[128:131], a[60:63], v[80:83], v[128:131]
    v_exp_f32 v244, v52
    v_mfma_f32_16x16x32_bf16 v[132:135], a[60:63], v[84:87], v[132:135]
    ds_read_b128 a[60:63], v19 offset:53248
    v_cvt_pk_bf16_f32 v89, v246, v247
    v_mfma_f32_16x16x32_bf16 v[136:139], a[64:67], v[80:83], v[136:139]
    v_exp_f32 v245, v53
    v_mfma_f32_16x16x32_bf16 v[140:143], a[64:67], v[84:87], v[140:143]
    ds_read_b64_tr_b16 a[64:65], v20 offset:40960
    ds_read_b64_tr_b16 a[66:67], v20 offset:45056
    v_mfma_f32_16x16x32_bf16 v[144:147], a[68:71], v[80:83], v[144:147]
    v_exp_f32 v246, v54
    v_mfma_f32_16x16x32_bf16 v[148:151], a[68:71], v[84:87], v[148:151]
    ds_read_b64_tr_b16 a[68:69], v21 offset:40960
    ds_read_b64_tr_b16 a[70:71], v21 offset:45056
    v_mfma_f32_16x16x32_bf16 v[152:155], a[72:75], v[80:83], v[152:155]
    v_cvt_pk_bf16_f32 v90, v244, v245
    v_exp_f32 v247, v55
    v_mfma_f32_16x16x32_bf16 v[156:159], a[72:75], v[84:87], v[156:159]
    ds_read_b64_tr_b16 a[72:73], v22 offset:40960
    ds_read_b64_tr_b16 a[74:75], v22 offset:45056
    v_mfma_f32_16x16x32_bf16 v[76:79], a[76:79], v[80:83], v[76:79]
    v_exp_f32 v244, v56
    v_mfma_f32_16x16x32_bf16 v[240:243], a[76:79], v[84:87], v[240:243]
    v_cvt_pk_bf16_f32 v91, v246, v247
    v_exp_f32 v245, v57
    s_waitcnt lgkmcnt(6)
    v_mfma_f32_16x16x32_bf16 v[32:35], a[32:35], v[160:163], v[64:67]
    v_exp_f32 v246, v58
    v_mfma_f32_16x16x32_bf16 v[32:35], a[36:39], v[164:167], v[32:35]
    v_cvt_pk_bf16_f32 v92, v244, v245
    v_exp_f32 v247, v59
    v_mfma_f32_16x16x32_bf16 v[32:35], a[40:43], v[168:171], v[32:35]
    v_exp_f32 v244, v60
    v_mfma_f32_16x16x32_bf16 v[32:35], a[44:47], v[172:175], v[32:35]
    v_cvt_pk_bf16_f32 v93, v246, v247
    v_exp_f32 v245, v61
    v_mfma_f32_16x16x32_bf16 v[40:43], a[32:35], v[176:179], v[68:71]
    ds_read_b64_tr_b16 a[32:33], v23 offset:40960
    ds_read_b64_tr_b16 a[34:35], v23 offset:45056
    v_mfma_f32_16x16x32_bf16 v[40:43], a[36:39], v[180:183], v[40:43]
    v_exp_f32 v246, v62
    v_mfma_f32_16x16x32_bf16 v[40:43], a[40:43], v[184:187], v[40:43]
    ds_read_b64_tr_b16 a[36:37], v24 offset:40960
    ds_read_b64_tr_b16 a[38:39], v24 offset:45056
    v_mfma_f32_16x16x32_bf16 v[40:43], a[44:47], v[188:191], v[40:43]
    v_cvt_pk_bf16_f32 v94, v244, v245
    v_mfma_f32_16x16x32_bf16 v[36:39], a[48:51], v[160:163], v[64:67]
    ds_read_b64_tr_b16 a[40:41], v25 offset:40960
    ds_read_b64_tr_b16 a[42:43], v25 offset:45056
    v_mfma_f32_16x16x32_bf16 v[36:39], a[52:55], v[164:167], v[36:39]
    v_exp_f32 v247, v63
    v_mfma_f32_16x16x32_bf16 v[36:39], a[56:59], v[168:171], v[36:39]
    ds_read_b64_tr_b16 a[44:45], v26 offset:40960
    ds_read_b64_tr_b16 a[46:47], v26 offset:45056
    v_mfma_f32_16x16x32_bf16 v[36:39], a[60:63], v[172:175], v[36:39]
    v_or3_b32 v14, v88, v89, v90
    v_cvt_pk_bf16_f32 v95, v246, v247
    v_mfma_f32_16x16x32_bf16 v[44:47], a[48:51], v[176:179], v[68:71]
    ds_read_b64_tr_b16 a[48:49], v27 offset:40960
    ds_read_b64_tr_b16 a[50:51], v27 offset:45056
    v_mfma_f32_16x16x32_bf16 v[44:47], a[52:55], v[180:183], v[44:47]
    v_or3_b32 v14, v14, v91, v92
    v_or3_b32 v14, v14, v93, v94
    v_mfma_f32_16x16x32_bf16 v[44:47], a[56:59], v[184:187], v[44:47]
    v_bitop3_b32 v14, v14, v95, s72 bitop3:0xa8
    v_cmp_ne_u32 vcc, 0, v14
    v_mfma_f32_16x16x32_bf16 v[44:47], a[60:63], v[188:191], v[44:47]
    s_cbranch_vccnz LA_r1_5
LA_b1_5:
    s_waitcnt lgkmcnt(0)
    s_barrier
    v_mfma_f32_16x16x32_bf16 v[96:99], a[64:67], v[88:91], v[96:99]
    ds_read_b128 a[52:55], v16 offset:57344
    ds_read_b128 a[56:59], v17 offset:57344
    ds_read_b128 a[60:63], v18 offset:57344
    s_add_u32 m0, s78, 40960
    s_mov_b32 s9, 106496
    buffer_load_dwordx4 v8, s[44:47], s9 offen nt lds
    v_mfma_f32_16x16x32_bf16 v[100:103], a[64:67], v[92:95], v[100:103]
    ds_read_b128 a[64:67], v19 offset:57344
    v_mfma_f32_16x16x32_bf16 v[104:107], a[68:71], v[88:91], v[104:107]
    buffer_load_dwordx4 v9, s[44:47], s9 offen offset:1024 nt lds
    s_waitcnt vmcnt(6)
    ds_read_b64_tr_b16 a[128:129], v28 offset:49152
    v_mfma_f32_16x16x32_bf16 v[108:111], a[68:71], v[92:95], v[108:111]
    ds_read_b128 a[68:71], v16 offset:61440
    v_exp_f32 v244, v32
    v_mfma_f32_16x16x32_bf16 v[112:115], a[72:75], v[88:91], v[112:115]
    s_add_u32 m0, s78, 98304
    s_mov_b32 s9, 98304
    buffer_load_dwordx4 v10, s[48:51], s9 offen nt lds
    ds_read_b64_tr_b16 a[130:131], v28 offset:51200
    v_mfma_f32_16x16x32_bf16 v[116:119], a[72:75], v[92:95], v[116:119]
    ds_read_b128 a[72:75], v17 offset:61440
    v_exp_f32 v245, v33
    v_mfma_f32_16x16x32_bf16 v[120:123], a[32:35], v[88:91], v[120:123]
    buffer_load_dwordx4 v5, s[48:51], s9 offen offset:1024 nt lds
    ds_read_b64_tr_b16 a[132:133], v29 offset:49152
    ds_read_b64_tr_b16 a[134:135], v29 offset:51200
    v_mfma_f32_16x16x32_bf16 v[124:127], a[32:35], v[92:95], v[124:127]
    ds_read_b128 a[32:35], v18 offset:61440
    v_exp_f32 v246, v34
    v_mfma_f32_16x16x32_bf16 v[128:131], a[36:39], v[88:91], v[128:131]
    ds_read_b64_tr_b16 a[136:137], v30 offset:49152
    ds_read_b64_tr_b16 a[138:139], v30 offset:51200
    v_cvt_pk_bf16_f32 v80, v244, v245
    v_mfma_f32_16x16x32_bf16 v[132:135], a[36:39], v[92:95], v[132:135]
    ds_read_b128 a[36:39], v19 offset:61440
    v_exp_f32 v247, v35
    v_mfma_f32_16x16x32_bf16 v[136:139], a[40:43], v[88:91], v[136:139]
    ds_read_b64_tr_b16 a[140:141], v31 offset:49152
    ds_read_b64_tr_b16 a[142:143], v31 offset:51200
    v_mfma_f32_16x16x32_bf16 v[140:143], a[40:43], v[92:95], v[140:143]
    ds_read_b64_tr_b16 a[40:41], v20 offset:49152
    ds_read_b64_tr_b16 a[42:43], v20 offset:53248
    v_mfma_f32_16x16x32_bf16 v[144:147], a[44:47], v[88:91], v[144:147]
    v_exp_f32 v244, v36
    v_cvt_pk_bf16_f32 v81, v246, v247
    v_mfma_f32_16x16x32_bf16 v[148:151], a[44:47], v[92:95], v[148:151]
    ds_read_b64_tr_b16 a[44:45], v21 offset:49152
    ds_read_b64_tr_b16 a[46:47], v21 offset:53248
    v_mfma_f32_16x16x32_bf16 v[152:155], a[48:51], v[88:91], v[152:155]
    v_exp_f32 v245, v37
    v_mfma_f32_16x16x32_bf16 v[156:159], a[48:51], v[92:95], v[156:159]
    ds_read_b64_tr_b16 a[48:49], v22 offset:49152
    ds_read_b64_tr_b16 a[50:51], v22 offset:53248
    v_mfma_f32_16x16x32_bf16 v[76:79], a[76:79], v[88:91], v[76:79]
    v_exp_f32 v246, v38
    v_cvt_pk_bf16_f32 v82, v244, v245
    v_mfma_f32_16x16x32_bf16 v[240:243], a[76:79], v[92:95], v[240:243]
    v_exp_f32 v247, v39
    s_waitcnt lgkmcnt(8)
    v_mfma_f32_16x16x32_bf16 v[48:51], a[52:55], v[160:163], v[64:67]
    v_exp_f32 v244, v40
    v_cvt_pk_bf16_f32 v83, v246, v247
    v_mfma_f32_16x16x32_bf16 v[48:51], a[56:59], v[164:167], v[48:51]
    v_exp_f32 v245, v41
    v_mfma_f32_16x16x32_bf16 v[48:51], a[60:63], v[168:171], v[48:51]
    v_exp_f32 v246, v42
    v_cvt_pk_bf16_f32 v84, v244, v245
    v_mfma_f32_16x16x32_bf16 v[48:51], a[64:67], v[172:175], v[48:51]
    v_exp_f32 v247, v43
    v_mfma_f32_16x16x32_bf16 v[56:59], a[52:55], v[176:179], v[68:71]
    ds_read_b64_tr_b16 a[52:53], v23 offset:49152
    ds_read_b64_tr_b16 a[54:55], v23 offset:53248
    v_mfma_f32_16x16x32_bf16 v[56:59], a[56:59], v[180:183], v[56:59]
    v_exp_f32 v244, v44
    v_cvt_pk_bf16_f32 v85, v246, v247
    v_mfma_f32_16x16x32_bf16 v[56:59], a[60:63], v[184:187], v[56:59]
    ds_read_b64_tr_b16 a[56:57], v24 offset:49152
    ds_read_b64_tr_b16 a[58:59], v24 offset:53248
    v_mfma_f32_16x16x32_bf16 v[56:59], a[64:67], v[188:191], v[56:59]
    v_exp_f32 v245, v45
    v_mfma_f32_16x16x32_bf16 v[52:55], a[68:71], v[160:163], v[64:67]
    ds_read_b64_tr_b16 a[60:61], v25 offset:49152
    ds_read_b64_tr_b16 a[62:63], v25 offset:53248
    v_mfma_f32_16x16x32_bf16 v[52:55], a[72:75], v[164:167], v[52:55]
    v_exp_f32 v246, v46
    v_cvt_pk_bf16_f32 v86, v244, v245
    v_mfma_f32_16x16x32_bf16 v[52:55], a[32:35], v[168:171], v[52:55]
    ds_read_b64_tr_b16 a[64:65], v26 offset:49152
    ds_read_b64_tr_b16 a[66:67], v26 offset:53248
    v_exp_f32 v247, v47
    v_mfma_f32_16x16x32_bf16 v[52:55], a[36:39], v[172:175], v[52:55]
    v_or3_b32 v14, v80, v81, v82
    v_cvt_pk_bf16_f32 v87, v246, v247
    v_or3_b32 v14, v14, v83, v84
    v_mfma_f32_16x16x32_bf16 v[60:63], a[68:71], v[176:179], v[68:71]
    ds_read_b64_tr_b16 a[68:69], v27 offset:49152
    ds_read_b64_tr_b16 a[70:71], v27 offset:53248
    s_add_u32 m0, s79, 131072
    s_nop 0
    buffer_load_dwordx4 v254, s[56:59], s82 offen offset:2048 lds
    v_mfma_f32_16x16x32_bf16 v[60:63], a[72:75], v[180:183], v[60:63]
    buffer_load_dwordx4 v255, s[56:59], s82 offen offset:3072 lds
    v_or3_b32 v14, v14, v85, v86
    v_mfma_f32_16x16x32_bf16 v[60:63], a[32:35], v[184:187], v[60:63]
    v_bitop3_b32 v14, v14, v87, s72 bitop3:0xa8
    v_cmp_ne_u32 vcc, 0, v14
    v_mfma_f32_16x16x32_bf16 v[60:63], a[36:39], v[188:191], v[60:63]
    s_cbranch_vccnz LA_r1_6
LA_b1_6:
    s_waitcnt lgkmcnt(0)
    s_barrier
    v_mfma_f32_16x16x32_bf16 v[96:99], a[40:43], v[80:83], v[96:99]
    ds_read_b128 a[72:75], v16 offset:0
    ds_read_b128 a[32:35], v17 offset:0
    ds_read_b128 a[36:39], v18 offset:0
    s_add_u32 m0, s78, 49152
    s_mov_b32 s9, 114688
    buffer_load_dwordx4 v8, s[44:47], s9 offen nt lds
    v_mfma_f32_16x16x32_bf16 v[100:103], a[40:43], v[84:87], v[100:103]
    ds_read_b128 a[40:43], v19 offset:0
    v_mfma_f32_16x16x32_bf16 v[104:107], a[44:47], v[80:83], v[104:107]
    buffer_load_dwordx4 v9, s[44:47], s9 offen offset:1024 nt lds
    v_exp_f32 v244, v48
    v_mfma_f32_16x16x32_bf16 v[108:111], a[44:47], v[84:87], v[108:111]
    ds_read_b128 a[44:47], v16 offset:4096
    v_exp_f32 v245, v49
    v_mfma_f32_16x16x32_bf16 v[112:115], a[48:51], v[80:83], v[112:115]
    s_add_u32 m0, s78, 106496
    s_mov_b32 s9, 106496
    buffer_load_dwordx4 v10, s[48:51], s9 offen nt lds
    v_mfma_f32_16x16x32_bf16 v[116:119], a[48:51], v[84:87], v[116:119]
    ds_read_b128 a[48:51], v17 offset:4096
    v_exp_f32 v246, v50
    v_mfma_f32_16x16x32_bf16 v[120:123], a[52:55], v[80:83], v[120:123]
    buffer_load_dwordx4 v5, s[48:51], s9 offen offset:1024 nt lds
    v_cvt_pk_bf16_f32 v88, v244, v245
    v_mfma_f32_16x16x32_bf16 v[124:127], a[52:55], v[84:87], v[124:127]
    ds_read_b128 a[52:55], v18 offset:4096
    v_exp_f32 v247, v51
    v_mfma_f32_16x16x32_bf16 v[128:131], a[56:59], v[80:83], v[128:131]
    v_exp_f32 v244, v52
    v_mfma_f32_16x16x32_bf16 v[132:135], a[56:59], v[84:87], v[132:135]
    ds_read_b128 a[56:59], v19 offset:4096
    v_cvt_pk_bf16_f32 v89, v246, v247
    v_mfma_f32_16x16x32_bf16 v[136:139], a[60:63], v[80:83], v[136:139]
    v_exp_f32 v245, v53
    v_mfma_f32_16x16x32_bf16 v[140:143], a[60:63], v[84:87], v[140:143]
    ds_read_b64_tr_b16 a[60:61], v20 offset:57344
    ds_read_b64_tr_b16 a[62:63], v20 offset:61440
    v_mfma_f32_16x16x32_bf16 v[144:147], a[64:67], v[80:83], v[144:147]
    v_exp_f32 v246, v54
    v_mfma_f32_16x16x32_bf16 v[148:151], a[64:67], v[84:87], v[148:151]
    ds_read_b64_tr_b16 a[64:65], v21 offset:57344
    ds_read_b64_tr_b16 a[66:67], v21 offset:61440
    v_mfma_f32_16x16x32_bf16 v[152:155], a[68:71], v[80:83], v[152:155]
    v_cvt_pk_bf16_f32 v90, v244, v245
    v_exp_f32 v247, v55
    v_mfma_f32_16x16x32_bf16 v[156:159], a[68:71], v[84:87], v[156:159]
    ds_read_b64_tr_b16 a[68:69], v22 offset:57344
    ds_read_b64_tr_b16 a[70:71], v22 offset:61440
    v_mfma_f32_16x16x32_bf16 v[76:79], a[76:79], v[80:83], v[76:79]
    v_exp_f32 v244, v56
    v_mfma_f32_16x16x32_bf16 v[240:243], a[76:79], v[84:87], v[240:243]
    v_cvt_pk_bf16_f32 v91, v246, v247
    v_exp_f32 v245, v57
    s_waitcnt lgkmcnt(6)
    v_mfma_f32_16x16x32_bf16 v[32:35], a[72:75], v[160:163], v[64:67]
    v_exp_f32 v246, v58
    v_mfma_f32_16x16x32_bf16 v[32:35], a[32:35], v[164:167], v[32:35]
    v_cvt_pk_bf16_f32 v92, v244, v245
    v_exp_f32 v247, v59
    v_mfma_f32_16x16x32_bf16 v[32:35], a[36:39], v[168:171], v[32:35]
    v_exp_f32 v244, v60
    v_mfma_f32_16x16x32_bf16 v[32:35], a[40:43], v[172:175], v[32:35]
    v_cvt_pk_bf16_f32 v93, v246, v247
    v_exp_f32 v245, v61
    v_mfma_f32_16x16x32_bf16 v[40:43], a[72:75], v[176:179], v[68:71]
    ds_read_b64_tr_b16 a[72:73], v23 offset:57344
    ds_read_b64_tr_b16 a[74:75], v23 offset:61440
    v_mfma_f32_16x16x32_bf16 v[40:43], a[32:35], v[180:183], v[40:43]
    v_exp_f32 v246, v62
    v_mfma_f32_16x16x32_bf16 v[40:43], a[36:39], v[184:187], v[40:43]
    ds_read_b64_tr_b16 a[32:33], v24 offset:57344
    ds_read_b64_tr_b16 a[34:35], v24 offset:61440
    v_cvt_pk_bf16_f32 v94, v244, v245
    v_mfma_f32_16x16x32_bf16 v[40:43], a[40:43], v[188:191], v[40:43]
    v_exp_f32 v247, v63
    v_mfma_f32_16x16x32_bf16 v[36:39], a[44:47], v[160:163], v[64:67]
    ds_read_b64_tr_b16 a[36:37], v25 offset:57344
    ds_read_b64_tr_b16 a[38:39], v25 offset:61440
    v_or3_b32 v14, v88, v89, v90
    v_mfma_f32_16x16x32_bf16 v[36:39], a[48:51], v[164:167], v[36:39]
    v_cvt_pk_bf16_f32 v95, v246, v247
    v_or3_b32 v14, v14, v91, v92
    v_mfma_f32_16x16x32_bf16 v[36:39], a[52:55], v[168:171], v[36:39]
    ds_read_b64_tr_b16 a[40:41], v26 offset:57344
    ds_read_b64_tr_b16 a[42:43], v26 offset:61440
    v_or3_b32 v14, v14, v93, v94
    v_mfma_f32_16x16x32_bf16 v[36:39], a[56:59], v[172:175], v[36:39]
    v_bitop3_b32 v14, v14, v95, s72 bitop3:0xa8
    v_cmp_ne_u32 vcc, 0, v14
    v_mfma_f32_16x16x32_bf16 v[44:47], a[44:47], v[176:179], v[68:71]
    ds_read_b64_tr_b16 a[44:45], v27 offset:57344
    ds_read_b64_tr_b16 a[46:47], v27 offset:61440
    s_add_u32 m0, s79, 147456
    s_add_u32 s82, s81, 73728
    s_and_b32 s82, s82, 0x7ffff
    buffer_load_dwordx4 v252, s[56:59], s82 offen lds
    v_mfma_f32_16x16x32_bf16 v[44:47], a[48:51], v[180:183], v[44:47]
    buffer_load_dwordx4 v253, s[56:59], s82 offen offset:1024 lds
    v_mfma_f32_16x16x32_bf16 v[44:47], a[52:55], v[184:187], v[44:47]
    v_mfma_f32_16x16x32_bf16 v[44:47], a[56:59], v[188:191], v[44:47]
    s_cbranch_vccnz LA_r1_7
LA_b1_7:
    s_waitcnt lgkmcnt(0)
    s_barrier
    v_mfma_f32_16x16x32_bf16 v[96:99], a[60:63], v[88:91], v[96:99]
    ds_read_b128 a[48:51], v16 offset:8192
    ds_read_b128 a[52:55], v17 offset:8192
    ds_read_b128 a[56:59], v18 offset:8192
    s_add_u32 m0, s78, 0
    s_mov_b32 s9, 122880
    buffer_load_dwordx4 v8, s[44:47], s9 offen nt lds
    v_mfma_f32_16x16x32_bf16 v[100:103], a[60:63], v[92:95], v[100:103]
    ds_read_b128 a[60:63], v19 offset:8192
    v_mfma_f32_16x16x32_bf16 v[104:107], a[64:67], v[88:91], v[104:107]
    buffer_load_dwordx4 v9, s[44:47], s9 offen offset:1024 nt lds
    s_waitcnt vmcnt(8)
    ds_read_b64_tr_b16 a[144:145], v28 offset:32768
    v_mfma_f32_16x16x32_bf16 v[108:111], a[64:67], v[92:95], v[108:111]
    ds_read_b128 a[64:67], v16 offset:12288
    v_exp_f32 v244, v32
    v_mfma_f32_16x16x32_bf16 v[112:115], a[68:71], v[88:91], v[112:115]
    s_add_u32 m0, s79, 147456
    s_nop 0
    buffer_load_dwordx4 v254, s[56:59], s82 offen offset:2048 lds
    ds_read_b64_tr_b16 a[146:147], v28 offset:34816
    v_mfma_f32_16x16x32_bf16 v[116:119], a[68:71], v[92:95], v[116:119]
    ds_read_b128 a[68:71], v17 offset:12288
    v_exp_f32 v245, v33
    v_mfma_f32_16x16x32_bf16 v[120:123], a[72:75], v[88:91], v[120:123]
    buffer_load_dwordx4 v255, s[56:59], s82 offen offset:3072 lds
    ds_read_b64_tr_b16 a[148:149], v29 offset:32768
    ds_read_b64_tr_b16 a[150:151], v29 offset:34816
    v_mfma_f32_16x16x32_bf16 v[124:127], a[72:75], v[92:95], v[124:127]
    ds_read_b128 a[72:75], v18 offset:12288
    v_exp_f32 v246, v34
    v_mfma_f32_16x16x32_bf16 v[128:131], a[32:35], v[88:91], v[128:131]
    ds_read_b64_tr_b16 a[152:153], v30 offset:32768
    ds_read_b64_tr_b16 a[154:155], v30 offset:34816
    v_cvt_pk_bf16_f32 v80, v244, v245
    v_mfma_f32_16x16x32_bf16 v[132:135], a[32:35], v[92:95], v[132:135]
    ds_read_b128 a[32:35], v19 offset:12288
    v_exp_f32 v247, v35
    v_mfma_f32_16x16x32_bf16 v[136:139], a[36:39], v[88:91], v[136:139]
    ds_read_b64_tr_b16 a[156:157], v31 offset:32768
    ds_read_b64_tr_b16 a[158:159], v31 offset:34816
    v_mfma_f32_16x16x32_bf16 v[140:143], a[36:39], v[92:95], v[140:143]
    ds_read_b64_tr_b16 a[36:37], v20 offset:0
    ds_read_b64_tr_b16 a[38:39], v20 offset:4096
    v_mfma_f32_16x16x32_bf16 v[144:147], a[40:43], v[88:91], v[144:147]
    v_exp_f32 v244, v36
    v_cvt_pk_bf16_f32 v81, v246, v247
    v_mfma_f32_16x16x32_bf16 v[148:151], a[40:43], v[92:95], v[148:151]
    ds_read_b64_tr_b16 a[40:41], v21 offset:0
    ds_read_b64_tr_b16 a[42:43], v21 offset:4096
    v_mfma_f32_16x16x32_bf16 v[152:155], a[44:47], v[88:91], v[152:155]
    v_exp_f32 v245, v37
    v_mfma_f32_16x16x32_bf16 v[156:159], a[44:47], v[92:95], v[156:159]
    ds_read_b64_tr_b16 a[44:45], v22 offset:0
    ds_read_b64_tr_b16 a[46:47], v22 offset:4096
    v_mfma_f32_16x16x32_bf16 v[76:79], a[76:79], v[88:91], v[76:79]
    v_exp_f32 v246, v38
    v_cvt_pk_bf16_f32 v82, v244, v245
    v_mfma_f32_16x16x32_bf16 v[240:243], a[76:79], v[92:95], v[240:243]
    v_exp_f32 v247, v39
    s_waitcnt lgkmcnt(8)
    v_mfma_f32_16x16x32_bf16 v[48:51], a[48:51], v[160:163], v[64:67]
    v_exp_f32 v244, v40
    v_cvt_pk_bf16_f32 v83, v246, v247
    v_mfma_f32_16x16x32_bf16 v[48:51], a[52:55], v[164:167], v[48:51]
    v_exp_f32 v245, v41
    v_mfma_f32_16x16x32_bf16 v[48:51], a[56:59], v[168:171], v[48:51]
    v_exp_f32 v246, v42
    v_cvt_pk_bf16_f32 v84, v244, v245
    v_mfma_f32_16x16x32_bf16 v[48:51], a[60:63], v[172:175], v[48:51]
    v_exp_f32 v247, v43
    v_mfma_f32_16x16x32_bf16 v[56:59], a[48:51], v[176:179], v[68:71]
    ds_read_b64_tr_b16 a[48:49], v23 offset:0
    ds_read_b64_tr_b16 a[50:51], v23 offset:4096
    v_mfma_f32_16x16x32_bf16 v[56:59], a[52:55], v[180:183], v[56:59]
    v_exp_f32 v244, v44
    v_cvt_pk_bf16_f32 v85, v246, v247
    v_mfma_f32_16x16x32_bf16 v[56:59], a[56:59], v[184:187], v[56:59]
    ds_read_b64_tr_b16 a[52:53], v24 offset:0
    ds_read_b64_tr_b16 a[54:55], v24 offset:4096
    v_mfma_f32_16x16x32_bf16 v[56:59], a[60:63], v[188:191], v[56:59]
    v_exp_f32 v245, v45
    v_mfma_f32_16x16x32_bf16 v[52:55], a[64:67], v[160:163], v[64:67]
    ds_read_b64_tr_b16 a[56:57], v25 offset:0
    ds_read_b64_tr_b16 a[58:59], v25 offset:4096
    v_exp_f32 v246, v46
    v_mfma_f32_16x16x32_bf16 v[52:55], a[68:71], v[164:167], v[52:55]
    v_cvt_pk_bf16_f32 v86, v244, v245
    v_exp_f32 v247, v47
    v_mfma_f32_16x16x32_bf16 v[52:55], a[72:75], v[168:171], v[52:55]
    ds_read_b64_tr_b16 a[60:61], v26 offset:0
    ds_read_b64_tr_b16 a[62:63], v26 offset:4096
    v_or3_b32 v14, v80, v81, v82
    v_mfma_f32_16x16x32_bf16 v[52:55], a[32:35], v[172:175], v[52:55]
    v_cvt_pk_bf16_f32 v87, v246, v247
    v_or3_b32 v14, v14, v83, v84
    v_or3_b32 v14, v14, v85, v86
    v_mfma_f32_16x16x32_bf16 v[60:63], a[64:67], v[176:179], v[68:71]
    ds_read_b64_tr_b16 a[64:65], v27 offset:0
    ds_read_b64_tr_b16 a[66:67], v27 offset:4096
    s_add_u32 m0, s79, 114688
    s_add_u32 s82, s81, 98304
    s_and_b32 s82, s82, 0x7ffff
    buffer_load_dwordx4 v252, s[56:59], s82 offen lds
    v_mfma_f32_16x16x32_bf16 v[60:63], a[68:71], v[180:183], v[60:63]
    v_bitop3_b32 v14, v14, v87, s72 bitop3:0xa8
    v_mfma_f32_16x16x32_bf16 v[60:63], a[72:75], v[184:187], v[60:63]
    v_cmp_ne_u32 vcc, 0, v14
    v_mfma_f32_16x16x32_bf16 v[60:63], a[32:35], v[188:191], v[60:63]
    s_cbranch_vccnz LA_r1_8
LA_b1_8:
    s_waitcnt lgkmcnt(0)
    s_barrier
    v_mfma_f32_16x16x32_bf16 v[96:99], a[36:39], v[80:83], v[96:99]
    ds_read_b128 a[68:71], v16 offset:16384
    ds_read_b128 a[72:75], v17 offset:16384
    ds_read_b128 a[32:35], v18 offset:16384
    s_add_u32 m0, s78, 65536
    s_mov_b32 s9, 114688
    buffer_load_dwordx4 v10, s[48:51], s9 offen nt lds
    v_mfma_f32_16x16x32_bf16 v[100:103], a[36:39], v[84:87], v[100:103]
    ds_read_b128 a[36:39], v19 offset:16384
    v_mfma_f32_16x16x32_bf16 v[104:107], a[40:43], v[80:83], v[104:107]
    buffer_load_dwordx4 v5, s[48:51], s9 offen offset:1024 nt lds
    v_exp_f32 v244, v48
    v_mfma_f32_16x16x32_bf16 v[108:111], a[40:43], v[84:87], v[108:111]
    ds_read_b128 a[40:43], v16 offset:20480
    v_exp_f32 v245, v49
    v_mfma_f32_16x16x32_bf16 v[112:115], a[44:47], v[80:83], v[112:115]
    s_add_u32 m0, s78, 8192
    s_mov_b32 s9, 131072
    buffer_load_dwordx4 v8, s[44:47], s9 offen nt lds
    v_mfma_f32_16x16x32_bf16 v[116:119], a[44:47], v[84:87], v[116:119]
    ds_read_b128 a[44:47], v17 offset:20480
    v_exp_f32 v246, v50
    v_mfma_f32_16x16x32_bf16 v[120:123], a[48:51], v[80:83], v[120:123]
    buffer_load_dwordx4 v9, s[44:47], s9 offen offset:1024 nt lds
    v_cvt_pk_bf16_f32 v88, v244, v245
    v_mfma_f32_16x16x32_bf16 v[124:127], a[48:51], v[84:87], v[124:127]
    ds_read_b128 a[48:51], v18 offset:20480
    v_exp_f32 v247, v51
    v_mfma_f32_16x16x32_bf16 v[128:131], a[52:55], v[80:83], v[128:131]
    v_exp_f32 v244, v52
    v_mfma_f32_16x16x32_bf16 v[132:135], a[52:55], v[84:87], v[132:135]
    ds_read_b128 a[52:55], v19 offset:20480
    v_cvt_pk_bf16_f32 v89, v246, v247
    v_mfma_f32_16x16x32_bf16 v[136:139], a[56:59], v[80:83], v[136:139]
    v_exp_f32 v245, v53
    v_mfma_f32_16x16x32_bf16 v[140:143], a[56:59], v[84:87], v[140:143]
    ds_read_b64_tr_b16 a[56:57], v20 offset:8192
    ds_read_b64_tr_b16 a[58:59], v20 offset:12288
    v_mfma_f32_16x16x32_bf16 v[144:147], a[60:63], v[80:83], v[144:147]
    v_exp_f32 v246, v54
    v_mfma_f32_16x16x32_bf16 v[148:151], a[60:63], v[84:87], v[148:151]
    ds_read_b64_tr_b16 a[60:61], v21 offset:8192
    ds_read_b64_tr_b16 a[62:63], v21 offset:12288
    v_mfma_f32_16x16x32_bf16 v[152:155], a[64:67], v[80:83], v[152:155]
    v_cvt_pk_bf16_f32 v90, v244, v245
    v_exp_f32 v247, v55
    v_mfma_f32_16x16x32_bf16 v[156:159], a[64:67], v[84:87], v[156:159]
    ds_read_b64_tr_b16 a[64:65], v22 offset:8192
    ds_read_b64_tr_b16 a[66:67], v22 offset:12288
    v_mfma_f32_16x16x32_bf16 v[76:79], a[76:79], v[80:83], v[76:79]
    v_exp_f32 v244, v56
    v_mfma_f32_16x16x32_bf16 v[240:243], a[76:79], v[84:87], v[240:243]
    v_cvt_pk_bf16_f32 v91, v246, v247
    v_exp_f32 v245, v57
    s_waitcnt lgkmcnt(6)
    v_mfma_f32_16x16x32_bf16 v[32:35], a[68:71], v[160:163], v[64:67]
    v_exp_f32 v246, v58
    v_mfma_f32_16x16x32_bf16 v[32:35], a[72:75], v[164:167], v[32:35]
    v_cvt_pk_bf16_f32 v92, v244, v245
    v_exp_f32 v247, v59
    v_mfma_f32_16x16x32_bf16 v[32:35], a[32:35], v[168:171], v[32:35]
    v_exp_f32 v244, v60
    v_mfma_f32_16x16x32_bf16 v[32:35], a[36:39], v[172:175], v[32:35]
    v_cvt_pk_bf16_f32 v93, v246, v247
    v_exp_f32 v245, v61
    v_mfma_f32_16x16x32_bf16 v[40:43], a[68:71], v[176:179], v[68:71]
    ds_read_b64_tr_b16 a[68:69], v23 offset:8192
    ds_read_b64_tr_b16 a[70:71], v23 offset:12288
    v_mfma_f32_16x16x32_bf16 v[40:43], a[72:75], v[180:183], v[40:43]
    v_exp_f32 v246, v62
    v_mfma_f32_16x16x32_bf16 v[40:43], a[32:35], v[184:187], v[40:43]
    ds_read_b64_tr_b16 a[72:73], v24 offset:8192
    ds_read_b64_tr_b16 a[74:75], v24 offset:12288
    v_mfma_f32_16x16x32_bf16 v[40:43], a[36:39], v[188:191], v[40:43]
    v_cvt_pk_bf16_f32 v94, v244, v245
    v_exp_f32 v247, v63
    v_mfma_f32_16x16x32_bf16 v[36:39], a[40:43], v[160:163], v[64:67]
    ds_read_b64_tr_b16 a[32:33], v25 offset:8192
    ds_read_b64_tr_b16 a[34:35], v25 offset:12288
    v_mfma_f32_16x16x32_bf16 v[36:39], a[44:47], v[164:167], v[36:39]
    v_or3_b32 v14, v88, v89, v90
    v_cvt_pk_bf16_f32 v95, v246, v247
    v_mfma_f32_16x16x32_bf16 v[36:39], a[48:51], v[168:171], v[36:39]
    ds_read_b64_tr_b16 a[36:37], v26 offset:8192
    ds_read_b64_tr_b16 a[38:39], v26 offset:12288
    v_mfma_f32_16x16x32_bf16 v[36:39], a[52:55], v[172:175], v[36:39]
    v_or3_b32 v14, v14, v91, v92
    v_or3_b32 v14, v14, v93, v94
    v_mfma_f32_16x16x32_bf16 v[44:47], a[40:43], v[176:179], v[68:71]
    ds_read_b64_tr_b16 a[40:41], v27 offset:8192
    ds_read_b64_tr_b16 a[42:43], v27 offset:12288
    s_add_u32 m0, s79, 114688
    s_nop 0
    buffer_load_dwordx4 v253, s[56:59], s82 offen offset:1024 lds
    v_mfma_f32_16x16x32_bf16 v[44:47], a[44:47], v[180:183], v[44:47]
    buffer_load_dwordx4 v254, s[56:59], s82 offen offset:2048 lds
    v_mfma_f32_16x16x32_bf16 v[44:47], a[48:51], v[184:187], v[44:47]
    v_bitop3_b32 v14, v14, v95, s72 bitop3:0xa8
    v_cmp_ne_u32 vcc, 0, v14
    v_mfma_f32_16x16x32_bf16 v[44:47], a[52:55], v[188:191], v[44:47]
    s_cbranch_vccnz LA_r1_9
LA_b1_9:
    s_waitcnt lgkmcnt(0)
    s_barrier
    v_mfma_f32_16x16x32_bf16 v[96:99], a[56:59], v[88:91], v[96:99]
    ds_read_b128 a[44:47], v16 offset:24576
    ds_read_b128 a[48:51], v17 offset:24576
    ds_read_b128 a[52:55], v18 offset:24576
    s_add_u32 m0, s78, 73728
    s_mov_b32 s9, 122880
    buffer_load_dwordx4 v10, s[48:51], s9 offen nt lds
    v_mfma_f32_16x16x32_bf16 v[100:103], a[56:59], v[92:95], v[100:103]
    ds_read_b128 a[56:59], v19 offset:24576
    v_mfma_f32_16x16x32_bf16 v[104:107], a[60:63], v[88:91], v[104:107]
    buffer_load_dwordx4 v5, s[48:51], s9 offen offset:1024 nt lds
    s_waitcnt vmcnt(9)
    ds_read_b64_tr_b16 a[160:161], v28 offset:49152
    v_mfma_f32_16x16x32_bf16 v[108:111], a[60:63], v[92:95], v[108:111]
    ds_read_b128 a[60:63], v16 offset:28672
    v_exp_f32 v244, v32
    v_mfma_f32_16x16x32_bf16 v[112:115], a[64:67], v[88:91], v[112:115]
    s_add_u32 m0, s79, 114688
    s_nop 0
    buffer_load_dwordx4 v255, s[56:59], s82 offen offset:3072 lds
    ds_read_b64_tr_b16 a[162:163], v28 offset:51200
    v_mfma_f32_16x16x32_bf16 v[116:119], a[64:67], v[92:95], v[116:119]
    ds_read_b128 a[64:67], v17 offset:28672
    v_exp_f32 v245, v33
    v_mfma_f32_16x16x32_bf16 v[120:123], a[68:71], v[88:91], v[120:123]
    s_add_u32 m0, s79, 131072
    s_add_u32 s82, s81, 106496
    s_and_b32 s82, s82, 0x7ffff
    buffer_load_dwordx4 v252, s[56:59], s82 offen lds
    ds_read_b64_tr_b16 a[164:165], v29 offset:49152
    ds_read_b64_tr_b16 a[166:167], v29 offset:51200
    v_mfma_f32_16x16x32_bf16 v[124:127], a[68:71], v[92:95], v[124:127]
    ds_read_b128 a[68:71], v18 offset:28672
    v_exp_f32 v246, v34
    v_mfma_f32_16x16x32_bf16 v[128:131], a[72:75], v[88:91], v[128:131]
    ds_read_b64_tr_b16 a[168:169], v30 offset:49152
    ds_read_b64_tr_b16 a[170:171], v30 offset:51200
    v_mfma_f32_16x16x32_bf16 v[132:135], a[72:75], v[92:95], v[132:135]
    ds_read_b128 a[72:75], v19 offset:28672
    v_cvt_pk_bf16_f32 v80, v244, v245
    v_mfma_f32_16x16x32_bf16 v[136:139], a[32:35], v[88:91], v[136:139]
    ds_read_b64_tr_b16 a[172:173], v31 offset:49152
    ds_read_b64_tr_b16 a[174:175], v31 offset:51200
    v_mfma_f32_16x16x32_bf16 v[140:143], a[32:35], v[92:95], v[140:143]
    ds_read_b64_tr_b16 a[32:33], v20 offset:16384
    ds_read_b64_tr_b16 a[34:35], v20 offset:20480
    v_mfma_f32_16x16x32_bf16 v[144:147], a[36:39], v[88:91], v[144:147]
    v_exp_f32 v247, v35
    v_mfma_f32_16x16x32_bf16 v[148:151], a[36:39], v[92:95], v[148:151]
    ds_read_b64_tr_b16 a[36:37], v21 offset:16384
    ds_read_b64_tr_b16 a[38:39], v21 offset:20480
    v_mfma_f32_16x16x32_bf16 v[152:155], a[40:43], v[88:91], v[152:155]
    v_exp_f32 v244, v36
    v_cvt_pk_bf16_f32 v81, v246, v247
    v_mfma_f32_16x16x32_bf16 v[156:159], a[40:43], v[92:95], v[156:159]
    ds_read_b64_tr_b16 a[40:41], v22 offset:16384
    ds_read_b64_tr_b16 a[42:43], v22 offset:20480
    v_mfma_f32_16x16x32_bf16 v[76:79], a[76:79], v[88:91], v[76:79]
    v_exp_f32 v245, v37
    v_mfma_f32_16x16x32_bf16 v[240:243], a[76:79], v[92:95], v[240:243]
    v_exp_f32 v246, v38
    v_cvt_pk_bf16_f32 v82, v244, v245
    s_waitcnt lgkmcnt(8)
    v_mfma_f32_16x16x32_bf16 v[48:51], a[44:47], v[160:163], v[64:67]
    v_exp_f32 v247, v39
    v_mfma_f32_16x16x32_bf16 v[48:51], a[48:51], v[164:167], v[48:51]
    v_exp_f32 v244, v40
    v_cvt_pk_bf16_f32 v83, v246, v247
    v_mfma_f32_16x16x32_bf16 v[48:51], a[52:55], v[168:171], v[48:51]
    v_exp_f32 v245, v41
    v_mfma_f32_16x16x32_bf16 v[48:51], a[56:59], v[172:175], v[48:51]
    v_exp_f32 v246, v42
    v_cvt_pk_bf16_f32 v84, v244, v245
    v_mfma_f32_16x16x32_bf16 v[56:59], a[44:47], v[176:179], v[68:71]
    ds_read_b64_tr_b16 a[44:45], v23 offset:16384
    ds_read_b64_tr_b16 a[46:47], v23 offset:20480
    v_mfma_f32_16x16x32_bf16 v[56:59], a[48:51], v[180:183], v[56:59]
    v_exp_f32 v247, v43
    v_mfma_f32_16x16x32_bf16 v[56:59], a[52:55], v[184:187], v[56:59]
    ds_read_b64_tr_b16 a[48:49], v24 offset:16384
    ds_read_b64_tr_b16 a[50:51], v24 offset:20480
    v_mfma_f32_16x16x32_bf16 v[56:59], a[56:59], v[188:191], v[56:59]
    v_exp_f32 v244, v44
    v_cvt_pk_bf16_f32 v85, v246, v247
    v_mfma_f32_16x16x32_bf16 v[52:55], a[60:63], v[160:163], v[64:67]
    ds_read_b64_tr_b16 a[52:53], v25 offset:16384
    ds_read_b64_tr_b16 a[54:55], v25 offset:20480
    v_mfma_f32_16x16x32_bf16 v[52:55], a[64:67], v[164:167], v[52:55]
    v_exp_f32 v245, v45
    v_exp_f32 v246, v46
    v_mfma_f32_16x16x32_bf16 v[52:55], a[68:71], v[168:171], v[52:55]
    ds_read_b64_tr_b16 a[56:57], v26 offset:16384
    ds_read_b64_tr_b16 a[58:59], v26 offset:20480
    v_cvt_pk_bf16_f32 v86, v244, v245
    v_mfma_f32_16x16x32_bf16 v[52:55], a[72:75], v[172:175], v[52:55]
    v_exp_f32 v247, v47
    v_or3_b32 v14, v80, v81, v82
    v_mfma_f32_16x16x32_bf16 v[60:63], a[60:63], v[176:179], v[68:71]
    ds_read_b64_tr_b16 a[60:61], v27 offset:16384
    ds_read_b64_tr_b16 a[62:63], v27 offset:20480
    buffer_load_dwordx4 v253, s[56:59], s82 offen offset:1024 lds
    v_mfma_f32_16x16x32_bf16 v[60:63], a[64:67], v[180:183], v[60:63]
    v_cvt_pk_bf16_f32 v87, v246, v247
    v_or3_b32 v14, v14, v83, v84
    v_or3_b32 v14, v14, v85, v86
    v_mfma_f32_16x16x32_bf16 v[60:63], a[68:71], v[184:187], v[60:63]
    v_bitop3_b32 v14, v14, v87, s72 bitop3:0xa8
    v_cmp_ne_u32 vcc, 0, v14
    v_mfma_f32_16x16x32_bf16 v[60:63], a[72:75], v[188:191], v[60:63]
    s_cbranch_vccnz LA_r1_10
LA_b1_10:
    s_waitcnt lgkmcnt(0)
    s_barrier
    v_mfma_f32_16x16x32_bf16 v[96:99], a[32:35], v[80:83], v[96:99]
    ds_read_b128 a[64:67], v16 offset:32768
    ds_read_b128 a[68:71], v17 offset:32768
    ds_read_b128 a[72:75], v18 offset:32768
    s_add_u32 m0, s78, 16384
    s_mov_b32 s9, 139264
    buffer_load_dwordx4 v8, s[44:47], s9 offen nt lds
    v_mfma_f32_16x16x32_bf16 v[100:103], a[32:35], v[84:87], v[100:103]
    ds_read_b128 a[32:35], v19 offset:32768
    v_mfma_f32_16x16x32_bf16 v[104:107], a[36:39], v[80:83], v[104:107]
    buffer_load_dwordx4 v9, s[44:47], s9 offen offset:1024 nt lds
    v_exp_f32 v244, v48
    v_mfma_f32_16x16x32_bf16 v[108:111], a[36:39], v[84:87], v[108:111]
    ds_read_b128 a[36:39], v16 offset:36864
    v_exp_f32 v245, v49
    v_mfma_f32_16x16x32_bf16 v[112:115], a[40:43], v[80:83], v[112:115]
    s_add_u32 m0, s78, 81920
    s_mov_b32 s9, 131072
    buffer_load_dwordx4 v10, s[48:51], s9 offen nt lds
    v_mfma_f32_16x16x32_bf16 v[116:119], a[40:43], v[84:87], v[116:119]
    ds_read_b128 a[40:43], v17 offset:36864
    v_exp_f32 v246, v50
    v_mfma_f32_16x16x32_bf16 v[120:123], a[44:47], v[80:83], v[120:123]
    buffer_load_dwordx4 v5, s[48:51], s9 offen offset:1024 nt lds
    v_cvt_pk_bf16_f32 v88, v244, v245
    v_mfma_f32_16x16x32_bf16 v[124:127], a[44:47], v[84:87], v[124:127]
    ds_read_b128 a[44:47], v18 offset:36864
    v_exp_f32 v247, v51
    v_mfma_f32_16x16x32_bf16 v[128:131], a[48:51], v[80:83], v[128:131]
    v_exp_f32 v244, v52
    v_mfma_f32_16x16x32_bf16 v[132:135], a[48:51], v[84:87], v[132:135]
    ds_read_b128 a[48:51], v19 offset:36864
    v_cvt_pk_bf16_f32 v89, v246, v247
    v_mfma_f32_16x16x32_bf16 v[136:139], a[52:55], v[80:83], v[136:139]
    v_exp_f32 v245, v53
    v_mfma_f32_16x16x32_bf16 v[140:143], a[52:55], v[84:87], v[140:143]
    ds_read_b64_tr_b16 a[52:53], v20 offset:24576
    ds_read_b64_tr_b16 a[54:55], v20 offset:28672
    v_mfma_f32_16x16x32_bf16 v[144:147], a[56:59], v[80:83], v[144:147]
    v_exp_f32 v246, v54
    v_mfma_f32_16x16x32_bf16 v[148:151], a[56:59], v[84:87], v[148:151]
    ds_read_b64_tr_b16 a[56:57], v21 offset:24576
    ds_read_b64_tr_b16 a[58:59], v21 offset:28672
    v_mfma_f32_16x16x32_bf16 v[152:155], a[60:63], v[80:83], v[152:155]
    v_cvt_pk_bf16_f32 v90, v244, v245
    v_exp_f32 v247, v55
    v_mfma_f32_16x16x32_bf16 v[156:159], a[60:63], v[84:87], v[156:159]
    ds_read_b64_tr_b16 a[60:61], v22 offset:24576
    ds_read_b64_tr_b16 a[62:63], v22 offset:28672
    v_mfma_f32_16x16x32_bf16 v[76:79], a[76:79], v[80:83], v[76:79]
    v_exp_f32 v244, v56
    v_mfma_f32_16x16x32_bf16 v[240:243], a[76:79], v[84:87], v[240:243]
    v_cvt_pk_bf16_f32 v91, v246, v247
    v_exp_f32 v245, v57
    s_waitcnt lgkmcnt(6)
    v_mfma_f32_16x16x32_bf16 v[32:35], a[64:67], v[160:163], v[64:67]
    v_exp_f32 v246, v58
    v_mfma_f32_16x16x32_bf16 v[32:35], a[68:71], v[164:167], v[32:35]
    v_cvt_pk_bf16_f32 v92, v244, v245
    v_exp_f32 v247, v59
    v_mfma_f32_16x16x32_bf16 v[32:35], a[72:75], v[168:171], v[32:35]
    v_exp_f32 v244, v60
    v_mfma_f32_16x16x32_bf16 v[32:35], a[32:35], v[172:175], v[32:35]
    v_cvt_pk_bf16_f32 v93, v246, v247
    v_exp_f32 v245, v61
    v_mfma_f32_16x16x32_bf16 v[40:43], a[64:67], v[176:179], v[68:71]
    ds_read_b64_tr_b16 a[64:65], v23 offset:24576
    ds_read_b64_tr_b16 a[66:67], v23 offset:28672
    v_mfma_f32_16x16x32_bf16 v[40:43], a[68:71], v[180:183], v[40:43]
    v_exp_f32 v246, v62
    v_mfma_f32_16x16x32_bf16 v[40:43], a[72:75], v[184:187], v[40:43]
    ds_read_b64_tr_b16 a[68:69], v24 offset:24576
    ds_read_b64_tr_b16 a[70:71], v24 offset:28672
    v_mfma_f32_16x16x32_bf16 v[40:43], a[32:35], v[188:191], v[40:43]
    v_cvt_pk_bf16_f32 v94, v244, v245
    v_exp_f32 v247, v63
    v_mfma_f32_16x16x32_bf16 v[36:39], a[36:39], v[160:163], v[64:67]
    ds_read_b64_tr_b16 a[72:73], v25 offset:24576
    ds_read_b64_tr_b16 a[74:75], v25 offset:28672
    v_mfma_f32_16x16x32_bf16 v[36:39], a[40:43], v[164:167], v[36:39]
    v_or3_b32 v14, v88, v89, v90
    v_cvt_pk_bf16_f32 v95, v246, v247
    v_mfma_f32_16x16x32_bf16 v[36:39], a[44:47], v[168:171], v[36:39]
    ds_read_b64_tr_b16 a[32:33], v26 offset:24576
    ds_read_b64_tr_b16 a[34:35], v26 offset:28672
    v_mfma_f32_16x16x32_bf16 v[36:39], a[48:51], v[172:175], v[36:39]
    v_or3_b32 v14, v14, v91, v92
    v_or3_b32 v14, v14, v93, v94
    v_mfma_f32_16x16x32_bf16 v[44:47], a[36:39], v[176:179], v[68:71]
    ds_read_b64_tr_b16 a[36:37], v27 offset:24576
    ds_read_b64_tr_b16 a[38:39], v27 offset:28672
    s_add_u32 m0, s79, 131072
    s_nop 0
    buffer_load_dwordx4 v254, s[56:59], s82 offen offset:2048 lds
    v_mfma_f32_16x16x32_bf16 v[44:47], a[40:43], v[180:183], v[44:47]
    buffer_load_dwordx4 v255, s[56:59], s82 offen offset:3072 lds
    v_mfma_f32_16x16x32_bf16 v[44:47], a[44:47], v[184:187], v[44:47]
    v_bitop3_b32 v14, v14, v95, s72 bitop3:0xa8
    v_cmp_ne_u32 vcc, 0, v14
    v_mfma_f32_16x16x32_bf16 v[44:47], a[48:51], v[188:191], v[44:47]
    s_cbranch_vccnz LA_r1_11
LA_b1_11:
    s_waitcnt lgkmcnt(0)
    s_barrier
    v_mfma_f32_16x16x32_bf16 v[96:99], a[52:55], v[88:91], v[96:99]
    ds_read_b128 a[40:43], v16 offset:40960
    ds_read_b128 a[44:47], v17 offset:40960
    ds_read_b128 a[48:51], v18 offset:40960
    s_add_u32 m0, s78, 24576
    s_mov_b32 s9, 147456
    buffer_load_dwordx4 v8, s[44:47], s9 offen nt lds
    v_mfma_f32_16x16x32_bf16 v[100:103], a[52:55], v[92:95], v[100:103]
    ds_read_b128 a[52:55], v19 offset:40960
    v_mfma_f32_16x16x32_bf16 v[104:107], a[56:59], v[88:91], v[104:107]
    buffer_load_dwordx4 v9, s[44:47], s9 offen offset:1024 nt lds
    s_waitcnt vmcnt(10)
    ds_read_b64_tr_b16 a[176:177], v28 offset:16384
    v_mfma_f32_16x16x32_bf16 v[108:111], a[56:59], v[92:95], v[108:111]
    ds_read_b128 a[56:59], v16 offset:45056
    v_exp_f32 v244, v32
    v_mfma_f32_16x16x32_bf16 v[112:115], a[60:63], v[88:91], v[112:115]
    s_add_u32 m0, s78, 90112
    s_mov_b32 s9, 139264
    buffer_load_dwordx4 v10, s[48:51], s9 offen nt lds
    ds_read_b64_tr_b16 a[178:179], v28 offset:18432
    v_mfma_f32_16x16x32_bf16 v[116:119], a[60:63], v[92:95], v[116:119]
    ds_read_b128 a[60:63], v17 offset:45056
    v_exp_f32 v245, v33
    v_mfma_f32_16x16x32_bf16 v[120:123], a[64:67], v[88:91], v[120:123]
    buffer_load_dwordx4 v5, s[48:51], s9 offen offset:1024 nt lds
    ds_read_b64_tr_b16 a[180:181], v29 offset:16384
    ds_read_b64_tr_b16 a[182:183], v29 offset:18432
    v_mfma_f32_16x16x32_bf16 v[124:127], a[64:67], v[92:95], v[124:127]
    ds_read_b128 a[64:67], v18 offset:45056
    v_exp_f32 v246, v34
    v_mfma_f32_16x16x32_bf16 v[128:131], a[68:71], v[88:91], v[128:131]
    ds_read_b64_tr_b16 a[184:185], v30 offset:16384
    ds_read_b64_tr_b16 a[186:187], v30 offset:18432
    v_cvt_pk_bf16_f32 v80, v244, v245
    v_mfma_f32_16x16x32_bf16 v[132:135], a[68:71], v[92:95], v[132:135]
    ds_read_b128 a[68:71], v19 offset:45056
    v_exp_f32 v247, v35
    v_mfma_f32_16x16x32_bf16 v[136:139], a[72:75], v[88:91], v[136:139]
    ds_read_b64_tr_b16 a[188:189], v31 offset:16384
    ds_read_b64_tr_b16 a[190:191], v31 offset:18432
    v_mfma_f32_16x16x32_bf16 v[140:143], a[72:75], v[92:95], v[140:143]
    ds_read_b64_tr_b16 a[72:73], v20 offset:32768
    ds_read_b64_tr_b16 a[74:75], v20 offset:36864
    v_mfma_f32_16x16x32_bf16 v[144:147], a[32:35], v[88:91], v[144:147]
    v_exp_f32 v244, v36
    v_cvt_pk_bf16_f32 v81, v246, v247
    v_mfma_f32_16x16x32_bf16 v[148:151], a[32:35], v[92:95], v[148:151]
    ds_read_b64_tr_b16 a[32:33], v21 offset:32768
    ds_read_b64_tr_b16 a[34:35], v21 offset:36864
    v_mfma_f32_16x16x32_bf16 v[152:155], a[36:39], v[88:91], v[152:155]
    v_exp_f32 v245, v37
    v_mfma_f32_16x16x32_bf16 v[156:159], a[36:39], v[92:95], v[156:159]
    ds_read_b64_tr_b16 a[36:37], v22 offset:32768
    ds_read_b64_tr_b16 a[38:39], v22 offset:36864
    v_mfma_f32_16x16x32_bf16 v[76:79], a[76:79], v[88:91], v[76:79]
    v_exp_f32 v246, v38
    v_cvt_pk_bf16_f32 v82, v244, v245
    v_mfma_f32_16x16x32_bf16 v[240:243], a[76:79], v[92:95], v[240:243]
    v_exp_f32 v247, v39
    s_waitcnt lgkmcnt(8)
    v_mfma_f32_16x16x32_bf16 v[48:51], a[40:43], v[160:163], v[64:67]
    v_exp_f32 v244, v40
    v_cvt_pk_bf16_f32 v83, v246, v247
    v_mfma_f32_16x16x32_bf16 v[48:51], a[44:47], v[164:167], v[48:51]
    v_exp_f32 v245, v41
    v_mfma_f32_16x16x32_bf16 v[48:51], a[48:51], v[168:171], v[48:51]
    v_exp_f32 v246, v42
    v_cvt_pk_bf16_f32 v84, v244, v245
    v_mfma_f32_16x16x32_bf16 v[48:51], a[52:55], v[172:175], v[48:51]
    v_exp_f32 v247, v43
    v_mfma_f32_16x16x32_bf16 v[56:59], a[40:43], v[176:179], v[68:71]
    ds_read_b64_tr_b16 a[40:41], v23 offset:32768
    ds_read_b64_tr_b16 a[42:43], v23 offset:36864
    v_exp_f32 v244, v44
    v_mfma_f32_16x16x32_bf16 v[56:59], a[44:47], v[180:183], v[56:59]
    v_cvt_pk_bf16_f32 v85, v246, v247
    v_exp_f32 v245, v45
    v_mfma_f32_16x16x32_bf16 v[56:59], a[48:51], v[184:187], v[56:59]
    ds_read_b64_tr_b16 a[44:45], v24 offset:32768
    ds_read_b64_tr_b16 a[46:47], v24 offset:36864
    v_mfma_f32_16x16x32_bf16 v[56:59], a[52:55], v[188:191], v[56:59]
    v_exp_f32 v246, v46
    v_cvt_pk_bf16_f32 v86, v244, v245
    v_mfma_f32_16x16x32_bf16 v[52:55], a[56:59], v[160:163], v[64:67]
    ds_read_b64_tr_b16 a[48:49], v25 offset:32768
    ds_read_b64_tr_b16 a[50:51], v25 offset:36864
    v_exp_f32 v247, v47
    v_mfma_f32_16x16x32_bf16 v[52:55], a[60:63], v[164:167], v[52:55]
    v_or3_b32 v14, v80, v81, v82
    v_cvt_pk_bf16_f32 v87, v246, v247
    v_or3_b32 v14, v14, v83, v84
    v_mfma_f32_16x16x32_bf16 v[52:55], a[64:67], v[168:171], v[52:55]
    ds_read_b64_tr_b16 a[52:53], v26 offset:32768
    ds_read_b64_tr_b16 a[54:55], v26 offset:36864
    s_add_u32 m0, s79, 147456
    s_add_u32 s82, s81, 131072
    s_and_b32 s82, s82, 0x7ffff
    buffer_load_dwordx4 v252, s[56:59], s82 offen lds
    v_mfma_f32_16x16x32_bf16 v[52:55], a[68:71], v[172:175], v[52:55]
    v_or3_b32 v14, v14, v85, v86
    v_bitop3_b32 v14, v14, v87, s72 bitop3:0xa8
    v_mfma_f32_16x16x32_bf16 v[60:63], a[56:59], v[176:179], v[68:71]
    ds_read_b64_tr_b16 a[56:57], v27 offset:32768
    ds_read_b64_tr_b16 a[58:59], v27 offset:36864
    buffer_load_dwordx4 v253, s[56:59], s82 offen offset:1024 lds
    v_mfma_f32_16x16x32_bf16 v[60:63], a[60:63], v[180:183], v[60:63]
    buffer_load_dwordx4 v254, s[56:59], s82 offen offset:2048 lds
    v_mfma_f32_16x16x32_bf16 v[60:63], a[64:67], v[184:187], v[60:63]
    v_cmp_ne_u32 vcc, 0, v14
    v_mfma_f32_16x16x32_bf16 v[60:63], a[68:71], v[188:191], v[60:63]
    s_cbranch_vccnz LA_r1_12
LA_b1_12:
    s_waitcnt lgkmcnt(0)
    s_barrier
    v_mfma_f32_16x16x32_bf16 v[96:99], a[72:75], v[80:83], v[96:99]
    ds_read_b128 a[60:63], v16 offset:49152
    ds_read_b128 a[64:67], v17 offset:49152
    ds_read_b128 a[68:71], v18 offset:49152
    s_add_u32 m0, s78, 32768
    s_mov_b32 s9, 155648
    buffer_load_dwordx4 v8, s[44:47], s9 offen nt lds
    v_mfma_f32_16x16x32_bf16 v[100:103], a[72:75], v[84:87], v[100:103]
    ds_read_b128 a[72:75], v19 offset:49152
    v_mfma_f32_16x16x32_bf16 v[104:107], a[32:35], v[80:83], v[104:107]
    buffer_load_dwordx4 v9, s[44:47], s9 offen offset:1024 nt lds
    s_waitcnt vmcnt(9)
    ds_read_b64_tr_b16 a[192:193], v28 offset:32768
    v_mfma_f32_16x16x32_bf16 v[108:111], a[32:35], v[84:87], v[108:111]
    ds_read_b128 a[32:35], v16 offset:53248
    v_exp_f32 v244, v48
    v_mfma_f32_16x16x32_bf16 v[112:115], a[36:39], v[80:83], v[112:115]
    s_add_u32 m0, s79, 147456
    s_nop 0
    buffer_load_dwordx4 v255, s[56:59], s82 offen offset:3072 lds
    ds_read_b64_tr_b16 a[194:195], v28 offset:34816
    v_mfma_f32_16x16x32_bf16 v[116:119], a[36:39], v[84:87], v[116:119]
    ds_read_b128 a[36:39], v17 offset:53248
    v_exp_f32 v245, v49
    v_mfma_f32_16x16x32_bf16 v[120:123], a[40:43], v[80:83], v[120:123]
    s_add_u32 m0, s79, 114688
    s_add_u32 s82, s81, 139264
    s_and_b32 s82, s82, 0x7ffff
    buffer_load_dwordx4 v252, s[56:59], s82 offen lds
    ds_read_b64_tr_b16 a[196:197], v29 offset:32768
    ds_read_b64_tr_b16 a[198:199], v29 offset:34816
    v_mfma_f32_16x16x32_bf16 v[124:127], a[40:43], v[84:87], v[124:127]
    ds_read_b128 a[40:43], v18 offset:53248
    v_exp_f32 v246, v50
    v_mfma_f32_16x16x32_bf16 v[128:131], a[44:47], v[80:83], v[128:131]
    ds_read_b64_tr_b16 a[200:201], v30 offset:32768
    ds_read_b64_tr_b16 a[202:203], v30 offset:34816
    v_mfma_f32_16x16x32_bf16 v[132:135], a[44:47], v[84:87], v[132:135]
    ds_read_b128 a[44:47], v19 offset:53248
    v_cvt_pk_bf16_f32 v88, v244, v245
    v_mfma_f32_16x16x32_bf16 v[136:139], a[48:51], v[80:83], v[136:139]
    ds_read_b64_tr_b16 a[204:205], v31 offset:32768
    ds_read_b64_tr_b16 a[206:207], v31 offset:34816
    v_mfma_f32_16x16x32_bf16 v[140:143], a[48:51], v[84:87], v[140:143]
    ds_read_b64_tr_b16 a[48:49], v20 offset:40960
    ds_read_b64_tr_b16 a[50:51], v20 offset:45056
    v_mfma_f32_16x16x32_bf16 v[144:147], a[52:55], v[80:83], v[144:147]
    v_exp_f32 v247, v51
    v_mfma_f32_16x16x32_bf16 v[148:151], a[52:55], v[84:87], v[148:151]
    ds_read_b64_tr_b16 a[52:53], v21 offset:40960
    ds_read_b64_tr_b16 a[54:55], v21 offset:45056
    v_mfma_f32_16x16x32_bf16 v[152:155], a[56:59], v[80:83], v[152:155]
    v_exp_f32 v244, v52
    v_cvt_pk_bf16_f32 v89, v246, v247
    v_mfma_f32_16x16x32_bf16 v[156:159], a[56:59], v[84:87], v[156:159]
    ds_read_b64_tr_b16 a[56:57], v22 offset:40960
    ds_read_b64_tr_b16 a[58:59], v22 offset:45056
    v_mfma_f32_16x16x32_bf16 v[76:79], a[76:79], v[80:83], v[76:79]
    v_exp_f32 v245, v53
    v_mfma_f32_16x16x32_bf16 v[240:243], a[76:79], v[84:87], v[240:243]
    v_exp_f32 v246, v54
    v_cvt_pk_bf16_f32 v90, v244, v245
    s_waitcnt lgkmcnt(8)
    v_mfma_f32_16x16x32_bf16 v[32:35], a[60:63], v[160:163], v[64:67]
    v_exp_f32 v247, v55
    v_mfma_f32_16x16x32_bf16 v[32:35], a[64:67], v[164:167], v[32:35]
    v_exp_f32 v244, v56
    v_cvt_pk_bf16_f32 v91, v246, v247
    v_mfma_f32_16x16x32_bf16 v[32:35], a[68:71], v[168:171], v[32:35]
    v_exp_f32 v245, v57
    v_mfma_f32_16x16x32_bf16 v[32:35], a[72:75], v[172:175], v[32:35]
    v_exp_f32 v246, v58
    v_cvt_pk_bf16_f32 v92, v244, v245
    v_mfma_f32_16x16x32_bf16 v[40:43], a[60:63], v[176:179], v[68:71]
    ds_read_b64_tr_b16 a[60:61], v23 offset:40960
    ds_read_b64_tr_b16 a[62:63], v23 offset:45056
    v_mfma_f32_16x16x32_bf16 v[40:43], a[64:67], v[180:183], v[40:43]
    v_exp_f32 v247, v59
    v_mfma_f32_16x16x32_bf16 v[40:43], a[68:71], v[184:187], v[40:43]
    ds_read_b64_tr_b16 a[64:65], v24 offset:40960
    ds_read_b64_tr_b16 a[66:67], v24 offset:45056
    v_mfma_f32_16x16x32_bf16 v[40:43], a[72:75], v[188:191], v[40:43]
    v_exp_f32 v244, v60
    v_cvt_pk_bf16_f32 v93, v246, v247
    v_mfma_f32_16x16x32_bf16 v[36:39], a[32:35], v[160:163], v[64:67]
    ds_read_b64_tr_b16 a[68:69], v25 offset:40960
    ds_read_b64_tr_b16 a[70:71], v25 offset:45056
    v_mfma_f32_16x16x32_bf16 v[36:39], a[36:39], v[164:167], v[36:39]
    v_exp_f32 v245, v61
    v_mfma_f32_16x16x32_bf16 v[36:39], a[40:43], v[168:171], v[36:39]
    ds_read_b64_tr_b16 a[72:73], v26 offset:40960
    ds_read_b64_tr_b16 a[74:75], v26 offset:45056
    v_exp_f32 v246, v62
    v_mfma_f32_16x16x32_bf16 v[36:39], a[44:47], v[172:175], v[36:39]
    v_cvt_pk_bf16_f32 v94, v244, v245
    v_exp_f32 v247, v63
    v_mfma_f32_16x16x32_bf16 v[44:47], a[32:35], v[176:179], v[68:71]
    ds_read_b64_tr_b16 a[32:33], v27 offset:40960
    ds_read_b64_tr_b16 a[34:35], v27 offset:45056
    v_or3_b32 v14, v88, v89, v90
    v_mfma_f32_16x16x32_bf16 v[44:47], a[36:39], v[180:183], v[44:47]
    v_cvt_pk_bf16_f32 v95, v246, v247
    v_or3_b32 v14, v14, v91, v92
    v_or3_b32 v14, v14, v93, v94
    v_mfma_f32_16x16x32_bf16 v[44:47], a[40:43], v[184:187], v[44:47]
    v_bitop3_b32 v14, v14, v95, s72 bitop3:0xa8
    v_cmp_ne_u32 vcc, 0, v14
    v_mfma_f32_16x16x32_bf16 v[44:47], a[44:47], v[188:191], v[44:47]
    s_cbranch_vccnz LA_r1_13
LA_b1_13:
    s_waitcnt lgkmcnt(0)
    s_barrier
    v_mfma_f32_16x16x32_bf16 v[96:99], a[48:51], v[88:91], v[96:99]
    ds_read_b128 a[36:39], v16 offset:0
    ds_read_b128 a[40:43], v17 offset:0
    ds_read_b128 a[44:47], v18 offset:0
    s_add_u32 m0, s78, 98304
    s_mov_b32 s9, 147456
    buffer_load_dwordx4 v10, s[48:51], s9 offen nt lds
    v_mfma_f32_16x16x32_bf16 v[100:103], a[48:51], v[92:95], v[100:103]
    ds_read_b128 a[48:51], v19 offset:0
    v_mfma_f32_16x16x32_bf16 v[104:107], a[52:55], v[88:91], v[104:107]
    buffer_load_dwordx4 v5, s[48:51], s9 offen offset:1024 nt lds
    v_exp_f32 v244, v32
    v_mfma_f32_16x16x32_bf16 v[108:111], a[52:55], v[92:95], v[108:111]
    ds_read_b128 a[52:55], v16 offset:4096
    v_exp_f32 v245, v33
    v_mfma_f32_16x16x32_bf16 v[112:115], a[56:59], v[88:91], v[112:115]
    s_add_u32 m0, s78, 40960
    s_mov_b32 s9, 163840
    buffer_load_dwordx4 v8, s[44:47], s9 offen nt lds
    v_mfma_f32_16x16x32_bf16 v[116:119], a[56:59], v[92:95], v[116:119]
    ds_read_b128 a[56:59], v17 offset:4096
    v_exp_f32 v246, v34
    v_mfma_f32_16x16x32_bf16 v[120:123], a[60:63], v[88:91], v[120:123]
    buffer_load_dwordx4 v9, s[44:47], s9 offen offset:1024 nt lds
    v_cvt_pk_bf16_f32 v80, v244, v245
    v_mfma_f32_16x16x32_bf16 v[124:127], a[60:63], v[92:95], v[124:127]
    ds_read_b128 a[60:63], v18 offset:4096
    v_exp_f32 v247, v35
    v_mfma_f32_16x16x32_bf16 v[128:131], a[64:67], v[88:91], v[128:131]
    v_exp_f32 v244, v36
    v_mfma_f32_16x16x32_bf16 v[132:135], a[64:67], v[92:95], v[132:135]
    ds_read_b128 a[64:67], v19 offset:4096
    v_cvt_pk_bf16_f32 v81, v246, v247
    v_mfma_f32_16x16x32_bf16 v[136:139], a[68:71], v[88:91], v[136:139]
    v_exp_f32 v245, v37
    v_mfma_f32_16x16x32_bf16 v[140:143], a[68:71], v[92:95], v[140:143]
    ds_read_b64_tr_b16 a[68:69], v20 offset:0
    ds_read_b64_tr_b16 a[70:71], v20 offset:4096
    v_mfma_f32_16x16x32_bf16 v[144:147], a[72:75], v[88:91], v[144:147]
    v_exp_f32 v246, v38
    v_mfma_f32_16x16x32_bf16 v[148:151], a[72:75], v[92:95], v[148:151]
    ds_read_b64_tr_b16 a[72:73], v21 offset:0
    ds_read_b64_tr_b16 a[74:75], v21 offset:4096
    v_mfma_f32_16x16x32_bf16 v[152:155], a[32:35], v[88:91], v[152:155]
    v_cvt_pk_bf16_f32 v82, v244, v245
    v_exp_f32 v247, v39
    v_mfma_f32_16x16x32_bf16 v[156:159], a[32:35], v[92:95], v[156:159]
    ds_read_b64_tr_b16 a[32:33], v22 offset:0
    ds_read_b64_tr_b16 a[34:35], v22 offset:4096
    v_mfma_f32_16x16x32_bf16 v[76:79], a[76:79], v[88:91], v[76:79]
    v_exp_f32 v244, v40
    v_mfma_f32_16x16x32_bf16 v[240:243], a[76:79], v[92:95], v[240:243]
    v_cvt_pk_bf16_f32 v83, v246, v247
    v_exp_f32 v245, v41
    s_waitcnt lgkmcnt(6)
    v_mfma_f32_16x16x32_bf16 v[48:51], a[36:39], v[160:163], v[64:67]
    v_exp_f32 v246, v42
    v_mfma_f32_16x16x32_bf16 v[48:51], a[40:43], v[164:167], v[48:51]
    v_cvt_pk_bf16_f32 v84, v244, v245
    v_exp_f32 v247, v43
    v_mfma_f32_16x16x32_bf16 v[48:51], a[44:47], v[168:171], v[48:51]
    v_exp_f32 v244, v44
    v_mfma_f32_16x16x32_bf16 v[48:51], a[48:51], v[172:175], v[48:51]
    v_cvt_pk_bf16_f32 v85, v246, v247
    v_exp_f32 v245, v45
    v_mfma_f32_16x16x32_bf16 v[56:59], a[36:39], v[176:179], v[68:71]
    ds_read_b64_tr_b16 a[36:37], v23 offset:0
    ds_read_b64_tr_b16 a[38:39], v23 offset:4096
    v_mfma_f32_16x16x32_bf16 v[56:59], a[40:43], v[180:183], v[56:59]
    v_exp_f32 v246, v46
    v_mfma_f32_16x16x32_bf16 v[56:59], a[44:47], v[184:187], v[56:59]
    ds_read_b64_tr_b16 a[40:41], v24 offset:0
    ds_read_b64_tr_b16 a[42:43], v24 offset:4096
    v_mfma_f32_16x16x32_bf16 v[56:59], a[48:51], v[188:191], v[56:59]
    v_cvt_pk_bf16_f32 v86, v244, v245
    v_exp_f32 v247, v47
    v_mfma_f32_16x16x32_bf16 v[52:55], a[52:55], v[160:163], v[64:67]
    ds_read_b64_tr_b16 a[44:45], v25 offset:0
    ds_read_b64_tr_b16 a[46:47], v25 offset:4096
    v_mfma_f32_16x16x32_bf16 v[52:55], a[56:59], v[164:167], v[52:55]
    v_or3_b32 v14, v80, v81, v82
    v_cvt_pk_bf16_f32 v87, v246, v247
    v_mfma_f32_16x16x32_bf16 v[52:55], a[60:63], v[168:171], v[52:55]
    ds_read_b64_tr_b16 a[48:49], v26 offset:0
    ds_read_b64_tr_b16 a[50:51], v26 offset:4096
    s_add_u32 m0, s79, 114688
    s_nop 0
    buffer_load_dwordx4 v253, s[56:59], s82 offen offset:1024 lds
    v_mfma_f32_16x16x32_bf16 v[52:55], a[64:67], v[172:175], v[52:55]
    v_or3_b32 v14, v14, v83, v84
    v_or3_b32 v14, v14, v85, v86
    v_mfma_f32_16x16x32_bf16 v[60:63], a[52:55], v[176:179], v[68:71]
    ds_read_b64_tr_b16 a[52:53], v27 offset:0
    ds_read_b64_tr_b16 a[54:55], v27 offset:4096
    buffer_load_dwordx4 v254, s[56:59], s82 offen offset:2048 lds
    v_mfma_f32_16x16x32_bf16 v[60:63], a[56:59], v[180:183], v[60:63]
    buffer_load_dwordx4 v255, s[56:59], s82 offen offset:3072 lds
    v_mfma_f32_16x16x32_bf16 v[60:63], a[60:63], v[184:187], v[60:63]
    v_bitop3_b32 v14, v14, v87, s72 bitop3:0xa8
    v_cmp_ne_u32 vcc, 0, v14
    v_mfma_f32_16x16x32_bf16 v[60:63], a[64:67], v[188:191], v[60:63]
    s_cbranch_vccnz LA_r1_14
LA_b1_14:
    s_waitcnt lgkmcnt(0)
    s_barrier
    v_mfma_f32_16x16x32_bf16 v[96:99], a[68:71], v[80:83], v[96:99]
    ds_read_b128 a[56:59], v16 offset:8192
    ds_read_b128 a[60:63], v17 offset:8192
    ds_read_b128 a[64:67], v18 offset:8192
    s_add_u32 m0, s78, 65536
    s_mov_b32 s9, 155648
    buffer_load_dwordx4 v10, s[48:51], s9 offen nt lds
    v_mfma_f32_16x16x32_bf16 v[100:103], a[68:71], v[84:87], v[100:103]
    ds_read_b128 a[68:71], v19 offset:8192
    v_mfma_f32_16x16x32_bf16 v[104:107], a[72:75], v[80:83], v[104:107]
    buffer_load_dwordx4 v5, s[48:51], s9 offen offset:1024 nt lds
    s_waitcnt vmcnt(10)
    ds_read_b64_tr_b16 a[208:209], v28 offset:49152
    v_mfma_f32_16x16x32_bf16 v[108:111], a[72:75], v[84:87], v[108:111]
    ds_read_b128 a[72:75], v16 offset:12288
    v_exp_f32 v244, v48
    v_mfma_f32_16x16x32_bf16 v[112:115], a[32:35], v[80:83], v[112:115]
    s_add_u32 m0, s78, 0
    s_mov_b32 s9, 172032
    buffer_load_dwordx4 v8, s[44:47], s9 offen nt lds
    ds_read_b64_tr_b16 a[210:211], v28 offset:51200
    v_mfma_f32_16x16x32_bf16 v[116:119], a[32:35], v[84:87], v[116:119]
    ds_read_b128 a[32:35], v17 offset:12288
    v_exp_f32 v245, v49
    v_mfma_f32_16x16x32_bf16 v[120:123], a[36:39], v[80:83], v[120:123]
    buffer_load_dwordx4 v9, s[44:47], s9 offen offset:1024 nt lds
    ds_read_b64_tr_b16 a[212:213], v29 offset:49152
    ds_read_b64_tr_b16 a[214:215], v29 offset:51200
    v_mfma_f32_16x16x32_bf16 v[124:127], a[36:39], v[84:87], v[124:127]
    ds_read_b128 a[36:39], v18 offset:12288
    v_exp_f32 v246, v50
    v_mfma_f32_16x16x32_bf16 v[128:131], a[40:43], v[80:83], v[128:131]
    ds_read_b64_tr_b16 a[216:217], v30 offset:49152
    ds_read_b64_tr_b16 a[218:219], v30 offset:51200
    v_cvt_pk_bf16_f32 v88, v244, v245
    v_mfma_f32_16x16x32_bf16 v[132:135], a[40:43], v[84:87], v[132:135]
    ds_read_b128 a[40:43], v19 offset:12288
    v_exp_f32 v247, v51
    v_mfma_f32_16x16x32_bf16 v[136:139], a[44:47], v[80:83], v[136:139]
    ds_read_b64_tr_b16 a[220:221], v31 offset:49152
    ds_read_b64_tr_b16 a[222:223], v31 offset:51200
    v_mfma_f32_16x16x32_bf16 v[140:143], a[44:47], v[84:87], v[140:143]
    ds_read_b64_tr_b16 a[44:45], v20 offset:8192
    ds_read_b64_tr_b16 a[46:47], v20 offset:12288
    v_mfma_f32_16x16x32_bf16 v[144:147], a[48:51], v[80:83], v[144:147]
    v_exp_f32 v244, v52
    v_cvt_pk_bf16_f32 v89, v246, v247
    v_mfma_f32_16x16x32_bf16 v[148:151], a[48:51], v[84:87], v[148:151]
    ds_read_b64_tr_b16 a[48:49], v21 offset:8192
    ds_read_b64_tr_b16 a[50:51], v21 offset:12288
    v_mfma_f32_16x16x32_bf16 v[152:155], a[52:55], v[80:83], v[152:155]
    v_exp_f32 v245, v53
    v_mfma_f32_16x16x32_bf16 v[156:159], a[52:55], v[84:87], v[156:159]
    ds_read_b64_tr_b16 a[52:53], v22 offset:8192
    ds_read_b64_tr_b16 a[54:55], v22 offset:12288
    v_mfma_f32_16x16x32_bf16 v[76:79], a[76:79], v[80:83], v[76:79]
    v_exp_f32 v246, v54
    v_cvt_pk_bf16_f32 v90, v244, v245
    v_mfma_f32_16x16x32_bf16 v[240:243], a[76:79], v[84:87], v[240:243]
    v_exp_f32 v247, v55
    s_waitcnt lgkmcnt(8)
    v_mfma_f32_16x16x32_bf16 v[32:35], a[56:59], v[160:163], v[64:67]
    v_exp_f32 v244, v56
    v_cvt_pk_bf16_f32 v91, v246, v247
    v_mfma_f32_16x16x32_bf16 v[32:35], a[60:63], v[164:167], v[32:35]
    v_exp_f32 v245, v57
    v_mfma_f32_16x16x32_bf16 v[32:35], a[64:67], v[168:171], v[32:35]
    v_exp_f32 v246, v58
    v_cvt_pk_bf16_f32 v92, v244, v245
    v_mfma_f32_16x16x32_bf16 v[32:35], a[68:71], v[172:175], v[32:35]
    v_exp_f32 v247, v59
    v_mfma_f32_16x16x32_bf16 v[40:43], a[56:59], v[176:179], v[68:71]
    ds_read_b64_tr_b16 a[56:57], v23 offset:8192
    ds_read_b64_tr_b16 a[58:59], v23 offset:12288
    v_mfma_f32_16x16x32_bf16 v[40:43], a[60:63], v[180:183], v[40:43]
    v_exp_f32 v244, v60
    v_cvt_pk_bf16_f32 v93, v246, v247
    v_mfma_f32_16x16x32_bf16 v[40:43], a[64:67], v[184:187], v[40:43]
    ds_read_b64_tr_b16 a[60:61], v24 offset:8192
    ds_read_b64_tr_b16 a[62:63], v24 offset:12288
    v_mfma_f32_16x16x32_bf16 v[40:43], a[68:71], v[188:191], v[40:43]
    v_exp_f32 v245, v61
    v_exp_f32 v246, v62
    v_mfma_f32_16x16x32_bf16 v[36:39], a[72:75], v[160:163], v[64:67]
    ds_read_b64_tr_b16 a[64:65], v25 offset:8192
    ds_read_b64_tr_b16 a[66:67], v25 offset:12288
    v_cvt_pk_bf16_f32 v94, v244, v245
    v_mfma_f32_16x16x32_bf16 v[36:39], a[32:35], v[164:167], v[36:39]
    v_exp_f32 v247, v63
    v_or3_b32 v14, v88, v89, v90
    v_mfma_f32_16x16x32_bf16 v[36:39], a[36:39], v[168:171], v[36:39]
    ds_read_b64_tr_b16 a[68:69], v26 offset:8192
    ds_read_b64_tr_b16 a[70:71], v26 offset:12288
    v_cvt_pk_bf16_f32 v95, v246, v247
    v_mfma_f32_16x16x32_bf16 v[36:39], a[40:43], v[172:175], v[36:39]
    v_or3_b32 v14, v14, v91, v92
    v_or3_b32 v14, v14, v93, v94
    v_bitop3_b32 v14, v14, v95, s72 bitop3:0xa8
    v_mfma_f32_16x16x32_bf16 v[44:47], a[72:75], v[176:179], v[68:71]
    ds_read_b64_tr_b16 a[72:73], v27 offset:8192
    ds_read_b64_tr_b16 a[74:75], v27 offset:12288
    s_add_u32 m0, s79, 49152
    s_add_u32 s82, s81, 163840
    s_and_b32 s82, s82, 0x7ffff
    buffer_load_dwordx4 v252, s[56:59], s82 offen lds
    v_mfma_f32_16x16x32_bf16 v[44:47], a[32:35], v[180:183], v[44:47]
    buffer_load_dwordx4 v253, s[56:59], s82 offen offset:1024 lds
    v_mfma_f32_16x16x32_bf16 v[44:47], a[36:39], v[184:187], v[44:47]
    v_cmp_ne_u32 vcc, 0, v14
    v_mfma_f32_16x16x32_bf16 v[44:47], a[40:43], v[188:191], v[44:47]
    s_cbranch_vccnz LA_r1_15
LA_b1_15:
    s_waitcnt lgkmcnt(0)
    s_barrier
    v_mfma_f32_16x16x32_bf16 v[96:99], a[44:47], v[88:91], v[96:99]
    ds_read_b128 a[32:35], v16 offset:16384
    ds_read_b128 a[36:39], v17 offset:16384
    ds_read_b128 a[40:43], v18 offset:16384
    s_add_u32 m0, s78, 73728
    s_mov_b32 s9, 163840
    buffer_load_dwordx4 v10, s[48:51], s9 offen nt lds
    v_mfma_f32_16x16x32_bf16 v[100:103], a[44:47], v[92:95], v[100:103]
    ds_read_b128 a[44:47], v19 offset:16384
    v_mfma_f32_16x16x32_bf16 v[104:107], a[48:51], v[88:91], v[104:107]
    buffer_load_dwordx4 v5, s[48:51], s9 offen offset:1024 nt lds
    s_waitcnt vmcnt(8)
    ds_read_b64_tr_b16 a[224:225], v28 offset:16384
    v_mfma_f32_16x16x32_bf16 v[108:111], a[48:51], v[92:95], v[108:111]
    ds_read_b128 a[48:51], v16 offset:20480
    v_exp_f32 v244, v32
    v_mfma_f32_16x16x32_bf16 v[112:115], a[52:55], v[88:91], v[112:115]
    s_add_u32 m0, s79, 49152
    s_nop 0
    buffer_load_dwordx4 v254, s[56:59], s82 offen offset:2048 lds
    ds_read_b64_tr_b16 a[226:227], v28 offset:18432
    v_mfma_f32_16x16x32_bf16 v[116:119], a[52:55], v[92:95], v[116:119]
    ds_read_b128 a[52:55], v17 offset:20480
    v_exp_f32 v245, v33
    v_mfma_f32_16x16x32_bf16 v[120:123], a[56:59], v[88:91], v[120:123]
    buffer_load_dwordx4 v255, s[56:59], s82 offen offset:3072 lds
    ds_read_b64_tr_b16 a[228:229], v29 offset:16384
    ds_read_b64_tr_b16 a[230:231], v29 offset:18432
    v_mfma_f32_16x16x32_bf16 v[124:127], a[56:59], v[92:95], v[124:127]
    ds_read_b128 a[56:59], v18 offset:20480
    v_exp_f32 v246, v34
    v_mfma_f32_16x16x32_bf16 v[128:131], a[60:63], v[88:91], v[128:131]
    ds_read_b64_tr_b16 a[232:233], v30 offset:16384
    ds_read_b64_tr_b16 a[234:235], v30 offset:18432
    v_cvt_pk_bf16_f32 v80, v244, v245
    v_mfma_f32_16x16x32_bf16 v[132:135], a[60:63], v[92:95], v[132:135]
    ds_read_b128 a[60:63], v19 offset:20480
    v_exp_f32 v247, v35
    v_mfma_f32_16x16x32_bf16 v[136:139], a[64:67], v[88:91], v[136:139]
    ds_read_b64_tr_b16 a[236:237], v31 offset:16384
    ds_read_b64_tr_b16 a[238:239], v31 offset:18432
    v_mfma_f32_16x16x32_bf16 v[140:143], a[64:67], v[92:95], v[140:143]
    ds_read_b64_tr_b16 a[64:65], v20 offset:16384
    ds_read_b64_tr_b16 a[66:67], v20 offset:20480
    v_mfma_f32_16x16x32_bf16 v[144:147], a[68:71], v[88:91], v[144:147]
    v_exp_f32 v244, v36
    v_cvt_pk_bf16_f32 v81, v246, v247
    v_mfma_f32_16x16x32_bf16 v[148:151], a[68:71], v[92:95], v[148:151]
    ds_read_b64_tr_b16 a[68:69], v21 offset:16384
    ds_read_b64_tr_b16 a[70:71], v21 offset:20480
    v_mfma_f32_16x16x32_bf16 v[152:155], a[72:75], v[88:91], v[152:155]
    v_exp_f32 v245, v37
    v_mfma_f32_16x16x32_bf16 v[156:159], a[72:75], v[92:95], v[156:159]
    ds_read_b64_tr_b16 a[72:73], v22 offset:16384
    ds_read_b64_tr_b16 a[74:75], v22 offset:20480
    v_mfma_f32_16x16x32_bf16 v[76:79], a[76:79], v[88:91], v[76:79]
    v_exp_f32 v246, v38
    v_cvt_pk_bf16_f32 v82, v244, v245
    v_mfma_f32_16x16x32_bf16 v[240:243], a[76:79], v[92:95], v[240:243]
    v_exp_f32 v247, v39
    s_waitcnt lgkmcnt(8)
    v_mfma_f32_16x16x32_bf16 v[48:51], a[32:35], v[160:163], v[64:67]
    v_exp_f32 v244, v40
    v_cvt_pk_bf16_f32 v83, v246, v247
    v_mfma_f32_16x16x32_bf16 v[48:51], a[36:39], v[164:167], v[48:51]
    v_exp_f32 v245, v41
    v_mfma_f32_16x16x32_bf16 v[48:51], a[40:43], v[168:171], v[48:51]
    v_exp_f32 v246, v42
    v_cvt_pk_bf16_f32 v84, v244, v245
    v_mfma_f32_16x16x32_bf16 v[48:51], a[44:47], v[172:175], v[48:51]
    v_exp_f32 v247, v43
    v_mfma_f32_16x16x32_bf16 v[56:59], a[32:35], v[176:179], v[68:71]
    ds_read_b64_tr_b16 a[32:33], v23 offset:16384
    ds_read_b64_tr_b16 a[34:35], v23 offset:20480
    v_mfma_f32_16x16x32_bf16 v[56:59], a[36:39], v[180:183], v[56:59]
    v_exp_f32 v244, v44
    v_cvt_pk_bf16_f32 v85, v246, v247
    v_mfma_f32_16x16x32_bf16 v[56:59], a[40:43], v[184:187], v[56:59]
    ds_read_b64_tr_b16 a[36:37], v24 offset:16384
    ds_read_b64_tr_b16 a[38:39], v24 offset:20480
    v_mfma_f32_16x16x32_bf16 v[56:59], a[44:47], v[188:191], v[56:59]
    v_exp_f32 v245, v45
    v_mfma_f32_16x16x32_bf16 v[52:55], a[48:51], v[160:163], v[64:67]
    ds_read_b64_tr_b16 a[40:41], v25 offset:16384
    ds_read_b64_tr_b16 a[42:43], v25 offset:20480
    v_exp_f32 v246, v46
    v_mfma_f32_16x16x32_bf16 v[52:55], a[52:55], v[164:167], v[52:55]
    v_cvt_pk_bf16_f32 v86, v244, v245
    v_exp_f32 v247, v47
    v_mfma_f32_16x16x32_bf16 v[52:55], a[56:59], v[168:171], v[52:55]
    ds_read_b64_tr_b16 a[44:45], v26 offset:16384
    ds_read_b64_tr_b16 a[46:47], v26 offset:20480
    v_or3_b32 v14, v80, v81, v82
    v_mfma_f32_16x16x32_bf16 v[52:55], a[60:63], v[172:175], v[52:55]
    v_cvt_pk_bf16_f32 v87, v246, v247
    v_or3_b32 v14, v14, v83, v84
    v_or3_b32 v14, v14, v85, v86
    v_mfma_f32_16x16x32_bf16 v[60:63], a[48:51], v[176:179], v[68:71]
    ds_read_b64_tr_b16 a[48:49], v27 offset:16384
    ds_read_b64_tr_b16 a[50:51], v27 offset:20480
    s_add_u32 m0, s79, 131072
    s_add_u32 s82, s81, 172032
    s_and_b32 s82, s82, 0x7ffff
    buffer_load_dwordx4 v252, s[56:59], s82 offen lds
    v_mfma_f32_16x16x32_bf16 v[60:63], a[52:55], v[180:183], v[60:63]
    v_bitop3_b32 v14, v14, v87, s72 bitop3:0xa8
    v_mfma_f32_16x16x32_bf16 v[60:63], a[56:59], v[184:187], v[60:63]
    v_cmp_ne_u32 vcc, 0, v14
    v_mfma_f32_16x16x32_bf16 v[60:63], a[60:63], v[188:191], v[60:63]
    s_cbranch_vccnz LA_r1_16
LA_b1_16:
    s_waitcnt lgkmcnt(0)
    s_barrier
    v_mfma_f32_16x16x32_bf16 v[96:99], a[64:67], v[80:83], v[96:99]
    ds_read_b128 a[52:55], v16 offset:24576
    ds_read_b128 a[56:59], v17 offset:24576
    ds_read_b128 a[60:63], v18 offset:24576
    s_add_u32 m0, s78, 8192
    s_mov_b32 s9, 180224
    buffer_load_dwordx4 v8, s[44:47], s9 offen nt lds
    v_mfma_f32_16x16x32_bf16 v[100:103], a[64:67], v[84:87], v[100:103]
    ds_read_b128 a[64:67], v19 offset:24576
    v_mfma_f32_16x16x32_bf16 v[104:107], a[68:71], v[80:83], v[104:107]
    buffer_load_dwordx4 v9, s[44:47], s9 offen offset:1024 nt lds
    v_exp_f32 v244, v48
    v_mfma_f32_16x16x32_bf16 v[108:111], a[68:71], v[84:87], v[108:111]
    ds_read_b128 a[68:71], v16 offset:28672
    v_exp_f32 v245, v49
    v_mfma_f32_16x16x32_bf16 v[112:115], a[72:75], v[80:83], v[112:115]
    s_add_u32 m0, s78, 81920
    s_mov_b32 s9, 172032
    buffer_load_dwordx4 v10, s[48:51], s9 offen nt lds
    v_mfma_f32_16x16x32_bf16 v[116:119], a[72:75], v[84:87], v[116:119]
    ds_read_b128 a[72:75], v17 offset:28672
    v_exp_f32 v246, v50
    v_mfma_f32_16x16x32_bf16 v[120:123], a[32:35], v[80:83], v[120:123]
    buffer_load_dwordx4 v5, s[48:51], s9 offen offset:1024 nt lds
    v_cvt_pk_bf16_f32 v88, v244, v245
    v_mfma_f32_16x16x32_bf16 v[124:127], a[32:35], v[84:87], v[124:127]
    ds_read_b128 a[32:35], v18 offset:28672
    v_exp_f32 v247, v51
    v_mfma_f32_16x16x32_bf16 v[128:131], a[36:39], v[80:83], v[128:131]
    v_exp_f32 v244, v52
    v_mfma_f32_16x16x32_bf16 v[132:135], a[36:39], v[84:87], v[132:135]
    ds_read_b128 a[36:39], v19 offset:28672
    v_cvt_pk_bf16_f32 v89, v246, v247
    v_mfma_f32_16x16x32_bf16 v[136:139], a[40:43], v[80:83], v[136:139]
    v_exp_f32 v245, v53
    v_mfma_f32_16x16x32_bf16 v[140:143], a[40:43], v[84:87], v[140:143]
    ds_read_b64_tr_b16 a[40:41], v20 offset:24576
    ds_read_b64_tr_b16 a[42:43], v20 offset:28672
    v_mfma_f32_16x16x32_bf16 v[144:147], a[44:47], v[80:83], v[144:147]
    v_exp_f32 v246, v54
    v_mfma_f32_16x16x32_bf16 v[148:151], a[44:47], v[84:87], v[148:151]
    ds_read_b64_tr_b16 a[44:45], v21 offset:24576
    ds_read_b64_tr_b16 a[46:47], v21 offset:28672
    v_mfma_f32_16x16x32_bf16 v[152:155], a[48:51], v[80:83], v[152:155]
    v_cvt_pk_bf16_f32 v90, v244, v245
    v_exp_f32 v247, v55
    v_mfma_f32_16x16x32_bf16 v[156:159], a[48:51], v[84:87], v[156:159]
    ds_read_b64_tr_b16 a[48:49], v22 offset:24576
    ds_read_b64_tr_b16 a[50:51], v22 offset:28672
    v_mfma_f32_16x16x32_bf16 v[76:79], a[76:79], v[80:83], v[76:79]
    v_exp_f32 v244, v56
    v_mfma_f32_16x16x32_bf16 v[240:243], a[76:79], v[84:87], v[240:243]
    v_cvt_pk_bf16_f32 v91, v246, v247
    v_exp_f32 v245, v57
    s_waitcnt lgkmcnt(6)
    v_mfma_f32_16x16x32_bf16 v[32:35], a[52:55], v[160:163], v[64:67]
    v_exp_f32 v246, v58
    v_mfma_f32_16x16x32_bf16 v[32:35], a[56:59], v[164:167], v[32:35]
    v_cvt_pk_bf16_f32 v92, v244, v245
    v_exp_f32 v247, v59
    v_mfma_f32_16x16x32_bf16 v[32:35], a[60:63], v[168:171], v[32:35]
    v_exp_f32 v244, v60
    v_mfma_f32_16x16x32_bf16 v[32:35], a[64:67], v[172:175], v[32:35]
    v_cvt_pk_bf16_f32 v93, v246, v247
    v_exp_f32 v245, v61
    v_mfma_f32_16x16x32_bf16 v[40:43], a[52:55], v[176:179], v[68:71]
    ds_read_b64_tr_b16 a[52:53], v23 offset:24576
    ds_read_b64_tr_b16 a[54:55], v23 offset:28672
    v_mfma_f32_16x16x32_bf16 v[40:43], a[56:59], v[180:183], v[40:43]
    v_exp_f32 v246, v62
    v_mfma_f32_16x16x32_bf16 v[40:43], a[60:63], v[184:187], v[40:43]
    ds_read_b64_tr_b16 a[56:57], v24 offset:24576
    ds_read_b64_tr_b16 a[58:59], v24 offset:28672
    v_mfma_f32_16x16x32_bf16 v[40:43], a[64:67], v[188:191], v[40:43]
    v_cvt_pk_bf16_f32 v94, v244, v245
    v_exp_f32 v247, v63
    v_mfma_f32_16x16x32_bf16 v[36:39], a[68:71], v[160:163], v[64:67]
    ds_read_b64_tr_b16 a[60:61], v25 offset:24576
    ds_read_b64_tr_b16 a[62:63], v25 offset:28672
    v_mfma_f32_16x16x32_bf16 v[36:39], a[72:75], v[164:167], v[36:39]
    v_or3_b32 v14, v88, v89, v90
    v_cvt_pk_bf16_f32 v95, v246, v247
    v_mfma_f32_16x16x32_bf16 v[36:39], a[32:35], v[168:171], v[36:39]
    ds_read_b64_tr_b16 a[64:65], v26 offset:24576
    ds_read_b64_tr_b16 a[66:67], v26 offset:28672
    v_mfma_f32_16x16x32_bf16 v[36:39], a[36:39], v[172:175], v[36:39]
    v_or3_b32 v14, v14, v91, v92
    v_or3_b32 v14, v14, v93, v94
    v_mfma_f32_16x16x32_bf16 v[44:47], a[68:71], v[176:179], v[68:71]
    ds_read_b64_tr_b16 a[68:69], v27 offset:24576
    ds_read_b64_tr_b16 a[70:71], v27 offset:28672
    s_add_u32 m0, s79, 131072
    s_nop 0
    buffer_load_dwordx4 v253, s[56:59], s82 offen offset:1024 lds
    v_mfma_f32_16x16x32_bf16 v[44:47], a[72:75], v[180:183], v[44:47]
    buffer_load_dwordx4 v254, s[56:59], s82 offen offset:2048 lds
    v_mfma_f32_16x16x32_bf16 v[44:47], a[32:35], v[184:187], v[44:47]
    v_bitop3_b32 v14, v14, v95, s72 bitop3:0xa8
    v_cmp_ne_u32 vcc, 0, v14
    v_mfma_f32_16x16x32_bf16 v[44:47], a[36:39], v[188:191], v[44:47]
    s_cbranch_vccnz LA_r1_17
LA_b1_17:
    s_waitcnt lgkmcnt(0)
    s_barrier
    v_mfma_f32_16x16x32_bf16 v[96:99], a[40:43], v[88:91], v[96:99]
    ds_read_b128 a[72:75], v16 offset:32768
    ds_read_b128 a[32:35], v17 offset:32768
    ds_read_b128 a[36:39], v18 offset:32768
    s_add_u32 m0, s78, 16384
    s_mov_b32 s9, 188416
    buffer_load_dwordx4 v8, s[44:47], s9 offen nt lds
    v_mfma_f32_16x16x32_bf16 v[100:103], a[40:43], v[92:95], v[100:103]
    ds_read_b128 a[40:43], v19 offset:32768
    v_mfma_f32_16x16x32_bf16 v[104:107], a[44:47], v[88:91], v[104:107]
    buffer_load_dwordx4 v9, s[44:47], s9 offen offset:1024 nt lds
    s_waitcnt vmcnt(9)
    v_subrev_u32 v28, 98304, v28
    v_subrev_u32 v29, 98304, v29
    v_subrev_u32 v30, 98304, v30
    v_subrev_u32 v31, 98304, v31
    ds_read_b64_tr_b16 a[240:241], v28 offset:49152
    v_mfma_f32_16x16x32_bf16 v[108:111], a[44:47], v[92:95], v[108:111]
    ds_read_b128 a[44:47], v16 offset:36864
    v_exp_f32 v244, v32
    v_mfma_f32_16x16x32_bf16 v[112:115], a[48:51], v[88:91], v[112:115]
    s_add_u32 m0, s78, 90112
    s_mov_b32 s9, 180224
    buffer_load_dwordx4 v10, s[48:51], s9 offen nt lds
    ds_read_b64_tr_b16 a[242:243], v28 offset:51200
    v_mfma_f32_16x16x32_bf16 v[116:119], a[48:51], v[92:95], v[116:119]
    ds_read_b128 a[48:51], v17 offset:36864
    v_exp_f32 v245, v33
    v_mfma_f32_16x16x32_bf16 v[120:123], a[52:55], v[88:91], v[120:123]
    buffer_load_dwordx4 v5, s[48:51], s9 offen offset:1024 nt lds
    ds_read_b64_tr_b16 a[244:245], v29 offset:49152
    ds_read_b64_tr_b16 a[246:247], v29 offset:51200
    v_mfma_f32_16x16x32_bf16 v[124:127], a[52:55], v[92:95], v[124:127]
    ds_read_b128 a[52:55], v18 offset:36864
    v_exp_f32 v246, v34
    v_mfma_f32_16x16x32_bf16 v[128:131], a[56:59], v[88:91], v[128:131]
    ds_read_b64_tr_b16 a[248:249], v30 offset:49152
    ds_read_b64_tr_b16 a[250:251], v30 offset:51200
    v_cvt_pk_bf16_f32 v80, v244, v245
    v_mfma_f32_16x16x32_bf16 v[132:135], a[56:59], v[92:95], v[132:135]
    ds_read_b128 a[56:59], v19 offset:36864
    v_exp_f32 v247, v35
    v_mfma_f32_16x16x32_bf16 v[136:139], a[60:63], v[88:91], v[136:139]
    ds_read_b64_tr_b16 a[252:253], v31 offset:49152
    ds_read_b64_tr_b16 a[254:255], v31 offset:51200
    v_mfma_f32_16x16x32_bf16 v[140:143], a[60:63], v[92:95], v[140:143]
    ds_read_b64_tr_b16 a[60:61], v20 offset:32768
    ds_read_b64_tr_b16 a[62:63], v20 offset:36864
    v_mfma_f32_16x16x32_bf16 v[144:147], a[64:67], v[88:91], v[144:147]
    v_exp_f32 v244, v36
    v_cvt_pk_bf16_f32 v81, v246, v247
    v_mfma_f32_16x16x32_bf16 v[148:151], a[64:67], v[92:95], v[148:151]
    ds_read_b64_tr_b16 a[64:65], v21 offset:32768
    ds_read_b64_tr_b16 a[66:67], v21 offset:36864
    v_mfma_f32_16x16x32_bf16 v[152:155], a[68:71], v[88:91], v[152:155]
    v_exp_f32 v245, v37
    v_mfma_f32_16x16x32_bf16 v[156:159], a[68:71], v[92:95], v[156:159]
    ds_read_b64_tr_b16 a[68:69], v22 offset:32768
    ds_read_b64_tr_b16 a[70:71], v22 offset:36864
    v_mfma_f32_16x16x32_bf16 v[76:79], a[76:79], v[88:91], v[76:79]
    v_exp_f32 v246, v38
    v_cvt_pk_bf16_f32 v82, v244, v245
    v_mfma_f32_16x16x32_bf16 v[240:243], a[76:79], v[92:95], v[240:243]
    v_exp_f32 v247, v39
    s_waitcnt lgkmcnt(8)
    v_mfma_f32_16x16x32_bf16 v[48:51], a[72:75], v[160:163], v[64:67]
    v_exp_f32 v244, v40
    v_cvt_pk_bf16_f32 v83, v246, v247
    v_mfma_f32_16x16x32_bf16 v[48:51], a[32:35], v[164:167], v[48:51]
    v_exp_f32 v245, v41
    v_mfma_f32_16x16x32_bf16 v[48:51], a[36:39], v[168:171], v[48:51]
    v_exp_f32 v246, v42
    v_cvt_pk_bf16_f32 v84, v244, v245
    v_mfma_f32_16x16x32_bf16 v[48:51], a[40:43], v[172:175], v[48:51]
    v_exp_f32 v247, v43
    v_mfma_f32_16x16x32_bf16 v[56:59], a[72:75], v[176:179], v[68:71]
    ds_read_b64_tr_b16 a[72:73], v23 offset:32768
    ds_read_b64_tr_b16 a[74:75], v23 offset:36864
    v_exp_f32 v244, v44
    v_mfma_f32_16x16x32_bf16 v[56:59], a[32:35], v[180:183], v[56:59]
    v_cvt_pk_bf16_f32 v85, v246, v247
    v_exp_f32 v245, v45
    v_mfma_f32_16x16x32_bf16 v[56:59], a[36:39], v[184:187], v[56:59]
    ds_read_b64_tr_b16 a[32:33], v24 offset:32768
    ds_read_b64_tr_b16 a[34:35], v24 offset:36864
    v_mfma_f32_16x16x32_bf16 v[56:59], a[40:43], v[188:191], v[56:59]
    v_exp_f32 v246, v46
    v_cvt_pk_bf16_f32 v86, v244, v245
    v_mfma_f32_16x16x32_bf16 v[52:55], a[44:47], v[160:163], v[64:67]
    ds_read_b64_tr_b16 a[36:37], v25 offset:32768
    ds_read_b64_tr_b16 a[38:39], v25 offset:36864
    v_exp_f32 v247, v47
    v_mfma_f32_16x16x32_bf16 v[52:55], a[48:51], v[164:167], v[52:55]
    v_or3_b32 v14, v80, v81, v82
    v_cvt_pk_bf16_f32 v87, v246, v247
    v_or3_b32 v14, v14, v83, v84
    v_mfma_f32_16x16x32_bf16 v[52:55], a[52:55], v[168:171], v[52:55]
    ds_read_b64_tr_b16 a[40:41], v26 offset:32768
    ds_read_b64_tr_b16 a[42:43], v26 offset:36864
    s_add_u32 m0, s79, 131072
    s_nop 0
    buffer_load_dwordx4 v255, s[56:59], s82 offen offset:3072 lds
    v_mfma_f32_16x16x32_bf16 v[52:55], a[56:59], v[172:175], v[52:55]
    v_or3_b32 v14, v14, v85, v86
    v_bitop3_b32 v14, v14, v87, s72 bitop3:0xa8
    v_cmp_ne_u32 vcc, 0, v14
    v_mfma_f32_16x16x32_bf16 v[60:63], a[44:47], v[176:179], v[68:71]
    ds_read_b64_tr_b16 a[44:45], v27 offset:32768
    ds_read_b64_tr_b16 a[46:47], v27 offset:36864
    s_add_u32 m0, s79, 114688
    s_add_u32 s82, s81, 196608
    s_and_b32 s82, s82, 0x7ffff
    buffer_load_dwordx4 v252, s[56:59], s82 offen lds
    v_mfma_f32_16x16x32_bf16 v[60:63], a[48:51], v[180:183], v[60:63]
    buffer_load_dwordx4 v253, s[56:59], s82 offen offset:1024 lds
    v_mfma_f32_16x16x32_bf16 v[60:63], a[52:55], v[184:187], v[60:63]
    v_mfma_f32_16x16x32_bf16 v[60:63], a[56:59], v[188:191], v[60:63]
    s_cbranch_vccnz LA_r1_18
LA_b1_18:
    s_waitcnt lgkmcnt(0)
    s_barrier
    v_mfma_f32_16x16x32_bf16 v[96:99], a[60:63], v[80:83], v[96:99]
    ds_read_b128 a[48:51], v16 offset:40960
    ds_read_b128 a[52:55], v17 offset:40960
    ds_read_b128 a[56:59], v18 offset:40960
    s_add_u32 m0, s78, 24576
    s_mov_b32 s9, 196608
    buffer_load_dwordx4 v8, s[44:47], s9 offen nt lds
    v_mfma_f32_16x16x32_bf16 v[100:103], a[60:63], v[84:87], v[100:103]
    ds_read_b128 a[60:63], v19 offset:40960
    v_mfma_f32_16x16x32_bf16 v[104:107], a[64:67], v[80:83], v[104:107]
    buffer_load_dwordx4 v9, s[44:47], s9 offen offset:1024 nt lds
    v_exp_f32 v244, v48
    v_mfma_f32_16x16x32_bf16 v[108:111], a[64:67], v[84:87], v[108:111]
    ds_read_b128 a[64:67], v16 offset:45056
    v_exp_f32 v245, v49
    v_mfma_f32_16x16x32_bf16 v[112:115], a[68:71], v[80:83], v[112:115]
    s_add_u32 m0, s79, 114688
    s_nop 0
    buffer_load_dwordx4 v254, s[56:59], s82 offen offset:2048 lds
    v_mfma_f32_16x16x32_bf16 v[116:119], a[68:71], v[84:87], v[116:119]
    ds_read_b128 a[68:71], v17 offset:45056
    v_exp_f32 v246, v50
    v_mfma_f32_16x16x32_bf16 v[120:123], a[72:75], v[80:83], v[120:123]
    buffer_load_dwordx4 v255, s[56:59], s82 offen offset:3072 lds
    v_cvt_pk_bf16_f32 v88, v244, v245
    v_mfma_f32_16x16x32_bf16 v[124:127], a[72:75], v[84:87], v[124:127]
    ds_read_b128 a[72:75], v18 offset:45056
    v_exp_f32 v247, v51
    v_mfma_f32_16x16x32_bf16 v[128:131], a[32:35], v[80:83], v[128:131]
    v_exp_f32 v244, v52
    v_mfma_f32_16x16x32_bf16 v[132:135], a[32:35], v[84:87], v[132:135]
    ds_read_b128 a[32:35], v19 offset:45056
    v_cvt_pk_bf16_f32 v89, v246, v247
    v_mfma_f32_16x16x32_bf16 v[136:139], a[36:39], v[80:83], v[136:139]
    v_exp_f32 v245, v53
    v_mfma_f32_16x16x32_bf16 v[140:143], a[36:39], v[84:87], v[140:143]
    ds_read_b64_tr_b16 a[36:37], v20 offset:0
    ds_read_b64_tr_b16 a[38:39], v20 offset:4096
    v_mfma_f32_16x16x32_bf16 v[144:147], a[40:43], v[80:83], v[144:147]
    v_exp_f32 v246, v54
    v_mfma_f32_16x16x32_bf16 v[148:151], a[40:43], v[84:87], v[148:151]
    ds_read_b64_tr_b16 a[40:41], v21 offset:0
    ds_read_b64_tr_b16 a[42:43], v21 offset:4096
    v_mfma_f32_16x16x32_bf16 v[152:155], a[44:47], v[80:83], v[152:155]
    v_cvt_pk_bf16_f32 v90, v244, v245
    v_exp_f32 v247, v55
    v_mfma_f32_16x16x32_bf16 v[156:159], a[44:47], v[84:87], v[156:159]
    ds_read_b64_tr_b16 a[44:45], v22 offset:0
    ds_read_b64_tr_b16 a[46:47], v22 offset:4096
    v_mfma_f32_16x16x32_bf16 v[76:79], a[76:79], v[80:83], v[76:79]
    v_exp_f32 v244, v56
    v_mfma_f32_16x16x32_bf16 v[240:243], a[76:79], v[84:87], v[240:243]
    v_cvt_pk_bf16_f32 v91, v246, v247
    v_exp_f32 v245, v57
    s_waitcnt lgkmcnt(6)
    v_mfma_f32_16x16x32_bf16 v[32:35], a[48:51], v[160:163], v[64:67]
    v_exp_f32 v246, v58
    v_mfma_f32_16x16x32_bf16 v[32:35], a[52:55], v[164:167], v[32:35]
    v_cvt_pk_bf16_f32 v92, v244, v245
    v_exp_f32 v247, v59
    v_mfma_f32_16x16x32_bf16 v[32:35], a[56:59], v[168:171], v[32:35]
    v_exp_f32 v244, v60
    v_mfma_f32_16x16x32_bf16 v[32:35], a[60:63], v[172:175], v[32:35]
    v_cvt_pk_bf16_f32 v93, v246, v247
    v_exp_f32 v245, v61
    v_mfma_f32_16x16x32_bf16 v[40:43], a[48:51], v[176:179], v[68:71]
    ds_read_b64_tr_b16 a[48:49], v23 offset:0
    ds_read_b64_tr_b16 a[50:51], v23 offset:4096
    v_mfma_f32_16x16x32_bf16 v[40:43], a[52:55], v[180:183], v[40:43]
    v_exp_f32 v246, v62
    v_mfma_f32_16x16x32_bf16 v[40:43], a[56:59], v[184:187], v[40:43]
    ds_read_b64_tr_b16 a[52:53], v24 offset:0
    ds_read_b64_tr_b16 a[54:55], v24 offset:4096
    v_mfma_f32_16x16x32_bf16 v[40:43], a[60:63], v[188:191], v[40:43]
    v_cvt_pk_bf16_f32 v94, v244, v245
    v_mfma_f32_16x16x32_bf16 v[36:39], a[64:67], v[160:163], v[64:67]
    ds_read_b64_tr_b16 a[56:57], v25 offset:0
    ds_read_b64_tr_b16 a[58:59], v25 offset:4096
    v_mfma_f32_16x16x32_bf16 v[36:39], a[68:71], v[164:167], v[36:39]
    v_exp_f32 v247, v63
    v_mfma_f32_16x16x32_bf16 v[36:39], a[72:75], v[168:171], v[36:39]
    ds_read_b64_tr_b16 a[60:61], v26 offset:0
    ds_read_b64_tr_b16 a[62:63], v26 offset:4096
    v_mfma_f32_16x16x32_bf16 v[36:39], a[32:35], v[172:175], v[36:39]
    v_or3_b32 v14, v88, v89, v90
    v_cvt_pk_bf16_f32 v95, v246, v247
    v_mfma_f32_16x16x32_bf16 v[44:47], a[64:67], v[176:179], v[68:71]
    ds_read_b64_tr_b16 a[64:65], v27 offset:0
    ds_read_b64_tr_b16 a[66:67], v27 offset:4096
    v_mfma_f32_16x16x32_bf16 v[44:47], a[68:71], v[180:183], v[44:47]
    v_or3_b32 v14, v14, v91, v92
    v_or3_b32 v14, v14, v93, v94
    v_mfma_f32_16x16x32_bf16 v[44:47], a[72:75], v[184:187], v[44:47]
    v_bitop3_b32 v14, v14, v95, s72 bitop3:0xa8
    v_cmp_ne_u32 vcc, 0, v14
    v_mfma_f32_16x16x32_bf16 v[44:47], a[32:35], v[188:191], v[44:47]
    s_cbranch_vccnz LA_r1_19
LA_b1_19:
    s_waitcnt lgkmcnt(0)
    s_barrier
    v_mfma_f32_16x16x32_bf16 v[96:99], a[36:39], v[88:91], v[96:99]
    ds_read_b128 a[68:71], v16 offset:0
    ds_read_b128 a[72:75], v17 offset:0
    ds_read_b128 a[32:35], v18 offset:0
    s_add_u32 m0, s78, 65536
    s_mov_b32 s9, 188416
    buffer_load_dwordx4 v10, s[48:51], s9 offen nt lds
    v_mfma_f32_16x16x32_bf16 v[100:103], a[36:39], v[92:95], v[100:103]
    ds_read_b128 a[36:39], v19 offset:0
    v_mfma_f32_16x16x32_bf16 v[104:107], a[40:43], v[88:91], v[104:107]
    buffer_load_dwordx4 v5, s[48:51], s9 offen offset:1024 nt lds
    s_waitcnt vmcnt(8)
    v_add_u32 v28, 98304, v28
    v_add_u32 v29, 98304, v29
    v_add_u32 v30, 98304, v30
    v_add_u32 v31, 98304, v31
    ds_read_b64_tr_b16 a[0:1], v28 offset:32768
    v_mfma_f32_16x16x32_bf16 v[108:111], a[40:43], v[92:95], v[108:111]
    ds_read_b128 a[40:43], v16 offset:4096
    v_exp_f32 v244, v32
    v_mfma_f32_16x16x32_bf16 v[112:115], a[44:47], v[88:91], v[112:115]
    s_add_u32 m0, s78, 32768
    s_mov_b32 s9, 204800
    buffer_load_dwordx4 v8, s[44:47], s9 offen nt lds
    ds_read_b64_tr_b16 a[2:3], v28 offset:34816
    v_mfma_f32_16x16x32_bf16 v[116:119], a[44:47], v[92:95], v[116:119]
    ds_read_b128 a[44:47], v17 offset:4096
    v_exp_f32 v245, v33
    v_mfma_f32_16x16x32_bf16 v[120:123], a[48:51], v[88:91], v[120:123]
    buffer_load_dwordx4 v9, s[44:47], s9 offen offset:1024 nt lds
    ds_read_b64_tr_b16 a[4:5], v29 offset:32768
    ds_read_b64_tr_b16 a[6:7], v29 offset:34816
    v_mfma_f32_16x16x32_bf16 v[124:127], a[48:51], v[92:95], v[124:127]
    ds_read_b128 a[48:51], v18 offset:4096
    v_exp_f32 v246, v34
    v_mfma_f32_16x16x32_bf16 v[128:131], a[52:55], v[88:91], v[128:131]
    ds_read_b64_tr_b16 a[8:9], v30 offset:32768
    ds_read_b64_tr_b16 a[10:11], v30 offset:34816
    v_cvt_pk_bf16_f32 v80, v244, v245
    v_mfma_f32_16x16x32_bf16 v[132:135], a[52:55], v[92:95], v[132:135]
    ds_read_b128 a[52:55], v19 offset:4096
    v_exp_f32 v247, v35
    v_mfma_f32_16x16x32_bf16 v[136:139], a[56:59], v[88:91], v[136:139]
    ds_read_b64_tr_b16 a[12:13], v31 offset:32768
    ds_read_b64_tr_b16 a[14:15], v31 offset:34816
    v_mfma_f32_16x16x32_bf16 v[140:143], a[56:59], v[92:95], v[140:143]
    ds_read_b64_tr_b16 a[56:57], v20 offset:8192
    ds_read_b64_tr_b16 a[58:59], v20 offset:12288
    v_mfma_f32_16x16x32_bf16 v[144:147], a[60:63], v[88:91], v[144:147]
    v_exp_f32 v244, v36
    v_cvt_pk_bf16_f32 v81, v246, v247
    v_mfma_f32_16x16x32_bf16 v[148:151], a[60:63], v[92:95], v[148:151]
    ds_read_b64_tr_b16 a[60:61], v21 offset:8192
    ds_read_b64_tr_b16 a[62:63], v21 offset:12288
    v_mfma_f32_16x16x32_bf16 v[152:155], a[64:67], v[88:91], v[152:155]
    v_exp_f32 v245, v37
    v_mfma_f32_16x16x32_bf16 v[156:159], a[64:67], v[92:95], v[156:159]
    ds_read_b64_tr_b16 a[64:65], v22 offset:8192
    ds_read_b64_tr_b16 a[66:67], v22 offset:12288
    v_mfma_f32_16x16x32_bf16 v[76:79], a[76:79], v[88:91], v[76:79]
    v_exp_f32 v246, v38
    v_cvt_pk_bf16_f32 v82, v244, v245
    v_mfma_f32_16x16x32_bf16 v[240:243], a[76:79], v[92:95], v[240:243]
    v_exp_f32 v247, v39
    s_waitcnt lgkmcnt(8)
    v_mfma_f32_16x16x32_bf16 v[48:51], a[68:71], v[160:163], v[64:67]
    v_exp_f32 v244, v40
    v_cvt_pk_bf16_f32 v83, v246, v247
    v_mfma_f32_16x16x32_bf16 v[48:51], a[72:75], v[164:167], v[48:51]
    v_exp_f32 v245, v41
    v_mfma_f32_16x16x32_bf16 v[48:51], a[32:35], v[168:171], v[48:51]
    v_exp_f32 v246, v42
    v_cvt_pk_bf16_f32 v84, v244, v245
    v_mfma_f32_16x16x32_bf16 v[48:51], a[36:39], v[172:175], v[48:51]
    v_exp_f32 v247, v43
    v_mfma_f32_16x16x32_bf16 v[56:59], a[68:71], v[176:179], v[68:71]
    ds_read_b64_tr_b16 a[68:69], v23 offset:8192
    ds_read_b64_tr_b16 a[70:71], v23 offset:12288
    v_exp_f32 v244, v44
    v_mfma_f32_16x16x32_bf16 v[56:59], a[72:75], v[180:183], v[56:59]
    v_cvt_pk_bf16_f32 v85, v246, v247
    v_exp_f32 v245, v45
    v_mfma_f32_16x16x32_bf16 v[56:59], a[32:35], v[184:187], v[56:59]
    ds_read_b64_tr_b16 a[72:73], v24 offset:8192
    ds_read_b64_tr_b16 a[74:75], v24 offset:12288
    v_mfma_f32_16x16x32_bf16 v[56:59], a[36:39], v[188:191], v[56:59]
    v_exp_f32 v246, v46
    v_cvt_pk_bf16_f32 v86, v244, v245
    v_mfma_f32_16x16x32_bf16 v[52:55], a[40:43], v[160:163], v[64:67]
    ds_read_b64_tr_b16 a[32:33], v25 offset:8192
    ds_read_b64_tr_b16 a[34:35], v25 offset:12288
    v_exp_f32 v247, v47
    v_mfma_f32_16x16x32_bf16 v[52:55], a[44:47], v[164:167], v[52:55]
    v_or3_b32 v14, v80, v81, v82
    v_cvt_pk_bf16_f32 v87, v246, v247
    v_or3_b32 v14, v14, v83, v84
    v_mfma_f32_16x16x32_bf16 v[52:55], a[48:51], v[168:171], v[52:55]
    ds_read_b64_tr_b16 a[36:37], v26 offset:8192
    ds_read_b64_tr_b16 a[38:39], v26 offset:12288
    s_add_u32 m0, s79, 49152
    s_add_u32 s82, s81, 204800
    s_and_b32 s82, s82, 0x7ffff
    buffer_load_dwordx4 v252, s[56:59], s82 offen lds
    v_mfma_f32_16x16x32_bf16 v[52:55], a[52:55], v[172:175], v[52:55]
    v_or3_b32 v14, v14, v85, v86
    v_bitop3_b32 v14, v14, v87, s72 bitop3:0xa8
    v_mfma_f32_16x16x32_bf16 v[60:63], a[40:43], v[176:179], v[68:71]
    ds_read_b64_tr_b16 a[40:41], v27 offset:8192
    ds_read_b64_tr_b16 a[42:43], v27 offset:12288
    buffer_load_dwordx4 v253, s[56:59], s82 offen offset:1024 lds
    v_mfma_f32_16x16x32_bf16 v[60:63], a[44:47], v[180:183], v[60:63]
    buffer_load_dwordx4 v254, s[56:59], s82 offen offset:2048 lds
    v_mfma_f32_16x16x32_bf16 v[60:63], a[48:51], v[184:187], v[60:63]
    v_cmp_ne_u32 vcc, 0, v14
    v_mfma_f32_16x16x32_bf16 v[60:63], a[52:55], v[188:191], v[60:63]
    s_cbranch_vccnz LA_r1_20
LA_b1_20:
    s_waitcnt lgkmcnt(0)
    s_barrier
    v_mfma_f32_16x16x32_bf16 v[96:99], a[56:59], v[80:83], v[96:99]
    ds_read_b128 a[44:47], v16 offset:8192
    ds_read_b128 a[48:51], v17 offset:8192
    ds_read_b128 a[52:55], v18 offset:8192
    s_add_u32 m0, s78, 73728
    s_mov_b32 s9, 196608
    buffer_load_dwordx4 v10, s[48:51], s9 offen nt lds
    v_mfma_f32_16x16x32_bf16 v[100:103], a[56:59], v[84:87], v[100:103]
    ds_read_b128 a[56:59], v19 offset:8192
    v_mfma_f32_16x16x32_bf16 v[104:107], a[60:63], v[80:83], v[104:107]
    buffer_load_dwordx4 v5, s[48:51], s9 offen offset:1024 nt lds
    s_waitcnt vmcnt(9)
    ds_read_b64_tr_b16 a[16:17], v28 offset:16384
    v_mfma_f32_16x16x32_bf16 v[108:111], a[60:63], v[84:87], v[108:111]
    ds_read_b128 a[60:63], v16 offset:12288
    v_exp_f32 v244, v48
    v_mfma_f32_16x16x32_bf16 v[112:115], a[64:67], v[80:83], v[112:115]
    s_add_u32 m0, s79, 49152
    s_nop 0
    buffer_load_dwordx4 v255, s[56:59], s82 offen offset:3072 lds
    ds_read_b64_tr_b16 a[18:19], v28 offset:18432
    v_mfma_f32_16x16x32_bf16 v[116:119], a[64:67], v[84:87], v[116:119]
    ds_read_b128 a[64:67], v17 offset:12288
    v_exp_f32 v245, v49
    v_mfma_f32_16x16x32_bf16 v[120:123], a[68:71], v[80:83], v[120:123]
    s_add_u32 m0, s79, 98304
    s_add_u32 s82, s81, 229376
    s_and_b32 s82, s82, 0x7ffff
    buffer_load_dwordx4 v252, s[56:59], s82 offen lds
    ds_read_b64_tr_b16 a[20:21], v29 offset:16384
    ds_read_b64_tr_b16 a[22:23], v29 offset:18432
    v_mfma_f32_16x16x32_bf16 v[124:127], a[68:71], v[84:87], v[124:127]
    ds_read_b128 a[68:71], v18 offset:12288
    v_exp_f32 v246, v50
    v_mfma_f32_16x16x32_bf16 v[128:131], a[72:75], v[80:83], v[128:131]
    ds_read_b64_tr_b16 a[24:25], v30 offset:16384
    ds_read_b64_tr_b16 a[26:27], v30 offset:18432
    v_mfma_f32_16x16x32_bf16 v[132:135], a[72:75], v[84:87], v[132:135]
    ds_read_b128 a[72:75], v19 offset:12288
    v_cvt_pk_bf16_f32 v88, v244, v245
    v_mfma_f32_16x16x32_bf16 v[136:139], a[32:35], v[80:83], v[136:139]
    ds_read_b64_tr_b16 a[28:29], v31 offset:16384
    ds_read_b64_tr_b16 a[30:31], v31 offset:18432
    v_mfma_f32_16x16x32_bf16 v[140:143], a[32:35], v[84:87], v[140:143]
    ds_read_b64_tr_b16 a[32:33], v20 offset:16384
    ds_read_b64_tr_b16 a[34:35], v20 offset:20480
    v_mfma_f32_16x16x32_bf16 v[144:147], a[36:39], v[80:83], v[144:147]
    v_exp_f32 v247, v51
    v_mfma_f32_16x16x32_bf16 v[148:151], a[36:39], v[84:87], v[148:151]
    ds_read_b64_tr_b16 a[36:37], v21 offset:16384
    ds_read_b64_tr_b16 a[38:39], v21 offset:20480
    v_mfma_f32_16x16x32_bf16 v[152:155], a[40:43], v[80:83], v[152:155]
    v_exp_f32 v244, v52
    v_cvt_pk_bf16_f32 v89, v246, v247
    v_mfma_f32_16x16x32_bf16 v[156:159], a[40:43], v[84:87], v[156:159]
    ds_read_b64_tr_b16 a[40:41], v22 offset:16384
    ds_read_b64_tr_b16 a[42:43], v22 offset:20480
    v_mfma_f32_16x16x32_bf16 v[76:79], a[76:79], v[80:83], v[76:79]
    v_exp_f32 v245, v53
    v_mfma_f32_16x16x32_bf16 v[240:243], a[76:79], v[84:87], v[240:243]
    v_exp_f32 v246, v54
    v_cvt_pk_bf16_f32 v90, v244, v245
    s_waitcnt lgkmcnt(8)
    v_mfma_f32_16x16x32_bf16 v[32:35], a[44:47], v[160:163], v[64:67]
    v_exp_f32 v247, v55
    v_mfma_f32_16x16x32_bf16 v[32:35], a[48:51], v[164:167], v[32:35]
    v_exp_f32 v244, v56
    v_cvt_pk_bf16_f32 v91, v246, v247
    v_mfma_f32_16x16x32_bf16 v[32:35], a[52:55], v[168:171], v[32:35]
    v_exp_f32 v245, v57
    v_mfma_f32_16x16x32_bf16 v[32:35], a[56:59], v[172:175], v[32:35]
    v_exp_f32 v246, v58
    v_cvt_pk_bf16_f32 v92, v244, v245
    v_mfma_f32_16x16x32_bf16 v[40:43], a[44:47], v[176:179], v[68:71]
    ds_read_b64_tr_b16 a[44:45], v23 offset:16384
    ds_read_b64_tr_b16 a[46:47], v23 offset:20480
    v_mfma_f32_16x16x32_bf16 v[40:43], a[48:51], v[180:183], v[40:43]
    v_exp_f32 v247, v59
    v_mfma_f32_16x16x32_bf16 v[40:43], a[52:55], v[184:187], v[40:43]
    ds_read_b64_tr_b16 a[48:49], v24 offset:16384
    ds_read_b64_tr_b16 a[50:51], v24 offset:20480
    v_mfma_f32_16x16x32_bf16 v[40:43], a[56:59], v[188:191], v[40:43]
    v_exp_f32 v244, v60
    v_cvt_pk_bf16_f32 v93, v246, v247
    v_mfma_f32_16x16x32_bf16 v[36:39], a[60:63], v[160:163], v[64:67]
    ds_read_b64_tr_b16 a[52:53], v25 offset:16384
    ds_read_b64_tr_b16 a[54:55], v25 offset:20480
    v_mfma_f32_16x16x32_bf16 v[36:39], a[64:67], v[164:167], v[36:39]
    v_exp_f32 v245, v61
    v_mfma_f32_16x16x32_bf16 v[36:39], a[68:71], v[168:171], v[36:39]
    ds_read_b64_tr_b16 a[56:57], v26 offset:16384
    ds_read_b64_tr_b16 a[58:59], v26 offset:20480
    v_exp_f32 v246, v62
    v_mfma_f32_16x16x32_bf16 v[36:39], a[72:75], v[172:175], v[36:39]
    v_cvt_pk_bf16_f32 v94, v244, v245
    v_exp_f32 v247, v63
    v_mfma_f32_16x16x32_bf16 v[44:47], a[60:63], v[176:179], v[68:71]
    ds_read_b64_tr_b16 a[60:61], v27 offset:16384
    ds_read_b64_tr_b16 a[62:63], v27 offset:20480
    v_or3_b32 v14, v88, v89, v90
    v_mfma_f32_16x16x32_bf16 v[44:47], a[64:67], v[180:183], v[44:47]
    v_cvt_pk_bf16_f32 v95, v246, v247
    v_or3_b32 v14, v14, v91, v92
    v_or3_b32 v14, v14, v93, v94
    v_mfma_f32_16x16x32_bf16 v[44:47], a[68:71], v[184:187], v[44:47]
    v_bitop3_b32 v14, v14, v95, s72 bitop3:0xa8
    v_cmp_ne_u32 vcc, 0, v14
    v_mfma_f32_16x16x32_bf16 v[44:47], a[72:75], v[188:191], v[44:47]
    s_cbranch_vccnz LA_r1_21
LA_b1_21:
    s_waitcnt lgkmcnt(0)
    s_barrier
    v_mfma_f32_16x16x32_bf16 v[96:99], a[32:35], v[88:91], v[96:99]
    ds_read_b128 a[64:67], v16 offset:16384
    ds_read_b128 a[68:71], v17 offset:16384
    ds_read_b128 a[72:75], v18 offset:16384
    s_add_u32 m0, s78, 0
    s_mov_b32 s9, 212992
    buffer_load_dwordx4 v8, s[44:47], s9 offen nt lds
    v_mfma_f32_16x16x32_bf16 v[100:103], a[32:35], v[92:95], v[100:103]
    ds_read_b128 a[32:35], v19 offset:16384
    v_mfma_f32_16x16x32_bf16 v[104:107], a[36:39], v[88:91], v[104:107]
    buffer_load_dwordx4 v9, s[44:47], s9 offen offset:1024 nt lds
    v_exp_f32 v244, v32
    v_mfma_f32_16x16x32_bf16 v[108:111], a[36:39], v[92:95], v[108:111]
    ds_read_b128 a[36:39], v16 offset:20480
    v_exp_f32 v245, v33
    v_mfma_f32_16x16x32_bf16 v[112:115], a[40:43], v[88:91], v[112:115]
    s_add_u32 m0, s78, 81920
    s_mov_b32 s9, 204800
    buffer_load_dwordx4 v10, s[48:51], s9 offen nt lds
    v_mfma_f32_16x16x32_bf16 v[116:119], a[40:43], v[92:95], v[116:119]
    ds_read_b128 a[40:43], v17 offset:20480
    v_exp_f32 v246, v34
    v_mfma_f32_16x16x32_bf16 v[120:123], a[44:47], v[88:91], v[120:123]
    buffer_load_dwordx4 v5, s[48:51], s9 offen offset:1024 nt lds
    v_cvt_pk_bf16_f32 v80, v244, v245
    v_mfma_f32_16x16x32_bf16 v[124:127], a[44:47], v[92:95], v[124:127]
    ds_read_b128 a[44:47], v18 offset:20480
    v_exp_f32 v247, v35
    v_mfma_f32_16x16x32_bf16 v[128:131], a[48:51], v[88:91], v[128:131]
    v_exp_f32 v244, v36
    v_mfma_f32_16x16x32_bf16 v[132:135], a[48:51], v[92:95], v[132:135]
    ds_read_b128 a[48:51], v19 offset:20480
    v_cvt_pk_bf16_f32 v81, v246, v247
    v_mfma_f32_16x16x32_bf16 v[136:139], a[52:55], v[88:91], v[136:139]
    v_exp_f32 v245, v37
    v_mfma_f32_16x16x32_bf16 v[140:143], a[52:55], v[92:95], v[140:143]
    ds_read_b64_tr_b16 a[52:53], v20 offset:24576
    ds_read_b64_tr_b16 a[54:55], v20 offset:28672
    v_mfma_f32_16x16x32_bf16 v[144:147], a[56:59], v[88:91], v[144:147]
    v_exp_f32 v246, v38
    v_mfma_f32_16x16x32_bf16 v[148:151], a[56:59], v[92:95], v[148:151]
    ds_read_b64_tr_b16 a[56:57], v21 offset:24576
    ds_read_b64_tr_b16 a[58:59], v21 offset:28672
    v_mfma_f32_16x16x32_bf16 v[152:155], a[60:63], v[88:91], v[152:155]
    v_cvt_pk_bf16_f32 v82, v244, v245
    v_exp_f32 v247, v39
    v_mfma_f32_16x16x32_bf16 v[156:159], a[60:63], v[92:95], v[156:159]
    ds_read_b64_tr_b16 a[60:61], v22 offset:24576
    ds_read_b64_tr_b16 a[62:63], v22 offset:28672
    v_mfma_f32_16x16x32_bf16 v[76:79], a[76:79], v[88:91], v[76:79]
    v_exp_f32 v244, v40
    v_mfma_f32_16x16x32_bf16 v[240:243], a[76:79], v[92:95], v[240:243]
    v_cvt_pk_bf16_f32 v83, v246, v247
    v_exp_f32 v245, v41
    s_waitcnt lgkmcnt(6)
    v_mfma_f32_16x16x32_bf16 v[48:51], a[64:67], v[160:163], v[64:67]
    v_exp_f32 v246, v42
    v_mfma_f32_16x16x32_bf16 v[48:51], a[68:71], v[164:167], v[48:51]
    v_cvt_pk_bf16_f32 v84, v244, v245
    v_exp_f32 v247, v43
    v_mfma_f32_16x16x32_bf16 v[48:51], a[72:75], v[168:171], v[48:51]
    v_exp_f32 v244, v44
    v_mfma_f32_16x16x32_bf16 v[48:51], a[32:35], v[172:175], v[48:51]
    v_cvt_pk_bf16_f32 v85, v246, v247
    v_exp_f32 v245, v45
    v_mfma_f32_16x16x32_bf16 v[56:59], a[64:67], v[176:179], v[68:71]
    ds_read_b64_tr_b16 a[64:65], v23 offset:24576
    ds_read_b64_tr_b16 a[66:67], v23 offset:28672
    v_mfma_f32_16x16x32_bf16 v[56:59], a[68:71], v[180:183], v[56:59]
    v_exp_f32 v246, v46
    v_mfma_f32_16x16x32_bf16 v[56:59], a[72:75], v[184:187], v[56:59]
    ds_read_b64_tr_b16 a[68:69], v24 offset:24576
    ds_read_b64_tr_b16 a[70:71], v24 offset:28672
    v_mfma_f32_16x16x32_bf16 v[56:59], a[32:35], v[188:191], v[56:59]
    v_cvt_pk_bf16_f32 v86, v244, v245
    v_exp_f32 v247, v47
    v_mfma_f32_16x16x32_bf16 v[52:55], a[36:39], v[160:163], v[64:67]
    ds_read_b64_tr_b16 a[72:73], v25 offset:24576
    ds_read_b64_tr_b16 a[74:75], v25 offset:28672
    v_mfma_f32_16x16x32_bf16 v[52:55], a[40:43], v[164:167], v[52:55]
    v_or3_b32 v14, v80, v81, v82
    v_cvt_pk_bf16_f32 v87, v246, v247
    v_mfma_f32_16x16x32_bf16 v[52:55], a[44:47], v[168:171], v[52:55]
    ds_read_b64_tr_b16 a[32:33], v26 offset:24576
    ds_read_b64_tr_b16 a[34:35], v26 offset:28672
    s_add_u32 m0, s79, 98304
    s_nop 0
    buffer_load_dwordx4 v253, s[56:59], s82 offen offset:1024 lds
    v_mfma_f32_16x16x32_bf16 v[52:55], a[48:51], v[172:175], v[52:55]
    v_or3_b32 v14, v14, v83, v84
    v_or3_b32 v14, v14, v85, v86
    v_mfma_f32_16x16x32_bf16 v[60:63], a[36:39], v[176:179], v[68:71]
    ds_read_b64_tr_b16 a[36:37], v27 offset:24576
    ds_read_b64_tr_b16 a[38:39], v27 offset:28672
    buffer_load_dwordx4 v254, s[56:59], s82 offen offset:2048 lds
    v_mfma_f32_16x16x32_bf16 v[60:63], a[40:43], v[180:183], v[60:63]
    buffer_load_dwordx4 v255, s[56:59], s82 offen offset:3072 lds
    v_mfma_f32_16x16x32_bf16 v[60:63], a[44:47], v[184:187], v[60:63]
    v_bitop3_b32 v14, v14, v87, s72 bitop3:0xa8
    v_cmp_ne_u32 vcc, 0, v14
    v_mfma_f32_16x16x32_bf16 v[60:63], a[48:51], v[188:191], v[60:63]
    s_cbranch_vccnz LA_r1_22
LA_b1_22:
    s_waitcnt vmcnt(16) lgkmcnt(0)
    s_barrier
    v_mfma_f32_16x16x32_bf16 v[96:99], a[52:55], v[80:83], v[96:99]
    ds_read_b128 a[40:43], v16 offset:24576
    ds_read_b128 a[44:47], v17 offset:24576
    ds_read_b128 a[48:51], v18 offset:24576
    s_add_u32 m0, s78, 8192
    s_mov_b32 s9, 221184
    buffer_load_dwordx4 v8, s[44:47], s9 offen nt lds
    v_mfma_f32_16x16x32_bf16 v[100:103], a[52:55], v[84:87], v[100:103]
    ds_read_b128 a[52:55], v19 offset:24576
    v_mfma_f32_16x16x32_bf16 v[104:107], a[56:59], v[80:83], v[104:107]
    buffer_load_dwordx4 v9, s[44:47], s9 offen offset:1024 nt lds
    s_waitcnt vmcnt(10)
    v_subrev_u32 v28, 98304, v28
    v_subrev_u32 v29, 98304, v29
    v_subrev_u32 v30, 98304, v30
    v_subrev_u32 v31, 98304, v31
    ds_read_b64_tr_b16 v[192:193], v28 offset:49152
    v_mfma_f32_16x16x32_bf16 v[108:111], a[56:59], v[84:87], v[108:111]
    ds_read_b128 a[56:59], v16 offset:28672
    v_exp_f32 v244, v48
    v_mfma_f32_16x16x32_bf16 v[112:115], a[60:63], v[80:83], v[112:115]
    s_add_u32 m0, s78, 90112
    s_mov_b32 s9, 212992
    buffer_load_dwordx4 v10, s[48:51], s9 offen nt lds
    ds_read_b64_tr_b16 v[194:195], v28 offset:51200
    v_mfma_f32_16x16x32_bf16 v[116:119], a[60:63], v[84:87], v[116:119]
    ds_read_b128 a[60:63], v17 offset:28672
    v_exp_f32 v245, v49
    v_mfma_f32_16x16x32_bf16 v[120:123], a[64:67], v[80:83], v[120:123]
    buffer_load_dwordx4 v5, s[48:51], s9 offen offset:1024 nt lds
    ds_read_b64_tr_b16 v[196:197], v29 offset:49152
    ds_read_b64_tr_b16 v[198:199], v29 offset:51200
    v_mfma_f32_16x16x32_bf16 v[124:127], a[64:67], v[84:87], v[124:127]
    ds_read_b128 a[64:67], v18 offset:28672
    v_exp_f32 v246, v50
    v_mfma_f32_16x16x32_bf16 v[128:131], a[68:71], v[80:83], v[128:131]
    ds_read_b64_tr_b16 v[200:201], v30 offset:49152
    ds_read_b64_tr_b16 v[202:203], v30 offset:51200
    v_cvt_pk_bf16_f32 v88, v244, v245
    v_mfma_f32_16x16x32_bf16 v[132:135], a[68:71], v[84:87], v[132:135]
    ds_read_b128 a[68:71], v19 offset:28672
    v_exp_f32 v247, v51
    v_mfma_f32_16x16x32_bf16 v[136:139], a[72:75], v[80:83], v[136:139]
    ds_read_b64_tr_b16 v[204:205], v31 offset:49152
    ds_read_b64_tr_b16 v[206:207], v31 offset:51200
    v_mfma_f32_16x16x32_bf16 v[140:143], a[72:75], v[84:87], v[140:143]
    ds_read_b64_tr_b16 a[72:73], v20 offset:0
    ds_read_b64_tr_b16 a[74:75], v20 offset:4096
    v_mfma_f32_16x16x32_bf16 v[144:147], a[32:35], v[80:83], v[144:147]
    v_exp_f32 v244, v52
    v_cvt_pk_bf16_f32 v89, v246, v247
    v_mfma_f32_16x16x32_bf16 v[148:151], a[32:35], v[84:87], v[148:151]
    ds_read_b64_tr_b16 a[32:33], v21 offset:0
    ds_read_b64_tr_b16 a[34:35], v21 offset:4096
    v_mfma_f32_16x16x32_bf16 v[152:155], a[36:39], v[80:83], v[152:155]
    v_exp_f32 v245, v53
    v_mfma_f32_16x16x32_bf16 v[156:159], a[36:39], v[84:87], v[156:159]
    ds_read_b64_tr_b16 a[36:37], v22 offset:0
    ds_read_b64_tr_b16 a[38:39], v22 offset:4096
    v_mfma_f32_16x16x32_bf16 v[76:79], a[76:79], v[80:83], v[76:79]
    v_exp_f32 v246, v54
    v_cvt_pk_bf16_f32 v90, v244, v245
    v_mfma_f32_16x16x32_bf16 v[240:243], a[76:79], v[84:87], v[240:243]
    v_exp_f32 v247, v55
    s_waitcnt lgkmcnt(8)
    v_mfma_f32_16x16x32_bf16 v[32:35], a[40:43], v[160:163], v[64:67]
    v_exp_f32 v244, v56
    v_cvt_pk_bf16_f32 v91, v246, v247
    v_mfma_f32_16x16x32_bf16 v[32:35], a[44:47], v[164:167], v[32:35]
    v_exp_f32 v245, v57
    v_mfma_f32_16x16x32_bf16 v[32:35], a[48:51], v[168:171], v[32:35]
    v_exp_f32 v246, v58
    v_cvt_pk_bf16_f32 v92, v244, v245
    v_mfma_f32_16x16x32_bf16 v[32:35], a[52:55], v[172:175], v[32:35]
    v_exp_f32 v247, v59
    v_mfma_f32_16x16x32_bf16 v[40:43], a[40:43], v[176:179], v[68:71]
    ds_read_b64_tr_b16 a[40:41], v23 offset:0
    ds_read_b64_tr_b16 a[42:43], v23 offset:4096
    v_mfma_f32_16x16x32_bf16 v[40:43], a[44:47], v[180:183], v[40:43]
    v_exp_f32 v244, v60
    v_cvt_pk_bf16_f32 v93, v246, v247
    v_mfma_f32_16x16x32_bf16 v[40:43], a[48:51], v[184:187], v[40:43]
    ds_read_b64_tr_b16 a[44:45], v24 offset:0
    ds_read_b64_tr_b16 a[46:47], v24 offset:4096
    v_mfma_f32_16x16x32_bf16 v[40:43], a[52:55], v[188:191], v[40:43]
    v_exp_f32 v245, v61
    v_exp_f32 v246, v62
    v_mfma_f32_16x16x32_bf16 v[36:39], a[56:59], v[160:163], v[64:67]
    ds_read_b64_tr_b16 a[48:49], v25 offset:0
    ds_read_b64_tr_b16 a[50:51], v25 offset:4096
    v_cvt_pk_bf16_f32 v94, v244, v245
    v_mfma_f32_16x16x32_bf16 v[36:39], a[60:63], v[164:167], v[36:39]
    v_exp_f32 v247, v63
    v_or3_b32 v14, v88, v89, v90
    v_mfma_f32_16x16x32_bf16 v[36:39], a[64:67], v[168:171], v[36:39]
    ds_read_b64_tr_b16 a[52:53], v26 offset:0
    ds_read_b64_tr_b16 a[54:55], v26 offset:4096
    v_cvt_pk_bf16_f32 v95, v246, v247
    v_mfma_f32_16x16x32_bf16 v[36:39], a[68:71], v[172:175], v[36:39]
    v_or3_b32 v14, v14, v91, v92
    v_or3_b32 v14, v14, v93, v94
    v_bitop3_b32 v14, v14, v95, s72 bitop3:0xa8
    v_mfma_f32_16x16x32_bf16 v[44:47], a[56:59], v[176:179], v[68:71]
    ds_read_b64_tr_b16 a[56:57], v27 offset:0
    ds_read_b64_tr_b16 a[58:59], v27 offset:4096
    s_add_u32 m0, s79, 114688
    s_add_u32 s82, s81, 237568
    s_and_b32 s82, s82, 0x7ffff
    buffer_load_dwordx4 v252, s[56:59], s82 offen lds
    v_mfma_f32_16x16x32_bf16 v[44:47], a[60:63], v[180:183], v[44:47]
    buffer_load_dwordx4 v253, s[56:59], s82 offen offset:1024 lds
    v_mfma_f32_16x16x32_bf16 v[44:47], a[64:67], v[184:187], v[44:47]
    v_cmp_ne_u32 vcc, 0, v14
    v_mfma_f32_16x16x32_bf16 v[44:47], a[68:71], v[188:191], v[44:47]
    s_cbranch_vccnz LA_r1_23
LA_b1_23:
    s_waitcnt lgkmcnt(0)
    s_barrier
    v_mfma_f32_16x16x32_bf16 v[96:99], a[72:75], v[88:91], v[96:99]
    ds_read_b128 a[60:63], v16 offset:32768
    ds_read_b128 a[64:67], v17 offset:32768
    ds_read_b128 a[68:71], v18 offset:32768
    s_add_u32 m0, s78, 16384
    s_mov_b32 s9, 229376
    buffer_load_dwordx4 v8, s[44:47], s9 offen nt lds
    v_mfma_f32_16x16x32_bf16 v[100:103], a[72:75], v[92:95], v[100:103]
    ds_read_b128 a[72:75], v19 offset:32768
    v_mfma_f32_16x16x32_bf16 v[104:107], a[32:35], v[88:91], v[104:107]
    buffer_load_dwordx4 v9, s[44:47], s9 offen offset:1024 nt lds
    s_waitcnt vmcnt(8)
    v_add_u32 v28, 65536, v28
    v_add_u32 v29, 65536, v29
    v_add_u32 v30, 65536, v30
    v_add_u32 v31, 65536, v31
    ds_read_b64_tr_b16 v[208:209], v28 offset:32768
    v_mfma_f32_16x16x32_bf16 v[108:111], a[32:35], v[92:95], v[108:111]
    ds_read_b128 a[32:35], v16 offset:36864
    v_exp_f32 v244, v32
    v_mfma_f32_16x16x32_bf16 v[112:115], a[36:39], v[88:91], v[112:115]
    s_add_u32 m0, s79, 114688
    s_nop 0
    buffer_load_dwordx4 v254, s[56:59], s82 offen offset:2048 lds
    ds_read_b64_tr_b16 v[210:211], v28 offset:34816
    v_mfma_f32_16x16x32_bf16 v[116:119], a[36:39], v[92:95], v[116:119]
    ds_read_b128 a[36:39], v17 offset:36864
    v_exp_f32 v245, v33
    v_mfma_f32_16x16x32_bf16 v[120:123], a[40:43], v[88:91], v[120:123]
    buffer_load_dwordx4 v255, s[56:59], s82 offen offset:3072 lds
    ds_read_b64_tr_b16 v[212:213], v29 offset:32768
    ds_read_b64_tr_b16 v[214:215], v29 offset:34816
    v_mfma_f32_16x16x32_bf16 v[124:127], a[40:43], v[92:95], v[124:127]
    ds_read_b128 a[40:43], v18 offset:36864
    v_exp_f32 v246, v34
    v_mfma_f32_16x16x32_bf16 v[128:131], a[44:47], v[88:91], v[128:131]
    ds_read_b64_tr_b16 v[216:217], v30 offset:32768
    ds_read_b64_tr_b16 v[218:219], v30 offset:34816
    v_cvt_pk_bf16_f32 v80, v244, v245
    v_mfma_f32_16x16x32_bf16 v[132:135], a[44:47], v[92:95], v[132:135]
    ds_read_b128 a[44:47], v19 offset:36864
    v_exp_f32 v247, v35
    v_mfma_f32_16x16x32_bf16 v[136:139], a[48:51], v[88:91], v[136:139]
    ds_read_b64_tr_b16 v[220:221], v31 offset:32768
    ds_read_b64_tr_b16 v[222:223], v31 offset:34816
    v_mfma_f32_16x16x32_bf16 v[140:143], a[48:51], v[92:95], v[140:143]
    ds_read_b64_tr_b16 a[48:49], v20 offset:8192
    ds_read_b64_tr_b16 a[50:51], v20 offset:12288
    v_mfma_f32_16x16x32_bf16 v[144:147], a[52:55], v[88:91], v[144:147]
    v_exp_f32 v244, v36
    v_cvt_pk_bf16_f32 v81, v246, v247
    v_mfma_f32_16x16x32_bf16 v[148:151], a[52:55], v[92:95], v[148:151]
    ds_read_b64_tr_b16 a[52:53], v21 offset:8192
    ds_read_b64_tr_b16 a[54:55], v21 offset:12288
    v_mfma_f32_16x16x32_bf16 v[152:155], a[56:59], v[88:91], v[152:155]
    v_exp_f32 v245, v37
    v_mfma_f32_16x16x32_bf16 v[156:159], a[56:59], v[92:95], v[156:159]
    ds_read_b64_tr_b16 a[56:57], v22 offset:8192
    ds_read_b64_tr_b16 a[58:59], v22 offset:12288
    v_mfma_f32_16x16x32_bf16 v[76:79], a[76:79], v[88:91], v[76:79]
    v_exp_f32 v246, v38
    v_cvt_pk_bf16_f32 v82, v244, v245
    v_mfma_f32_16x16x32_bf16 v[240:243], a[76:79], v[92:95], v[240:243]
    v_exp_f32 v247, v39
    s_waitcnt lgkmcnt(8)
    v_mfma_f32_16x16x32_bf16 v[48:51], a[60:63], v[160:163], v[64:67]
    v_exp_f32 v244, v40
    v_cvt_pk_bf16_f32 v83, v246, v247
    v_mfma_f32_16x16x32_bf16 v[48:51], a[64:67], v[164:167], v[48:51]
    v_exp_f32 v245, v41
    v_mfma_f32_16x16x32_bf16 v[48:51], a[68:71], v[168:171], v[48:51]
    v_exp_f32 v246, v42
    v_cvt_pk_bf16_f32 v84, v244, v245
    v_mfma_f32_16x16x32_bf16 v[48:51], a[72:75], v[172:175], v[48:51]
    v_exp_f32 v247, v43
    v_mfma_f32_16x16x32_bf16 v[56:59], a[60:63], v[176:179], v[68:71]
    ds_read_b64_tr_b16 a[60:61], v23 offset:8192
    ds_read_b64_tr_b16 a[62:63], v23 offset:12288
    v_mfma_f32_16x16x32_bf16 v[56:59], a[64:67], v[180:183], v[56:59]
    v_exp_f32 v244, v44
    v_cvt_pk_bf16_f32 v85, v246, v247
    v_mfma_f32_16x16x32_bf16 v[56:59], a[68:71], v[184:187], v[56:59]
    ds_read_b64_tr_b16 a[64:65], v24 offset:8192
    ds_read_b64_tr_b16 a[66:67], v24 offset:12288
    v_mfma_f32_16x16x32_bf16 v[56:59], a[72:75], v[188:191], v[56:59]
    v_exp_f32 v245, v45
    v_mfma_f32_16x16x32_bf16 v[52:55], a[32:35], v[160:163], v[64:67]
    ds_read_b64_tr_b16 a[68:69], v25 offset:8192
    ds_read_b64_tr_b16 a[70:71], v25 offset:12288
    v_exp_f32 v246, v46
    v_mfma_f32_16x16x32_bf16 v[52:55], a[36:39], v[164:167], v[52:55]
    v_cvt_pk_bf16_f32 v86, v244, v245
    v_exp_f32 v247, v47
    v_mfma_f32_16x16x32_bf16 v[52:55], a[40:43], v[168:171], v[52:55]
    ds_read_b64_tr_b16 a[72:73], v26 offset:8192
    ds_read_b64_tr_b16 a[74:75], v26 offset:12288
    v_or3_b32 v14, v80, v81, v82
    v_mfma_f32_16x16x32_bf16 v[52:55], a[44:47], v[172:175], v[52:55]
    v_cvt_pk_bf16_f32 v87, v246, v247
    v_or3_b32 v14, v14, v83, v84
    v_or3_b32 v14, v14, v85, v86
    v_mfma_f32_16x16x32_bf16 v[60:63], a[32:35], v[176:179], v[68:71]
    ds_read_b64_tr_b16 a[32:33], v27 offset:8192
    ds_read_b64_tr_b16 a[34:35], v27 offset:12288
    s_add_u32 m0, s79, 49152
    s_add_u32 s82, s81, 262144
    s_and_b32 s82, s82, 0x7ffff
    buffer_load_dwordx4 v252, s[56:59], s82 offen lds
    v_mfma_f32_16x16x32_bf16 v[60:63], a[36:39], v[180:183], v[60:63]
    v_bitop3_b32 v14, v14, v87, s72 bitop3:0xa8
    v_mfma_f32_16x16x32_bf16 v[60:63], a[40:43], v[184:187], v[60:63]
    v_cmp_ne_u32 vcc, 0, v14
    v_mfma_f32_16x16x32_bf16 v[60:63], a[44:47], v[188:191], v[60:63]
    s_cbranch_vccnz LA_r1_24
LA_b1_24:
    s_waitcnt lgkmcnt(0)
    s_barrier
    v_mfma_f32_16x16x32_bf16 v[96:99], a[48:51], v[80:83], v[96:99]
    ds_read_b128 a[36:39], v16 offset:0
    ds_read_b128 a[40:43], v17 offset:0
    ds_read_b128 a[44:47], v18 offset:0
    s_add_u32 m0, s78, 65536
    s_mov_b32 s9, 221184
    buffer_load_dwordx4 v10, s[48:51], s9 offen nt lds
    v_mfma_f32_16x16x32_bf16 v[100:103], a[48:51], v[84:87], v[100:103]
    ds_read_b128 a[48:51], v19 offset:0
    v_mfma_f32_16x16x32_bf16 v[104:107], a[52:55], v[80:83], v[104:107]
    buffer_load_dwordx4 v5, s[48:51], s9 offen offset:1024 nt lds
    v_exp_f32 v244, v48
    v_mfma_f32_16x16x32_bf16 v[108:111], a[52:55], v[84:87], v[108:111]
    ds_read_b128 a[52:55], v16 offset:4096
    v_exp_f32 v245, v49
    v_mfma_f32_16x16x32_bf16 v[112:115], a[56:59], v[80:83], v[112:115]
    s_add_u32 m0, s78, 24576
    s_mov_b32 s9, 237568
    buffer_load_dwordx4 v8, s[44:47], s9 offen nt lds
    v_mfma_f32_16x16x32_bf16 v[116:119], a[56:59], v[84:87], v[116:119]
    ds_read_b128 a[56:59], v17 offset:4096
    v_exp_f32 v246, v50
    v_mfma_f32_16x16x32_bf16 v[120:123], a[60:63], v[80:83], v[120:123]
    buffer_load_dwordx4 v9, s[44:47], s9 offen offset:1024 nt lds
    v_cvt_pk_bf16_f32 v88, v244, v245
    v_mfma_f32_16x16x32_bf16 v[124:127], a[60:63], v[84:87], v[124:127]
    ds_read_b128 a[60:63], v18 offset:4096
    v_exp_f32 v247, v51
    v_mfma_f32_16x16x32_bf16 v[128:131], a[64:67], v[80:83], v[128:131]
    v_exp_f32 v244, v52
    v_mfma_f32_16x16x32_bf16 v[132:135], a[64:67], v[84:87], v[132:135]
    ds_read_b128 a[64:67], v19 offset:4096
    v_cvt_pk_bf16_f32 v89, v246, v247
    v_mfma_f32_16x16x32_bf16 v[136:139], a[68:71], v[80:83], v[136:139]
    v_exp_f32 v245, v53
    v_mfma_f32_16x16x32_bf16 v[140:143], a[68:71], v[84:87], v[140:143]
    ds_read_b64_tr_b16 a[68:69], v20 offset:16384
    ds_read_b64_tr_b16 a[70:71], v20 offset:20480
    v_mfma_f32_16x16x32_bf16 v[144:147], a[72:75], v[80:83], v[144:147]
    v_exp_f32 v246, v54
    v_mfma_f32_16x16x32_bf16 v[148:151], a[72:75], v[84:87], v[148:151]
    ds_read_b64_tr_b16 a[72:73], v21 offset:16384
    ds_read_b64_tr_b16 a[74:75], v21 offset:20480
    v_mfma_f32_16x16x32_bf16 v[152:155], a[32:35], v[80:83], v[152:155]
    v_cvt_pk_bf16_f32 v90, v244, v245
    v_exp_f32 v247, v55
    v_mfma_f32_16x16x32_bf16 v[156:159], a[32:35], v[84:87], v[156:159]
    ds_read_b64_tr_b16 a[32:33], v22 offset:16384
    ds_read_b64_tr_b16 a[34:35], v22 offset:20480
    v_mfma_f32_16x16x32_bf16 v[76:79], a[76:79], v[80:83], v[76:79]
    v_exp_f32 v244, v56
    v_mfma_f32_16x16x32_bf16 v[240:243], a[76:79], v[84:87], v[240:243]
    v_cvt_pk_bf16_f32 v91, v246, v247
    v_exp_f32 v245, v57
    s_waitcnt lgkmcnt(6)
    v_mfma_f32_16x16x32_bf16 v[32:35], a[36:39], v[160:163], v[64:67]
    v_exp_f32 v246, v58
    v_mfma_f32_16x16x32_bf16 v[32:35], a[40:43], v[164:167], v[32:35]
    v_cvt_pk_bf16_f32 v92, v244, v245
    v_exp_f32 v247, v59
    v_mfma_f32_16x16x32_bf16 v[32:35], a[44:47], v[168:171], v[32:35]
    v_exp_f32 v244, v60
    v_mfma_f32_16x16x32_bf16 v[32:35], a[48:51], v[172:175], v[32:35]
    v_cvt_pk_bf16_f32 v93, v246, v247
    v_exp_f32 v245, v61
    v_mfma_f32_16x16x32_bf16 v[40:43], a[36:39], v[176:179], v[68:71]
    ds_read_b64_tr_b16 a[36:37], v23 offset:16384
    ds_read_b64_tr_b16 a[38:39], v23 offset:20480
    v_mfma_f32_16x16x32_bf16 v[40:43], a[40:43], v[180:183], v[40:43]
    v_exp_f32 v246, v62
    v_mfma_f32_16x16x32_bf16 v[40:43], a[44:47], v[184:187], v[40:43]
    ds_read_b64_tr_b16 a[40:41], v24 offset:16384
    ds_read_b64_tr_b16 a[42:43], v24 offset:20480
    v_mfma_f32_16x16x32_bf16 v[40:43], a[48:51], v[188:191], v[40:43]
    v_cvt_pk_bf16_f32 v94, v244, v245
    v_exp_f32 v247, v63
    v_mfma_f32_16x16x32_bf16 v[36:39], a[52:55], v[160:163], v[64:67]
    ds_read_b64_tr_b16 a[44:45], v25 offset:16384
    ds_read_b64_tr_b16 a[46:47], v25 offset:20480
    v_mfma_f32_16x16x32_bf16 v[36:39], a[56:59], v[164:167], v[36:39]
    v_or3_b32 v14, v88, v89, v90
    v_cvt_pk_bf16_f32 v95, v246, v247
    v_mfma_f32_16x16x32_bf16 v[36:39], a[60:63], v[168:171], v[36:39]
    ds_read_b64_tr_b16 a[48:49], v26 offset:16384
    ds_read_b64_tr_b16 a[50:51], v26 offset:20480
    v_mfma_f32_16x16x32_bf16 v[36:39], a[64:67], v[172:175], v[36:39]
    v_or3_b32 v14, v14, v91, v92
    v_or3_b32 v14, v14, v93, v94
    v_mfma_f32_16x16x32_bf16 v[44:47], a[52:55], v[176:179], v[68:71]
    ds_read_b64_tr_b16 a[52:53], v27 offset:16384
    ds_read_b64_tr_b16 a[54:55], v27 offset:20480
    s_add_u32 m0, s79, 49152
    s_nop 0
    buffer_load_dwordx4 v253, s[56:59], s82 offen offset:1024 lds
    v_mfma_f32_16x16x32_bf16 v[44:47], a[56:59], v[180:183], v[44:47]
    buffer_load_dwordx4 v254, s[56:59], s82 offen offset:2048 lds
    v_mfma_f32_16x16x32_bf16 v[44:47], a[60:63], v[184:187], v[44:47]
    v_bitop3_b32 v14, v14, v95, s72 bitop3:0xa8
    v_cmp_ne_u32 vcc, 0, v14
    v_mfma_f32_16x16x32_bf16 v[44:47], a[64:67], v[188:191], v[44:47]
    s_cbranch_vccnz LA_r1_25
LA_b1_25:
    s_waitcnt vmcnt(13) lgkmcnt(0)
    s_barrier
    v_mfma_f32_16x16x32_bf16 v[96:99], a[68:71], v[88:91], v[96:99]
    ds_read_b128 a[56:59], v16 offset:8192
    ds_read_b128 a[60:63], v17 offset:8192
    ds_read_b128 a[64:67], v18 offset:8192
    s_add_u32 m0, s78, 73728
    s_mov_b32 s9, 229376
    buffer_load_dwordx4 v10, s[48:51], s9 offen nt lds
    v_mfma_f32_16x16x32_bf16 v[100:103], a[68:71], v[92:95], v[100:103]
    ds_read_b128 a[68:71], v19 offset:8192
    v_mfma_f32_16x16x32_bf16 v[104:107], a[72:75], v[88:91], v[104:107]
    buffer_load_dwordx4 v5, s[48:51], s9 offen offset:1024 nt lds
    s_waitcnt vmcnt(9)
    ds_read_b64_tr_b16 v[224:225], v28 offset:49152
    v_mfma_f32_16x16x32_bf16 v[108:111], a[72:75], v[92:95], v[108:111]
    ds_read_b128 a[72:75], v16 offset:12288
    v_exp_f32 v244, v32
    v_mfma_f32_16x16x32_bf16 v[112:115], a[32:35], v[88:91], v[112:115]
    s_add_u32 m0, s78, 0
    s_mov_b32 s9, 245760
    buffer_load_dwordx4 v8, s[44:47], s9 offen nt lds
    ds_read_b64_tr_b16 v[226:227], v28 offset:51200
    v_mfma_f32_16x16x32_bf16 v[116:119], a[32:35], v[92:95], v[116:119]
    ds_read_b128 a[32:35], v17 offset:12288
    v_exp_f32 v245, v33
    v_mfma_f32_16x16x32_bf16 v[120:123], a[36:39], v[88:91], v[120:123]
    buffer_load_dwordx4 v9, s[44:47], s9 offen offset:1024 nt lds
    ds_read_b64_tr_b16 v[228:229], v29 offset:49152
    ds_read_b64_tr_b16 v[230:231], v29 offset:51200
    v_mfma_f32_16x16x32_bf16 v[124:127], a[36:39], v[92:95], v[124:127]
    ds_read_b128 a[36:39], v18 offset:12288
    v_exp_f32 v246, v34
    v_mfma_f32_16x16x32_bf16 v[128:131], a[40:43], v[88:91], v[128:131]
    ds_read_b64_tr_b16 v[232:233], v30 offset:49152
    ds_read_b64_tr_b16 v[234:235], v30 offset:51200
    v_cvt_pk_bf16_f32 v80, v244, v245
    v_mfma_f32_16x16x32_bf16 v[132:135], a[40:43], v[92:95], v[132:135]
    ds_read_b128 a[40:43], v19 offset:12288
    v_exp_f32 v247, v35
    v_mfma_f32_16x16x32_bf16 v[136:139], a[44:47], v[88:91], v[136:139]
    ds_read_b64_tr_b16 v[236:237], v31 offset:49152
    ds_read_b64_tr_b16 v[238:239], v31 offset:51200
    v_mfma_f32_16x16x32_bf16 v[140:143], a[44:47], v[92:95], v[140:143]
    ds_read_b64_tr_b16 a[44:45], v20 offset:24576
    ds_read_b64_tr_b16 a[46:47], v20 offset:28672
    v_mfma_f32_16x16x32_bf16 v[144:147], a[48:51], v[88:91], v[144:147]
    v_exp_f32 v244, v36
    v_cvt_pk_bf16_f32 v81, v246, v247
    v_mfma_f32_16x16x32_bf16 v[148:151], a[48:51], v[92:95], v[148:151]
    ds_read_b64_tr_b16 a[48:49], v21 offset:24576
    ds_read_b64_tr_b16 a[50:51], v21 offset:28672
    v_mfma_f32_16x16x32_bf16 v[152:155], a[52:55], v[88:91], v[152:155]
    v_exp_f32 v245, v37
    v_mfma_f32_16x16x32_bf16 v[156:159], a[52:55], v[92:95], v[156:159]
    ds_read_b64_tr_b16 a[52:53], v22 offset:24576
    ds_read_b64_tr_b16 a[54:55], v22 offset:28672
    v_mfma_f32_16x16x32_bf16 v[76:79], a[76:79], v[88:91], v[76:79]
    v_exp_f32 v246, v38
    v_cvt_pk_bf16_f32 v82, v244, v245
    v_mfma_f32_16x16x32_bf16 v[240:243], a[76:79], v[92:95], v[240:243]
    v_exp_f32 v247, v39
    s_waitcnt lgkmcnt(8)
    v_mfma_f32_16x16x32_bf16 v[48:51], a[56:59], v[160:163], v[64:67]
    v_exp_f32 v244, v40
    v_cvt_pk_bf16_f32 v83, v246, v247
    v_mfma_f32_16x16x32_bf16 v[48:51], a[60:63], v[164:167], v[48:51]
    v_exp_f32 v245, v41
    v_mfma_f32_16x16x32_bf16 v[48:51], a[64:67], v[168:171], v[48:51]
    v_exp_f32 v246, v42
    v_cvt_pk_bf16_f32 v84, v244, v245
    v_mfma_f32_16x16x32_bf16 v[48:51], a[68:71], v[172:175], v[48:51]
    v_exp_f32 v247, v43
    v_mfma_f32_16x16x32_bf16 v[56:59], a[56:59], v[176:179], v[68:71]
    ds_read_b64_tr_b16 a[56:57], v23 offset:24576
    ds_read_b64_tr_b16 a[58:59], v23 offset:28672
    v_exp_f32 v244, v44
    v_mfma_f32_16x16x32_bf16 v[56:59], a[60:63], v[180:183], v[56:59]
    v_cvt_pk_bf16_f32 v85, v246, v247
    v_exp_f32 v245, v45
    v_mfma_f32_16x16x32_bf16 v[56:59], a[64:67], v[184:187], v[56:59]
    ds_read_b64_tr_b16 a[60:61], v24 offset:24576
    ds_read_b64_tr_b16 a[62:63], v24 offset:28672
    v_mfma_f32_16x16x32_bf16 v[56:59], a[68:71], v[188:191], v[56:59]
    v_exp_f32 v246, v46
    v_cvt_pk_bf16_f32 v86, v244, v245
    v_mfma_f32_16x16x32_bf16 v[52:55], a[72:75], v[160:163], v[64:67]
    ds_read_b64_tr_b16 a[64:65], v25 offset:24576
    ds_read_b64_tr_b16 a[66:67], v25 offset:28672
    v_exp_f32 v247, v47
    v_mfma_f32_16x16x32_bf16 v[52:55], a[32:35], v[164:167], v[52:55]
    v_or3_b32 v14, v80, v81, v82
    v_cvt_pk_bf16_f32 v87, v246, v247
    v_or3_b32 v14, v14, v83, v84
    v_mfma_f32_16x16x32_bf16 v[52:55], a[36:39], v[168:171], v[52:55]
    ds_read_b64_tr_b16 a[68:69], v26 offset:24576
    ds_read_b64_tr_b16 a[70:71], v26 offset:28672
    s_add_u32 m0, s79, 49152
    s_nop 0
    buffer_load_dwordx4 v255, s[56:59], s82 offen offset:3072 lds
    v_mfma_f32_16x16x32_bf16 v[52:55], a[40:43], v[172:175], v[52:55]
    v_or3_b32 v14, v14, v85, v86
    v_bitop3_b32 v14, v14, v87, s72 bitop3:0xa8
    v_cmp_ne_u32 vcc, 0, v14
    v_mfma_f32_16x16x32_bf16 v[60:63], a[72:75], v[176:179], v[68:71]
    ds_read_b64_tr_b16 a[72:73], v27 offset:24576
    ds_read_b64_tr_b16 a[74:75], v27 offset:28672
    s_add_u32 m0, s79, 32768
    s_add_u32 s82, s81, 270336
    s_and_b32 s82, s82, 0x7ffff
    buffer_load_dwordx4 v252, s[56:59], s82 offen lds
    v_mfma_f32_16x16x32_bf16 v[60:63], a[32:35], v[180:183], v[60:63]
    buffer_load_dwordx4 v253, s[56:59], s82 offen offset:1024 lds
    v_mfma_f32_16x16x32_bf16 v[60:63], a[36:39], v[184:187], v[60:63]
    v_mfma_f32_16x16x32_bf16 v[60:63], a[40:43], v[188:191], v[60:63]
    s_cbranch_vccnz LA_r1_26
LA_b1_26:
    s_waitcnt vmcnt(11) lgkmcnt(0)
    s_barrier
    v_mfma_f32_16x16x32_bf16 v[96:99], a[44:47], v[80:83], v[96:99]
    ds_read_b128 a[32:35], v16 offset:16384
    ds_read_b128 a[36:39], v17 offset:16384
    ds_read_b128 a[40:43], v18 offset:16384
    s_add_u32 m0, s78, 81920
    s_mov_b32 s9, 237568
    buffer_load_dwordx4 v10, s[48:51], s9 offen nt lds
    v_mfma_f32_16x16x32_bf16 v[100:103], a[44:47], v[84:87], v[100:103]
    ds_read_b128 a[44:47], v19 offset:16384
    v_mfma_f32_16x16x32_bf16 v[104:107], a[48:51], v[80:83], v[104:107]
    buffer_load_dwordx4 v5, s[48:51], s9 offen offset:1024 nt lds
    v_exp_f32 v244, v48
    v_mfma_f32_16x16x32_bf16 v[108:111], a[48:51], v[84:87], v[108:111]
    ds_read_b128 a[48:51], v16 offset:20480
    v_exp_f32 v245, v49
    v_mfma_f32_16x16x32_bf16 v[112:115], a[52:55], v[80:83], v[112:115]
    s_add_u32 m0, s79, 32768
    s_nop 0
    buffer_load_dwordx4 v254, s[56:59], s82 offen offset:2048 lds
    v_mfma_f32_16x16x32_bf16 v[116:119], a[52:55], v[84:87], v[116:119]
    ds_read_b128 a[52:55], v17 offset:20480
    v_exp_f32 v246, v50
    v_mfma_f32_16x16x32_bf16 v[120:123], a[56:59], v[80:83], v[120:123]
    buffer_load_dwordx4 v255, s[56:59], s82 offen offset:3072 lds
    v_cvt_pk_bf16_f32 v88, v244, v245
    v_mfma_f32_16x16x32_bf16 v[124:127], a[56:59], v[84:87], v[124:127]
    ds_read_b128 a[56:59], v18 offset:20480
    v_exp_f32 v247, v51
    v_mfma_f32_16x16x32_bf16 v[128:131], a[60:63], v[80:83], v[128:131]
    v_exp_f32 v244, v52
    v_mfma_f32_16x16x32_bf16 v[132:135], a[60:63], v[84:87], v[132:135]
    ds_read_b128 a[60:63], v19 offset:20480
    v_cvt_pk_bf16_f32 v89, v246, v247
    v_mfma_f32_16x16x32_bf16 v[136:139], a[64:67], v[80:83], v[136:139]
    v_exp_f32 v245, v53
    v_mfma_f32_16x16x32_bf16 v[140:143], a[64:67], v[84:87], v[140:143]
    ds_read_b64_tr_b16 a[64:65], v20 offset:0
    ds_read_b64_tr_b16 a[66:67], v20 offset:4096
    v_mfma_f32_16x16x32_bf16 v[144:147], a[68:71], v[80:83], v[144:147]
    v_exp_f32 v246, v54
    v_mfma_f32_16x16x32_bf16 v[148:151], a[68:71], v[84:87], v[148:151]
    ds_read_b64_tr_b16 a[68:69], v21 offset:0
    ds_read_b64_tr_b16 a[70:71], v21 offset:4096
    v_mfma_f32_16x16x32_bf16 v[152:155], a[72:75], v[80:83], v[152:155]
    v_cvt_pk_bf16_f32 v90, v244, v245
    v_exp_f32 v247, v55
    v_mfma_f32_16x16x32_bf16 v[156:159], a[72:75], v[84:87], v[156:159]
    ds_read_b64_tr_b16 a[72:73], v22 offset:0
    ds_read_b64_tr_b16 a[74:75], v22 offset:4096
    v_mfma_f32_16x16x32_bf16 v[76:79], a[76:79], v[80:83], v[76:79]
    v_exp_f32 v244, v56
    v_mfma_f32_16x16x32_bf16 v[240:243], a[76:79], v[84:87], v[240:243]
    v_cvt_pk_bf16_f32 v91, v246, v247
    v_exp_f32 v245, v57
    s_waitcnt lgkmcnt(6)
    v_mfma_f32_16x16x32_bf16 v[32:35], a[32:35], v[160:163], v[64:67]
    v_exp_f32 v246, v58
    v_mfma_f32_16x16x32_bf16 v[32:35], a[36:39], v[164:167], v[32:35]
    v_cvt_pk_bf16_f32 v92, v244, v245
    v_exp_f32 v247, v59
    v_mfma_f32_16x16x32_bf16 v[32:35], a[40:43], v[168:171], v[32:35]
    v_exp_f32 v244, v60
    v_mfma_f32_16x16x32_bf16 v[32:35], a[44:47], v[172:175], v[32:35]
    v_cvt_pk_bf16_f32 v93, v246, v247
    v_exp_f32 v245, v61
    v_mfma_f32_16x16x32_bf16 v[40:43], a[32:35], v[176:179], v[68:71]
    ds_read_b64_tr_b16 a[32:33], v23 offset:0
    ds_read_b64_tr_b16 a[34:35], v23 offset:4096
    v_mfma_f32_16x16x32_bf16 v[40:43], a[36:39], v[180:183], v[40:43]
    v_exp_f32 v246, v62
    v_mfma_f32_16x16x32_bf16 v[40:43], a[40:43], v[184:187], v[40:43]
    ds_read_b64_tr_b16 a[36:37], v24 offset:0
    ds_read_b64_tr_b16 a[38:39], v24 offset:4096
    v_mfma_f32_16x16x32_bf16 v[40:43], a[44:47], v[188:191], v[40:43]
    v_cvt_pk_bf16_f32 v94, v244, v245
    v_mfma_f32_16x16x32_bf16 v[36:39], a[48:51], v[160:163], v[64:67]
    ds_read_b64_tr_b16 a[40:41], v25 offset:0
    ds_read_b64_tr_b16 a[42:43], v25 offset:4096
    v_mfma_f32_16x16x32_bf16 v[36:39], a[52:55], v[164:167], v[36:39]
    v_exp_f32 v247, v63
    v_mfma_f32_16x16x32_bf16 v[36:39], a[56:59], v[168:171], v[36:39]
    ds_read_b64_tr_b16 a[44:45], v26 offset:0
    ds_read_b64_tr_b16 a[46:47], v26 offset:4096
    v_mfma_f32_16x16x32_bf16 v[36:39], a[60:63], v[172:175], v[36:39]
    v_or3_b32 v14, v88, v89, v90
    v_cvt_pk_bf16_f32 v95, v246, v247
    v_mfma_f32_16x16x32_bf16 v[44:47], a[48:51], v[176:179], v[68:71]
    ds_read_b64_tr_b16 a[48:49], v27 offset:0
    ds_read_b64_tr_b16 a[50:51], v27 offset:4096
    v_mfma_f32_16x16x32_bf16 v[44:47], a[52:55], v[180:183], v[44:47]
    v_or3_b32 v14, v14, v91, v92
    v_or3_b32 v14, v14, v93, v94
    v_mfma_f32_16x16x32_bf16 v[44:47], a[56:59], v[184:187], v[44:47]
    v_bitop3_b32 v14, v14, v95, s72 bitop3:0xa8
    v_cmp_ne_u32 vcc, 0, v14
    v_mfma_f32_16x16x32_bf16 v[44:47], a[60:63], v[188:191], v[44:47]
    s_cbranch_vccnz LA_r1_27
LA_b1_27:
    s_waitcnt vmcnt(9) lgkmcnt(0)
    s_barrier
    v_mfma_f32_16x16x32_bf16 v[96:99], a[64:67], v[88:91], v[96:99]
    ds_read_b128 a[52:55], v16 offset:24576
    ds_read_b128 a[56:59], v17 offset:24576
    ds_read_b128 a[60:63], v18 offset:24576
    s_add_u32 m0, s78, 8192
    s_mov_b32 s9, 253952
    buffer_load_dwordx4 v8, s[44:47], s9 offen nt lds
    v_mfma_f32_16x16x32_bf16 v[100:103], a[64:67], v[92:95], v[100:103]
    ds_read_b128 a[64:67], v19 offset:24576
    v_mfma_f32_16x16x32_bf16 v[104:107], a[68:71], v[88:91], v[104:107]
    buffer_load_dwordx4 v9, s[44:47], s9 offen offset:1024 nt lds
    v_exp_f32 v244, v32
    v_mfma_f32_16x16x32_bf16 v[108:111], a[68:71], v[92:95], v[108:111]
    ds_read_b128 a[68:71], v16 offset:28672
    v_exp_f32 v245, v33
    v_mfma_f32_16x16x32_bf16 v[112:115], a[72:75], v[88:91], v[112:115]
    s_add_u32 m0, s78, 65536
    s_mov_b32 s9, 245760
    buffer_load_dwordx4 v10, s[48:51], s9 offen nt lds
    v_mfma_f32_16x16x32_bf16 v[116:119], a[72:75], v[92:95], v[116:119]
    ds_read_b128 a[72:75], v17 offset:28672
    v_exp_f32 v246, v34
    v_mfma_f32_16x16x32_bf16 v[120:123], a[32:35], v[88:91], v[120:123]
    buffer_load_dwordx4 v5, s[48:51], s9 offen offset:1024 nt lds
    v_cvt_pk_bf16_f32 v80, v244, v245
    v_mfma_f32_16x16x32_bf16 v[124:127], a[32:35], v[92:95], v[124:127]
    ds_read_b128 a[32:35], v18 offset:28672
    v_exp_f32 v247, v35
    v_mfma_f32_16x16x32_bf16 v[128:131], a[36:39], v[88:91], v[128:131]
    v_exp_f32 v244, v36
    v_mfma_f32_16x16x32_bf16 v[132:135], a[36:39], v[92:95], v[132:135]
    ds_read_b128 a[36:39], v19 offset:28672
    v_cvt_pk_bf16_f32 v81, v246, v247
    v_mfma_f32_16x16x32_bf16 v[136:139], a[40:43], v[88:91], v[136:139]
    v_exp_f32 v245, v37
    v_mfma_f32_16x16x32_bf16 v[140:143], a[40:43], v[92:95], v[140:143]
    ds_read_b64_tr_b16 a[40:41], v20 offset:8192
    ds_read_b64_tr_b16 a[42:43], v20 offset:12288
    v_mfma_f32_16x16x32_bf16 v[144:147], a[44:47], v[88:91], v[144:147]
    v_exp_f32 v246, v38
    v_cvt_pk_bf16_f32 v82, v244, v245
    v_mfma_f32_16x16x32_bf16 v[148:151], a[44:47], v[92:95], v[148:151]
    ds_read_b64_tr_b16 a[44:45], v21 offset:8192
    ds_read_b64_tr_b16 a[46:47], v21 offset:12288
    v_mfma_f32_16x16x32_bf16 v[152:155], a[48:51], v[88:91], v[152:155]
    v_exp_f32 v247, v39
    v_mfma_f32_16x16x32_bf16 v[156:159], a[48:51], v[92:95], v[156:159]
    ds_read_b64_tr_b16 a[48:49], v22 offset:8192
    ds_read_b64_tr_b16 a[50:51], v22 offset:12288
    v_mfma_f32_16x16x32_bf16 v[76:79], a[76:79], v[88:91], v[76:79]
    v_exp_f32 v244, v40
    v_cvt_pk_bf16_f32 v83, v246, v247
    v_mfma_f32_16x16x32_bf16 v[240:243], a[76:79], v[92:95], v[240:243]
    v_exp_f32 v245, v41
    s_waitcnt lgkmcnt(6)
    v_mfma_f32_16x16x32_bf16 v[48:51], a[52:55], v[160:163], v[64:67]
    v_exp_f32 v246, v42
    v_cvt_pk_bf16_f32 v84, v244, v245
    v_mfma_f32_16x16x32_bf16 v[48:51], a[56:59], v[164:167], v[48:51]
    v_exp_f32 v247, v43
    v_mfma_f32_16x16x32_bf16 v[48:51], a[60:63], v[168:171], v[48:51]
    v_exp_f32 v244, v44
    v_cvt_pk_bf16_f32 v85, v246, v247
    v_mfma_f32_16x16x32_bf16 v[48:51], a[64:67], v[172:175], v[48:51]
    v_exp_f32 v245, v45
    v_mfma_f32_16x16x32_bf16 v[56:59], a[52:55], v[176:179], v[68:71]
    ds_read_b64_tr_b16 a[52:53], v23 offset:8192
    ds_read_b64_tr_b16 a[54:55], v23 offset:12288
    v_mfma_f32_16x16x32_bf16 v[56:59], a[56:59], v[180:183], v[56:59]
    v_exp_f32 v246, v46
    v_cvt_pk_bf16_f32 v86, v244, v245
    v_mfma_f32_16x16x32_bf16 v[56:59], a[60:63], v[184:187], v[56:59]
    ds_read_b64_tr_b16 a[56:57], v24 offset:8192
    ds_read_b64_tr_b16 a[58:59], v24 offset:12288
    v_mfma_f32_16x16x32_bf16 v[56:59], a[64:67], v[188:191], v[56:59]
    v_exp_f32 v247, v47
    v_or3_b32 v14, v80, v81, v82
    v_mfma_f32_16x16x32_bf16 v[52:55], a[68:71], v[160:163], v[64:67]
    ds_read_b64_tr_b16 a[60:61], v25 offset:8192
    ds_read_b64_tr_b16 a[62:63], v25 offset:12288
    s_add_u32 m0, s79, 98304
    s_add_u32 s82, s81, 294912
    s_and_b32 s82, s82, 0x7ffff
    buffer_load_dwordx4 v252, s[56:59], s82 offen lds
    v_mfma_f32_16x16x32_bf16 v[52:55], a[72:75], v[164:167], v[52:55]
    v_cvt_pk_bf16_f32 v87, v246, v247
    v_or3_b32 v14, v14, v83, v84
    v_mfma_f32_16x16x32_bf16 v[52:55], a[32:35], v[168:171], v[52:55]
    ds_read_b64_tr_b16 a[64:65], v26 offset:8192
    ds_read_b64_tr_b16 a[66:67], v26 offset:12288
    buffer_load_dwordx4 v253, s[56:59], s82 offen offset:1024 lds
    v_mfma_f32_16x16x32_bf16 v[52:55], a[36:39], v[172:175], v[52:55]
    v_or3_b32 v14, v14, v85, v86
    v_bitop3_b32 v14, v14, v87, s72 bitop3:0xa8
    v_mfma_f32_16x16x32_bf16 v[60:63], a[68:71], v[176:179], v[68:71]
    ds_read_b64_tr_b16 a[68:69], v27 offset:8192
    ds_read_b64_tr_b16 a[70:71], v27 offset:12288
    buffer_load_dwordx4 v254, s[56:59], s82 offen offset:2048 lds
    v_mfma_f32_16x16x32_bf16 v[60:63], a[72:75], v[180:183], v[60:63]
    buffer_load_dwordx4 v255, s[56:59], s82 offen offset:3072 lds
    v_mfma_f32_16x16x32_bf16 v[60:63], a[32:35], v[184:187], v[60:63]
    v_cmp_ne_u32 vcc, 0, v14
    v_mfma_f32_16x16x32_bf16 v[60:63], a[36:39], v[188:191], v[60:63]
    s_cbranch_vccnz LA_r1_28
LA_b1_28:
    s_waitcnt vmcnt(10) lgkmcnt(0)
    s_barrier
    v_mfma_f32_16x16x32_bf16 v[96:99], a[40:43], v[80:83], v[96:99]
    ds_read_b128 a[72:75], v16 offset:0
    ds_read_b128 a[32:35], v17 offset:0
    ds_read_b128 a[36:39], v18 offset:0
    s_add_u32 m0, s78, 73728
    s_mov_b32 s9, 253952
    buffer_load_dwordx4 v10, s[48:51], s9 offen nt lds
    v_mfma_f32_16x16x32_bf16 v[100:103], a[40:43], v[84:87], v[100:103]
    ds_read_b128 a[40:43], v19 offset:0
    v_mfma_f32_16x16x32_bf16 v[104:107], a[44:47], v[80:83], v[104:107]
    buffer_load_dwordx4 v5, s[48:51], s9 offen offset:1024 nt lds
    v_exp_f32 v244, v48
    v_mfma_f32_16x16x32_bf16 v[108:111], a[44:47], v[84:87], v[108:111]
    ds_read_b128 a[44:47], v16 offset:4096
    v_exp_f32 v245, v49
    v_mfma_f32_16x16x32_bf16 v[112:115], a[48:51], v[80:83], v[112:115]
    s_add_u32 m0, s79, 114688
    s_add_u32 s82, s81, 303104
    s_and_b32 s82, s82, 0x7ffff
    buffer_load_dwordx4 v252, s[56:59], s82 offen lds
    v_mfma_f32_16x16x32_bf16 v[116:119], a[48:51], v[84:87], v[116:119]
    ds_read_b128 a[48:51], v17 offset:4096
    v_exp_f32 v246, v50
    v_mfma_f32_16x16x32_bf16 v[120:123], a[52:55], v[80:83], v[120:123]
    buffer_load_dwordx4 v253, s[56:59], s82 offen offset:1024 lds
    v_cvt_pk_bf16_f32 v88, v244, v245
    v_mfma_f32_16x16x32_bf16 v[124:127], a[52:55], v[84:87], v[124:127]
    ds_read_b128 a[52:55], v18 offset:4096
    v_exp_f32 v247, v51
    v_mfma_f32_16x16x32_bf16 v[128:131], a[56:59], v[80:83], v[128:131]
    v_exp_f32 v244, v52
    v_mfma_f32_16x16x32_bf16 v[132:135], a[56:59], v[84:87], v[132:135]
    ds_read_b128 a[56:59], v19 offset:4096
    v_cvt_pk_bf16_f32 v89, v246, v247
    v_mfma_f32_16x16x32_bf16 v[136:139], a[60:63], v[80:83], v[136:139]
    v_exp_f32 v245, v53
    v_mfma_f32_16x16x32_bf16 v[140:143], a[60:63], v[84:87], v[140:143]
    ds_read_b64_tr_b16 a[60:61], v20 offset:16384
    ds_read_b64_tr_b16 a[62:63], v20 offset:20480
    v_mfma_f32_16x16x32_bf16 v[144:147], a[64:67], v[80:83], v[144:147]
    v_exp_f32 v246, v54
    v_mfma_f32_16x16x32_bf16 v[148:151], a[64:67], v[84:87], v[148:151]
    ds_read_b64_tr_b16 a[64:65], v21 offset:16384
    ds_read_b64_tr_b16 a[66:67], v21 offset:20480
    v_mfma_f32_16x16x32_bf16 v[152:155], a[68:71], v[80:83], v[152:155]
    v_cvt_pk_bf16_f32 v90, v244, v245
    v_exp_f32 v247, v55
    v_mfma_f32_16x16x32_bf16 v[156:159], a[68:71], v[84:87], v[156:159]
    ds_read_b64_tr_b16 a[68:69], v22 offset:16384
    ds_read_b64_tr_b16 a[70:71], v22 offset:20480
    v_mfma_f32_16x16x32_bf16 v[76:79], a[76:79], v[80:83], v[76:79]
    v_exp_f32 v244, v56
    v_mfma_f32_16x16x32_bf16 v[240:243], a[76:79], v[84:87], v[240:243]
    v_cvt_pk_bf16_f32 v91, v246, v247
    v_exp_f32 v245, v57
    s_waitcnt lgkmcnt(6)
    v_mfma_f32_16x16x32_bf16 v[32:35], a[72:75], v[160:163], v[64:67]
    v_exp_f32 v246, v58
    v_mfma_f32_16x16x32_bf16 v[32:35], a[32:35], v[164:167], v[32:35]
    v_cvt_pk_bf16_f32 v92, v244, v245
    v_exp_f32 v247, v59
    v_mfma_f32_16x16x32_bf16 v[32:35], a[36:39], v[168:171], v[32:35]
    v_exp_f32 v244, v60
    v_mfma_f32_16x16x32_bf16 v[32:35], a[40:43], v[172:175], v[32:35]
    v_cvt_pk_bf16_f32 v93, v246, v247
    v_exp_f32 v245, v61
    v_mfma_f32_16x16x32_bf16 v[40:43], a[72:75], v[176:179], v[68:71]
    ds_read_b64_tr_b16 a[72:73], v23 offset:16384
    ds_read_b64_tr_b16 a[74:75], v23 offset:20480
    v_mfma_f32_16x16x32_bf16 v[40:43], a[32:35], v[180:183], v[40:43]
    v_exp_f32 v246, v62
    v_mfma_f32_16x16x32_bf16 v[40:43], a[36:39], v[184:187], v[40:43]
    ds_read_b64_tr_b16 a[32:33], v24 offset:16384
    ds_read_b64_tr_b16 a[34:35], v24 offset:20480
    v_mfma_f32_16x16x32_bf16 v[40:43], a[40:43], v[188:191], v[40:43]
    v_cvt_pk_bf16_f32 v94, v244, v245
    v_exp_f32 v247, v63
    v_mfma_f32_16x16x32_bf16 v[36:39], a[44:47], v[160:163], v[64:67]
    ds_read_b64_tr_b16 a[36:37], v25 offset:16384
    ds_read_b64_tr_b16 a[38:39], v25 offset:20480
    v_mfma_f32_16x16x32_bf16 v[36:39], a[48:51], v[164:167], v[36:39]
    v_or3_b32 v14, v88, v89, v90
    v_cvt_pk_bf16_f32 v95, v246, v247
    v_mfma_f32_16x16x32_bf16 v[36:39], a[52:55], v[168:171], v[36:39]
    ds_read_b64_tr_b16 a[40:41], v26 offset:16384
    ds_read_b64_tr_b16 a[42:43], v26 offset:20480
    v_mfma_f32_16x16x32_bf16 v[36:39], a[56:59], v[172:175], v[36:39]
    v_or3_b32 v14, v14, v91, v92
    v_or3_b32 v14, v14, v93, v94
    v_mfma_f32_16x16x32_bf16 v[44:47], a[44:47], v[176:179], v[68:71]
    ds_read_b64_tr_b16 a[44:45], v27 offset:16384
    ds_read_b64_tr_b16 a[46:47], v27 offset:20480
    buffer_load_dwordx4 v254, s[56:59], s82 offen offset:2048 lds
    v_mfma_f32_16x16x32_bf16 v[44:47], a[48:51], v[180:183], v[44:47]
    buffer_load_dwordx4 v255, s[56:59], s82 offen offset:3072 lds
    v_mfma_f32_16x16x32_bf16 v[44:47], a[52:55], v[184:187], v[44:47]
    v_bitop3_b32 v14, v14, v95, s72 bitop3:0xa8
    v_cmp_ne_u32 vcc, 0, v14
    v_mfma_f32_16x16x32_bf16 v[44:47], a[56:59], v[188:191], v[44:47]
    s_cbranch_vccnz LA_r1_29
LA_b1_29:
    s_waitcnt vmcnt(12) lgkmcnt(0)
    s_barrier
    v_mfma_f32_16x16x32_bf16 v[96:99], a[60:63], v[88:91], v[96:99]
    ds_read_b128 a[48:51], v16 offset:8192
    ds_read_b128 a[52:55], v17 offset:8192
    ds_read_b128 a[56:59], v18 offset:8192
    s_add_u32 m0, s79, 81920
    s_add_u32 s82, s81, 327680
    s_and_b32 s82, s82, 0x7ffff
    buffer_load_dwordx4 v252, s[56:59], s82 offen lds
    v_mfma_f32_16x16x32_bf16 v[100:103], a[60:63], v[92:95], v[100:103]
    ds_read_b128 a[60:63], v19 offset:8192
    v_mfma_f32_16x16x32_bf16 v[104:107], a[64:67], v[88:91], v[104:107]
    buffer_load_dwordx4 v253, s[56:59], s82 offen offset:1024 lds
    v_mfma_f32_16x16x32_bf16 v[108:111], a[64:67], v[92:95], v[108:111]
    ds_read_b128 a[64:67], v16 offset:12288
    v_exp_f32 v244, v32
    v_mfma_f32_16x16x32_bf16 v[112:115], a[68:71], v[88:91], v[112:115]
    buffer_load_dwordx4 v254, s[56:59], s82 offen offset:2048 lds
    v_mfma_f32_16x16x32_bf16 v[116:119], a[68:71], v[92:95], v[116:119]
    ds_read_b128 a[68:71], v17 offset:12288
    v_exp_f32 v245, v33
    v_mfma_f32_16x16x32_bf16 v[120:123], a[72:75], v[88:91], v[120:123]
    buffer_load_dwordx4 v255, s[56:59], s82 offen offset:3072 lds
    v_mfma_f32_16x16x32_bf16 v[124:127], a[72:75], v[92:95], v[124:127]
    ds_read_b128 a[72:75], v18 offset:12288
    v_exp_f32 v246, v34
    v_mfma_f32_16x16x32_bf16 v[128:131], a[32:35], v[88:91], v[128:131]
    v_cvt_pk_bf16_f32 v80, v244, v245
    v_exp_f32 v247, v35
    v_mfma_f32_16x16x32_bf16 v[132:135], a[32:35], v[92:95], v[132:135]
    ds_read_b128 a[32:35], v19 offset:12288
    v_exp_f32 v244, v36
    v_mfma_f32_16x16x32_bf16 v[136:139], a[36:39], v[88:91], v[136:139]
    v_cvt_pk_bf16_f32 v81, v246, v247
    v_exp_f32 v245, v37
    v_mfma_f32_16x16x32_bf16 v[140:143], a[36:39], v[92:95], v[140:143]
    s_waitcnt vmcnt(14)
    s_barrier
    ds_read_b64_tr_b16 a[36:37], v20 offset:0
    ds_read_b64_tr_b16 a[38:39], v20 offset:4096
    v_mfma_f32_16x16x32_bf16 v[144:147], a[40:43], v[88:91], v[144:147]
    v_exp_f32 v246, v38
    v_mfma_f32_16x16x32_bf16 v[148:151], a[40:43], v[92:95], v[148:151]
    ds_read_b64_tr_b16 a[40:41], v21 offset:0
    ds_read_b64_tr_b16 a[42:43], v21 offset:4096
    v_mfma_f32_16x16x32_bf16 v[152:155], a[44:47], v[88:91], v[152:155]
    v_cvt_pk_bf16_f32 v82, v244, v245
    v_exp_f32 v247, v39
    v_mfma_f32_16x16x32_bf16 v[156:159], a[44:47], v[92:95], v[156:159]
    ds_read_b64_tr_b16 a[44:45], v22 offset:0
    ds_read_b64_tr_b16 a[46:47], v22 offset:4096
    v_mfma_f32_16x16x32_bf16 v[76:79], a[76:79], v[88:91], v[76:79]
    v_exp_f32 v244, v40
    v_mfma_f32_16x16x32_bf16 v[240:243], a[76:79], v[92:95], v[240:243]
    v_cvt_pk_bf16_f32 v83, v246, v247
    v_exp_f32 v245, v41
    s_waitcnt lgkmcnt(6)
    v_mfma_f32_16x16x32_bf16 v[48:51], a[48:51], v[160:163], v[64:67]
    v_exp_f32 v246, v42
    v_mfma_f32_16x16x32_bf16 v[48:51], a[52:55], v[164:167], v[48:51]
    v_cvt_pk_bf16_f32 v84, v244, v245
    v_exp_f32 v247, v43
    v_mfma_f32_16x16x32_bf16 v[48:51], a[56:59], v[168:171], v[48:51]
    v_exp_f32 v244, v44
    v_mfma_f32_16x16x32_bf16 v[48:51], a[60:63], v[172:175], v[48:51]
    v_cvt_pk_bf16_f32 v85, v246, v247
    v_exp_f32 v245, v45
    v_mfma_f32_16x16x32_bf16 v[56:59], a[48:51], v[176:179], v[68:71]
    ds_read_b64_tr_b16 a[48:49], v23 offset:0
    ds_read_b64_tr_b16 a[50:51], v23 offset:4096
    v_mfma_f32_16x16x32_bf16 v[56:59], a[52:55], v[180:183], v[56:59]
    v_exp_f32 v246, v46
    v_mfma_f32_16x16x32_bf16 v[56:59], a[56:59], v[184:187], v[56:59]
    ds_read_b64_tr_b16 a[52:53], v24 offset:0
    ds_read_b64_tr_b16 a[54:55], v24 offset:4096
    v_mfma_f32_16x16x32_bf16 v[56:59], a[60:63], v[188:191], v[56:59]
    v_cvt_pk_bf16_f32 v86, v244, v245
    v_mfma_f32_16x16x32_bf16 v[52:55], a[64:67], v[160:163], v[64:67]
    ds_read_b64_tr_b16 a[56:57], v25 offset:0
    ds_read_b64_tr_b16 a[58:59], v25 offset:4096
    v_mfma_f32_16x16x32_bf16 v[52:55], a[68:71], v[164:167], v[52:55]
    v_exp_f32 v247, v47
    v_mfma_f32_16x16x32_bf16 v[52:55], a[72:75], v[168:171], v[52:55]
    ds_read_b64_tr_b16 a[60:61], v26 offset:0
    ds_read_b64_tr_b16 a[62:63], v26 offset:4096
    v_mfma_f32_16x16x32_bf16 v[52:55], a[32:35], v[172:175], v[52:55]
    v_or3_b32 v14, v80, v81, v82
    v_cvt_pk_bf16_f32 v87, v246, v247
    v_mfma_f32_16x16x32_bf16 v[60:63], a[64:67], v[176:179], v[68:71]
    ds_read_b64_tr_b16 a[64:65], v27 offset:0
    ds_read_b64_tr_b16 a[66:67], v27 offset:4096
    v_mfma_f32_16x16x32_bf16 v[60:63], a[68:71], v[180:183], v[60:63]
    v_or3_b32 v14, v14, v83, v84
    v_or3_b32 v14, v14, v85, v86
    v_mfma_f32_16x16x32_bf16 v[60:63], a[72:75], v[184:187], v[60:63]
    v_bitop3_b32 v14, v14, v87, s72 bitop3:0xa8
    v_cmp_ne_u32 vcc, 0, v14
    v_mfma_f32_16x16x32_bf16 v[60:63], a[32:35], v[188:191], v[60:63]
    s_cbranch_vccnz LA_r1_30
LA_b1_30:
    s_waitcnt lgkmcnt(0)
    s_barrier
    v_mfma_f32_16x16x32_bf16 v[96:99], a[36:39], v[80:83], v[96:99]
    v_lshlrev_b32 v3, 4, v1
    v_and_b32 v2, 15, v1
    v_lshlrev_b32 v2, 4, v2
    v_lshrrev_b32 v4, 4, v1
    v_lshl_add_u32 v2, v4, 9, v2
    s_lshl_b32 s10, s3, 3
    s_lshl_b32 s11, s5, 1
    s_sub_u32 s10, s10, s11
    s_add_u32 m0, s79, 131072
    s_add_u32 s82, s81, 335872
    s_and_b32 s82, s82, 0x7ffff
    buffer_load_dwordx4 v252, s[56:59], s82 offen lds
    v_mfma_f32_16x16x32_bf16 v[100:103], a[36:39], v[84:87], v[100:103]
    s_add_u32 s11, s10, 0
    s_and_b32 s11, s11, 31
    s_lshl_b32 s11, s11, 10
    v_add_u32 v16, s11, v2
    v_mfma_f32_16x16x32_bf16 v[104:107], a[40:43], v[80:83], v[104:107]
    s_add_u32 s11, s10, 2
    s_and_b32 s11, s11, 31
    s_lshl_b32 s11, s11, 10
    v_add_u32 v17, s11, v2
    buffer_load_dwordx4 v253, s[56:59], s82 offen offset:1024 lds
    v_subrev_u32 v28, 65536, v28
    v_subrev_u32 v29, 65536, v29
    v_subrev_u32 v30, 65536, v30
    v_subrev_u32 v31, 65536, v31
    ds_read_b64_tr_b16 v[160:161], v28 offset:49152
    v_mfma_f32_16x16x32_bf16 v[108:111], a[40:43], v[84:87], v[108:111]
    s_add_u32 s11, s10, 4
    s_and_b32 s11, s11, 31
    s_lshl_b32 s11, s11, 10
    v_add_u32 v18, s11, v2
    v_mfma_f32_16x16x32_bf16 v[112:115], a[44:47], v[80:83], v[112:115]
    s_add_u32 s11, s10, 6
    s_and_b32 s11, s11, 31
    s_lshl_b32 s11, s11, 10
    v_add_u32 v19, s11, v2
    buffer_load_dwordx4 v254, s[56:59], s82 offen offset:2048 lds
    ds_read_b64_tr_b16 v[162:163], v28 offset:51200
    v_mfma_f32_16x16x32_bf16 v[116:119], a[44:47], v[84:87], v[116:119]
    v_exp_f32 v244, v48
    v_mfma_f32_16x16x32_bf16 v[120:123], a[48:51], v[80:83], v[120:123]
    buffer_load_dwordx4 v255, s[56:59], s82 offen offset:3072 lds
    ds_read_b64_tr_b16 v[164:165], v29 offset:49152
    ds_read_b64_tr_b16 v[166:167], v29 offset:51200
    v_mfma_f32_16x16x32_bf16 v[124:127], a[48:51], v[84:87], v[124:127]
    v_exp_f32 v245, v49
    v_mfma_f32_16x16x32_bf16 v[128:131], a[52:55], v[80:83], v[128:131]
    ds_read_b64_tr_b16 v[168:169], v30 offset:49152
    ds_read_b64_tr_b16 v[170:171], v30 offset:51200
    v_mfma_f32_16x16x32_bf16 v[132:135], a[52:55], v[84:87], v[132:135]
    v_exp_f32 v246, v50
    v_mfma_f32_16x16x32_bf16 v[136:139], a[56:59], v[80:83], v[136:139]
    ds_read_b64_tr_b16 v[172:173], v31 offset:49152
    ds_read_b64_tr_b16 v[174:175], v31 offset:51200
    v_mfma_f32_16x16x32_bf16 v[140:143], a[56:59], v[84:87], v[140:143]
    ds_read_b64_tr_b16 v[176:177], v28 offset:32768
    ds_read_b64_tr_b16 v[178:179], v28 offset:34816
    v_mfma_f32_16x16x32_bf16 v[144:147], a[60:63], v[80:83], v[144:147]
    ds_read_b64_tr_b16 v[180:181], v29 offset:32768
    ds_read_b64_tr_b16 v[182:183], v29 offset:34816
    v_mfma_f32_16x16x32_bf16 v[148:151], a[60:63], v[84:87], v[148:151]
    ds_read_b64_tr_b16 v[184:185], v30 offset:32768
    ds_read_b64_tr_b16 v[186:187], v30 offset:34816
    v_mfma_f32_16x16x32_bf16 v[152:155], a[64:67], v[80:83], v[152:155]
    ds_read_b64_tr_b16 v[188:189], v31 offset:32768
    ds_read_b64_tr_b16 v[190:191], v31 offset:34816
    v_mfma_f32_16x16x32_bf16 v[156:159], a[64:67], v[84:87], v[156:159]
    v_cvt_pk_bf16_f32 v88, v244, v245
    v_exp_f32 v247, v51
    v_mfma_f32_16x16x32_bf16 v[76:79], a[76:79], v[80:83], v[76:79]
    v_exp_f32 v244, v52
    v_mfma_f32_16x16x32_bf16 v[240:243], a[76:79], v[84:87], v[240:243]
    v_cvt_pk_bf16_f32 v89, v246, v247
    v_exp_f32 v245, v53
    v_exp_f32 v246, v54
    v_cvt_pk_bf16_f32 v90, v244, v245
    v_exp_f32 v247, v55
    v_exp_f32 v244, v56
    v_cvt_pk_bf16_f32 v91, v246, v247
    v_exp_f32 v245, v57
    v_exp_f32 v246, v58
    v_cvt_pk_bf16_f32 v92, v244, v245
    v_exp_f32 v247, v59
    v_exp_f32 v244, v60
    v_cvt_pk_bf16_f32 v93, v246, v247
    v_exp_f32 v245, v61
    v_exp_f32 v246, v62
    v_cvt_pk_bf16_f32 v94, v244, v245
    v_exp_f32 v247, v63
    v_or3_b32 v14, v88, v89, v90
    v_cvt_pk_bf16_f32 v95, v246, v247
    v_or3_b32 v14, v14, v91, v92
    v_or3_b32 v14, v14, v93, v94
    v_bitop3_b32 v14, v14, v95, s72 bitop3:0xa8
    v_cmp_ne_u32 vcc, 0, v14
    s_cbranch_vccnz LA_r1_31
LA_b1_31:
    v_mfma_f32_16x16x32_bf16 v[76:79], a[76:79], v[88:91], v[76:79]
    v_mfma_f32_16x16x32_bf16 v[240:243], a[76:79], v[92:95], v[240:243]
    s_waitcnt vmcnt(12)
    s_barrier
    ds_read_b64_tr_b16 a[56:57], v20 offset:8192
    ds_read_b64_tr_b16 a[58:59], v20 offset:12288
    ds_read_b64_tr_b16 a[60:61], v21 offset:8192
    ds_read_b64_tr_b16 a[62:63], v21 offset:12288
    ds_read_b64_tr_b16 a[64:65], v22 offset:8192
    ds_read_b64_tr_b16 a[66:67], v22 offset:12288
    ds_read_b64_tr_b16 a[68:69], v23 offset:8192
    ds_read_b64_tr_b16 a[70:71], v23 offset:12288
    ds_read_b64_tr_b16 a[72:73], v24 offset:8192
    ds_read_b64_tr_b16 a[74:75], v24 offset:12288
    ds_read_b64_tr_b16 a[32:33], v25 offset:8192
    ds_read_b64_tr_b16 a[34:35], v25 offset:12288
    ds_read_b64_tr_b16 a[36:37], v26 offset:8192
    ds_read_b64_tr_b16 a[38:39], v26 offset:12288
    ds_read_b64_tr_b16 a[40:41], v27 offset:8192
    ds_read_b64_tr_b16 a[42:43], v27 offset:12288
    v_rcp_f32 v74, v76
    v_rcp_f32 v14, v240
    v_mov_b32 v75, v74
    v_mov_b32 v15, v14
    s_waitcnt lgkmcnt(14)
    v_mfma_f32_16x16x32_bf16 v[96:99], a[56:59], v[88:91], v[96:99]
    v_add_u32 v20, 65536, v28
    v_add_u32 v21, 65536, v29
    v_mfma_f32_16x16x32_bf16 v[100:103], a[56:59], v[92:95], v[100:103]
    v_add_u32 v22, 65536, v30
    v_add_u32 v23, 65536, v31
    s_waitcnt lgkmcnt(12)
    v_mfma_f32_16x16x32_bf16 v[104:107], a[60:63], v[88:91], v[104:107]
    v_add_u32 v24, 98304, v28
    v_add_u32 v25, 98304, v29
    v_mfma_f32_16x16x32_bf16 v[108:111], a[60:63], v[92:95], v[108:111]
    v_add_u32 v26, 98304, v30
    v_add_u32 v27, 98304, v31
    s_waitcnt lgkmcnt(10)
    v_mfma_f32_16x16x32_bf16 v[112:115], a[64:67], v[88:91], v[112:115]
    s_lshl_b32 s10, s3, 4
    s_add_u32 s10, s10, s4
    v_mfma_f32_16x16x32_bf16 v[116:119], a[64:67], v[92:95], v[116:119]
    s_lshl_b32 s10, s10, 12
    s_add_u32 s10, s10, s75
    s_waitcnt lgkmcnt(8)
    v_mfma_f32_16x16x32_bf16 v[120:123], a[68:71], v[88:91], v[120:123]
    s_add_u32 s11, s10, 32768
    v_pk_mul_f32 v[96:97], v[96:97], v[74:75]
    v_pk_mul_f32 v[98:99], v[98:99], v[74:75]
    v_pk_mul_f32 v[104:105], v[104:105], v[74:75]
    v_pk_mul_f32 v[106:107], v[106:107], v[74:75]
    v_mfma_f32_16x16x32_bf16 v[124:127], a[68:71], v[92:95], v[124:127]
    v_cvt_pk_bf16_f32 v32, v96, v97
    v_cvt_pk_bf16_f32 v33, v98, v99
    v_cvt_pk_bf16_f32 v34, v104, v105
    v_cvt_pk_bf16_f32 v35, v106, v107
    s_waitcnt lgkmcnt(6)
    v_mfma_f32_16x16x32_bf16 v[128:131], a[72:75], v[88:91], v[128:131]
    ds_write_b128 v16, v[32:35] offset:0
    v_pk_mul_f32 v[100:101], v[100:101], v[14:15]
    v_pk_mul_f32 v[102:103], v[102:103], v[14:15]
    v_pk_mul_f32 v[108:109], v[108:109], v[14:15]
    v_mfma_f32_16x16x32_bf16 v[132:135], a[72:75], v[92:95], v[132:135]
    v_pk_mul_f32 v[110:111], v[110:111], v[14:15]
    v_cvt_pk_bf16_f32 v36, v100, v101
    v_cvt_pk_bf16_f32 v37, v102, v103
    v_cvt_pk_bf16_f32 v38, v108, v109
    s_waitcnt lgkmcnt(5)
    v_mfma_f32_16x16x32_bf16 v[136:139], a[32:35], v[88:91], v[136:139]
    v_cvt_pk_bf16_f32 v39, v110, v111
    ds_write_b128 v16, v[36:39] offset:256
    v_pk_mul_f32 v[112:113], v[112:113], v[74:75]
    v_pk_mul_f32 v[114:115], v[114:115], v[74:75]
    v_mfma_f32_16x16x32_bf16 v[140:143], a[32:35], v[92:95], v[140:143]
    v_pk_mul_f32 v[120:121], v[120:121], v[74:75]
    v_pk_mul_f32 v[122:123], v[122:123], v[74:75]
    v_cvt_pk_bf16_f32 v40, v112, v113
    v_cvt_pk_bf16_f32 v41, v114, v115
    s_waitcnt lgkmcnt(4)
    v_mfma_f32_16x16x32_bf16 v[144:147], a[36:39], v[88:91], v[144:147]
    v_cvt_pk_bf16_f32 v42, v120, v121
    v_cvt_pk_bf16_f32 v43, v122, v123
    ds_write_b128 v17, v[40:43] offset:0
    v_pk_mul_f32 v[116:117], v[116:117], v[14:15]
    v_mfma_f32_16x16x32_bf16 v[148:151], a[36:39], v[92:95], v[148:151]
    v_pk_mul_f32 v[118:119], v[118:119], v[14:15]
    v_pk_mul_f32 v[124:125], v[124:125], v[14:15]
    v_pk_mul_f32 v[126:127], v[126:127], v[14:15]
    v_cvt_pk_bf16_f32 v44, v116, v117
    s_waitcnt lgkmcnt(3)
    v_mfma_f32_16x16x32_bf16 v[152:155], a[40:43], v[88:91], v[152:155]
    v_cvt_pk_bf16_f32 v45, v118, v119
    v_cvt_pk_bf16_f32 v46, v124, v125
    v_cvt_pk_bf16_f32 v47, v126, v127
    ds_write_b128 v17, v[44:47] offset:256
    v_mfma_f32_16x16x32_bf16 v[156:159], a[40:43], v[92:95], v[156:159]
    v_pk_mul_f32 v[128:129], v[128:129], v[74:75]
    v_pk_mul_f32 v[130:131], v[130:131], v[74:75]
    v_pk_mul_f32 v[136:137], v[136:137], v[74:75]
    v_pk_mul_f32 v[138:139], v[138:139], v[74:75]
    v_cvt_pk_bf16_f32 v48, v128, v129
    v_cvt_pk_bf16_f32 v49, v130, v131
    v_cvt_pk_bf16_f32 v50, v136, v137
    v_cvt_pk_bf16_f32 v51, v138, v139
    ds_write_b128 v18, v[48:51] offset:0
    v_pk_mul_f32 v[132:133], v[132:133], v[14:15]
    v_pk_mul_f32 v[134:135], v[134:135], v[14:15]
    v_pk_mul_f32 v[140:141], v[140:141], v[14:15]
    v_pk_mul_f32 v[142:143], v[142:143], v[14:15]
    v_cvt_pk_bf16_f32 v52, v132, v133
    v_cvt_pk_bf16_f32 v53, v134, v135
    v_cvt_pk_bf16_f32 v54, v140, v141
    v_cvt_pk_bf16_f32 v55, v142, v143
    ds_write_b128 v18, v[52:55] offset:256
    v_pk_mul_f32 v[144:145], v[144:145], v[74:75]
    v_pk_mul_f32 v[146:147], v[146:147], v[74:75]
    v_pk_mul_f32 v[152:153], v[152:153], v[74:75]
    v_pk_mul_f32 v[154:155], v[154:155], v[74:75]
    v_cvt_pk_bf16_f32 v56, v144, v145
    v_cvt_pk_bf16_f32 v57, v146, v147
    v_cvt_pk_bf16_f32 v58, v152, v153
    v_cvt_pk_bf16_f32 v59, v154, v155
    ds_write_b128 v19, v[56:59] offset:0
    v_pk_mul_f32 v[148:149], v[148:149], v[14:15]
    v_pk_mul_f32 v[150:151], v[150:151], v[14:15]
    v_pk_mul_f32 v[156:157], v[156:157], v[14:15]
    v_pk_mul_f32 v[158:159], v[158:159], v[14:15]
    v_cvt_pk_bf16_f32 v60, v148, v149
    v_cvt_pk_bf16_f32 v61, v150, v151
    v_cvt_pk_bf16_f32 v62, v156, v157
    v_cvt_pk_bf16_f32 v63, v158, v159
    ds_write_b128 v19, v[60:63] offset:256
    s_waitcnt lgkmcnt(0)
    s_barrier
    ds_read_b128 v[96:99], v3 offset:0
    ds_read_b128 v[100:103], v3 offset:1024
    s_waitcnt lgkmcnt(1)
    v_mfma_f32_32x32x16_bf16 v[32:47], a[80:83], v[96:99], 0
    ds_read_b128 v[104:107], v3 offset:18432
    ds_read_b64_tr_b16 a[32:33], v20 offset:32768
    ds_read_b64_tr_b16 a[34:35], v20 offset:34816
    s_add_u32 m0, s79, 32768
    s_add_u32 s82, s81, 360448
    s_and_b32 s82, s82, 0x7ffff
    buffer_load_dwordx4 v252, s[56:59], s82 offen lds
    v_mfma_f32_32x32x16_bf16 v[48:63], a[84:87], v[96:99], 0
    ds_read_b64_tr_b16 a[36:37], v21 offset:32768
    ds_read_b64_tr_b16 a[38:39], v21 offset:34816
    v_mfma_f32_32x32x16_bf16 v[64:79], a[88:91], v[96:99], 0
    ds_read_b64_tr_b16 a[40:41], v22 offset:32768
    ds_read_b64_tr_b16 a[42:43], v22 offset:34816
    buffer_load_dwordx4 v253, s[56:59], s82 offen offset:1024 lds
    v_mfma_f32_32x32x16_bf16 v[80:95], a[92:95], v[96:99], 0
    ds_read_b64_tr_b16 a[44:45], v23 offset:32768
    ds_read_b64_tr_b16 a[46:47], v23 offset:34816
    s_waitcnt lgkmcnt(9)
    v_mfma_f32_32x32x16_bf16 v[32:47], a[96:99], v[100:103], v[32:47]
    ds_read_b128 v[108:111], v3 offset:19456
    s_waitcnt vmcnt(10)
    ds_read_b64_tr_b16 a[48:49], v20 offset:49152
    ds_read_b64_tr_b16 a[50:51], v20 offset:51200
    buffer_load_dwordx4 v254, s[56:59], s82 offen offset:2048 lds
    v_mfma_f32_32x32x16_bf16 v[48:63], a[100:103], v[100:103], v[48:63]
    ds_read_b64_tr_b16 a[52:53], v21 offset:49152
    ds_read_b64_tr_b16 a[54:55], v21 offset:51200
    v_mfma_f32_32x32x16_bf16 v[64:79], a[104:107], v[100:103], v[64:79]
    ds_read_b64_tr_b16 a[56:57], v22 offset:49152
    ds_read_b64_tr_b16 a[58:59], v22 offset:51200
    buffer_load_dwordx4 v255, s[56:59], s82 offen offset:3072 lds
    v_mfma_f32_32x32x16_bf16 v[80:95], a[108:111], v[100:103], v[80:95]
    ds_read_b64_tr_b16 a[60:61], v23 offset:49152
    ds_read_b64_tr_b16 a[62:63], v23 offset:51200
    s_waitcnt lgkmcnt(9)
    v_mfma_f32_32x32x16_bf16 v[32:47], a[32:35], v[104:107], v[32:47]
    ds_read_b128 v[112:115], v3 offset:20480
    s_waitcnt vmcnt(8)
    ds_read_b64_tr_b16 v[128:129], v20 offset:16384
    ds_read_b64_tr_b16 v[130:131], v20 offset:18432
    s_add_u32 m0, s79, 49152
    s_add_u32 s82, s81, 368640
    s_and_b32 s82, s82, 0x7ffff
    buffer_load_dwordx4 v252, s[56:59], s82 offen lds
    v_mfma_f32_32x32x16_bf16 v[48:63], a[36:39], v[104:107], v[48:63]
    ds_read_b64_tr_b16 v[132:133], v21 offset:16384
    ds_read_b64_tr_b16 v[134:135], v21 offset:18432
    v_mfma_f32_32x32x16_bf16 v[64:79], a[40:43], v[104:107], v[64:79]
    ds_read_b64_tr_b16 v[136:137], v22 offset:16384
    ds_read_b64_tr_b16 v[138:139], v22 offset:18432
    buffer_load_dwordx4 v253, s[56:59], s82 offen offset:1024 lds
    v_mfma_f32_32x32x16_bf16 v[80:95], a[44:47], v[104:107], v[80:95]
    ds_read_b64_tr_b16 v[140:141], v23 offset:16384
    ds_read_b64_tr_b16 v[142:143], v23 offset:18432
    s_waitcnt lgkmcnt(9)
    v_mfma_f32_32x32x16_bf16 v[32:47], a[48:51], v[108:111], v[32:47]
    ds_read_b128 v[116:119], v3 offset:21504
    s_waitcnt vmcnt(6)
    ds_read_b64_tr_b16 a[32:33], v24 offset:32768
    ds_read_b64_tr_b16 a[34:35], v24 offset:34816
    buffer_load_dwordx4 v254, s[56:59], s82 offen offset:2048 lds
    v_mfma_f32_32x32x16_bf16 v[48:63], a[52:55], v[108:111], v[48:63]
    ds_read_b64_tr_b16 a[36:37], v25 offset:32768
    ds_read_b64_tr_b16 a[38:39], v25 offset:34816
    v_mfma_f32_32x32x16_bf16 v[64:79], a[56:59], v[108:111], v[64:79]
    ds_read_b64_tr_b16 a[40:41], v26 offset:32768
    ds_read_b64_tr_b16 a[42:43], v26 offset:34816
    buffer_load_dwordx4 v255, s[56:59], s82 offen offset:3072 lds
    v_mfma_f32_32x32x16_bf16 v[80:95], a[60:63], v[108:111], v[80:95]
    ds_read_b64_tr_b16 a[44:45], v27 offset:32768
    ds_read_b64_tr_b16 a[46:47], v27 offset:34816
    s_waitcnt lgkmcnt(9)
    v_mfma_f32_32x32x16_bf16 v[32:47], v[128:131], v[112:115], v[32:47]
    ds_read_b128 v[96:99], v3 offset:2048
    s_add_u32 m0, s79, 65536
    s_add_u32 s82, s81, 393216
    s_and_b32 s82, s82, 0x7ffff
    buffer_load_dwordx4 v252, s[56:59], s82 offen lds
    v_mfma_f32_32x32x16_bf16 v[48:63], v[132:135], v[112:115], v[48:63]
    v_mfma_f32_32x32x16_bf16 v[64:79], v[136:139], v[112:115], v[64:79]
    buffer_load_dwordx4 v253, s[56:59], s82 offen offset:1024 lds
    v_mfma_f32_32x32x16_bf16 v[80:95], v[140:143], v[112:115], v[80:95]
    s_waitcnt lgkmcnt(1)
    v_mfma_f32_32x32x16_bf16 v[32:47], a[32:35], v[116:119], v[32:47]
    ds_read_b128 v[100:103], v3 offset:22528
    s_waitcnt vmcnt(6)
    ds_read_b64_tr_b16 a[48:49], v28 offset:32768
    ds_read_b64_tr_b16 a[50:51], v28 offset:34816
    buffer_load_dwordx4 v254, s[56:59], s82 offen offset:2048 lds
    v_mfma_f32_32x32x16_bf16 v[48:63], a[36:39], v[116:119], v[48:63]
    ds_read_b64_tr_b16 a[52:53], v29 offset:32768
    ds_read_b64_tr_b16 a[54:55], v29 offset:34816
    v_mfma_f32_32x32x16_bf16 v[64:79], a[40:43], v[116:119], v[64:79]
    ds_read_b64_tr_b16 a[56:57], v30 offset:32768
    ds_read_b64_tr_b16 a[58:59], v30 offset:34816
    buffer_load_dwordx4 v255, s[56:59], s82 offen offset:3072 lds
    v_mfma_f32_32x32x16_bf16 v[80:95], a[44:47], v[116:119], v[80:95]
    ds_read_b64_tr_b16 a[60:61], v31 offset:32768
    ds_read_b64_tr_b16 a[62:63], v31 offset:34816
    s_waitcnt lgkmcnt(9)
    v_mfma_f32_32x32x16_bf16 v[32:47], a[112:115], v[96:99], v[32:47]
    ds_read_b128 v[104:107], v3 offset:3072
    s_add_u32 m0, s79, 147456
    s_add_u32 s82, s81, 401408
    s_and_b32 s82, s82, 0x7ffff
    buffer_load_dwordx4 v252, s[56:59], s82 offen lds
    v_mfma_f32_32x32x16_bf16 v[48:63], a[116:119], v[96:99], v[48:63]
    v_mfma_f32_32x32x16_bf16 v[64:79], a[120:123], v[96:99], v[64:79]
    buffer_load_dwordx4 v253, s[56:59], s82 offen offset:1024 lds
    v_mfma_f32_32x32x16_bf16 v[80:95], a[124:127], v[96:99], v[80:95]
    s_waitcnt lgkmcnt(1)
    v_mfma_f32_32x32x16_bf16 v[32:47], a[48:51], v[100:103], v[32:47]
    ds_read_b128 v[108:111], v3 offset:23552
    s_waitcnt vmcnt(6)
    ds_read_b64_tr_b16 v[128:129], v28 offset:49152
    ds_read_b64_tr_b16 v[130:131], v28 offset:51200
    buffer_load_dwordx4 v254, s[56:59], s82 offen offset:2048 lds
    v_mfma_f32_32x32x16_bf16 v[48:63], a[52:55], v[100:103], v[48:63]
    ds_read_b64_tr_b16 v[132:133], v29 offset:49152
    ds_read_b64_tr_b16 v[134:135], v29 offset:51200
    v_mfma_f32_32x32x16_bf16 v[64:79], a[56:59], v[100:103], v[64:79]
    ds_read_b64_tr_b16 v[136:137], v30 offset:49152
    ds_read_b64_tr_b16 v[138:139], v30 offset:51200
    buffer_load_dwordx4 v255, s[56:59], s82 offen offset:3072 lds
    v_mfma_f32_32x32x16_bf16 v[80:95], a[60:63], v[100:103], v[80:95]
    ds_read_b64_tr_b16 v[140:141], v31 offset:49152
    ds_read_b64_tr_b16 v[142:143], v31 offset:51200
    s_waitcnt lgkmcnt(9)
    v_mfma_f32_32x32x16_bf16 v[32:47], a[128:131], v[104:107], v[32:47]
    ds_read_b128 v[112:115], v3 offset:4096
    s_add_u32 m0, s79, 98304
    s_add_u32 s82, s81, 425984
    s_and_b32 s82, s82, 0x7ffff
    buffer_load_dwordx4 v252, s[56:59], s82 offen lds
    v_mfma_f32_32x32x16_bf16 v[48:63], a[132:135], v[104:107], v[48:63]
    v_mfma_f32_32x32x16_bf16 v[64:79], a[136:139], v[104:107], v[64:79]
    buffer_load_dwordx4 v253, s[56:59], s82 offen offset:1024 lds
    v_mfma_f32_32x32x16_bf16 v[80:95], a[140:143], v[104:107], v[80:95]
    s_waitcnt lgkmcnt(1)
    v_mfma_f32_32x32x16_bf16 v[32:47], v[128:131], v[108:111], v[32:47]
    ds_read_b128 v[116:119], v3 offset:24576
    s_waitcnt vmcnt(6)
    ds_read_b64_tr_b16 a[32:33], v20 offset:0
    ds_read_b64_tr_b16 a[34:35], v20 offset:2048
    buffer_load_dwordx4 v254, s[56:59], s82 offen offset:2048 lds
    v_mfma_f32_32x32x16_bf16 v[48:63], v[132:135], v[108:111], v[48:63]
    ds_read_b64_tr_b16 a[36:37], v21 offset:0
    ds_read_b64_tr_b16 a[38:39], v21 offset:2048
    v_mfma_f32_32x32x16_bf16 v[64:79], v[136:139], v[108:111], v[64:79]
    ds_read_b64_tr_b16 a[40:41], v22 offset:0
    ds_read_b64_tr_b16 a[42:43], v22 offset:2048
    buffer_load_dwordx4 v255, s[56:59], s82 offen offset:3072 lds
    v_mfma_f32_32x32x16_bf16 v[80:95], v[140:143], v[108:111], v[80:95]
    ds_read_b64_tr_b16 a[44:45], v23 offset:0
    ds_read_b64_tr_b16 a[46:47], v23 offset:2048
    s_waitcnt lgkmcnt(9)
    v_mfma_f32_32x32x16_bf16 v[32:47], a[144:147], v[112:115], v[32:47]
    ds_read_b128 v[96:99], v3 offset:5120
    s_add_u32 m0, s79, 114688
    s_add_u32 s82, s81, 434176
    s_and_b32 s82, s82, 0x7ffff
    buffer_load_dwordx4 v252, s[56:59], s82 offen lds
    v_mfma_f32_32x32x16_bf16 v[48:63], a[148:151], v[112:115], v[48:63]
    v_mfma_f32_32x32x16_bf16 v[64:79], a[152:155], v[112:115], v[64:79]
    buffer_load_dwordx4 v253, s[56:59], s82 offen offset:1024 lds
    v_mfma_f32_32x32x16_bf16 v[80:95], a[156:159], v[112:115], v[80:95]
    s_waitcnt lgkmcnt(1)
    v_mfma_f32_32x32x16_bf16 v[32:47], a[32:35], v[116:119], v[32:47]
    ds_read_b128 v[100:103], v3 offset:25600
    s_waitcnt vmcnt(6)
    ds_read_b64_tr_b16 a[48:49], v24 offset:49152
    ds_read_b64_tr_b16 a[50:51], v24 offset:51200
    buffer_load_dwordx4 v254, s[56:59], s82 offen offset:2048 lds
    v_mfma_f32_32x32x16_bf16 v[48:63], a[36:39], v[116:119], v[48:63]
    ds_read_b64_tr_b16 a[52:53], v25 offset:49152
    ds_read_b64_tr_b16 a[54:55], v25 offset:51200
    v_mfma_f32_32x32x16_bf16 v[64:79], a[40:43], v[116:119], v[64:79]
    ds_read_b64_tr_b16 a[56:57], v26 offset:49152
    ds_read_b64_tr_b16 a[58:59], v26 offset:51200
    buffer_load_dwordx4 v255, s[56:59], s82 offen offset:3072 lds
    v_mfma_f32_32x32x16_bf16 v[80:95], a[44:47], v[116:119], v[80:95]
    ds_read_b64_tr_b16 a[60:61], v27 offset:49152
    ds_read_b64_tr_b16 a[62:63], v27 offset:51200
    s_waitcnt lgkmcnt(9)
    v_mfma_f32_32x32x16_bf16 v[32:47], a[160:163], v[96:99], v[32:47]
    ds_read_b128 v[104:107], v3 offset:6144
    s_add_u32 m0, s79, 81920
    s_add_u32 s82, s81, 458752
    s_and_b32 s82, s82, 0x7ffff
    buffer_load_dwordx4 v252, s[56:59], s82 offen lds
    v_mfma_f32_32x32x16_bf16 v[48:63], a[164:167], v[96:99], v[48:63]
    v_mfma_f32_32x32x16_bf16 v[64:79], a[168:171], v[96:99], v[64:79]
    buffer_load_dwordx4 v253, s[56:59], s82 offen offset:1024 lds
    v_mfma_f32_32x32x16_bf16 v[80:95], a[172:175], v[96:99], v[80:95]
    s_waitcnt lgkmcnt(1)
    v_mfma_f32_32x32x16_bf16 v[32:47], a[48:51], v[100:103], v[32:47]
    ds_read_b128 v[108:111], v3 offset:26624
    s_waitcnt vmcnt(6)
    ds_read_b64_tr_b16 v[128:129], v20 offset:32768
    ds_read_b64_tr_b16 v[130:131], v20 offset:34816
    buffer_load_dwordx4 v254, s[56:59], s82 offen offset:2048 lds
    v_mfma_f32_32x32x16_bf16 v[48:63], a[52:55], v[100:103], v[48:63]
    ds_read_b64_tr_b16 v[132:133], v21 offset:32768
    ds_read_b64_tr_b16 v[134:135], v21 offset:34816
    v_mfma_f32_32x32x16_bf16 v[64:79], a[56:59], v[100:103], v[64:79]
    ds_read_b64_tr_b16 v[136:137], v22 offset:32768
    ds_read_b64_tr_b16 v[138:139], v22 offset:34816
    buffer_load_dwordx4 v255, s[56:59], s82 offen offset:3072 lds
    v_mfma_f32_32x32x16_bf16 v[80:95], a[60:63], v[100:103], v[80:95]
    ds_read_b64_tr_b16 v[140:141], v23 offset:32768
    ds_read_b64_tr_b16 v[142:143], v23 offset:34816
    s_waitcnt lgkmcnt(9)
    v_mfma_f32_32x32x16_bf16 v[32:47], a[176:179], v[104:107], v[32:47]
    ds_read_b128 v[112:115], v3 offset:7168
    s_add_u32 m0, s79, 131072
    s_add_u32 s82, s81, 466944
    s_and_b32 s82, s82, 0x7ffff
    buffer_load_dwordx4 v252, s[56:59], s82 offen lds
    v_mfma_f32_32x32x16_bf16 v[48:63], a[180:183], v[104:107], v[48:63]
    v_mfma_f32_32x32x16_bf16 v[64:79], a[184:187], v[104:107], v[64:79]
    buffer_load_dwordx4 v253, s[56:59], s82 offen offset:1024 lds
    v_mfma_f32_32x32x16_bf16 v[80:95], a[188:191], v[104:107], v[80:95]
    s_waitcnt lgkmcnt(1)
    v_mfma_f32_32x32x16_bf16 v[32:47], v[128:131], v[108:111], v[32:47]
    ds_read_b128 v[116:119], v3 offset:27648
    s_waitcnt vmcnt(6)
    ds_read_b64_tr_b16 a[32:33], v20 offset:49152
    ds_read_b64_tr_b16 a[34:35], v20 offset:51200
    buffer_load_dwordx4 v254, s[56:59], s82 offen offset:2048 lds
    v_mfma_f32_32x32x16_bf16 v[48:63], v[132:135], v[108:111], v[48:63]
    ds_read_b64_tr_b16 a[36:37], v21 offset:49152
    ds_read_b64_tr_b16 a[38:39], v21 offset:51200
    v_mfma_f32_32x32x16_bf16 v[64:79], v[136:139], v[108:111], v[64:79]
    ds_read_b64_tr_b16 a[40:41], v22 offset:49152
    ds_read_b64_tr_b16 a[42:43], v22 offset:51200
    buffer_load_dwordx4 v255, s[56:59], s82 offen offset:3072 lds
    v_mfma_f32_32x32x16_bf16 v[80:95], v[140:143], v[108:111], v[80:95]
    ds_read_b64_tr_b16 a[44:45], v23 offset:49152
    ds_read_b64_tr_b16 a[46:47], v23 offset:51200
    s_waitcnt lgkmcnt(9)
    v_mfma_f32_32x32x16_bf16 v[32:47], a[192:195], v[112:115], v[32:47]
    ds_read_b128 v[96:99], v3 offset:8192
    s_add_u32 m0, s79, 32768
    s_add_u32 s82, s81, 491520
    s_and_b32 s82, s82, 0x7ffff
    buffer_load_dwordx4 v252, s[56:59], s82 offen lds
    v_mfma_f32_32x32x16_bf16 v[48:63], a[196:199], v[112:115], v[48:63]
    v_mfma_f32_32x32x16_bf16 v[64:79], a[200:203], v[112:115], v[64:79]
    buffer_load_dwordx4 v253, s[56:59], s82 offen offset:1024 lds
    v_mfma_f32_32x32x16_bf16 v[80:95], a[204:207], v[112:115], v[80:95]
    s_waitcnt lgkmcnt(1)
    v_mfma_f32_32x32x16_bf16 v[32:47], a[32:35], v[116:119], v[32:47]
    ds_read_b128 v[100:103], v3 offset:28672
    s_waitcnt vmcnt(6)
    ds_read_b64_tr_b16 a[48:49], v20 offset:16384
    ds_read_b64_tr_b16 a[50:51], v20 offset:18432
    buffer_load_dwordx4 v254, s[56:59], s82 offen offset:2048 lds
    v_mfma_f32_32x32x16_bf16 v[48:63], a[36:39], v[116:119], v[48:63]
    ds_read_b64_tr_b16 a[52:53], v21 offset:16384
    ds_read_b64_tr_b16 a[54:55], v21 offset:18432
    v_mfma_f32_32x32x16_bf16 v[64:79], a[40:43], v[116:119], v[64:79]
    ds_read_b64_tr_b16 a[56:57], v22 offset:16384
    ds_read_b64_tr_b16 a[58:59], v22 offset:18432
    buffer_load_dwordx4 v255, s[56:59], s82 offen offset:3072 lds
    v_mfma_f32_32x32x16_bf16 v[80:95], a[44:47], v[116:119], v[80:95]
    ds_read_b64_tr_b16 a[60:61], v23 offset:16384
    ds_read_b64_tr_b16 a[62:63], v23 offset:18432
    s_waitcnt lgkmcnt(9)
    v_mfma_f32_32x32x16_bf16 v[32:47], a[208:211], v[96:99], v[32:47]
    ds_read_b128 v[104:107], v3 offset:9216
    s_add_u32 m0, s79, 49152
    s_add_u32 s82, s81, 499712
    s_and_b32 s82, s82, 0x7ffff
    buffer_load_dwordx4 v252, s[56:59], s82 offen lds
    v_mfma_f32_32x32x16_bf16 v[48:63], a[212:215], v[96:99], v[48:63]
    v_mfma_f32_32x32x16_bf16 v[64:79], a[216:219], v[96:99], v[64:79]
    buffer_load_dwordx4 v253, s[56:59], s82 offen offset:1024 lds
    v_mfma_f32_32x32x16_bf16 v[80:95], a[220:223], v[96:99], v[80:95]
    s_waitcnt lgkmcnt(1)
    v_mfma_f32_32x32x16_bf16 v[32:47], a[48:51], v[100:103], v[32:47]
    ds_read_b128 v[108:111], v3 offset:29696
    s_waitcnt vmcnt(6)
    ds_read_b64_tr_b16 v[128:129], v24 offset:32768
    ds_read_b64_tr_b16 v[130:131], v24 offset:34816
    buffer_load_dwordx4 v254, s[56:59], s82 offen offset:2048 lds
    v_mfma_f32_32x32x16_bf16 v[48:63], a[52:55], v[100:103], v[48:63]
    ds_read_b64_tr_b16 v[132:133], v25 offset:32768
    ds_read_b64_tr_b16 v[134:135], v25 offset:34816
    v_mfma_f32_32x32x16_bf16 v[64:79], a[56:59], v[100:103], v[64:79]
    ds_read_b64_tr_b16 v[136:137], v26 offset:32768
    ds_read_b64_tr_b16 v[138:139], v26 offset:34816
    buffer_load_dwordx4 v255, s[56:59], s82 offen offset:3072 lds
    v_mfma_f32_32x32x16_bf16 v[80:95], a[60:63], v[100:103], v[80:95]
    ds_read_b64_tr_b16 v[140:141], v27 offset:32768
    ds_read_b64_tr_b16 v[142:143], v27 offset:34816
    s_waitcnt lgkmcnt(9)
    v_mfma_f32_32x32x16_bf16 v[32:47], a[224:227], v[104:107], v[32:47]
    ds_read_b128 v[112:115], v3 offset:10240
    v_mfma_f32_32x32x16_bf16 v[48:63], a[228:231], v[104:107], v[48:63]
    v_mfma_f32_32x32x16_bf16 v[64:79], a[232:235], v[104:107], v[64:79]
    v_mfma_f32_32x32x16_bf16 v[80:95], a[236:239], v[104:107], v[80:95]
    s_waitcnt lgkmcnt(1)
    v_mfma_f32_32x32x16_bf16 v[32:47], v[128:131], v[108:111], v[32:47]
    ds_read_b128 v[116:119], v3 offset:30720
    s_waitcnt vmcnt(4)
    ds_read_b64_tr_b16 a[32:33], v28 offset:32768
    ds_read_b64_tr_b16 a[34:35], v28 offset:34816
    v_mfma_f32_32x32x16_bf16 v[48:63], v[132:135], v[108:111], v[48:63]
    ds_read_b64_tr_b16 a[36:37], v29 offset:32768
    ds_read_b64_tr_b16 a[38:39], v29 offset:34816
    v_mfma_f32_32x32x16_bf16 v[64:79], v[136:139], v[108:111], v[64:79]
    ds_read_b64_tr_b16 a[40:41], v30 offset:32768
    ds_read_b64_tr_b16 a[42:43], v30 offset:34816
    v_mfma_f32_32x32x16_bf16 v[80:95], v[140:143], v[108:111], v[80:95]
    ds_read_b64_tr_b16 a[44:45], v31 offset:32768
    ds_read_b64_tr_b16 a[46:47], v31 offset:34816
    s_waitcnt lgkmcnt(9)
    v_mfma_f32_32x32x16_bf16 v[32:47], a[240:243], v[112:115], v[32:47]
    ds_read_b128 v[96:99], v3 offset:11264
    v_mfma_f32_32x32x16_bf16 v[48:63], a[244:247], v[112:115], v[48:63]
    v_mfma_f32_32x32x16_bf16 v[64:79], a[248:251], v[112:115], v[64:79]
    v_mfma_f32_32x32x16_bf16 v[80:95], a[252:255], v[112:115], v[80:95]
    s_waitcnt lgkmcnt(1)
    v_mfma_f32_32x32x16_bf16 v[32:47], a[32:35], v[116:119], v[32:47]
    ds_read_b128 v[100:103], v3 offset:31744
    s_waitcnt vmcnt(0)
    ds_read_b64_tr_b16 a[48:49], v28 offset:49152
    ds_read_b64_tr_b16 a[50:51], v28 offset:51200
    v_mfma_f32_32x32x16_bf16 v[48:63], a[36:39], v[116:119], v[48:63]
    ds_read_b64_tr_b16 a[52:53], v29 offset:49152
    ds_read_b64_tr_b16 a[54:55], v29 offset:51200
    v_mfma_f32_32x32x16_bf16 v[64:79], a[40:43], v[116:119], v[64:79]
    ds_read_b64_tr_b16 a[56:57], v30 offset:49152
    ds_read_b64_tr_b16 a[58:59], v30 offset:51200
    v_mfma_f32_32x32x16_bf16 v[80:95], a[44:47], v[116:119], v[80:95]
    ds_read_b64_tr_b16 a[60:61], v31 offset:49152
    ds_read_b64_tr_b16 a[62:63], v31 offset:51200
    s_waitcnt lgkmcnt(9)
    v_mfma_f32_32x32x16_bf16 v[32:47], a[0:3], v[96:99], v[32:47]
    ds_read_b128 v[104:107], v3 offset:12288
    v_mfma_f32_32x32x16_bf16 v[48:63], a[4:7], v[96:99], v[48:63]
    v_mfma_f32_32x32x16_bf16 v[64:79], a[8:11], v[96:99], v[64:79]
    v_mfma_f32_32x32x16_bf16 v[80:95], a[12:15], v[96:99], v[80:95]
    s_waitcnt lgkmcnt(1)
    v_mfma_f32_32x32x16_bf16 v[32:47], a[48:51], v[100:103], v[32:47]
    ds_read_b128 v[108:111], v3 offset:13312
    v_mfma_f32_32x32x16_bf16 v[48:63], a[52:55], v[100:103], v[48:63]
    v_mfma_f32_32x32x16_bf16 v[64:79], a[56:59], v[100:103], v[64:79]
    v_mfma_f32_32x32x16_bf16 v[80:95], a[60:63], v[100:103], v[80:95]
    s_waitcnt lgkmcnt(1)
    v_mfma_f32_32x32x16_bf16 v[32:47], a[16:19], v[104:107], v[32:47]
    ds_read_b128 v[112:115], v3 offset:14336
    v_mfma_f32_32x32x16_bf16 v[48:63], a[20:23], v[104:107], v[48:63]
    v_mfma_f32_32x32x16_bf16 v[64:79], a[24:27], v[104:107], v[64:79]
    v_mfma_f32_32x32x16_bf16 v[80:95], a[28:31], v[104:107], v[80:95]
    s_waitcnt lgkmcnt(1)
    v_mfma_f32_32x32x16_bf16 v[32:47], v[192:195], v[108:111], v[32:47]
    ds_read_b128 v[100:103], v3 offset:17408
    v_mfma_f32_32x32x16_bf16 v[48:63], v[196:199], v[108:111], v[48:63]
    ds_read_b128 v[96:99], v3 offset:16384
    v_mfma_f32_32x32x16_bf16 v[64:79], v[200:203], v[108:111], v[64:79]
    ds_read_b128 v[116:119], v3 offset:15360
    v_mfma_f32_32x32x16_bf16 v[80:95], v[204:207], v[108:111], v[80:95]
    s_waitcnt lgkmcnt(3)
    v_mfma_f32_32x32x16_bf16 v[32:47], v[208:211], v[112:115], v[32:47]
    v_mfma_f32_32x32x16_bf16 v[48:63], v[212:215], v[112:115], v[48:63]
    v_mfma_f32_32x32x16_bf16 v[64:79], v[216:219], v[112:115], v[64:79]
    v_mfma_f32_32x32x16_bf16 v[80:95], v[220:223], v[112:115], v[80:95]
    s_waitcnt lgkmcnt(0)
    v_mfma_f32_32x32x16_bf16 v[32:47], v[224:227], v[116:119], v[32:47]
    v_mfma_f32_32x32x16_bf16 v[32:47], v[160:163], v[96:99], v[32:47]
    v_mfma_f32_32x32x16_bf16 v[32:47], v[176:179], v[100:103], v[32:47]
    v_mfma_f32_32x32x16_bf16 v[48:63], v[228:231], v[116:119], v[48:63]
    v_mfma_f32_32x32x16_bf16 v[48:63], v[164:167], v[96:99], v[48:63]
    v_mfma_f32_32x32x16_bf16 v[48:63], v[180:183], v[100:103], v[48:63]
    s_nop 8
    v_cvt_pk_bf16_f32 v128, v32, v33
    v_cvt_pk_bf16_f32 v129, v34, v35
    v_cvt_pk_bf16_f32 v130, v36, v37
    v_cvt_pk_bf16_f32 v131, v38, v39
    buffer_store_dwordx4 v[128:131], v3, s[64:67], s10 offen sc1
    v_cvt_pk_bf16_f32 v132, v40, v41
    v_mfma_f32_32x32x16_bf16 v[64:79], v[232:235], v[116:119], v[64:79]
    v_cvt_pk_bf16_f32 v133, v42, v43
    v_cvt_pk_bf16_f32 v134, v44, v45
    v_cvt_pk_bf16_f32 v135, v46, v47
    buffer_store_dwordx4 v[132:135], v3, s[64:67], s10 offen offset:1024 sc1
    v_mfma_f32_32x32x16_bf16 v[64:79], v[168:171], v[96:99], v[64:79]
    v_mfma_f32_32x32x16_bf16 v[64:79], v[184:187], v[100:103], v[64:79]
    v_cvt_pk_bf16_f32 v136, v48, v49
    v_cvt_pk_bf16_f32 v137, v50, v51
    v_cvt_pk_bf16_f32 v138, v52, v53
    v_cvt_pk_bf16_f32 v139, v54, v55
    buffer_store_dwordx4 v[136:139], v3, s[64:67], s10 offen offset:2048 sc1
    v_cvt_pk_bf16_f32 v140, v56, v57
    v_mfma_f32_32x32x16_bf16 v[80:95], v[236:239], v[116:119], v[80:95]
    v_cvt_pk_bf16_f32 v141, v58, v59
    v_cvt_pk_bf16_f32 v142, v60, v61
    v_cvt_pk_bf16_f32 v143, v62, v63
    buffer_store_dwordx4 v[140:143], v3, s[64:67], s10 offen offset:3072 sc1
    v_mfma_f32_32x32x16_bf16 v[80:95], v[172:175], v[96:99], v[80:95]
    v_mfma_f32_32x32x16_bf16 v[80:95], v[188:191], v[100:103], v[80:95]
    v_cvt_pk_bf16_f32 v144, v64, v65
    v_cvt_pk_bf16_f32 v145, v66, v67
    v_cvt_pk_bf16_f32 v146, v68, v69
    v_cvt_pk_bf16_f32 v147, v70, v71
    buffer_store_dwordx4 v[144:147], v3, s[64:67], s11 offen sc1
    v_cvt_pk_bf16_f32 v148, v72, v73
    v_cvt_pk_bf16_f32 v149, v74, v75
    v_cvt_pk_bf16_f32 v150, v76, v77
    v_cvt_pk_bf16_f32 v151, v78, v79
    buffer_store_dwordx4 v[148:151], v3, s[64:67], s11 offen offset:1024 sc1
    s_nop 1
    v_cvt_pk_bf16_f32 v152, v80, v81
    v_cvt_pk_bf16_f32 v153, v82, v83
    v_cvt_pk_bf16_f32 v154, v84, v85
    v_cvt_pk_bf16_f32 v155, v86, v87
    buffer_store_dwordx4 v[152:155], v3, s[64:67], s11 offen offset:2048 sc1
    v_cvt_pk_bf16_f32 v156, v88, v89
    v_cvt_pk_bf16_f32 v157, v90, v91
    v_cvt_pk_bf16_f32 v158, v92, v93
    v_cvt_pk_bf16_f32 v159, v94, v95
    buffer_store_dwordx4 v[156:159], v3, s[64:67], s11 offen offset:3072 sc1
    s_mov_b32 s13, 0
    s_mov_b64 exec, 3
    s_waitcnt vmcnt(0)
    buffer_store_dword v250, v249, s[64:67], 0 offen sc1
    s_mov_b64 exec, -1
    buffer_load_dword v4, v248, s[64:67], 0 offen sc1
    s_waitcnt vmcnt(0)
    v_cmp_ne_u32 vcc, s42, v4
    s_cbranch_vccz LA_go
    buffer_load_dword v4, v248, s[64:67], 0 offen sc1
    s_sleep 5
LA_poll:
    buffer_load_dword v2, v248, s[64:67], 0 offen sc1
    s_add_u32 s13, s13, 1
    s_waitcnt vmcnt(1)
    v_cmp_ne_u32 vcc, s42, v4
    s_cbranch_vccz LA_go
    buffer_load_dword v4, v248, s[64:67], 0 offen sc1
    s_cmp_ge_u32 s13, 200000
    s_waitcnt vmcnt(1)
    v_cmp_ne_u32 vcc, s42, v2
    s_cbranch_scc1 LA_go
    s_cbranch_vccnz LA_poll
LA_go:
    s_mov_b32 s12, 0
    buffer_load_dwordx4 v[128:131], v12, s[64:67], s12 offen sc1
    s_mov_b32 s12, 4096
    buffer_load_dwordx4 v[132:135], v12, s[64:67], s12 offen sc1
    s_mov_b32 s12, 8192
    buffer_load_dwordx4 v[136:139], v12, s[64:67], s12 offen sc1
    s_mov_b32 s12, 12288
    buffer_load_dwordx4 v[140:143], v12, s[64:67], s12 offen sc1
    s_mov_b32 s12, 16384
    buffer_load_dwordx4 v[144:147], v12, s[64:67], s12 offen sc1
    s_mov_b32 s12, 20480
    buffer_load_dwordx4 v[148:151], v12, s[64:67], s12 offen sc1
    s_mov_b32 s12, 24576
    buffer_load_dwordx4 v[152:155], v12, s[64:67], s12 offen sc1
    s_mov_b32 s12, 28672
    buffer_load_dwordx4 v[156:159], v12, s[64:67], s12 offen sc1
    s_mov_b32 s13, 0
    s_waitcnt vmcnt(7)
    v_lshlrev_b32 v32, 16, v128
    v_and_b32 v33, 0xffff0000, v128
    v_lshlrev_b32 v34, 16, v129
    v_and_b32 v35, 0xffff0000, v129
    v_lshlrev_b32 v36, 16, v130
    v_and_b32 v37, 0xffff0000, v130
    v_lshlrev_b32 v38, 16, v131
    v_and_b32 v39, 0xffff0000, v131
    s_waitcnt vmcnt(6)
    v_lshlrev_b32 v44, 16, v132
    v_and_b32 v45, 0xffff0000, v132
    v_pk_add_f32 v[32:33], v[32:33], v[44:45]
    v_lshlrev_b32 v46, 16, v133
    v_and_b32 v47, 0xffff0000, v133
    v_pk_add_f32 v[34:35], v[34:35], v[46:47]
    v_lshlrev_b32 v44, 16, v134
    v_and_b32 v45, 0xffff0000, v134
    v_pk_add_f32 v[36:37], v[36:37], v[44:45]
    v_lshlrev_b32 v46, 16, v135
    v_and_b32 v47, 0xffff0000, v135
    v_pk_add_f32 v[38:39], v[38:39], v[46:47]
    s_waitcnt vmcnt(5)
    v_lshlrev_b32 v44, 16, v136
    v_and_b32 v45, 0xffff0000, v136
    v_pk_add_f32 v[32:33], v[32:33], v[44:45]
    v_lshlrev_b32 v46, 16, v137
    v_and_b32 v47, 0xffff0000, v137
    v_pk_add_f32 v[34:35], v[34:35], v[46:47]
    v_lshlrev_b32 v44, 16, v138
    v_and_b32 v45, 0xffff0000, v138
    v_pk_add_f32 v[36:37], v[36:37], v[44:45]
    v_lshlrev_b32 v46, 16, v139
    v_and_b32 v47, 0xffff0000, v139
    v_pk_add_f32 v[38:39], v[38:39], v[46:47]
    s_waitcnt vmcnt(4)
    v_lshlrev_b32 v44, 16, v140
    v_and_b32 v45, 0xffff0000, v140
    v_pk_add_f32 v[32:33], v[32:33], v[44:45]
    v_lshlrev_b32 v46, 16, v141
    v_and_b32 v47, 0xffff0000, v141
    v_pk_add_f32 v[34:35], v[34:35], v[46:47]
    v_lshlrev_b32 v44, 16, v142
    v_and_b32 v45, 0xffff0000, v142
    v_pk_add_f32 v[36:37], v[36:37], v[44:45]
    v_lshlrev_b32 v46, 16, v143
    v_and_b32 v47, 0xffff0000, v143
    v_pk_add_f32 v[38:39], v[38:39], v[46:47]
    s_waitcnt vmcnt(3)
    v_lshlrev_b32 v44, 16, v144
    v_and_b32 v45, 0xffff0000, v144
    v_pk_add_f32 v[32:33], v[32:33], v[44:45]
    v_lshlrev_b32 v46, 16, v145
    v_and_b32 v47, 0xffff0000, v145
    v_pk_add_f32 v[34:35], v[34:35], v[46:47]
    v_lshlrev_b32 v44, 16, v146
    v_and_b32 v45, 0xffff0000, v146
    v_pk_add_f32 v[36:37], v[36:37], v[44:45]
    v_lshlrev_b32 v46, 16, v147
    v_and_b32 v47, 0xffff0000, v147
    v_pk_add_f32 v[38:39], v[38:39], v[46:47]
    s_waitcnt vmcnt(2)
    v_lshlrev_b32 v44, 16, v148
    v_and_b32 v45, 0xffff0000, v148
    v_pk_add_f32 v[32:33], v[32:33], v[44:45]
    v_lshlrev_b32 v46, 16, v149
    v_and_b32 v47, 0xffff0000, v149
    v_pk_add_f32 v[34:35], v[34:35], v[46:47]
    v_lshlrev_b32 v44, 16, v150
    v_and_b32 v45, 0xffff0000, v150
    v_pk_add_f32 v[36:37], v[36:37], v[44:45]
    v_lshlrev_b32 v46, 16, v151
    v_and_b32 v47, 0xffff0000, v151
    v_pk_add_f32 v[38:39], v[38:39], v[46:47]
    s_waitcnt vmcnt(1)
    v_lshlrev_b32 v44, 16, v152
    v_and_b32 v45, 0xffff0000, v152
    v_pk_add_f32 v[32:33], v[32:33], v[44:45]
    v_lshlrev_b32 v46, 16, v153
    v_and_b32 v47, 0xffff0000, v153
    v_pk_add_f32 v[34:35], v[34:35], v[46:47]
    v_lshlrev_b32 v44, 16, v154
    v_and_b32 v45, 0xffff0000, v154
    v_pk_add_f32 v[36:37], v[36:37], v[44:45]
    v_lshlrev_b32 v46, 16, v155
    v_and_b32 v47, 0xffff0000, v155
    v_pk_add_f32 v[38:39], v[38:39], v[46:47]
    s_waitcnt vmcnt(0)
    v_lshlrev_b32 v44, 16, v156
    v_and_b32 v45, 0xffff0000, v156
    v_pk_add_f32 v[32:33], v[32:33], v[44:45]
    v_lshlrev_b32 v46, 16, v157
    v_and_b32 v47, 0xffff0000, v157
    v_pk_add_f32 v[34:35], v[34:35], v[46:47]
    v_lshlrev_b32 v44, 16, v158
    v_and_b32 v45, 0xffff0000, v158
    v_pk_add_f32 v[36:37], v[36:37], v[44:45]
    v_lshlrev_b32 v46, 16, v159
    v_and_b32 v47, 0xffff0000, v159
    v_pk_add_f32 v[38:39], v[38:39], v[46:47]
    v_cvt_pk_bf16_f32 v40, v32, v33
    v_cvt_pk_bf16_f32 v41, v34, v35
    v_cvt_pk_bf16_f32 v42, v36, v37
    v_cvt_pk_bf16_f32 v43, v38, v39
    s_nop 1
    v_permlane32_swap_b32 v40, v42
    v_permlane32_swap_b32 v41, v43
    buffer_store_dwordx4 v[40:43], v13, s[68:71], 0 offen
LA_end:
    s_endpgm
LA_nononce:
    v_mov_b32 v2, 0
    s_mov_b32 s10, 0
LA_nn_loop:
    buffer_load_dword v4, v2, s[92:95], 0 offen sc1
    s_add_u32 s10, s10, 1
    s_waitcnt vmcnt(0)
    v_readfirstlane_b32 s42, v4
    s_cmp_ge_u32 s10, 200000
    s_cbranch_scc1 LA_nonce
    s_sleep 4
    s_cmp_eq_u32 s42, 0
    s_cbranch_scc1 LA_nn_loop
    s_branch LA_nonce
LA_r1_1:
    s_call_b64 s[76:77], LA_rare1_1
    s_branch LA_b1_1
LA_r1_2:
    s_call_b64 s[76:77], LA_rare1_0
    s_branch LA_b1_2
LA_r1_3:
    s_call_b64 s[76:77], LA_rare1_1
    s_branch LA_b1_3
LA_r1_4:
    s_call_b64 s[76:77], LA_rare1_0
    s_branch LA_b1_4
LA_r1_5:
    s_call_b64 s[76:77], LA_rare1_1
    s_branch LA_b1_5
LA_r1_6:
    s_call_b64 s[76:77], LA_rare1_0
    s_branch LA_b1_6
LA_r1_7:
    s_call_b64 s[76:77], LA_rare1_1
    s_branch LA_b1_7
LA_r1_8:
    s_call_b64 s[76:77], LA_rare1_0
    s_branch LA_b1_8
LA_r1_9:
    s_call_b64 s[76:77], LA_rare1_1
    s_branch LA_b1_9
LA_r1_10:
    s_call_b64 s[76:77], LA_rare1_0
    s_branch LA_b1_10
LA_r1_11:
    s_call_b64 s[76:77], LA_rare1_1
    s_branch LA_b1_11
LA_r1_12:
    s_call_b64 s[76:77], LA_rare1_0
    s_branch LA_b1_12
LA_r1_13:
    s_call_b64 s[76:77], LA_rare1_1
    s_branch LA_b1_13
LA_r1_14:
    s_call_b64 s[76:77], LA_rare1_0
    s_branch LA_b1_14
LA_r1_15:
    s_call_b64 s[76:77], LA_rare1_1
    s_branch LA_b1_15
LA_r1_16:
    s_call_b64 s[76:77], LA_rare1_0
    s_branch LA_b1_16
LA_r1_17:
    s_call_b64 s[76:77], LA_rare1_1
    s_branch LA_b1_17
LA_r1_18:
    s_call_b64 s[76:77], LA_rare1_0
    s_branch LA_b1_18
LA_r1_19:
    s_call_b64 s[76:77], LA_rare1_1
    s_branch LA_b1_19
LA_r1_20:
    s_call_b64 s[76:77], LA_rare1_0
    s_branch LA_b1_20
LA_r1_21:
    s_call_b64 s[76:77], LA_rare1_1
    s_branch LA_b1_21
LA_r1_22:
    s_call_b64 s[76:77], LA_rare1_0
    s_branch LA_b1_22
LA_r1_23:
    s_call_b64 s[76:77], LA_rare1_1
    s_branch LA_b1_23
LA_r1_24:
    s_call_b64 s[76:77], LA_rare1_0
    s_branch LA_b1_24
LA_r1_25:
    s_call_b64 s[76:77], LA_rare1_1
    s_branch LA_b1_25
LA_r1_26:
    s_call_b64 s[76:77], LA_rare1_0
    s_branch LA_b1_26
LA_r1_27:
    s_call_b64 s[76:77], LA_rare1_1
    s_branch LA_b1_27
LA_r1_28:
    s_call_b64 s[76:77], LA_rare1_0
    s_branch LA_b1_28
LA_r1_29:
    s_call_b64 s[76:77], LA_rare1_1
    s_branch LA_b1_29
LA_r1_30:
    s_call_b64 s[76:77], LA_rare1_0
    s_branch LA_b1_30
LA_r1_31:
    s_call_b64 s[76:77], LA_rare1_1
    s_branch LA_b1_31
LA_rare1_0:
    s_nop 7
    v_max3_f32 v14, v32, v33, v34
    v_max3_f32 v14, v14, v35, v36
    v_max3_f32 v14, v14, v37, v38
    v_max_f32 v14, v14, v39
    v_max3_f32 v73, v40, v41, v42
    v_max3_f32 v73, v73, v43, v44
    v_max3_f32 v73, v73, v45, v46
    v_max_f32 v73, v73, v47
    v_mov_b32 v74, v14
    v_mov_b32 v75, v73
    s_nop 0
    v_permlane16_swap_b32 v74, v14
    v_permlane16_swap_b32 v75, v73
    v_max_f32 v14, v14, v74
    v_max_f32 v73, v73, v75
    v_mov_b32 v74, v14
    v_mov_b32 v75, v73
    s_nop 0
    v_permlane32_swap_b32 v74, v14
    v_permlane32_swap_b32 v75, v73
    v_max_f32 v14, v14, v74
    v_max_f32 v73, v73, v75
    v_add_f32 v14, 1088421888, v14
    v_add_f32 v73, 1088421888, v73
    v_max_f32 v14, 0, v14
    v_max_f32 v73, 0, v73
    v_exp_f32 v15, -v14
    v_exp_f32 v72, -v73
    v_sub_f32 v32, v32, v14
    v_sub_f32 v33, v33, v14
    v_sub_f32 v34, v34, v14
    v_sub_f32 v35, v35, v14
    v_sub_f32 v36, v36, v14
    v_sub_f32 v37, v37, v14
    v_sub_f32 v38, v38, v14
    v_sub_f32 v39, v39, v14
    v_sub_f32 v40, v40, v73
    v_sub_f32 v41, v41, v73
    v_sub_f32 v42, v42, v73
    v_sub_f32 v43, v43, v73
    v_sub_f32 v44, v44, v73
    v_sub_f32 v45, v45, v73
    v_sub_f32 v46, v46, v73
    v_sub_f32 v47, v47, v73
    v_sub_f32 v48, v48, v14
    v_sub_f32 v49, v49, v14
    v_sub_f32 v50, v50, v14
    v_sub_f32 v51, v51, v14
    v_sub_f32 v52, v52, v14
    v_sub_f32 v53, v53, v14
    v_sub_f32 v54, v54, v14
    v_sub_f32 v55, v55, v14
    v_sub_f32 v56, v56, v73
    v_sub_f32 v57, v57, v73
    v_sub_f32 v58, v58, v73
    v_sub_f32 v59, v59, v73
    v_sub_f32 v60, v60, v73
    v_sub_f32 v61, v61, v73
    v_sub_f32 v62, v62, v73
    v_sub_f32 v63, v63, v73
    v_sub_f32 v64, v64, v14
    v_sub_f32 v65, v65, v14
    v_sub_f32 v66, v66, v14
    v_sub_f32 v67, v67, v14
    v_sub_f32 v68, v68, v73
    v_sub_f32 v69, v69, v73
    v_sub_f32 v70, v70, v73
    v_sub_f32 v71, v71, v73
    v_mul_f32 v96, v96, v15
    v_mul_f32 v97, v97, v15
    v_mul_f32 v98, v98, v15
    v_mul_f32 v99, v99, v15
    v_mul_f32 v100, v100, v72
    v_mul_f32 v101, v101, v72
    v_mul_f32 v102, v102, v72
    v_mul_f32 v103, v103, v72
    v_mul_f32 v104, v104, v15
    v_mul_f32 v105, v105, v15
    v_mul_f32 v106, v106, v15
    v_mul_f32 v107, v107, v15
    v_mul_f32 v108, v108, v72
    v_mul_f32 v109, v109, v72
    v_mul_f32 v110, v110, v72
    v_mul_f32 v111, v111, v72
    v_mul_f32 v112, v112, v15
    v_mul_f32 v113, v113, v15
    v_mul_f32 v114, v114, v15
    v_mul_f32 v115, v115, v15
    v_mul_f32 v116, v116, v72
    v_mul_f32 v117, v117, v72
    v_mul_f32 v118, v118, v72
    v_mul_f32 v119, v119, v72
    v_mul_f32 v120, v120, v15
    v_mul_f32 v121, v121, v15
    v_mul_f32 v122, v122, v15
    v_mul_f32 v123, v123, v15
    v_mul_f32 v124, v124, v72
    v_mul_f32 v125, v125, v72
    v_mul_f32 v126, v126, v72
    v_mul_f32 v127, v127, v72
    v_mul_f32 v128, v128, v15
    v_mul_f32 v129, v129, v15
    v_mul_f32 v130, v130, v15
    v_mul_f32 v131, v131, v15
    v_mul_f32 v132, v132, v72
    v_mul_f32 v133, v133, v72
    v_mul_f32 v134, v134, v72
    v_mul_f32 v135, v135, v72
    v_mul_f32 v136, v136, v15
    v_mul_f32 v137, v137, v15
    v_mul_f32 v138, v138, v15
    v_mul_f32 v139, v139, v15
    v_mul_f32 v140, v140, v72
    v_mul_f32 v141, v141, v72
    v_mul_f32 v142, v142, v72
    v_mul_f32 v143, v143, v72
    v_mul_f32 v144, v144, v15
    v_mul_f32 v145, v145, v15
    v_mul_f32 v146, v146, v15
    v_mul_f32 v147, v147, v15
    v_mul_f32 v148, v148, v72
    v_mul_f32 v149, v149, v72
    v_mul_f32 v150, v150, v72
    v_mul_f32 v151, v151, v72
    v_mul_f32 v152, v152, v15
    v_mul_f32 v153, v153, v15
    v_mul_f32 v154, v154, v15
    v_mul_f32 v155, v155, v15
    v_mul_f32 v156, v156, v72
    v_mul_f32 v157, v157, v72
    v_mul_f32 v158, v158, v72
    v_mul_f32 v159, v159, v72
    v_mul_f32 v76, v76, v15
    v_mul_f32 v240, v240, v72
    v_mul_f32 v77, v77, v15
    v_mul_f32 v241, v241, v72
    v_mul_f32 v78, v78, v15
    v_mul_f32 v242, v242, v72
    v_mul_f32 v79, v79, v15
    v_mul_f32 v243, v243, v72
    v_exp_f32 v244, v32
    v_exp_f32 v245, v33
    v_exp_f32 v246, v34
    v_cvt_pk_bf16_f32 v80, v244, v245
    v_exp_f32 v247, v35
    v_exp_f32 v244, v36
    v_cvt_pk_bf16_f32 v81, v246, v247
    v_exp_f32 v245, v37
    v_exp_f32 v246, v38
    v_cvt_pk_bf16_f32 v82, v244, v245
    v_exp_f32 v247, v39
    v_exp_f32 v244, v40
    v_cvt_pk_bf16_f32 v83, v246, v247
    v_exp_f32 v245, v41
    v_exp_f32 v246, v42
    v_cvt_pk_bf16_f32 v84, v244, v245
    v_exp_f32 v247, v43
    v_exp_f32 v244, v44
    v_cvt_pk_bf16_f32 v85, v246, v247
    v_exp_f32 v245, v45
    v_exp_f32 v246, v46
    v_cvt_pk_bf16_f32 v86, v244, v245
    v_exp_f32 v247, v47
    s_nop 0
    v_cvt_pk_bf16_f32 v87, v246, v247
    s_nop 1
    s_setpc_b64 s[76:77]
LA_rare1_1:
    s_nop 7
    v_max3_f32 v14, v48, v49, v50
    v_max3_f32 v14, v14, v51, v52
    v_max3_f32 v14, v14, v53, v54
    v_max_f32 v14, v14, v55
    v_max3_f32 v73, v56, v57, v58
    v_max3_f32 v73, v73, v59, v60
    v_max3_f32 v73, v73, v61, v62
    v_max_f32 v73, v73, v63
    v_mov_b32 v74, v14
    v_mov_b32 v75, v73
    s_nop 0
    v_permlane16_swap_b32 v74, v14
    v_permlane16_swap_b32 v75, v73
    v_max_f32 v14, v14, v74
    v_max_f32 v73, v73, v75
    v_mov_b32 v74, v14
    v_mov_b32 v75, v73
    s_nop 0
    v_permlane32_swap_b32 v74, v14
    v_permlane32_swap_b32 v75, v73
    v_max_f32 v14, v14, v74
    v_max_f32 v73, v73, v75
    v_add_f32 v14, 1088421888, v14
    v_add_f32 v73, 1088421888, v73
    v_max_f32 v14, 0, v14
    v_max_f32 v73, 0, v73
    v_exp_f32 v15, -v14
    v_exp_f32 v72, -v73
    v_sub_f32 v48, v48, v14
    v_sub_f32 v49, v49, v14
    v_sub_f32 v50, v50, v14
    v_sub_f32 v51, v51, v14
    v_sub_f32 v52, v52, v14
    v_sub_f32 v53, v53, v14
    v_sub_f32 v54, v54, v14
    v_sub_f32 v55, v55, v14
    v_sub_f32 v56, v56, v73
    v_sub_f32 v57, v57, v73
    v_sub_f32 v58, v58, v73
    v_sub_f32 v59, v59, v73
    v_sub_f32 v60, v60, v73
    v_sub_f32 v61, v61, v73
    v_sub_f32 v62, v62, v73
    v_sub_f32 v63, v63, v73
    v_sub_f32 v32, v32, v14
    v_sub_f32 v33, v33, v14
    v_sub_f32 v34, v34, v14
    v_sub_f32 v35, v35, v14
    v_sub_f32 v36, v36, v14
    v_sub_f32 v37, v37, v14
    v_sub_f32 v38, v38, v14
    v_sub_f32 v39, v39, v14
    v_sub_f32 v40, v40, v73
    v_sub_f32 v41, v41, v73
    v_sub_f32 v42, v42, v73
    v_sub_f32 v43, v43, v73
    v_sub_f32 v44, v44, v73
    v_sub_f32 v45, v45, v73
    v_sub_f32 v46, v46, v73
    v_sub_f32 v47, v47, v73
    v_sub_f32 v64, v64, v14
    v_sub_f32 v65, v65, v14
    v_sub_f32 v66, v66, v14
    v_sub_f32 v67, v67, v14
    v_sub_f32 v68, v68, v73
    v_sub_f32 v69, v69, v73
    v_sub_f32 v70, v70, v73
    v_sub_f32 v71, v71, v73
    v_mul_f32 v96, v96, v15
    v_mul_f32 v97, v97, v15
    v_mul_f32 v98, v98, v15
    v_mul_f32 v99, v99, v15
    v_mul_f32 v100, v100, v72
    v_mul_f32 v101, v101, v72
    v_mul_f32 v102, v102, v72
    v_mul_f32 v103, v103, v72
    v_mul_f32 v104, v104, v15
    v_mul_f32 v105, v105, v15
    v_mul_f32 v106, v106, v15
    v_mul_f32 v107, v107, v15
    v_mul_f32 v108, v108, v72
    v_mul_f32 v109, v109, v72
    v_mul_f32 v110, v110, v72
    v_mul_f32 v111, v111, v72
    v_mul_f32 v112, v112, v15
    v_mul_f32 v113, v113, v15
    v_mul_f32 v114, v114, v15
    v_mul_f32 v115, v115, v15
    v_mul_f32 v116, v116, v72
    v_mul_f32 v117, v117, v72
    v_mul_f32 v118, v118, v72
    v_mul_f32 v119, v119, v72
    v_mul_f32 v120, v120, v15
    v_mul_f32 v121, v121, v15
    v_mul_f32 v122, v122, v15
    v_mul_f32 v123, v123, v15
    v_mul_f32 v124, v124, v72
    v_mul_f32 v125, v125, v72
    v_mul_f32 v126, v126, v72
    v_mul_f32 v127, v127, v72
    v_mul_f32 v128, v128, v15
    v_mul_f32 v129, v129, v15
    v_mul_f32 v130, v130, v15
    v_mul_f32 v131, v131, v15
    v_mul_f32 v132, v132, v72
    v_mul_f32 v133, v133, v72
    v_mul_f32 v134, v134, v72
    v_mul_f32 v135, v135, v72
    v_mul_f32 v136, v136, v15
    v_mul_f32 v137, v137, v15
    v_mul_f32 v138, v138, v15
    v_mul_f32 v139, v139, v15
    v_mul_f32 v140, v140, v72
    v_mul_f32 v141, v141, v72
    v_mul_f32 v142, v142, v72
    v_mul_f32 v143, v143, v72
    v_mul_f32 v144, v144, v15
    v_mul_f32 v145, v145, v15
    v_mul_f32 v146, v146, v15
    v_mul_f32 v147, v147, v15
    v_mul_f32 v148, v148, v72
    v_mul_f32 v149, v149, v72
    v_mul_f32 v150, v150, v72
    v_mul_f32 v151, v151, v72
    v_mul_f32 v152, v152, v15
    v_mul_f32 v153, v153, v15
    v_mul_f32 v154, v154, v15
    v_mul_f32 v155, v155, v15
    v_mul_f32 v156, v156, v72
    v_mul_f32 v157, v157, v72
    v_mul_f32 v158, v158, v72
    v_mul_f32 v159, v159, v72
    v_mul_f32 v76, v76, v15
    v_mul_f32 v240, v240, v72
    v_mul_f32 v77, v77, v15
    v_mul_f32 v241, v241, v72
    v_mul_f32 v78, v78, v15
    v_mul_f32 v242, v242, v72
    v_mul_f32 v79, v79, v15
    v_mul_f32 v243, v243, v72
    v_exp_f32 v244, v48
    v_exp_f32 v245, v49
    v_exp_f32 v246, v50
    v_cvt_pk_bf16_f32 v88, v244, v245
    v_exp_f32 v247, v51
    v_exp_f32 v244, v52
    v_cvt_pk_bf16_f32 v89, v246, v247
    v_exp_f32 v245, v53
    v_exp_f32 v246, v54
    v_cvt_pk_bf16_f32 v90, v244, v245
    v_exp_f32 v247, v55
    v_exp_f32 v244, v56
    v_cvt_pk_bf16_f32 v91, v246, v247
    v_exp_f32 v245, v57
    v_exp_f32 v246, v58
    v_cvt_pk_bf16_f32 v92, v244, v245
    v_exp_f32 v247, v59
    v_exp_f32 v244, v60
    v_cvt_pk_bf16_f32 v93, v246, v247
    v_exp_f32 v245, v61
    v_exp_f32 v246, v62
    v_cvt_pk_bf16_f32 v94, v244, v245
    v_exp_f32 v247, v63
    s_nop 0
    v_cvt_pk_bf16_f32 v95, v246, v247
    s_nop 1
    s_setpc_b64 s[76:77]
LA_code_end:
.p2align 6
LB_top:
    s_cmp_ge_u32 s2, 256
    s_cbranch_scc1 LB_end
    s_mov_b32 s100, 0
LB_again:
    s_load_dwordx16 s[16:31], s[0:1], 0
    s_load_dwordx8 s[32:39], s[0:1], 64
    s_load_dwordx2 s[40:41], s[0:1], 96
    s_getpc_b64 s[12:13]
LB_pc:
    s_bfe_u32 s10, s2, 0x40003
    s_lshl_b32 s10, s10, 12
    v_lshl_add_u32 v6, v0, 4, s10
    v_min_u32 v6, 0xa844, v6
    global_load_dwordx4 v[48:51], v6, s[12:13]
    v_lshrrev_b32 v2, 6, v0
    v_and_b32 v1, 63, v0
    v_readfirstlane_b32 s3, v2
    s_and_b32 s4, s2, 7
    s_lshr_b32 s7, s2, 3
    s_and_b32 s5, s7, 15
    s_lshr_b32 s6, s7, 4
    v_lshrrev_b32 v3, 4, v1
    v_and_b32 v4, 15, v1
    s_lshl_b32 s13, s4, 10
    s_lshl_b32 s14, s3, 8
    s_add_u32 s13, s13, s14
    v_lshlrev_b32 v11, 16, v3
    v_lshl_add_u32 v11, v4, 4, v11
    v_add_u32 v11, s13, v11
    s_mov_b32 s54, 4194304
    s_mov_b32 s55, 0x20000
    s_cmp_eq_u32 s6, 1
    s_waitcnt lgkmcnt(0)
    s_cselect_b32 s52, s32, s22
    s_cselect_b32 s53, s33, s23
    s_cselect_b32 s16, s26, s16
    s_cselect_b32 s17, s27, s17
    s_cselect_b32 s18, s28, s18
    s_cselect_b32 s19, s29, s19
    s_cselect_b32 s20, s30, s20
    s_cselect_b32 s21, s31, s21
    s_cselect_b32 s24, s34, s24
    s_cselect_b32 s25, s35, s25
    s_add_u32 s80, s5, 0
    s_and_b32 s80, s80, 15
    s_lshl_b32 s80, s80, 18
    buffer_load_dwordx4 v[160:163], v11, s[52:55], s80 offen
    s_add_u32 s80, s80, 8192
    buffer_load_dwordx4 v[164:167], v11, s[52:55], s80 offen
    s_add_u32 s80, s80, 8192
    buffer_load_dwordx4 v[168:171], v11, s[52:55], s80 offen
    s_add_u32 s80, s80, 8192
    buffer_load_dwordx4 v[172:175], v11, s[52:55], s80 offen
    s_add_u32 s80, s80, 8192
    buffer_load_dwordx4 v[176:179], v11, s[52:55], s80 offen
    s_add_u32 s80, s80, 8192
    buffer_load_dwordx4 v[180:183], v11, s[52:55], s80 offen
    s_add_u32 s80, s80, 8192
    buffer_load_dwordx4 v[184:187], v11, s[52:55], s80 offen
    s_add_u32 s80, s80, 8192
    buffer_load_dwordx4 v[188:191], v11, s[52:55], s80 offen
    s_lshl_b32 s10, s5, 15
    s_add_u32 s60, s16, s10
    s_addc_u32 s61, s17, 0
    s_mov_b32 s62, 32768
    s_mov_b32 s63, 0x20000
    s_and_b32 s8, s3, 1
    s_lshl_b32 s8, s8, 3
    s_lshl_b32 s11, s5, 2
    s_lshl_b32 s12, s3, 13
    s_add_u32 s15, s12, 131072
    v_xor_b32 v5, s8, v1
    v_xor_b32 v32, 0, v5
    v_add_u32 v32, s11, v32
    v_and_b32 v32, 63, v32
    v_lshl_add_u32 v32, v32, 4, s12
    v_xor_b32 v33, 1, v5
    v_add_u32 v33, s11, v33
    v_and_b32 v33, 63, v33
    v_lshl_add_u32 v33, v33, 4, s12
    v_xor_b32 v34, 2, v5
    v_add_u32 v34, s11, v34
    v_and_b32 v34, 63, v34
    v_lshl_add_u32 v34, v34, 4, s12
    v_xor_b32 v35, 3, v5
    v_add_u32 v35, s11, v35
    v_and_b32 v35, 63, v35
    v_lshl_add_u32 v35, v35, 4, s12
    v_xor_b32 v36, 4, v5
    v_add_u32 v36, s11, v36
    v_and_b32 v36, 63, v36
    v_lshl_add_u32 v36, v36, 4, s12
    v_xor_b32 v37, 5, v5
    v_add_u32 v37, s11, v37
    v_and_b32 v37, 63, v37
    v_lshl_add_u32 v37, v37, 4, s12
    v_xor_b32 v38, 6, v5
    v_add_u32 v38, s11, v38
    v_and_b32 v38, 63, v38
    v_lshl_add_u32 v38, v38, 4, s12
    v_xor_b32 v39, 7, v5
    v_add_u32 v39, s11, v39
    v_and_b32 v39, 63, v39
    v_lshl_add_u32 v39, v39, 4, s12
    s_and_b32 s10, s2, 127
    s_lshl_b32 s10, s10, 18
    s_add_u32 s44, s18, s10
    s_addc_u32 s45, s19, 0
    s_mov_b32 s46, 262144
    s_mov_b32 s47, 0x20000
    s_add_u32 s48, s20, s10
    s_addc_u32 s49, s21, 0
    s_mov_b32 s50, 262144
    s_mov_b32 s51, 0x20000
    s_lshl_b32 s10, s4, 19
    s_add_u32 s56, s24, s10
    s_addc_u32 s57, s25, 0
    s_mov_b32 s58, 524288
    s_mov_b32 s59, 0x20000
    s_mov_b32 s64, s40
    s_mov_b32 s65, s41
    s_mov_b32 s66, 0x10000000
    s_mov_b32 s67, 0x20000
    s_mov_b32 s68, s36
    s_mov_b32 s69, s37
    s_mov_b32 s70, 1048576
    s_mov_b32 s71, 0x20000
    s_mov_b32 s92, s38
    s_mov_b32 s93, s39
    s_mov_b32 s94, 256
    s_mov_b32 s95, 0x20000
    s_lshl_b32 s75, s7, 20
    v_mov_b32 v56, 270336
    s_xor_b32 s10, s2, 128
    s_or_b32 s10, s10, s3
    s_cbranch_scc1 LB_ne0
    buffer_load_dword v57, v56, s[64:67], 0 offen sc1
LB_ne0:
    s_mov_b32 s72, 0x05040100
    s_mov_b32 s73, 0x07060302
    s_mov_b32 s74, 1040356334
    s_lshl_b32 s78, s3, 11
    s_lshl_b32 s79, s3, 12
    s_lshl_b32 s81, s5, 15
    s_mul_i32 s10, s3, 2048
    v_lshl_add_u32 v6, v3, 8, s10
    v_add_u32 v7, s8, v3
    v_xor_b32 v7, v7, v4
    v_lshl_add_u32 v8, v7, 4, v6
    v_xor_b32 v9, 192, v8
    v_lshlrev_b32 v7, 1, v3
    v_xor_b32 v7, v7, v4
    v_lshl_add_u32 v10, v7, 4, v6
    v_lshlrev_b32 v7, 2, v3
    v_xor_b32 v7, v7, v4
    v_lshlrev_b32 v7, 4, v7
    v_lshl_add_u32 v7, v3, 10, v7
    v_add_u32 v60, s14, v7
    v_add_u32 v61, 3072, v60
    v_add_u32 v62, 14336, v60
    v_add_u32 v63, 17408, v60
    v_and_b32 v7, 4, v4
    v_lshlrev_b32 v7, 1, v7
    v_xor_b32 v7, v7, v4
    v_lshlrev_b32 v5, 2, v3
    v_xor_b32 v7, v7, v5
    v_lshlrev_b32 v7, 4, v7
    v_lshl_add_u32 v16, v4, 8, v7
    v_xor_b32 v17, 16, v16
    v_xor_b32 v18, 32, v16
    v_xor_b32 v19, 48, v16
    v_lshrrev_b32 v5, 2, v1
    v_and_b32 v6, 7, v5
    v_lshlrev_b32 v7, 8, v5
    v_lshl_add_u32 v7, v6, 5, v7
    v_and_b32 v5, 3, v1
    v_lshl_add_u32 v7, v5, 3, v7
    v_add_u32 v20, 65536, v7
    v_xor_b32 v21, 32, v20
    v_xor_b32 v22, 64, v20
    v_xor_b32 v23, 96, v20
    v_xor_b32 v24, 128, v20
    v_xor_b32 v25, 160, v20
    v_xor_b32 v26, 192, v20
    v_xor_b32 v27, 224, v20
    v_lshrrev_b32 v6, 5, v1
    v_bfe_u32 v5, v1, 2, 2
    v_lshl_add_u32 v7, v6, 2, v5
    v_lshlrev_b32 v7, 8, v7
    v_lshl_add_u32 v7, v5, 6, v7
    v_and_b32 v5, 1, v3
    v_lshl_add_u32 v7, v5, 5, v7
    v_and_b32 v5, 3, v1
    v_lshl_add_u32 v7, v5, 3, v7
    v_add_u32 v28, s79, v7
    v_xor_b32 v29, 64, v28
    v_xor_b32 v30, 128, v28
    v_xor_b32 v31, 192, v28
    v_xor_b32 v5, v3, v4
    v_lshlrev_b32 v5, 4, v5
    v_lshl_add_u32 v5, v4, 10, v5
    v_add_u32 v44, 131072, v5
    v_xor_b32 v45, 64, v44
    v_xor_b32 v46, 128, v44
    v_xor_b32 v47, 192, v44
    v_xor_b32 v5, 128, v10
    s_mov_b32 m0, s15
    s_movk_i32 s10, 0x1000
    buffer_load_dwordx4 v32, s[60:63], 0 offen lds
    buffer_load_dwordx4 v33, s[60:63], 0 offen offset:1024 lds
    buffer_load_dwordx4 v34, s[60:63], 0 offen offset:2048 lds
    buffer_load_dwordx4 v35, s[60:63], 0 offen offset:3072 lds
    s_add_u32 m0, s15, 4096
    s_nop 0
    buffer_load_dwordx4 v36, s[60:63], s10 offen lds
    buffer_load_dwordx4 v37, s[60:63], s10 offen offset:1024 lds
    buffer_load_dwordx4 v38, s[60:63], s10 offen offset:2048 lds
    buffer_load_dwordx4 v39, s[60:63], s10 offen offset:3072 lds
    s_add_u32 s80, s5, 1
    s_and_b32 s80, s80, 15
    s_lshl_b32 s80, s80, 18
    buffer_load_dwordx4 v[192:195], v11, s[52:55], s80 offen
    s_add_u32 s80, s80, 8192
    buffer_load_dwordx4 v[196:199], v11, s[52:55], s80 offen
    s_add_u32 s80, s80, 8192
    buffer_load_dwordx4 v[200:203], v11, s[52:55], s80 offen
    s_add_u32 s80, s80, 8192
    buffer_load_dwordx4 v[204:207], v11, s[52:55], s80 offen
    s_add_u32 s80, s80, 8192
    buffer_load_dwordx4 v[208:211], v11, s[52:55], s80 offen
    s_add_u32 s80, s80, 8192
    buffer_load_dwordx4 v[212:215], v11, s[52:55], s80 offen
    s_add_u32 s80, s80, 8192
    buffer_load_dwordx4 v[216:219], v11, s[52:55], s80 offen
    s_add_u32 s80, s80, 8192
    buffer_load_dwordx4 v[220:223], v11, s[52:55], s80 offen
    s_waitcnt vmcnt(8)
    s_barrier
    ds_read_b128 a[0:3], v44 offset:0
    ds_read_b128 a[4:7], v44 offset:16384
    ds_read_b128 a[8:11], v45 offset:0
    ds_read_b128 a[12:15], v45 offset:16384
    ds_read_b128 a[16:19], v46 offset:0
    ds_read_b128 a[20:23], v46 offset:16384
    ds_read_b128 a[24:27], v47 offset:0
    ds_read_b128 a[28:31], v47 offset:16384
    ds_read_b128 a[32:35], v44 offset:256
    ds_read_b128 a[36:39], v44 offset:16640
    ds_read_b128 a[40:43], v45 offset:256
    ds_read_b128 a[44:47], v45 offset:16640
    ds_read_b128 a[48:51], v46 offset:256
    ds_read_b128 a[52:55], v46 offset:16640
    ds_read_b128 a[56:59], v47 offset:256
    ds_read_b128 a[60:63], v47 offset:16640
    ds_read_b128 a[64:67], v44 offset:512
    ds_read_b128 a[68:71], v44 offset:16896
    s_add_u32 s80, s5, 2
    s_and_b32 s80, s80, 15
    s_lshl_b32 s80, s80, 18
    buffer_load_dwordx4 v[224:227], v11, s[52:55], s80 offen
    ds_read_b128 a[72:75], v45 offset:512
    ds_read_b128 a[76:79], v45 offset:16896
    s_add_u32 s80, s80, 8192
    buffer_load_dwordx4 v[228:231], v11, s[52:55], s80 offen
    ds_read_b128 a[80:83], v46 offset:512
    ds_read_b128 a[84:87], v46 offset:16896
    s_add_u32 s80, s80, 8192
    buffer_load_dwordx4 v[232:235], v11, s[52:55], s80 offen
    ds_read_b128 a[88:91], v47 offset:512
    ds_read_b128 a[92:95], v47 offset:16896
    s_add_u32 s80, s80, 8192
    buffer_load_dwordx4 v[236:239], v11, s[52:55], s80 offen
    ds_read_b128 a[96:99], v44 offset:768
    ds_read_b128 a[100:103], v44 offset:17152
    s_add_u32 s80, s80, 8192
    buffer_load_dwordx4 v[240:243], v11, s[52:55], s80 offen
    ds_read_b128 a[104:107], v45 offset:768
    ds_read_b128 a[108:111], v45 offset:17152
    s_add_u32 s80, s80, 8192
    buffer_load_dwordx4 v[244:247], v11, s[52:55], s80 offen
    ds_read_b128 a[112:115], v46 offset:768
    ds_read_b128 a[116:119], v46 offset:17152
    s_add_u32 s80, s80, 8192
    buffer_load_dwordx4 v[248:251], v11, s[52:55], s80 offen
    ds_read_b128 a[120:123], v47 offset:768
    ds_read_b128 a[124:127], v47 offset:17152
    s_add_u32 s80, s80, 8192
    buffer_load_dwordx4 v[252:255], v11, s[52:55], s80 offen
    v_perm_b32 v32, v164, v160, s72
    v_perm_b32 v33, v172, v168, s72
    v_perm_b32 v34, v180, v176, s72
    v_perm_b32 v35, v188, v184, s72
    v_perm_b32 v36, v164, v160, s73
    v_perm_b32 v37, v172, v168, s73
    v_perm_b32 v38, v180, v176, s73
    v_perm_b32 v39, v188, v184, s73
    s_waitcnt lgkmcnt(15)
    v_mfma_f32_16x16x32_bf16 v[96:99], v[32:35], a[0:3], 0
    v_mfma_f32_16x16x32_bf16 v[100:103], v[32:35], a[4:7], 0
    s_add_u32 s80, s5, 3
    s_and_b32 s80, s80, 15
    s_lshl_b32 s80, s80, 18
    buffer_load_dwordx4 v[64:67], v11, s[52:55], s80 offen
    v_perm_b32 v40, v165, v161, s72
    v_perm_b32 v41, v173, v169, s72
    v_perm_b32 v42, v181, v177, s72
    v_perm_b32 v43, v189, v185, s72
    v_mfma_f32_16x16x32_bf16 v[104:107], v[36:39], a[0:3], 0
    v_mfma_f32_16x16x32_bf16 v[108:111], v[36:39], a[4:7], 0
    s_add_u32 s80, s80, 8192
    buffer_load_dwordx4 v[68:71], v11, s[52:55], s80 offen
    v_perm_b32 v32, v165, v161, s73
    v_perm_b32 v33, v173, v169, s73
    v_perm_b32 v34, v181, v177, s73
    v_perm_b32 v35, v189, v185, s73
    v_mfma_f32_16x16x32_bf16 v[112:115], v[40:43], a[0:3], 0
    v_mfma_f32_16x16x32_bf16 v[116:119], v[40:43], a[4:7], 0
    s_add_u32 s80, s80, 8192
    buffer_load_dwordx4 v[72:75], v11, s[52:55], s80 offen
    v_perm_b32 v36, v166, v162, s72
    v_perm_b32 v37, v174, v170, s72
    v_perm_b32 v38, v182, v178, s72
    v_perm_b32 v39, v190, v186, s72
    v_mfma_f32_16x16x32_bf16 v[120:123], v[32:35], a[0:3], 0
    v_mfma_f32_16x16x32_bf16 v[124:127], v[32:35], a[4:7], 0
    s_add_u32 s80, s80, 8192
    buffer_load_dwordx4 v[76:79], v11, s[52:55], s80 offen
    v_perm_b32 v40, v166, v162, s73
    v_perm_b32 v41, v174, v170, s73
    v_perm_b32 v42, v182, v178, s73
    v_perm_b32 v43, v190, v186, s73
    v_mfma_f32_16x16x32_bf16 v[128:131], v[36:39], a[0:3], 0
    v_mfma_f32_16x16x32_bf16 v[132:135], v[36:39], a[4:7], 0
    s_add_u32 s80, s80, 8192
    buffer_load_dwordx4 v[80:83], v11, s[52:55], s80 offen
    v_perm_b32 v32, v167, v163, s72
    v_perm_b32 v33, v175, v171, s72
    v_perm_b32 v34, v183, v179, s72
    v_perm_b32 v35, v191, v187, s72
    v_mfma_f32_16x16x32_bf16 v[136:139], v[40:43], a[0:3], 0
    v_mfma_f32_16x16x32_bf16 v[140:143], v[40:43], a[4:7], 0
    s_add_u32 s80, s80, 8192
    buffer_load_dwordx4 v[84:87], v11, s[52:55], s80 offen
    v_perm_b32 v36, v167, v163, s73
    v_perm_b32 v37, v175, v171, s73
    v_perm_b32 v38, v183, v179, s73
    v_perm_b32 v39, v191, v187, s73
    v_mfma_f32_16x16x32_bf16 v[144:147], v[32:35], a[0:3], 0
    v_mfma_f32_16x16x32_bf16 v[148:151], v[32:35], a[4:7], 0
    s_add_u32 s80, s80, 8192
    buffer_load_dwordx4 v[88:91], v11, s[52:55], s80 offen
    v_mfma_f32_16x16x32_bf16 v[152:155], v[36:39], a[0:3], 0
    v_mfma_f32_16x16x32_bf16 v[156:159], v[36:39], a[4:7], 0
    s_add_u32 s80, s80, 8192
    buffer_load_dwordx4 v[92:95], v11, s[52:55], s80 offen
    s_xor_b32 s10, s2, 128
    s_or_b32 s10, s10, s3
    s_cbranch_scc1 LB_ne1
    v_add_u32 v57, 1, v57
    v_mov_b32 v2, 0
    v_max_u32 v57, 1, v57
    s_mov_b64 exec, 1
    buffer_store_dword v57, v56, s[64:67], 0 offen sc1
    buffer_store_dword v57, v2, s[92:95], 0 offen sc1
    s_mov_b64 exec, -1
LB_ne1:
    s_waitcnt vmcnt(16)
    v_perm_b32 v40, v196, v192, s72
    v_perm_b32 v41, v204, v200, s72
    v_perm_b32 v42, v212, v208, s72
    v_perm_b32 v43, v220, v216, s72
    v_perm_b32 v32, v196, v192, s73
    v_perm_b32 v33, v204, v200, s73
    v_perm_b32 v34, v212, v208, s73
    v_perm_b32 v35, v220, v216, s73
    v_mfma_f32_16x16x32_bf16 v[96:99], v[40:43], a[8:11], v[96:99]
    v_mfma_f32_16x16x32_bf16 v[100:103], v[40:43], a[12:15], v[100:103]
    s_add_u32 s80, s5, 4
    s_and_b32 s80, s80, 15
    s_lshl_b32 s80, s80, 18
    buffer_load_dwordx4 v[160:163], v11, s[52:55], s80 offen
    v_perm_b32 v36, v197, v193, s72
    v_perm_b32 v37, v205, v201, s72
    v_perm_b32 v38, v213, v209, s72
    v_perm_b32 v39, v221, v217, s72
    v_mfma_f32_16x16x32_bf16 v[104:107], v[32:35], a[8:11], v[104:107]
    v_mfma_f32_16x16x32_bf16 v[108:111], v[32:35], a[12:15], v[108:111]
    s_add_u32 s80, s80, 8192
    buffer_load_dwordx4 v[164:167], v11, s[52:55], s80 offen
    v_perm_b32 v40, v197, v193, s73
    v_perm_b32 v41, v205, v201, s73
    v_perm_b32 v42, v213, v209, s73
    v_perm_b32 v43, v221, v217, s73
    v_mfma_f32_16x16x32_bf16 v[112:115], v[36:39], a[8:11], v[112:115]
    v_mfma_f32_16x16x32_bf16 v[116:119], v[36:39], a[12:15], v[116:119]
    s_add_u32 s80, s80, 8192
    buffer_load_dwordx4 v[168:171], v11, s[52:55], s80 offen
    v_perm_b32 v32, v198, v194, s72
    v_perm_b32 v33, v206, v202, s72
    v_perm_b32 v34, v214, v210, s72
    v_perm_b32 v35, v222, v218, s72
    v_mfma_f32_16x16x32_bf16 v[120:123], v[40:43], a[8:11], v[120:123]
    v_mfma_f32_16x16x32_bf16 v[124:127], v[40:43], a[12:15], v[124:127]
    s_add_u32 s80, s80, 8192
    buffer_load_dwordx4 v[172:175], v11, s[52:55], s80 offen
    v_perm_b32 v36, v198, v194, s73
    v_perm_b32 v37, v206, v202, s73
    v_perm_b32 v38, v214, v210, s73
    v_perm_b32 v39, v222, v218, s73
    v_mfma_f32_16x16x32_bf16 v[128:131], v[32:35], a[8:11], v[128:131]
    v_mfma_f32_16x16x32_bf16 v[132:135], v[32:35], a[12:15], v[132:135]
    s_add_u32 s80, s80, 8192
    buffer_load_dwordx4 v[176:179], v11, s[52:55], s80 offen
    v_perm_b32 v40, v199, v195, s72
    v_perm_b32 v41, v207, v203, s72
    v_perm_b32 v42, v215, v211, s72
    v_perm_b32 v43, v223, v219, s72
    v_mfma_f32_16x16x32_bf16 v[136:139], v[36:39], a[8:11], v[136:139]
    v_mfma_f32_16x16x32_bf16 v[140:143], v[36:39], a[12:15], v[140:143]
    s_add_u32 s80, s80, 8192
    buffer_load_dwordx4 v[180:183], v11, s[52:55], s80 offen
    v_perm_b32 v32, v199, v195, s73
    v_perm_b32 v33, v207, v203, s73
    v_perm_b32 v34, v215, v211, s73
    v_perm_b32 v35, v223, v219, s73
    v_mfma_f32_16x16x32_bf16 v[144:147], v[40:43], a[8:11], v[144:147]
    v_mfma_f32_16x16x32_bf16 v[148:151], v[40:43], a[12:15], v[148:151]
    s_add_u32 s80, s80, 8192
    buffer_load_dwordx4 v[184:187], v11, s[52:55], s80 offen
    v_mfma_f32_16x16x32_bf16 v[152:155], v[32:35], a[8:11], v[152:155]
    v_mfma_f32_16x16x32_bf16 v[156:159], v[32:35], a[12:15], v[156:159]
    s_add_u32 s80, s80, 8192
    buffer_load_dwordx4 v[188:191], v11, s[52:55], s80 offen
    s_waitcnt vmcnt(16)
    v_perm_b32 v36, v228, v224, s72
    v_perm_b32 v37, v236, v232, s72
    v_perm_b32 v38, v244, v240, s72
    v_perm_b32 v39, v252, v248, s72
    v_perm_b32 v40, v228, v224, s73
    v_perm_b32 v41, v236, v232, s73
    v_perm_b32 v42, v244, v240, s73
    v_perm_b32 v43, v252, v248, s73
    v_mfma_f32_16x16x32_bf16 v[96:99], v[36:39], a[16:19], v[96:99]
    v_mfma_f32_16x16x32_bf16 v[100:103], v[36:39], a[20:23], v[100:103]
    s_add_u32 s80, s5, 5
    s_and_b32 s80, s80, 15
    s_lshl_b32 s80, s80, 18
    buffer_load_dwordx4 v[192:195], v11, s[52:55], s80 offen
    v_perm_b32 v32, v229, v225, s72
    v_perm_b32 v33, v237, v233, s72
    v_perm_b32 v34, v245, v241, s72
    v_perm_b32 v35, v253, v249, s72
    v_mfma_f32_16x16x32_bf16 v[104:107], v[40:43], a[16:19], v[104:107]
    v_mfma_f32_16x16x32_bf16 v[108:111], v[40:43], a[20:23], v[108:111]
    s_add_u32 s80, s80, 8192
    buffer_load_dwordx4 v[196:199], v11, s[52:55], s80 offen
    v_perm_b32 v36, v229, v225, s73
    v_perm_b32 v37, v237, v233, s73
    v_perm_b32 v38, v245, v241, s73
    v_perm_b32 v39, v253, v249, s73
    v_mfma_f32_16x16x32_bf16 v[112:115], v[32:35], a[16:19], v[112:115]
    v_mfma_f32_16x16x32_bf16 v[116:119], v[32:35], a[20:23], v[116:119]
    s_add_u32 s80, s80, 8192
    buffer_load_dwordx4 v[200:203], v11, s[52:55], s80 offen
    v_perm_b32 v40, v230, v226, s72
    v_perm_b32 v41, v238, v234, s72
    v_perm_b32 v42, v246, v242, s72
    v_perm_b32 v43, v254, v250, s72
    v_mfma_f32_16x16x32_bf16 v[120:123], v[36:39], a[16:19], v[120:123]
    v_mfma_f32_16x16x32_bf16 v[124:127], v[36:39], a[20:23], v[124:127]
    s_add_u32 s80, s80, 8192
    buffer_load_dwordx4 v[204:207], v11, s[52:55], s80 offen
    v_perm_b32 v32, v230, v226, s73
    v_perm_b32 v33, v238, v234, s73
    v_perm_b32 v34, v246, v242, s73
    v_perm_b32 v35, v254, v250, s73
    v_mfma_f32_16x16x32_bf16 v[128:131], v[40:43], a[16:19], v[128:131]
    v_mfma_f32_16x16x32_bf16 v[132:135], v[40:43], a[20:23], v[132:135]
    s_add_u32 s80, s80, 8192
    buffer_load_dwordx4 v[208:211], v11, s[52:55], s80 offen
    v_perm_b32 v36, v231, v227, s72
    v_perm_b32 v37, v239, v235, s72
    v_perm_b32 v38, v247, v243, s72
    v_perm_b32 v39, v255, v251, s72
    v_mfma_f32_16x16x32_bf16 v[136:139], v[32:35], a[16:19], v[136:139]
    v_mfma_f32_16x16x32_bf16 v[140:143], v[32:35], a[20:23], v[140:143]
    s_add_u32 s80, s80, 8192
    buffer_load_dwordx4 v[212:215], v11, s[52:55], s80 offen
    v_perm_b32 v40, v231, v227, s73
    v_perm_b32 v41, v239, v235, s73
    v_perm_b32 v42, v247, v243, s73
    v_perm_b32 v43, v255, v251, s73
    v_mfma_f32_16x16x32_bf16 v[144:147], v[36:39], a[16:19], v[144:147]
    v_mfma_f32_16x16x32_bf16 v[148:151], v[36:39], a[20:23], v[148:151]
    s_add_u32 s80, s80, 8192
    buffer_load_dwordx4 v[216:219], v11, s[52:55], s80 offen
    v_mfma_f32_16x16x32_bf16 v[152:155], v[40:43], a[16:19], v[152:155]
    v_mfma_f32_16x16x32_bf16 v[156:159], v[40:43], a[20:23], v[156:159]
    s_add_u32 s80, s80, 8192
    buffer_load_dwordx4 v[220:223], v11, s[52:55], s80 offen
    s_waitcnt vmcnt(16)
    v_perm_b32 v32, v68, v64, s72
    v_perm_b32 v33, v76, v72, s72
    v_perm_b32 v34, v84, v80, s72
    v_perm_b32 v35, v92, v88, s72
    v_perm_b32 v36, v68, v64, s73
    v_perm_b32 v37, v76, v72, s73
    v_perm_b32 v38, v84, v80, s73
    v_perm_b32 v39, v92, v88, s73
    v_mfma_f32_16x16x32_bf16 v[96:99], v[32:35], a[24:27], v[96:99]
    v_mfma_f32_16x16x32_bf16 v[100:103], v[32:35], a[28:31], v[100:103]
    s_add_u32 s80, s5, 6
    s_and_b32 s80, s80, 15
    s_lshl_b32 s80, s80, 18
    buffer_load_dwordx4 v[224:227], v11, s[52:55], s80 offen
    v_perm_b32 v40, v69, v65, s72
    v_perm_b32 v41, v77, v73, s72
    v_perm_b32 v42, v85, v81, s72
    v_perm_b32 v43, v93, v89, s72
    v_mfma_f32_16x16x32_bf16 v[104:107], v[36:39], a[24:27], v[104:107]
    v_mfma_f32_16x16x32_bf16 v[108:111], v[36:39], a[28:31], v[108:111]
    s_add_u32 s80, s80, 8192
    buffer_load_dwordx4 v[228:231], v11, s[52:55], s80 offen
    v_perm_b32 v32, v69, v65, s73
    v_perm_b32 v33, v77, v73, s73
    v_perm_b32 v34, v85, v81, s73
    v_perm_b32 v35, v93, v89, s73
    v_mfma_f32_16x16x32_bf16 v[112:115], v[40:43], a[24:27], v[112:115]
    v_mfma_f32_16x16x32_bf16 v[116:119], v[40:43], a[28:31], v[116:119]
    s_add_u32 s80, s80, 8192
    buffer_load_dwordx4 v[232:235], v11, s[52:55], s80 offen
    v_perm_b32 v36, v70, v66, s72
    v_perm_b32 v37, v78, v74, s72
    v_perm_b32 v38, v86, v82, s72
    v_perm_b32 v39, v94, v90, s72
    v_mfma_f32_16x16x32_bf16 v[120:123], v[32:35], a[24:27], v[120:123]
    v_mfma_f32_16x16x32_bf16 v[124:127], v[32:35], a[28:31], v[124:127]
    s_add_u32 s80, s80, 8192
    buffer_load_dwordx4 v[236:239], v11, s[52:55], s80 offen
    v_perm_b32 v40, v70, v66, s73
    v_perm_b32 v41, v78, v74, s73
    v_perm_b32 v42, v86, v82, s73
    v_perm_b32 v43, v94, v90, s73
    v_mfma_f32_16x16x32_bf16 v[128:131], v[36:39], a[24:27], v[128:131]
    v_mfma_f32_16x16x32_bf16 v[132:135], v[36:39], a[28:31], v[132:135]
    s_add_u32 s80, s80, 8192
    buffer_load_dwordx4 v[240:243], v11, s[52:55], s80 offen
    v_perm_b32 v32, v71, v67, s72
    v_perm_b32 v33, v79, v75, s72
    v_perm_b32 v34, v87, v83, s72
    v_perm_b32 v35, v95, v91, s72
    v_mfma_f32_16x16x32_bf16 v[136:139], v[40:43], a[24:27], v[136:139]
    v_mfma_f32_16x16x32_bf16 v[140:143], v[40:43], a[28:31], v[140:143]
    s_add_u32 s80, s80, 8192
    buffer_load_dwordx4 v[244:247], v11, s[52:55], s80 offen
    v_perm_b32 v36, v71, v67, s73
    v_perm_b32 v37, v79, v75, s73
    v_perm_b32 v38, v87, v83, s73
    v_perm_b32 v39, v95, v91, s73
    v_mfma_f32_16x16x32_bf16 v[144:147], v[32:35], a[24:27], v[144:147]
    v_mfma_f32_16x16x32_bf16 v[148:151], v[32:35], a[28:31], v[148:151]
    s_add_u32 s80, s80, 8192
    buffer_load_dwordx4 v[248:251], v11, s[52:55], s80 offen
    v_mfma_f32_16x16x32_bf16 v[152:155], v[36:39], a[24:27], v[152:155]
    v_mfma_f32_16x16x32_bf16 v[156:159], v[36:39], a[28:31], v[156:159]
    s_add_u32 s80, s80, 8192
    buffer_load_dwordx4 v[252:255], v11, s[52:55], s80 offen
    s_waitcnt vmcnt(16)
    v_perm_b32 v40, v164, v160, s72
    v_perm_b32 v41, v172, v168, s72
    v_perm_b32 v42, v180, v176, s72
    v_perm_b32 v43, v188, v184, s72
    v_perm_b32 v32, v164, v160, s73
    v_perm_b32 v33, v172, v168, s73
    v_perm_b32 v34, v180, v176, s73
    v_perm_b32 v35, v188, v184, s73
    v_mfma_f32_16x16x32_bf16 v[96:99], v[40:43], a[32:35], v[96:99]
    v_mfma_f32_16x16x32_bf16 v[100:103], v[40:43], a[36:39], v[100:103]
    s_add_u32 s80, s5, 7
    s_and_b32 s80, s80, 15
    s_lshl_b32 s80, s80, 18
    buffer_load_dwordx4 v[64:67], v11, s[52:55], s80 offen
    v_perm_b32 v36, v165, v161, s72
    v_perm_b32 v37, v173, v169, s72
    v_perm_b32 v38, v181, v177, s72
    v_perm_b32 v39, v189, v185, s72
    v_mfma_f32_16x16x32_bf16 v[104:107], v[32:35], a[32:35], v[104:107]
    v_mfma_f32_16x16x32_bf16 v[108:111], v[32:35], a[36:39], v[108:111]
    s_add_u32 s80, s80, 8192
    buffer_load_dwordx4 v[68:71], v11, s[52:55], s80 offen
    v_perm_b32 v40, v165, v161, s73
    v_perm_b32 v41, v173, v169, s73
    v_perm_b32 v42, v181, v177, s73
    v_perm_b32 v43, v189, v185, s73
    v_mfma_f32_16x16x32_bf16 v[112:115], v[36:39], a[32:35], v[112:115]
    v_mfma_f32_16x16x32_bf16 v[116:119], v[36:39], a[36:39], v[116:119]
    s_add_u32 s80, s80, 8192
    buffer_load_dwordx4 v[72:75], v11, s[52:55], s80 offen
    v_perm_b32 v32, v166, v162, s72
    v_perm_b32 v33, v174, v170, s72
    v_perm_b32 v34, v182, v178, s72
    v_perm_b32 v35, v190, v186, s72
    v_mfma_f32_16x16x32_bf16 v[120:123], v[40:43], a[32:35], v[120:123]
    v_mfma_f32_16x16x32_bf16 v[124:127], v[40:43], a[36:39], v[124:127]
    s_add_u32 s80, s80, 8192
    buffer_load_dwordx4 v[76:79], v11, s[52:55], s80 offen
    v_perm_b32 v36, v166, v162, s73
    v_perm_b32 v37, v174, v170, s73
    v_perm_b32 v38, v182, v178, s73
    v_perm_b32 v39, v190, v186, s73
    v_mfma_f32_16x16x32_bf16 v[128:131], v[32:35], a[32:35], v[128:131]
    v_mfma_f32_16x16x32_bf16 v[132:135], v[32:35], a[36:39], v[132:135]
    s_add_u32 s80, s80, 8192
    buffer_load_dwordx4 v[80:83], v11, s[52:55], s80 offen
    v_perm_b32 v40, v167, v163, s72
    v_perm_b32 v41, v175, v171, s72
    v_perm_b32 v42, v183, v179, s72
    v_perm_b32 v43, v191, v187, s72
    v_mfma_f32_16x16x32_bf16 v[136:139], v[36:39], a[32:35], v[136:139]
    v_mfma_f32_16x16x32_bf16 v[140:143], v[36:39], a[36:39], v[140:143]
    s_add_u32 s80, s80, 8192
    buffer_load_dwordx4 v[84:87], v11, s[52:55], s80 offen
    v_perm_b32 v32, v167, v163, s73
    v_perm_b32 v33, v175, v171, s73
    v_perm_b32 v34, v183, v179, s73
    v_perm_b32 v35, v191, v187, s73
    v_mfma_f32_16x16x32_bf16 v[144:147], v[40:43], a[32:35], v[144:147]
    v_mfma_f32_16x16x32_bf16 v[148:151], v[40:43], a[36:39], v[148:151]
    s_add_u32 s80, s80, 8192
    buffer_load_dwordx4 v[88:91], v11, s[52:55], s80 offen
    v_mfma_f32_16x16x32_bf16 v[152:155], v[32:35], a[32:35], v[152:155]
    v_mfma_f32_16x16x32_bf16 v[156:159], v[32:35], a[36:39], v[156:159]
    s_add_u32 s80, s80, 8192
    buffer_load_dwordx4 v[92:95], v11, s[52:55], s80 offen
    s_waitcnt vmcnt(16)
    v_perm_b32 v36, v196, v192, s72
    v_perm_b32 v37, v204, v200, s72
    v_perm_b32 v38, v212, v208, s72
    v_perm_b32 v39, v220, v216, s72
    v_perm_b32 v40, v196, v192, s73
    v_perm_b32 v41, v204, v200, s73
    v_perm_b32 v42, v212, v208, s73
    v_perm_b32 v43, v220, v216, s73
    v_mfma_f32_16x16x32_bf16 v[96:99], v[36:39], a[40:43], v[96:99]
    v_mfma_f32_16x16x32_bf16 v[100:103], v[36:39], a[44:47], v[100:103]
    s_add_u32 s80, s5, 8
    s_and_b32 s80, s80, 15
    s_lshl_b32 s80, s80, 18
    buffer_load_dwordx4 v[160:163], v11, s[52:55], s80 offen
    v_perm_b32 v32, v197, v193, s72
    v_perm_b32 v33, v205, v201, s72
    v_perm_b32 v34, v213, v209, s72
    v_perm_b32 v35, v221, v217, s72
    v_mfma_f32_16x16x32_bf16 v[104:107], v[40:43], a[40:43], v[104:107]
    v_mfma_f32_16x16x32_bf16 v[108:111], v[40:43], a[44:47], v[108:111]
    s_add_u32 s80, s80, 8192
    buffer_load_dwordx4 v[164:167], v11, s[52:55], s80 offen
    v_perm_b32 v36, v197, v193, s73
    v_perm_b32 v37, v205, v201, s73
    v_perm_b32 v38, v213, v209, s73
    v_perm_b32 v39, v221, v217, s73
    v_mfma_f32_16x16x32_bf16 v[112:115], v[32:35], a[40:43], v[112:115]
    v_mfma_f32_16x16x32_bf16 v[116:119], v[32:35], a[44:47], v[116:119]
    s_add_u32 s80, s80, 8192
    buffer_load_dwordx4 v[168:171], v11, s[52:55], s80 offen
    v_perm_b32 v40, v198, v194, s72
    v_perm_b32 v41, v206, v202, s72
    v_perm_b32 v42, v214, v210, s72
    v_perm_b32 v43, v222, v218, s72
    v_mfma_f32_16x16x32_bf16 v[120:123], v[36:39], a[40:43], v[120:123]
    v_mfma_f32_16x16x32_bf16 v[124:127], v[36:39], a[44:47], v[124:127]
    s_add_u32 s80, s80, 8192
    buffer_load_dwordx4 v[172:175], v11, s[52:55], s80 offen
    v_perm_b32 v32, v198, v194, s73
    v_perm_b32 v33, v206, v202, s73
    v_perm_b32 v34, v214, v210, s73
    v_perm_b32 v35, v222, v218, s73
    v_mfma_f32_16x16x32_bf16 v[128:131], v[40:43], a[40:43], v[128:131]
    v_mfma_f32_16x16x32_bf16 v[132:135], v[40:43], a[44:47], v[132:135]
    s_add_u32 s80, s80, 8192
    buffer_load_dwordx4 v[176:179], v11, s[52:55], s80 offen
    v_perm_b32 v36, v199, v195, s72
    v_perm_b32 v37, v207, v203, s72
    v_perm_b32 v38, v215, v211, s72
    v_perm_b32 v39, v223, v219, s72
    v_mfma_f32_16x16x32_bf16 v[136:139], v[32:35], a[40:43], v[136:139]
    v_mfma_f32_16x16x32_bf16 v[140:143], v[32:35], a[44:47], v[140:143]
    s_add_u32 s80, s80, 8192
    buffer_load_dwordx4 v[180:183], v11, s[52:55], s80 offen
    v_perm_b32 v40, v199, v195, s73
    v_perm_b32 v41, v207, v203, s73
    v_perm_b32 v42, v215, v211, s73
    v_perm_b32 v43, v223, v219, s73
    v_mfma_f32_16x16x32_bf16 v[144:147], v[36:39], a[40:43], v[144:147]
    v_mfma_f32_16x16x32_bf16 v[148:151], v[36:39], a[44:47], v[148:151]
    s_add_u32 s80, s80, 8192
    buffer_load_dwordx4 v[184:187], v11, s[52:55], s80 offen
    v_mfma_f32_16x16x32_bf16 v[152:155], v[40:43], a[40:43], v[152:155]
    v_mfma_f32_16x16x32_bf16 v[156:159], v[40:43], a[44:47], v[156:159]
    s_add_u32 s80, s80, 8192
    buffer_load_dwordx4 v[188:191], v11, s[52:55], s80 offen
    s_waitcnt vmcnt(16)
    v_perm_b32 v32, v228, v224, s72
    v_perm_b32 v33, v236, v232, s72
    v_perm_b32 v34, v244, v240, s72
    v_perm_b32 v35, v252, v248, s72
    v_perm_b32 v36, v228, v224, s73
    v_perm_b32 v37, v236, v232, s73
    v_perm_b32 v38, v244, v240, s73
    v_perm_b32 v39, v252, v248, s73
    v_mfma_f32_16x16x32_bf16 v[96:99], v[32:35], a[48:51], v[96:99]
    v_mfma_f32_16x16x32_bf16 v[100:103], v[32:35], a[52:55], v[100:103]
    s_add_u32 s80, s5, 9
    s_and_b32 s80, s80, 15
    s_lshl_b32 s80, s80, 18
    buffer_load_dwordx4 v[192:195], v11, s[52:55], s80 offen
    v_perm_b32 v40, v229, v225, s72
    v_perm_b32 v41, v237, v233, s72
    v_perm_b32 v42, v245, v241, s72
    v_perm_b32 v43, v253, v249, s72
    v_mfma_f32_16x16x32_bf16 v[104:107], v[36:39], a[48:51], v[104:107]
    v_mfma_f32_16x16x32_bf16 v[108:111], v[36:39], a[52:55], v[108:111]
    s_add_u32 s80, s80, 8192
    buffer_load_dwordx4 v[196:199], v11, s[52:55], s80 offen
    v_perm_b32 v32, v229, v225, s73
    v_perm_b32 v33, v237, v233, s73
    v_perm_b32 v34, v245, v241, s73
    v_perm_b32 v35, v253, v249, s73
    v_mfma_f32_16x16x32_bf16 v[112:115], v[40:43], a[48:51], v[112:115]
    v_mfma_f32_16x16x32_bf16 v[116:119], v[40:43], a[52:55], v[116:119]
    s_add_u32 s80, s80, 8192
    buffer_load_dwordx4 v[200:203], v11, s[52:55], s80 offen
    v_perm_b32 v36, v230, v226, s72
    v_perm_b32 v37, v238, v234, s72
    v_perm_b32 v38, v246, v242, s72
    v_perm_b32 v39, v254, v250, s72
    v_mfma_f32_16x16x32_bf16 v[120:123], v[32:35], a[48:51], v[120:123]
    v_mfma_f32_16x16x32_bf16 v[124:127], v[32:35], a[52:55], v[124:127]
    s_add_u32 s80, s80, 8192
    buffer_load_dwordx4 v[204:207], v11, s[52:55], s80 offen
    v_perm_b32 v40, v230, v226, s73
    v_perm_b32 v41, v238, v234, s73
    v_perm_b32 v42, v246, v242, s73
    v_perm_b32 v43, v254, v250, s73
    v_mfma_f32_16x16x32_bf16 v[128:131], v[36:39], a[48:51], v[128:131]
    v_mfma_f32_16x16x32_bf16 v[132:135], v[36:39], a[52:55], v[132:135]
    s_add_u32 s80, s80, 8192
    buffer_load_dwordx4 v[208:211], v11, s[52:55], s80 offen
    v_perm_b32 v32, v231, v227, s72
    v_perm_b32 v33, v239, v235, s72
    v_perm_b32 v34, v247, v243, s72
    v_perm_b32 v35, v255, v251, s72
    v_mfma_f32_16x16x32_bf16 v[136:139], v[40:43], a[48:51], v[136:139]
    v_mfma_f32_16x16x32_bf16 v[140:143], v[40:43], a[52:55], v[140:143]
    s_add_u32 s80, s80, 8192
    buffer_load_dwordx4 v[212:215], v11, s[52:55], s80 offen
    v_perm_b32 v36, v231, v227, s73
    v_perm_b32 v37, v239, v235, s73
    v_perm_b32 v38, v247, v243, s73
    v_perm_b32 v39, v255, v251, s73
    v_mfma_f32_16x16x32_bf16 v[144:147], v[32:35], a[48:51], v[144:147]
    v_mfma_f32_16x16x32_bf16 v[148:151], v[32:35], a[52:55], v[148:151]
    s_add_u32 s80, s80, 8192
    buffer_load_dwordx4 v[216:219], v11, s[52:55], s80 offen
    v_mfma_f32_16x16x32_bf16 v[152:155], v[36:39], a[48:51], v[152:155]
    v_mfma_f32_16x16x32_bf16 v[156:159], v[36:39], a[52:55], v[156:159]
    s_add_u32 s80, s80, 8192
    buffer_load_dwordx4 v[220:223], v11, s[52:55], s80 offen
    s_waitcnt vmcnt(16)
    v_perm_b32 v40, v68, v64, s72
    v_perm_b32 v41, v76, v72, s72
    v_perm_b32 v42, v84, v80, s72
    v_perm_b32 v43, v92, v88, s72
    v_perm_b32 v32, v68, v64, s73
    v_perm_b32 v33, v76, v72, s73
    v_perm_b32 v34, v84, v80, s73
    v_perm_b32 v35, v92, v88, s73
    v_mfma_f32_16x16x32_bf16 v[96:99], v[40:43], a[56:59], v[96:99]
    v_mfma_f32_16x16x32_bf16 v[100:103], v[40:43], a[60:63], v[100:103]
    s_add_u32 s80, s5, 10
    s_and_b32 s80, s80, 15
    s_lshl_b32 s80, s80, 18
    buffer_load_dwordx4 v[224:227], v11, s[52:55], s80 offen
    v_perm_b32 v36, v69, v65, s72
    v_perm_b32 v37, v77, v73, s72
    v_perm_b32 v38, v85, v81, s72
    v_perm_b32 v39, v93, v89, s72
    v_mfma_f32_16x16x32_bf16 v[104:107], v[32:35], a[56:59], v[104:107]
    v_mfma_f32_16x16x32_bf16 v[108:111], v[32:35], a[60:63], v[108:111]
    s_add_u32 s80, s80, 8192
    buffer_load_dwordx4 v[228:231], v11, s[52:55], s80 offen
    v_perm_b32 v40, v69, v65, s73
    v_perm_b32 v41, v77, v73, s73
    v_perm_b32 v42, v85, v81, s73
    v_perm_b32 v43, v93, v89, s73
    v_mfma_f32_16x16x32_bf16 v[112:115], v[36:39], a[56:59], v[112:115]
    v_mfma_f32_16x16x32_bf16 v[116:119], v[36:39], a[60:63], v[116:119]
    s_add_u32 s80, s80, 8192
    buffer_load_dwordx4 v[232:235], v11, s[52:55], s80 offen
    v_perm_b32 v32, v70, v66, s72
    v_perm_b32 v33, v78, v74, s72
    v_perm_b32 v34, v86, v82, s72
    v_perm_b32 v35, v94, v90, s72
    v_mfma_f32_16x16x32_bf16 v[120:123], v[40:43], a[56:59], v[120:123]
    v_mfma_f32_16x16x32_bf16 v[124:127], v[40:43], a[60:63], v[124:127]
    s_add_u32 s80, s80, 8192
    buffer_load_dwordx4 v[236:239], v11, s[52:55], s80 offen
    v_perm_b32 v36, v70, v66, s73
    v_perm_b32 v37, v78, v74, s73
    v_perm_b32 v38, v86, v82, s73
    v_perm_b32 v39, v94, v90, s73
    v_mfma_f32_16x16x32_bf16 v[128:131], v[32:35], a[56:59], v[128:131]
    v_mfma_f32_16x16x32_bf16 v[132:135], v[32:35], a[60:63], v[132:135]
    s_add_u32 s80, s80, 8192
    buffer_load_dwordx4 v[240:243], v11, s[52:55], s80 offen
    v_perm_b32 v40, v71, v67, s72
    v_perm_b32 v41, v79, v75, s72
    v_perm_b32 v42, v87, v83, s72
    v_perm_b32 v43, v95, v91, s72
    v_mfma_f32_16x16x32_bf16 v[136:139], v[36:39], a[56:59], v[136:139]
    v_mfma_f32_16x16x32_bf16 v[140:143], v[36:39], a[60:63], v[140:143]
    s_add_u32 s80, s80, 8192
    buffer_load_dwordx4 v[244:247], v11, s[52:55], s80 offen
    v_perm_b32 v32, v71, v67, s73
    v_perm_b32 v33, v79, v75, s73
    v_perm_b32 v34, v87, v83, s73
    v_perm_b32 v35, v95, v91, s73
    v_mfma_f32_16x16x32_bf16 v[144:147], v[40:43], a[56:59], v[144:147]
    v_mfma_f32_16x16x32_bf16 v[148:151], v[40:43], a[60:63], v[148:151]
    s_add_u32 s80, s80, 8192
    buffer_load_dwordx4 v[248:251], v11, s[52:55], s80 offen
    v_mfma_f32_16x16x32_bf16 v[152:155], v[32:35], a[56:59], v[152:155]
    v_mfma_f32_16x16x32_bf16 v[156:159], v[32:35], a[60:63], v[156:159]
    s_add_u32 s80, s80, 8192
    buffer_load_dwordx4 v[252:255], v11, s[52:55], s80 offen
    s_waitcnt vmcnt(16)
    v_perm_b32 v36, v164, v160, s72
    v_perm_b32 v37, v172, v168, s72
    v_perm_b32 v38, v180, v176, s72
    v_perm_b32 v39, v188, v184, s72
    v_perm_b32 v40, v164, v160, s73
    v_perm_b32 v41, v172, v168, s73
    v_perm_b32 v42, v180, v176, s73
    v_perm_b32 v43, v188, v184, s73
    s_waitcnt lgkmcnt(14)
    v_mfma_f32_16x16x32_bf16 v[96:99], v[36:39], a[64:67], v[96:99]
    v_mfma_f32_16x16x32_bf16 v[100:103], v[36:39], a[68:71], v[100:103]
    s_add_u32 s80, s5, 11
    s_and_b32 s80, s80, 15
    s_lshl_b32 s80, s80, 18
    buffer_load_dwordx4 v[64:67], v11, s[52:55], s80 offen
    v_perm_b32 v32, v165, v161, s72
    v_perm_b32 v33, v173, v169, s72
    v_perm_b32 v34, v181, v177, s72
    v_perm_b32 v35, v189, v185, s72
    v_mfma_f32_16x16x32_bf16 v[104:107], v[40:43], a[64:67], v[104:107]
    v_mfma_f32_16x16x32_bf16 v[108:111], v[40:43], a[68:71], v[108:111]
    s_add_u32 s80, s80, 8192
    buffer_load_dwordx4 v[68:71], v11, s[52:55], s80 offen
    v_perm_b32 v36, v165, v161, s73
    v_perm_b32 v37, v173, v169, s73
    v_perm_b32 v38, v181, v177, s73
    v_perm_b32 v39, v189, v185, s73
    v_mfma_f32_16x16x32_bf16 v[112:115], v[32:35], a[64:67], v[112:115]
    v_mfma_f32_16x16x32_bf16 v[116:119], v[32:35], a[68:71], v[116:119]
    s_add_u32 s80, s80, 8192
    buffer_load_dwordx4 v[72:75], v11, s[52:55], s80 offen
    v_perm_b32 v40, v166, v162, s72
    v_perm_b32 v41, v174, v170, s72
    v_perm_b32 v42, v182, v178, s72
    v_perm_b32 v43, v190, v186, s72
    v_mfma_f32_16x16x32_bf16 v[120:123], v[36:39], a[64:67], v[120:123]
    v_mfma_f32_16x16x32_bf16 v[124:127], v[36:39], a[68:71], v[124:127]
    s_add_u32 s80, s80, 8192
    buffer_load_dwordx4 v[76:79], v11, s[52:55], s80 offen
    v_perm_b32 v32, v166, v162, s73
    v_perm_b32 v33, v174, v170, s73
    v_perm_b32 v34, v182, v178, s73
    v_perm_b32 v35, v190, v186, s73
    v_mfma_f32_16x16x32_bf16 v[128:131], v[40:43], a[64:67], v[128:131]
    v_mfma_f32_16x16x32_bf16 v[132:135], v[40:43], a[68:71], v[132:135]
    s_add_u32 s80, s80, 8192
    buffer_load_dwordx4 v[80:83], v11, s[52:55], s80 offen
    v_perm_b32 v36, v167, v163, s72
    v_perm_b32 v37, v175, v171, s72
    v_perm_b32 v38, v183, v179, s72
    v_perm_b32 v39, v191, v187, s72
    v_mfma_f32_16x16x32_bf16 v[136:139], v[32:35], a[64:67], v[136:139]
    v_mfma_f32_16x16x32_bf16 v[140:143], v[32:35], a[68:71], v[140:143]
    s_add_u32 s80, s80, 8192
    buffer_load_dwordx4 v[84:87], v11, s[52:55], s80 offen
    v_perm_b32 v40, v167, v163, s73
    v_perm_b32 v41, v175, v171, s73
    v_perm_b32 v42, v183, v179, s73
    v_perm_b32 v43, v191, v187, s73
    v_mfma_f32_16x16x32_bf16 v[144:147], v[36:39], a[64:67], v[144:147]
    v_mfma_f32_16x16x32_bf16 v[148:151], v[36:39], a[68:71], v[148:151]
    s_add_u32 s80, s80, 8192
    buffer_load_dwordx4 v[88:91], v11, s[52:55], s80 offen
    v_mfma_f32_16x16x32_bf16 v[152:155], v[40:43], a[64:67], v[152:155]
    v_mfma_f32_16x16x32_bf16 v[156:159], v[40:43], a[68:71], v[156:159]
    s_add_u32 s80, s80, 8192
    buffer_load_dwordx4 v[92:95], v11, s[52:55], s80 offen
    s_waitcnt vmcnt(16)
    v_perm_b32 v32, v196, v192, s72
    v_perm_b32 v33, v204, v200, s72
    v_perm_b32 v34, v212, v208, s72
    v_perm_b32 v35, v220, v216, s72
    v_perm_b32 v36, v196, v192, s73
    v_perm_b32 v37, v204, v200, s73
    v_perm_b32 v38, v212, v208, s73
    v_perm_b32 v39, v220, v216, s73
    s_waitcnt lgkmcnt(12)
    v_mfma_f32_16x16x32_bf16 v[96:99], v[32:35], a[72:75], v[96:99]
    v_mfma_f32_16x16x32_bf16 v[100:103], v[32:35], a[76:79], v[100:103]
    s_add_u32 s80, s5, 12
    s_and_b32 s80, s80, 15
    s_lshl_b32 s80, s80, 18
    buffer_load_dwordx4 v[160:163], v11, s[52:55], s80 offen
    v_perm_b32 v40, v197, v193, s72
    v_perm_b32 v41, v205, v201, s72
    v_perm_b32 v42, v213, v209, s72
    v_perm_b32 v43, v221, v217, s72
    v_mfma_f32_16x16x32_bf16 v[104:107], v[36:39], a[72:75], v[104:107]
    v_mfma_f32_16x16x32_bf16 v[108:111], v[36:39], a[76:79], v[108:111]
    s_add_u32 s80, s80, 8192
    buffer_load_dwordx4 v[164:167], v11, s[52:55], s80 offen
    v_perm_b32 v32, v197, v193, s73
    v_perm_b32 v33, v205, v201, s73
    v_perm_b32 v34, v213, v209, s73
    v_perm_b32 v35, v221, v217, s73
    v_mfma_f32_16x16x32_bf16 v[112:115], v[40:43], a[72:75], v[112:115]
    v_mfma_f32_16x16x32_bf16 v[116:119], v[40:43], a[76:79], v[116:119]
    s_add_u32 s80, s80, 8192
    buffer_load_dwordx4 v[168:171], v11, s[52:55], s80 offen
    v_perm_b32 v36, v198, v194, s72
    v_perm_b32 v37, v206, v202, s72
    v_perm_b32 v38, v214, v210, s72
    v_perm_b32 v39, v222, v218, s72
    v_mfma_f32_16x16x32_bf16 v[120:123], v[32:35], a[72:75], v[120:123]
    v_mfma_f32_16x16x32_bf16 v[124:127], v[32:35], a[76:79], v[124:127]
    s_add_u32 s80, s80, 8192
    buffer_load_dwordx4 v[172:175], v11, s[52:55], s80 offen
    v_perm_b32 v40, v198, v194, s73
    v_perm_b32 v41, v206, v202, s73
    v_perm_b32 v42, v214, v210, s73
    v_perm_b32 v43, v222, v218, s73
    v_mfma_f32_16x16x32_bf16 v[128:131], v[36:39], a[72:75], v[128:131]
    v_mfma_f32_16x16x32_bf16 v[132:135], v[36:39], a[76:79], v[132:135]
    s_add_u32 s80, s80, 8192
    buffer_load_dwordx4 v[176:179], v11, s[52:55], s80 offen
    v_perm_b32 v32, v199, v195, s72
    v_perm_b32 v33, v207, v203, s72
    v_perm_b32 v34, v215, v211, s72
    v_perm_b32 v35, v223, v219, s72
    v_mfma_f32_16x16x32_bf16 v[136:139], v[40:43], a[72:75], v[136:139]
    v_mfma_f32_16x16x32_bf16 v[140:143], v[40:43], a[76:79], v[140:143]
    s_add_u32 s80, s80, 8192
    buffer_load_dwordx4 v[180:183], v11, s[52:55], s80 offen
    v_perm_b32 v36, v199, v195, s73
    v_perm_b32 v37, v207, v203, s73
    v_perm_b32 v38, v215, v211, s73
    v_perm_b32 v39, v223, v219, s73
    v_mfma_f32_16x16x32_bf16 v[144:147], v[32:35], a[72:75], v[144:147]
    v_mfma_f32_16x16x32_bf16 v[148:151], v[32:35], a[76:79], v[148:151]
    s_add_u32 s80, s80, 8192
    buffer_load_dwordx4 v[184:187], v11, s[52:55], s80 offen
    v_mfma_f32_16x16x32_bf16 v[152:155], v[36:39], a[72:75], v[152:155]
    v_mfma_f32_16x16x32_bf16 v[156:159], v[36:39], a[76:79], v[156:159]
    s_add_u32 s80, s80, 8192
    buffer_load_dwordx4 v[188:191], v11, s[52:55], s80 offen
    s_waitcnt vmcnt(16)
    v_perm_b32 v40, v228, v224, s72
    v_perm_b32 v41, v236, v232, s72
    v_perm_b32 v42, v244, v240, s72
    v_perm_b32 v43, v252, v248, s72
    v_perm_b32 v32, v228, v224, s73
    v_perm_b32 v33, v236, v232, s73
    v_perm_b32 v34, v244, v240, s73
    v_perm_b32 v35, v252, v248, s73
    s_waitcnt lgkmcnt(10)
    v_mfma_f32_16x16x32_bf16 v[96:99], v[40:43], a[80:83], v[96:99]
    v_mfma_f32_16x16x32_bf16 v[100:103], v[40:43], a[84:87], v[100:103]
    s_add_u32 s80, s5, 13
    s_and_b32 s80, s80, 15
    s_lshl_b32 s80, s80, 18
    buffer_load_dwordx4 v[192:195], v11, s[52:55], s80 offen
    v_perm_b32 v36, v229, v225, s72
    v_perm_b32 v37, v237, v233, s72
    v_perm_b32 v38, v245, v241, s72
    v_perm_b32 v39, v253, v249, s72
    v_mfma_f32_16x16x32_bf16 v[104:107], v[32:35], a[80:83], v[104:107]
    v_mfma_f32_16x16x32_bf16 v[108:111], v[32:35], a[84:87], v[108:111]
    s_add_u32 s80, s80, 8192
    buffer_load_dwordx4 v[196:199], v11, s[52:55], s80 offen
    v_perm_b32 v40, v229, v225, s73
    v_perm_b32 v41, v237, v233, s73
    v_perm_b32 v42, v245, v241, s73
    v_perm_b32 v43, v253, v249, s73
    v_mfma_f32_16x16x32_bf16 v[112:115], v[36:39], a[80:83], v[112:115]
    v_mfma_f32_16x16x32_bf16 v[116:119], v[36:39], a[84:87], v[116:119]
    s_add_u32 s80, s80, 8192
    buffer_load_dwordx4 v[200:203], v11, s[52:55], s80 offen
    v_perm_b32 v32, v230, v226, s72
    v_perm_b32 v33, v238, v234, s72
    v_perm_b32 v34, v246, v242, s72
    v_perm_b32 v35, v254, v250, s72
    v_mfma_f32_16x16x32_bf16 v[120:123], v[40:43], a[80:83], v[120:123]
    v_mfma_f32_16x16x32_bf16 v[124:127], v[40:43], a[84:87], v[124:127]
    s_add_u32 s80, s80, 8192
    buffer_load_dwordx4 v[204:207], v11, s[52:55], s80 offen
    v_perm_b32 v36, v230, v226, s73
    v_perm_b32 v37, v238, v234, s73
    v_perm_b32 v38, v246, v242, s73
    v_perm_b32 v39, v254, v250, s73
    v_mfma_f32_16x16x32_bf16 v[128:131], v[32:35], a[80:83], v[128:131]
    v_mfma_f32_16x16x32_bf16 v[132:135], v[32:35], a[84:87], v[132:135]
    s_add_u32 s80, s80, 8192
    buffer_load_dwordx4 v[208:211], v11, s[52:55], s80 offen
    v_perm_b32 v40, v231, v227, s72
    v_perm_b32 v41, v239, v235, s72
    v_perm_b32 v42, v247, v243, s72
    v_perm_b32 v43, v255, v251, s72
    v_mfma_f32_16x16x32_bf16 v[136:139], v[36:39], a[80:83], v[136:139]
    v_mfma_f32_16x16x32_bf16 v[140:143], v[36:39], a[84:87], v[140:143]
    s_add_u32 s80, s80, 8192
    buffer_load_dwordx4 v[212:215], v11, s[52:55], s80 offen
    v_perm_b32 v32, v231, v227, s73
    v_perm_b32 v33, v239, v235, s73
    v_perm_b32 v34, v247, v243, s73
    v_perm_b32 v35, v255, v251, s73
    v_mfma_f32_16x16x32_bf16 v[144:147], v[40:43], a[80:83], v[144:147]
    v_mfma_f32_16x16x32_bf16 v[148:151], v[40:43], a[84:87], v[148:151]
    s_add_u32 s80, s80, 8192
    buffer_load_dwordx4 v[216:219], v11, s[52:55], s80 offen
    v_mfma_f32_16x16x32_bf16 v[152:155], v[32:35], a[80:83], v[152:155]
    v_mfma_f32_16x16x32_bf16 v[156:159], v[32:35], a[84:87], v[156:159]
    s_add_u32 s80, s80, 8192
    buffer_load_dwordx4 v[220:223], v11, s[52:55], s80 offen
    v_mov_b32 v2, 0x3f803f80
    v_accvgpr_write_b32 a76, v2
    v_accvgpr_write_b32 a77, v2
    v_accvgpr_write_b32 a78, v2
    v_accvgpr_write_b32 a79, v2
    s_waitcnt vmcnt(16)
    v_perm_b32 v36, v68, v64, s72
    v_perm_b32 v37, v76, v72, s72
    v_perm_b32 v38, v84, v80, s72
    v_perm_b32 v39, v92, v88, s72
    v_perm_b32 v40, v68, v64, s73
    v_perm_b32 v41, v76, v72, s73
    v_perm_b32 v42, v84, v80, s73
    v_perm_b32 v43, v92, v88, s73
    s_waitcnt lgkmcnt(8)
    v_mfma_f32_16x16x32_bf16 v[96:99], v[36:39], a[88:91], v[96:99]
    v_mfma_f32_16x16x32_bf16 v[100:103], v[36:39], a[92:95], v[100:103]
    s_add_u32 s80, s5, 14
    s_and_b32 s80, s80, 15
    s_lshl_b32 s80, s80, 18
    buffer_load_dwordx4 v[224:227], v11, s[52:55], s80 offen
    v_perm_b32 v32, v69, v65, s72
    v_perm_b32 v33, v77, v73, s72
    v_perm_b32 v34, v85, v81, s72
    v_perm_b32 v35, v93, v89, s72
    v_mfma_f32_16x16x32_bf16 v[104:107], v[40:43], a[88:91], v[104:107]
    v_mfma_f32_16x16x32_bf16 v[108:111], v[40:43], a[92:95], v[108:111]
    s_add_u32 s80, s80, 8192
    buffer_load_dwordx4 v[228:231], v11, s[52:55], s80 offen
    v_perm_b32 v36, v69, v65, s73
    v_perm_b32 v37, v77, v73, s73
    v_perm_b32 v38, v85, v81, s73
    v_perm_b32 v39, v93, v89, s73
    v_mfma_f32_16x16x32_bf16 v[112:115], v[32:35], a[88:91], v[112:115]
    v_mfma_f32_16x16x32_bf16 v[116:119], v[32:35], a[92:95], v[116:119]
    s_add_u32 s80, s80, 8192
    buffer_load_dwordx4 v[232:235], v11, s[52:55], s80 offen
    v_perm_b32 v40, v70, v66, s72
    v_perm_b32 v41, v78, v74, s72
    v_perm_b32 v42, v86, v82, s72
    v_perm_b32 v43, v94, v90, s72
    v_mfma_f32_16x16x32_bf16 v[120:123], v[36:39], a[88:91], v[120:123]
    v_mfma_f32_16x16x32_bf16 v[124:127], v[36:39], a[92:95], v[124:127]
    s_add_u32 s80, s80, 8192
    buffer_load_dwordx4 v[236:239], v11, s[52:55], s80 offen
    v_perm_b32 v32, v70, v66, s73
    v_perm_b32 v33, v78, v74, s73
    v_perm_b32 v34, v86, v82, s73
    v_perm_b32 v35, v94, v90, s73
    v_mfma_f32_16x16x32_bf16 v[128:131], v[40:43], a[88:91], v[128:131]
    v_mfma_f32_16x16x32_bf16 v[132:135], v[40:43], a[92:95], v[132:135]
    s_add_u32 s80, s80, 8192
    buffer_load_dwordx4 v[240:243], v11, s[52:55], s80 offen
    v_perm_b32 v36, v71, v67, s72
    v_perm_b32 v37, v79, v75, s72
    v_perm_b32 v38, v87, v83, s72
    v_perm_b32 v39, v95, v91, s72
    v_mfma_f32_16x16x32_bf16 v[136:139], v[32:35], a[88:91], v[136:139]
    v_mfma_f32_16x16x32_bf16 v[140:143], v[32:35], a[92:95], v[140:143]
    s_add_u32 s80, s80, 8192
    buffer_load_dwordx4 v[244:247], v11, s[52:55], s80 offen
    v_perm_b32 v40, v71, v67, s73
    v_perm_b32 v41, v79, v75, s73
    v_perm_b32 v42, v87, v83, s73
    v_perm_b32 v43, v95, v91, s73
    v_mfma_f32_16x16x32_bf16 v[144:147], v[36:39], a[88:91], v[144:147]
    v_mfma_f32_16x16x32_bf16 v[148:151], v[36:39], a[92:95], v[148:151]
    s_add_u32 s80, s80, 8192
    buffer_load_dwordx4 v[248:251], v11, s[52:55], s80 offen
    v_mfma_f32_16x16x32_bf16 v[152:155], v[40:43], a[88:91], v[152:155]
    v_mfma_f32_16x16x32_bf16 v[156:159], v[40:43], a[92:95], v[156:159]
    s_add_u32 s80, s80, 8192
    buffer_load_dwordx4 v[252:255], v11, s[52:55], s80 offen
    s_load_dword s42, s[92:93], 0
    s_waitcnt vmcnt(16)
    v_perm_b32 v32, v164, v160, s72
    v_perm_b32 v33, v172, v168, s72
    v_perm_b32 v34, v180, v176, s72
    v_perm_b32 v35, v188, v184, s72
    v_perm_b32 v36, v164, v160, s73
    v_perm_b32 v37, v172, v168, s73
    v_perm_b32 v38, v180, v176, s73
    v_perm_b32 v39, v188, v184, s73
    s_waitcnt lgkmcnt(6)
    v_mfma_f32_16x16x32_bf16 v[96:99], v[32:35], a[96:99], v[96:99]
    v_mfma_f32_16x16x32_bf16 v[100:103], v[32:35], a[100:103], v[100:103]
    s_add_u32 s80, s5, 15
    s_and_b32 s80, s80, 15
    s_lshl_b32 s80, s80, 18
    buffer_load_dwordx4 v[64:67], v11, s[52:55], s80 offen
    v_perm_b32 v40, v165, v161, s72
    v_perm_b32 v41, v173, v169, s72
    v_perm_b32 v42, v181, v177, s72
    v_perm_b32 v43, v189, v185, s72
    v_mfma_f32_16x16x32_bf16 v[104:107], v[36:39], a[96:99], v[104:107]
    v_mfma_f32_16x16x32_bf16 v[108:111], v[36:39], a[100:103], v[108:111]
    s_add_u32 s80, s80, 8192
    buffer_load_dwordx4 v[68:71], v11, s[52:55], s80 offen
    v_perm_b32 v32, v165, v161, s73
    v_perm_b32 v33, v173, v169, s73
    v_perm_b32 v34, v181, v177, s73
    v_perm_b32 v35, v189, v185, s73
    v_mfma_f32_16x16x32_bf16 v[112:115], v[40:43], a[96:99], v[112:115]
    v_mfma_f32_16x16x32_bf16 v[116:119], v[40:43], a[100:103], v[116:119]
    s_add_u32 s80, s80, 8192
    buffer_load_dwordx4 v[72:75], v11, s[52:55], s80 offen
    v_perm_b32 v36, v166, v162, s72
    v_perm_b32 v37, v174, v170, s72
    v_perm_b32 v38, v182, v178, s72
    v_perm_b32 v39, v190, v186, s72
    v_mfma_f32_16x16x32_bf16 v[120:123], v[32:35], a[96:99], v[120:123]
    v_mfma_f32_16x16x32_bf16 v[124:127], v[32:35], a[100:103], v[124:127]
    s_add_u32 s80, s80, 8192
    buffer_load_dwordx4 v[76:79], v11, s[52:55], s80 offen
    v_perm_b32 v40, v166, v162, s73
    v_perm_b32 v41, v174, v170, s73
    v_perm_b32 v42, v182, v178, s73
    v_perm_b32 v43, v190, v186, s73
    v_mfma_f32_16x16x32_bf16 v[128:131], v[36:39], a[96:99], v[128:131]
    v_mfma_f32_16x16x32_bf16 v[132:135], v[36:39], a[100:103], v[132:135]
    s_add_u32 s80, s80, 8192
    buffer_load_dwordx4 v[80:83], v11, s[52:55], s80 offen
    v_perm_b32 v32, v167, v163, s72
    v_perm_b32 v33, v175, v171, s72
    v_perm_b32 v34, v183, v179, s72
    v_perm_b32 v35, v191, v187, s72
    v_mfma_f32_16x16x32_bf16 v[136:139], v[40:43], a[96:99], v[136:139]
    v_mfma_f32_16x16x32_bf16 v[140:143], v[40:43], a[100:103], v[140:143]
    s_add_u32 s80, s80, 8192
    buffer_load_dwordx4 v[84:87], v11, s[52:55], s80 offen
    v_perm_b32 v36, v167, v163, s73
    v_perm_b32 v37, v175, v171, s73
    v_perm_b32 v38, v183, v179, s73
    v_perm_b32 v39, v191, v187, s73
    v_mfma_f32_16x16x32_bf16 v[144:147], v[32:35], a[96:99], v[144:147]
    v_mfma_f32_16x16x32_bf16 v[148:151], v[32:35], a[100:103], v[148:151]
    s_add_u32 s80, s80, 8192
    buffer_load_dwordx4 v[88:91], v11, s[52:55], s80 offen
    v_mfma_f32_16x16x32_bf16 v[152:155], v[36:39], a[96:99], v[152:155]
    v_mfma_f32_16x16x32_bf16 v[156:159], v[36:39], a[100:103], v[156:159]
    s_add_u32 s80, s80, 8192
    buffer_load_dwordx4 v[92:95], v11, s[52:55], s80 offen
    s_add_u32 m0, s78, 0
    s_mov_b32 s9, 0
    buffer_load_dwordx4 v8, s[44:47], s9 offen nt lds
    buffer_load_dwordx4 v9, s[44:47], s9 offen offset:1024 nt lds
    s_add_u32 m0, s78, 8192
    s_mov_b32 s9, 8192
    buffer_load_dwordx4 v8, s[44:47], s9 offen nt lds
    buffer_load_dwordx4 v9, s[44:47], s9 offen offset:1024 nt lds
    s_add_u32 m0, s78, 65536
    s_mov_b32 s9, 0
    buffer_load_dwordx4 v10, s[48:51], s9 offen nt lds
    buffer_load_dwordx4 v5, s[48:51], s9 offen offset:1024 nt lds
    s_waitcnt vmcnt(22)
    v_perm_b32 v40, v196, v192, s72
    v_perm_b32 v41, v204, v200, s72
    v_perm_b32 v42, v212, v208, s72
    v_perm_b32 v43, v220, v216, s72
    v_perm_b32 v32, v196, v192, s73
    v_perm_b32 v33, v204, v200, s73
    v_perm_b32 v34, v212, v208, s73
    v_perm_b32 v35, v220, v216, s73
    s_waitcnt lgkmcnt(4)
    v_mfma_f32_16x16x32_bf16 v[96:99], v[40:43], a[104:107], v[96:99]
    v_mfma_f32_16x16x32_bf16 v[100:103], v[40:43], a[108:111], v[100:103]
    v_perm_b32 v36, v197, v193, s72
    v_perm_b32 v37, v205, v201, s72
    v_perm_b32 v38, v213, v209, s72
    v_perm_b32 v39, v221, v217, s72
    v_mfma_f32_16x16x32_bf16 v[104:107], v[32:35], a[104:107], v[104:107]
    v_mfma_f32_16x16x32_bf16 v[108:111], v[32:35], a[108:111], v[108:111]
    v_perm_b32 v40, v197, v193, s73
    v_perm_b32 v41, v205, v201, s73
    v_perm_b32 v42, v213, v209, s73
    v_perm_b32 v43, v221, v217, s73
    v_mfma_f32_16x16x32_bf16 v[112:115], v[36:39], a[104:107], v[112:115]
    v_mfma_f32_16x16x32_bf16 v[116:119], v[36:39], a[108:111], v[116:119]
    v_perm_b32 v32, v198, v194, s72
    v_perm_b32 v33, v206, v202, s72
    v_perm_b32 v34, v214, v210, s72
    v_perm_b32 v35, v222, v218, s72
    v_mfma_f32_16x16x32_bf16 v[120:123], v[40:43], a[104:107], v[120:123]
    v_mfma_f32_16x16x32_bf16 v[124:127], v[40:43], a[108:111], v[124:127]
    v_perm_b32 v36, v198, v194, s73
    v_perm_b32 v37, v206, v202, s73
    v_perm_b32 v38, v214, v210, s73
    v_perm_b32 v39, v222, v218, s73
    v_mfma_f32_16x16x32_bf16 v[128:131], v[32:35], a[104:107], v[128:131]
    v_mfma_f32_16x16x32_bf16 v[132:135], v[32:35], a[108:111], v[132:135]
    v_perm_b32 v40, v199, v195, s72
    v_perm_b32 v41, v207, v203, s72
    v_perm_b32 v42, v215, v211, s72
    v_perm_b32 v43, v223, v219, s72
    v_mfma_f32_16x16x32_bf16 v[136:139], v[36:39], a[104:107], v[136:139]
    v_mfma_f32_16x16x32_bf16 v[140:143], v[36:39], a[108:111], v[140:143]
    v_perm_b32 v32, v199, v195, s73
    v_perm_b32 v33, v207, v203, s73
    v_perm_b32 v34, v215, v211, s73
    v_perm_b32 v35, v223, v219, s73
    v_mfma_f32_16x16x32_bf16 v[144:147], v[40:43], a[104:107], v[144:147]
    v_mfma_f32_16x16x32_bf16 v[148:151], v[40:43], a[108:111], v[148:151]
    v_mfma_f32_16x16x32_bf16 v[152:155], v[32:35], a[104:107], v[152:155]
    v_mfma_f32_16x16x32_bf16 v[156:159], v[32:35], a[108:111], v[156:159]
    s_add_u32 m0, s78, 16384
    s_mov_b32 s9, 16384
    buffer_load_dwordx4 v8, s[44:47], s9 offen nt lds
    buffer_load_dwordx4 v9, s[44:47], s9 offen offset:1024 nt lds
    s_add_u32 m0, s78, 73728
    s_mov_b32 s9, 8192
    buffer_load_dwordx4 v10, s[48:51], s9 offen nt lds
    buffer_load_dwordx4 v5, s[48:51], s9 offen offset:1024 nt lds
    s_add_u32 m0, s78, 24576
    s_mov_b32 s9, 24576
    buffer_load_dwordx4 v8, s[44:47], s9 offen nt lds
    buffer_load_dwordx4 v9, s[44:47], s9 offen offset:1024 nt lds
    s_waitcnt lgkmcnt(0)
    s_cmp_eq_u32 s42, 0
    s_cbranch_scc1 LB_nononce
LB_nonce:
    s_waitcnt vmcnt(20)
    v_perm_b32 v36, v228, v224, s72
    v_perm_b32 v37, v236, v232, s72
    v_perm_b32 v38, v244, v240, s72
    v_perm_b32 v39, v252, v248, s72
    v_perm_b32 v40, v228, v224, s73
    v_perm_b32 v41, v236, v232, s73
    v_perm_b32 v42, v244, v240, s73
    v_perm_b32 v43, v252, v248, s73
    s_waitcnt lgkmcnt(2)
    v_mfma_f32_16x16x32_bf16 v[96:99], v[36:39], a[112:115], v[96:99]
    v_mfma_f32_16x16x32_bf16 v[100:103], v[36:39], a[116:119], v[100:103]
    v_perm_b32 v32, v229, v225, s72
    v_perm_b32 v33, v237, v233, s72
    v_perm_b32 v34, v245, v241, s72
    v_perm_b32 v35, v253, v249, s72
    v_mfma_f32_16x16x32_bf16 v[104:107], v[40:43], a[112:115], v[104:107]
    v_mfma_f32_16x16x32_bf16 v[108:111], v[40:43], a[116:119], v[108:111]
    v_perm_b32 v36, v229, v225, s73
    v_perm_b32 v37, v237, v233, s73
    v_perm_b32 v38, v245, v241, s73
    v_perm_b32 v39, v253, v249, s73
    v_mfma_f32_16x16x32_bf16 v[112:115], v[32:35], a[112:115], v[112:115]
    v_mfma_f32_16x16x32_bf16 v[116:119], v[32:35], a[116:119], v[116:119]
    v_perm_b32 v40, v230, v226, s72
    v_perm_b32 v41, v238, v234, s72
    v_perm_b32 v42, v246, v242, s72
    v_perm_b32 v43, v254, v250, s72
    v_mfma_f32_16x16x32_bf16 v[120:123], v[36:39], a[112:115], v[120:123]
    v_mfma_f32_16x16x32_bf16 v[124:127], v[36:39], a[116:119], v[124:127]
    v_perm_b32 v32, v230, v226, s73
    v_perm_b32 v33, v238, v234, s73
    v_perm_b32 v34, v246, v242, s73
    v_perm_b32 v35, v254, v250, s73
    v_mfma_f32_16x16x32_bf16 v[128:131], v[40:43], a[112:115], v[128:131]
    v_mfma_f32_16x16x32_bf16 v[132:135], v[40:43], a[116:119], v[132:135]
    v_perm_b32 v36, v231, v227, s72
    v_perm_b32 v37, v239, v235, s72
    v_perm_b32 v38, v247, v243, s72
    v_perm_b32 v39, v255, v251, s72
    v_mfma_f32_16x16x32_bf16 v[136:139], v[32:35], a[112:115], v[136:139]
    v_mfma_f32_16x16x32_bf16 v[140:143], v[32:35], a[116:119], v[140:143]
    v_perm_b32 v40, v231, v227, s73
    v_perm_b32 v41, v239, v235, s73
    v_perm_b32 v42, v247, v243, s73
    v_perm_b32 v43, v255, v251, s73
    v_mfma_f32_16x16x32_bf16 v[144:147], v[36:39], a[112:115], v[144:147]
    v_mfma_f32_16x16x32_bf16 v[148:151], v[36:39], a[116:119], v[148:151]
    v_mfma_f32_16x16x32_bf16 v[152:155], v[40:43], a[112:115], v[152:155]
    v_mfma_f32_16x16x32_bf16 v[156:159], v[40:43], a[116:119], v[156:159]
    s_add_u32 m0, s78, 81920
    s_mov_b32 s9, 16384
    buffer_load_dwordx4 v10, s[48:51], s9 offen nt lds
    buffer_load_dwordx4 v5, s[48:51], s9 offen offset:1024 nt lds
    s_add_u32 m0, s78, 32768
    s_mov_b32 s9, 32768
    buffer_load_dwordx4 v8, s[44:47], s9 offen nt lds
    buffer_load_dwordx4 v9, s[44:47], s9 offen offset:1024 nt lds
    s_waitcnt vmcnt(14)
    s_barrier
    v_mov_b32 v252, v60
    v_mov_b32 v253, v61
    v_mov_b32 v254, v62
    v_mov_b32 v255, v63
    v_perm_b32 v32, v68, v64, s72
    v_perm_b32 v33, v76, v72, s72
    v_perm_b32 v34, v84, v80, s72
    v_perm_b32 v35, v92, v88, s72
    ds_read_b128 a[32:35], v16 offset:0
    v_perm_b32 v36, v68, v64, s73
    v_perm_b32 v37, v76, v72, s73
    v_perm_b32 v38, v84, v80, s73
    v_perm_b32 v39, v92, v88, s73
    s_waitcnt lgkmcnt(1)
    v_mfma_f32_16x16x32_bf16 v[96:99], v[32:35], a[120:123], v[96:99]
    v_mfma_f32_16x16x32_bf16 v[100:103], v[32:35], a[124:127], v[100:103]
    ds_read_b128 a[36:39], v17 offset:0
    v_perm_b32 v40, v69, v65, s72
    v_perm_b32 v41, v77, v73, s72
    v_perm_b32 v42, v85, v81, s72
    v_perm_b32 v43, v93, v89, s72
    v_mfma_f32_16x16x32_bf16 v[104:107], v[36:39], a[120:123], v[104:107]
    v_mfma_f32_16x16x32_bf16 v[108:111], v[36:39], a[124:127], v[108:111]
    ds_read_b128 a[40:43], v18 offset:0
    v_perm_b32 v32, v69, v65, s73
    v_perm_b32 v33, v77, v73, s73
    v_perm_b32 v34, v85, v81, s73
    v_perm_b32 v35, v93, v89, s73
    v_mfma_f32_16x16x32_bf16 v[112:115], v[40:43], a[120:123], v[112:115]
    v_mfma_f32_16x16x32_bf16 v[116:119], v[40:43], a[124:127], v[116:119]
    ds_read_b128 a[44:47], v19 offset:0
    v_perm_b32 v36, v70, v66, s72
    v_perm_b32 v37, v78, v74, s72
    v_perm_b32 v38, v86, v82, s72
    v_perm_b32 v39, v94, v90, s72
    v_mfma_f32_16x16x32_bf16 v[120:123], v[32:35], a[120:123], v[120:123]
    v_mfma_f32_16x16x32_bf16 v[124:127], v[32:35], a[124:127], v[124:127]
    ds_read_b128 a[48:51], v16 offset:4096
    v_perm_b32 v40, v70, v66, s73
    v_perm_b32 v41, v78, v74, s73
    v_perm_b32 v42, v86, v82, s73
    v_perm_b32 v43, v94, v90, s73
    v_mfma_f32_16x16x32_bf16 v[128:131], v[36:39], a[120:123], v[128:131]
    v_mfma_f32_16x16x32_bf16 v[132:135], v[36:39], a[124:127], v[132:135]
    ds_read_b128 a[52:55], v17 offset:4096
    v_perm_b32 v32, v71, v67, s72
    v_perm_b32 v33, v79, v75, s72
    v_perm_b32 v34, v87, v83, s72
    v_perm_b32 v35, v95, v91, s72
    v_mfma_f32_16x16x32_bf16 v[136:139], v[40:43], a[120:123], v[136:139]
    v_mfma_f32_16x16x32_bf16 v[140:143], v[40:43], a[124:127], v[140:143]
    ds_read_b128 a[56:59], v18 offset:4096
    v_perm_b32 v36, v71, v67, s73
    v_perm_b32 v37, v79, v75, s73
    v_perm_b32 v38, v87, v83, s73
    v_perm_b32 v39, v95, v91, s73
    v_mfma_f32_16x16x32_bf16 v[144:147], v[32:35], a[120:123], v[144:147]
    v_mfma_f32_16x16x32_bf16 v[148:151], v[32:35], a[124:127], v[148:151]
    ds_read_b128 a[60:63], v19 offset:4096
    v_mfma_f32_16x16x32_bf16 v[152:155], v[36:39], a[120:123], v[152:155]
    v_mfma_f32_16x16x32_bf16 v[156:159], v[36:39], a[124:127], v[156:159]
    s_mov_b32 s14, s74
    s_mov_b32 s15, s74
    v_pk_mul_f32 v[96:97], v[96:97], s[14:15]
    v_pk_mul_f32 v[104:105], v[104:105], s[14:15]
    v_pk_mul_f32 v[112:113], v[112:113], s[14:15]
    v_pk_mul_f32 v[120:121], v[120:121], s[14:15]
    v_pk_mul_f32 v[128:129], v[128:129], s[14:15]
    v_pk_mul_f32 v[136:137], v[136:137], s[14:15]
    v_pk_mul_f32 v[144:145], v[144:145], s[14:15]
    v_pk_mul_f32 v[152:153], v[152:153], s[14:15]
    v_cvt_pk_bf16_f32 v160, v96, v104
    v_cvt_pk_bf16_f32 v161, v112, v120
    v_cvt_pk_bf16_f32 v162, v128, v136
    v_cvt_pk_bf16_f32 v163, v144, v152
    v_cvt_pk_bf16_f32 v164, v97, v105
    v_cvt_pk_bf16_f32 v165, v113, v121
    v_cvt_pk_bf16_f32 v166, v129, v137
    v_cvt_pk_bf16_f32 v167, v145, v153
    v_pk_mul_f32 v[98:99], v[98:99], s[14:15]
    v_pk_mul_f32 v[106:107], v[106:107], s[14:15]
    v_pk_mul_f32 v[114:115], v[114:115], s[14:15]
    v_pk_mul_f32 v[122:123], v[122:123], s[14:15]
    v_pk_mul_f32 v[130:131], v[130:131], s[14:15]
    v_pk_mul_f32 v[138:139], v[138:139], s[14:15]
    v_pk_mul_f32 v[146:147], v[146:147], s[14:15]
    v_pk_mul_f32 v[154:155], v[154:155], s[14:15]
    v_cvt_pk_bf16_f32 v168, v98, v106
    v_cvt_pk_bf16_f32 v169, v114, v122
    v_cvt_pk_bf16_f32 v170, v130, v138
    v_cvt_pk_bf16_f32 v171, v146, v154
    v_cvt_pk_bf16_f32 v172, v99, v107
    v_cvt_pk_bf16_f32 v173, v115, v123
    v_cvt_pk_bf16_f32 v174, v131, v139
    v_cvt_pk_bf16_f32 v175, v147, v155
    s_waitcnt lgkmcnt(0)
    v_mfma_f32_16x16x32_bf16 v[32:35], a[32:35], v[160:163], 0
    v_pk_mul_f32 v[100:101], v[100:101], s[14:15]
    v_pk_mul_f32 v[108:109], v[108:109], s[14:15]
    v_pk_mul_f32 v[116:117], v[116:117], s[14:15]
    v_pk_mul_f32 v[124:125], v[124:125], s[14:15]
    v_mfma_f32_16x16x32_bf16 v[32:35], a[36:39], v[164:167], v[32:35]
    v_pk_mul_f32 v[132:133], v[132:133], s[14:15]
    v_pk_mul_f32 v[140:141], v[140:141], s[14:15]
    v_pk_mul_f32 v[148:149], v[148:149], s[14:15]
    v_pk_mul_f32 v[156:157], v[156:157], s[14:15]
    v_mfma_f32_16x16x32_bf16 v[32:35], a[40:43], v[168:171], v[32:35]
    v_cvt_pk_bf16_f32 v176, v100, v108
    v_cvt_pk_bf16_f32 v177, v116, v124
    v_cvt_pk_bf16_f32 v178, v132, v140
    v_cvt_pk_bf16_f32 v179, v148, v156
    v_mfma_f32_16x16x32_bf16 v[32:35], a[44:47], v[172:175], v[32:35]
    v_cvt_pk_bf16_f32 v180, v101, v109
    v_cvt_pk_bf16_f32 v181, v117, v125
    v_cvt_pk_bf16_f32 v182, v133, v141
    v_cvt_pk_bf16_f32 v183, v149, v157
    v_mfma_f32_16x16x32_bf16 v[36:39], a[48:51], v[160:163], 0
    v_pk_mul_f32 v[102:103], v[102:103], s[14:15]
    v_pk_mul_f32 v[110:111], v[110:111], s[14:15]
    v_pk_mul_f32 v[118:119], v[118:119], s[14:15]
    v_pk_mul_f32 v[126:127], v[126:127], s[14:15]
    v_mfma_f32_16x16x32_bf16 v[36:39], a[52:55], v[164:167], v[36:39]
    v_pk_mul_f32 v[134:135], v[134:135], s[14:15]
    v_pk_mul_f32 v[142:143], v[142:143], s[14:15]
    v_pk_mul_f32 v[150:151], v[150:151], s[14:15]
    v_pk_mul_f32 v[158:159], v[158:159], s[14:15]
    v_mfma_f32_16x16x32_bf16 v[36:39], a[56:59], v[168:171], v[36:39]
    v_cvt_pk_bf16_f32 v184, v102, v110
    v_cvt_pk_bf16_f32 v185, v118, v126
    v_cvt_pk_bf16_f32 v186, v134, v142
    v_cvt_pk_bf16_f32 v187, v150, v158
    v_mfma_f32_16x16x32_bf16 v[36:39], a[60:63], v[172:175], v[36:39]
    v_cvt_pk_bf16_f32 v188, v103, v111
    v_cvt_pk_bf16_f32 v189, v119, v127
    v_cvt_pk_bf16_f32 v190, v135, v143
    v_cvt_pk_bf16_f32 v191, v151, v159
    v_mfma_f32_16x16x32_bf16 v[40:43], a[32:35], v[176:179], 0
    v_mfma_f32_16x16x32_bf16 v[40:43], a[36:39], v[180:183], v[40:43]
    v_mfma_f32_16x16x32_bf16 v[40:43], a[40:43], v[184:187], v[40:43]
    v_mfma_f32_16x16x32_bf16 v[40:43], a[44:47], v[188:191], v[40:43]
    v_mfma_f32_16x16x32_bf16 v[44:47], a[48:51], v[176:179], 0
    v_mfma_f32_16x16x32_bf16 v[44:47], a[52:55], v[180:183], v[44:47]
    v_mfma_f32_16x16x32_bf16 v[44:47], a[56:59], v[184:187], v[44:47]
    v_mfma_f32_16x16x32_bf16 v[44:47], a[60:63], v[188:191], v[44:47]
    s_mov_b32 s72, 0x40004000
    s_waitcnt vmcnt(10)
    s_barrier
    ds_read_b128 a[64:67], v16 offset:8192
    ds_read_b128 a[68:71], v17 offset:8192
    ds_read_b128 a[72:75], v18 offset:8192
    s_add_u32 m0, s78, 90112
    s_mov_b32 s9, 24576
    buffer_load_dwordx4 v10, s[48:51], s9 offen nt lds
    ds_read_b128 a[32:35], v19 offset:8192
    buffer_load_dwordx4 v5, s[48:51], s9 offen offset:1024 nt lds
    v_max3_f32 v14, v32, v33, v34
    v_max3_f32 v14, v14, v35, v36
    v_max3_f32 v14, v14, v37, v38
    v_max_f32 v14, v14, v39
    v_max3_f32 v73, v40, v41, v42
    v_max3_f32 v73, v73, v43, v44
    v_max3_f32 v73, v73, v45, v46
    v_max_f32 v73, v73, v47
    v_mov_b32 v74, v14
    v_mov_b32 v75, v73
    s_nop 0
    v_permlane16_swap_b32 v74, v14
    v_permlane16_swap_b32 v75, v73
    v_max_f32 v14, v14, v74
    v_max_f32 v73, v73, v75
    v_mov_b32 v74, v14
    v_mov_b32 v75, v73
    s_nop 0
    v_permlane32_swap_b32 v74, v14
    v_permlane32_swap_b32 v75, v73
    v_max_f32 v14, v14, v74
    v_max_f32 v73, v73, v75
    v_add_f32 v14, 1088421888, v14
    v_add_f32 v73, 1088421888, v73
    v_sub_f32 v32, v32, v14
    v_sub_f32 v33, v33, v14
    v_sub_f32 v34, v34, v14
    v_sub_f32 v35, v35, v14
    v_sub_f32 v36, v36, v14
    v_sub_f32 v37, v37, v14
    v_sub_f32 v38, v38, v14
    v_sub_f32 v39, v39, v14
    v_sub_f32 v40, v40, v73
    v_sub_f32 v41, v41, v73
    v_sub_f32 v42, v42, v73
    v_sub_f32 v43, v43, v73
    v_sub_f32 v44, v44, v73
    v_sub_f32 v45, v45, v73
    v_sub_f32 v46, v46, v73
    v_sub_f32 v47, v47, v73
    v_sub_f32 v64, 0, v14
    v_sub_f32 v65, 0, v14
    v_sub_f32 v66, 0, v14
    v_sub_f32 v67, 0, v14
    v_sub_f32 v68, 0, v73
    v_sub_f32 v69, 0, v73
    v_sub_f32 v70, 0, v73
    v_sub_f32 v71, 0, v73
    ds_read_b128 a[36:39], v16 offset:12288
    v_exp_f32 v244, v32
    s_add_u32 m0, s78, 0
    s_mov_b32 s9, 40960
    buffer_load_dwordx4 v8, s[44:47], s9 offen nt lds
    ds_read_b128 a[40:43], v17 offset:12288
    v_exp_f32 v245, v33
    buffer_load_dwordx4 v9, s[44:47], s9 offen offset:1024 nt lds
    v_exp_f32 v246, v34
    ds_read_b128 a[44:47], v18 offset:12288
    v_cvt_pk_bf16_f32 v80, v244, v245
    v_exp_f32 v247, v35
    ds_read_b128 a[48:51], v19 offset:12288
    v_exp_f32 v244, v36
    v_cvt_pk_bf16_f32 v81, v246, v247
    v_exp_f32 v245, v37
    ds_read_b64_tr_b16 a[52:53], v20 offset:0
    ds_read_b64_tr_b16 a[54:55], v20 offset:4096
    v_exp_f32 v246, v38
    ds_read_b64_tr_b16 a[56:57], v21 offset:0
    ds_read_b64_tr_b16 a[58:59], v21 offset:4096
    v_cvt_pk_bf16_f32 v82, v244, v245
    v_exp_f32 v247, v39
    ds_read_b64_tr_b16 a[60:61], v22 offset:0
    ds_read_b64_tr_b16 a[62:63], v22 offset:4096
    v_exp_f32 v244, v40
    v_cvt_pk_bf16_f32 v83, v246, v247
    v_exp_f32 v245, v41
    s_waitcnt lgkmcnt(13)
    v_mfma_f32_16x16x32_bf16 v[48:51], a[64:67], v[160:163], v[64:67]
    v_exp_f32 v246, v42
    s_waitcnt lgkmcnt(12)
    v_mfma_f32_16x16x32_bf16 v[48:51], a[68:71], v[164:167], v[48:51]
    v_cvt_pk_bf16_f32 v84, v244, v245
    v_exp_f32 v247, v43
    s_waitcnt lgkmcnt(11)
    v_mfma_f32_16x16x32_bf16 v[48:51], a[72:75], v[168:171], v[48:51]
    v_exp_f32 v244, v44
    s_waitcnt lgkmcnt(10)
    v_mfma_f32_16x16x32_bf16 v[48:51], a[32:35], v[172:175], v[48:51]
    v_cvt_pk_bf16_f32 v85, v246, v247
    v_exp_f32 v245, v45
    v_mfma_f32_16x16x32_bf16 v[56:59], a[64:67], v[176:179], v[68:71]
    ds_read_b64_tr_b16 a[64:65], v23 offset:0
    ds_read_b64_tr_b16 a[66:67], v23 offset:4096
    v_mfma_f32_16x16x32_bf16 v[56:59], a[68:71], v[180:183], v[56:59]
    v_exp_f32 v246, v46
    v_mfma_f32_16x16x32_bf16 v[56:59], a[72:75], v[184:187], v[56:59]
    ds_read_b64_tr_b16 a[68:69], v24 offset:0
    ds_read_b64_tr_b16 a[70:71], v24 offset:4096
    v_mfma_f32_16x16x32_bf16 v[56:59], a[32:35], v[188:191], v[56:59]
    v_cvt_pk_bf16_f32 v86, v244, v245
    v_exp_f32 v247, v47
    s_waitcnt lgkmcnt(13)
    v_mfma_f32_16x16x32_bf16 v[52:55], a[36:39], v[160:163], v[64:67]
    ds_read_b64_tr_b16 a[72:73], v25 offset:0
    ds_read_b64_tr_b16 a[74:75], v25 offset:4096
    s_waitcnt lgkmcnt(14)
    v_mfma_f32_16x16x32_bf16 v[52:55], a[40:43], v[164:167], v[52:55]
    v_cvt_pk_bf16_f32 v87, v246, v247
    s_waitcnt lgkmcnt(13)
    v_mfma_f32_16x16x32_bf16 v[52:55], a[44:47], v[168:171], v[52:55]
    ds_read_b64_tr_b16 a[32:33], v26 offset:0
    ds_read_b64_tr_b16 a[34:35], v26 offset:4096
    s_add_u32 m0, s79, 49152
    s_add_u32 s82, s81, 0
    s_and_b32 s82, s82, 0x7ffff
    buffer_load_dwordx4 v252, s[56:59], s82 offen lds
    s_waitcnt lgkmcnt(14)
    v_mfma_f32_16x16x32_bf16 v[52:55], a[48:51], v[172:175], v[52:55]
    v_mfma_f32_16x16x32_bf16 v[60:63], a[36:39], v[176:179], v[68:71]
    ds_read_b64_tr_b16 a[36:37], v27 offset:0
    ds_read_b64_tr_b16 a[38:39], v27 offset:4096
    buffer_load_dwordx4 v253, s[56:59], s82 offen offset:1024 lds
    v_mfma_f32_16x16x32_bf16 v[60:63], a[40:43], v[180:183], v[60:63]
    buffer_load_dwordx4 v254, s[56:59], s82 offen offset:2048 lds
    v_mfma_f32_16x16x32_bf16 v[60:63], a[44:47], v[184:187], v[60:63]
    v_mfma_f32_16x16x32_bf16 v[60:63], a[48:51], v[188:191], v[60:63]
    s_waitcnt vmcnt(13) lgkmcnt(0)
    s_barrier
    v_mfma_f32_16x16x32_bf16 v[96:99], a[52:55], v[80:83], 0
    ds_read_b128 a[40:43], v16 offset:16384
    ds_read_b128 a[44:47], v17 offset:16384
    ds_read_b128 a[48:51], v18 offset:16384
    s_add_u32 m0, s78, 65536
    s_mov_b32 s9, 32768
    buffer_load_dwordx4 v10, s[48:51], s9 offen nt lds
    v_mfma_f32_16x16x32_bf16 v[100:103], a[52:55], v[84:87], 0
    ds_read_b128 a[52:55], v19 offset:16384
    v_mfma_f32_16x16x32_bf16 v[104:107], a[56:59], v[80:83], 0
    buffer_load_dwordx4 v5, s[48:51], s9 offen offset:1024 nt lds
    v_exp_f32 v244, v48
    v_mfma_f32_16x16x32_bf16 v[108:111], a[56:59], v[84:87], 0
    ds_read_b128 a[56:59], v16 offset:20480
    v_exp_f32 v245, v49
    v_mfma_f32_16x16x32_bf16 v[112:115], a[60:63], v[80:83], 0
    s_add_u32 m0, s78, 8192
    s_mov_b32 s9, 49152
    buffer_load_dwordx4 v8, s[44:47], s9 offen nt lds
    v_mfma_f32_16x16x32_bf16 v[116:119], a[60:63], v[84:87], 0
    ds_read_b128 a[60:63], v17 offset:20480
    v_exp_f32 v246, v50
    v_mfma_f32_16x16x32_bf16 v[120:123], a[64:67], v[80:83], 0
    buffer_load_dwordx4 v9, s[44:47], s9 offen offset:1024 nt lds
    v_cvt_pk_bf16_f32 v88, v244, v245
    v_mfma_f32_16x16x32_bf16 v[124:127], a[64:67], v[84:87], 0
    ds_read_b128 a[64:67], v18 offset:20480
    v_exp_f32 v247, v51
    v_mfma_f32_16x16x32_bf16 v[128:131], a[68:71], v[80:83], 0
    v_exp_f32 v244, v52
    v_mfma_f32_16x16x32_bf16 v[132:135], a[68:71], v[84:87], 0
    ds_read_b128 a[68:71], v19 offset:20480
    v_cvt_pk_bf16_f32 v89, v246, v247
    v_mfma_f32_16x16x32_bf16 v[136:139], a[72:75], v[80:83], 0
    v_exp_f32 v245, v53
    v_mfma_f32_16x16x32_bf16 v[140:143], a[72:75], v[84:87], 0
    ds_read_b64_tr_b16 a[72:73], v20 offset:8192
    ds_read_b64_tr_b16 a[74:75], v20 offset:12288
    v_mfma_f32_16x16x32_bf16 v[144:147], a[32:35], v[80:83], 0
    v_exp_f32 v246, v54
    v_mfma_f32_16x16x32_bf16 v[148:151], a[32:35], v[84:87], 0
    ds_read_b64_tr_b16 a[32:33], v21 offset:8192
    ds_read_b64_tr_b16 a[34:35], v21 offset:12288
    v_cvt_pk_bf16_f32 v90, v244, v245
    v_mfma_f32_16x16x32_bf16 v[152:155], a[36:39], v[80:83], 0
    v_exp_f32 v247, v55
    v_mfma_f32_16x16x32_bf16 v[156:159], a[36:39], v[84:87], 0
    ds_read_b64_tr_b16 a[36:37], v22 offset:8192
    ds_read_b64_tr_b16 a[38:39], v22 offset:12288
    v_mfma_f32_16x16x32_bf16 v[76:79], a[76:79], v[80:83], 0
    v_exp_f32 v244, v56
    v_cvt_pk_bf16_f32 v91, v246, v247
    v_mfma_f32_16x16x32_bf16 v[240:243], a[76:79], v[84:87], 0
    v_exp_f32 v245, v57
    s_waitcnt lgkmcnt(6)
    v_mfma_f32_16x16x32_bf16 v[32:35], a[40:43], v[160:163], v[64:67]
    v_exp_f32 v246, v58
    v_cvt_pk_bf16_f32 v92, v244, v245
    v_mfma_f32_16x16x32_bf16 v[32:35], a[44:47], v[164:167], v[32:35]
    v_exp_f32 v247, v59
    v_mfma_f32_16x16x32_bf16 v[32:35], a[48:51], v[168:171], v[32:35]
    v_exp_f32 v244, v60
    v_cvt_pk_bf16_f32 v93, v246, v247
    v_mfma_f32_16x16x32_bf16 v[32:35], a[52:55], v[172:175], v[32:35]
    v_exp_f32 v245, v61
    v_mfma_f32_16x16x32_bf16 v[40:43], a[40:43], v[176:179], v[68:71]
    ds_read_b64_tr_b16 a[40:41], v23 offset:8192
    ds_read_b64_tr_b16 a[42:43], v23 offset:12288
    v_mfma_f32_16x16x32_bf16 v[40:43], a[44:47], v[180:183], v[40:43]
    v_exp_f32 v246, v62
    v_cvt_pk_bf16_f32 v94, v244, v245
    v_mfma_f32_16x16x32_bf16 v[40:43], a[48:51], v[184:187], v[40:43]
    ds_read_b64_tr_b16 a[44:45], v24 offset:8192
    ds_read_b64_tr_b16 a[46:47], v24 offset:12288
    v_mfma_f32_16x16x32_bf16 v[40:43], a[52:55], v[188:191], v[40:43]
    v_exp_f32 v247, v63
    v_or3_b32 v14, v88, v89, v90
    v_mfma_f32_16x16x32_bf16 v[36:39], a[56:59], v[160:163], v[64:67]
    ds_read_b64_tr_b16 a[48:49], v25 offset:8192
    ds_read_b64_tr_b16 a[50:51], v25 offset:12288
    v_cvt_pk_bf16_f32 v95, v246, v247
    v_mfma_f32_16x16x32_bf16 v[36:39], a[60:63], v[164:167], v[36:39]
    v_or3_b32 v14, v14, v91, v92
    v_or3_b32 v14, v14, v93, v94
    v_bitop3_b32 v14, v14, v95, s72 bitop3:0xa8
    v_mfma_f32_16x16x32_bf16 v[36:39], a[64:67], v[168:171], v[36:39]
    ds_read_b64_tr_b16 a[52:53], v26 offset:8192
    ds_read_b64_tr_b16 a[54:55], v26 offset:12288
    s_add_u32 m0, s79, 49152
    s_nop 0
    buffer_load_dwordx4 v255, s[56:59], s82 offen offset:3072 lds
    v_mfma_f32_16x16x32_bf16 v[36:39], a[68:71], v[172:175], v[36:39]
    v_cmp_ne_u32 vcc, 0, v14
    v_mfma_f32_16x16x32_bf16 v[44:47], a[56:59], v[176:179], v[68:71]
    ds_read_b64_tr_b16 a[56:57], v27 offset:8192
    ds_read_b64_tr_b16 a[58:59], v27 offset:12288
    s_add_u32 m0, s79, 98304
    s_add_u32 s82, s81, 8192
    s_and_b32 s82, s82, 0x7ffff
    buffer_load_dwordx4 v252, s[56:59], s82 offen lds
    v_mfma_f32_16x16x32_bf16 v[44:47], a[60:63], v[180:183], v[44:47]
    buffer_load_dwordx4 v253, s[56:59], s82 offen offset:1024 lds
    v_mfma_f32_16x16x32_bf16 v[44:47], a[64:67], v[184:187], v[44:47]
    v_mfma_f32_16x16x32_bf16 v[44:47], a[68:71], v[188:191], v[44:47]
    s_cbranch_vccnz LB_r1_1
LB_b1_1:
    s_waitcnt vmcnt(16) lgkmcnt(0)
    s_barrier
    s_lshl_b32 s13, s4, 15
    s_add_u32 s13, s13, s75
    v_lshl_add_u32 v12, v0, 4, s13
    s_lshl_b32 s13, s5, 16
    s_lshl_b32 s12, s6, 10
    s_add_u32 s13, s13, s12
    s_lshl_b32 s12, s4, 7
    s_add_u32 s13, s13, s12
    v_and_b32 v13, 31, v0
    v_lshlrev_b32 v13, 11, v13
    v_lshrrev_b32 v2, 5, v0
    v_lshl_add_u32 v13, v2, 4, v13
    v_add_u32 v13, s13, v13
    s_lshl_b32 s10, s4, 8
    s_add_u32 s10, s10, s75
    s_add_u32 s10, s10, 262144
    v_and_b32 v2, 7, v1
    v_lshl_add_u32 v248, v2, 2, s10
    s_lshl_b32 s10, s3, 1
    v_add_u32 v249, s10, v1
    s_lshl_b32 s11, s4, 2
    s_add_u32 s11, s11, s75
    s_add_u32 s11, s11, 262144
    v_lshl_add_u32 v249, v249, 8, s11
    v_mov_b32 v250, s42
    v_mfma_f32_16x16x32_bf16 v[96:99], a[72:75], v[88:91], v[96:99]
    ds_read_b128 a[60:63], v16 offset:24576
    ds_read_b128 a[64:67], v17 offset:24576
    ds_read_b128 a[68:71], v18 offset:24576
    s_add_u32 m0, s78, 73728
    s_mov_b32 s9, 40960
    buffer_load_dwordx4 v10, s[48:51], s9 offen nt lds
    v_mfma_f32_16x16x32_bf16 v[100:103], a[72:75], v[92:95], v[100:103]
    ds_read_b128 a[72:75], v19 offset:24576
    v_mfma_f32_16x16x32_bf16 v[104:107], a[32:35], v[88:91], v[104:107]
    buffer_load_dwordx4 v5, s[48:51], s9 offen offset:1024 nt lds
    v_exp_f32 v244, v32
    v_mfma_f32_16x16x32_bf16 v[108:111], a[32:35], v[92:95], v[108:111]
    ds_read_b128 a[32:35], v16 offset:28672
    v_exp_f32 v245, v33
    v_mfma_f32_16x16x32_bf16 v[112:115], a[36:39], v[88:91], v[112:115]
    s_add_u32 m0, s78, 16384
    s_mov_b32 s9, 57344
    buffer_load_dwordx4 v8, s[44:47], s9 offen nt lds
    v_mfma_f32_16x16x32_bf16 v[116:119], a[36:39], v[92:95], v[116:119]
    ds_read_b128 a[36:39], v17 offset:28672
    v_exp_f32 v246, v34
    v_mfma_f32_16x16x32_bf16 v[120:123], a[40:43], v[88:91], v[120:123]
    buffer_load_dwordx4 v9, s[44:47], s9 offen offset:1024 nt lds
    v_cvt_pk_bf16_f32 v80, v244, v245
    v_mfma_f32_16x16x32_bf16 v[124:127], a[40:43], v[92:95], v[124:127]
    ds_read_b128 a[40:43], v18 offset:28672
    v_exp_f32 v247, v35
    v_mfma_f32_16x16x32_bf16 v[128:131], a[44:47], v[88:91], v[128:131]
    v_exp_f32 v244, v36
    v_mfma_f32_16x16x32_bf16 v[132:135], a[44:47], v[92:95], v[132:135]
    ds_read_b128 a[44:47], v19 offset:28672
    v_cvt_pk_bf16_f32 v81, v246, v247
    v_mfma_f32_16x16x32_bf16 v[136:139], a[48:51], v[88:91], v[136:139]
    v_exp_f32 v245, v37
    v_mfma_f32_16x16x32_bf16 v[140:143], a[48:51], v[92:95], v[140:143]
    ds_read_b64_tr_b16 a[48:49], v20 offset:16384
    ds_read_b64_tr_b16 a[50:51], v20 offset:20480
    v_mfma_f32_16x16x32_bf16 v[144:147], a[52:55], v[88:91], v[144:147]
    v_exp_f32 v246, v38
    v_mfma_f32_16x16x32_bf16 v[148:151], a[52:55], v[92:95], v[148:151]
    ds_read_b64_tr_b16 a[52:53], v21 offset:16384
    ds_read_b64_tr_b16 a[54:55], v21 offset:20480
    v_cvt_pk_bf16_f32 v82, v244, v245
    v_mfma_f32_16x16x32_bf16 v[152:155], a[56:59], v[88:91], v[152:155]
    v_exp_f32 v247, v39
    v_mfma_f32_16x16x32_bf16 v[156:159], a[56:59], v[92:95], v[156:159]
    ds_read_b64_tr_b16 a[56:57], v22 offset:16384
    ds_read_b64_tr_b16 a[58:59], v22 offset:20480
    v_mfma_f32_16x16x32_bf16 v[76:79], a[76:79], v[88:91], v[76:79]
    v_exp_f32 v244, v40
    v_cvt_pk_bf16_f32 v83, v246, v247
    v_mfma_f32_16x16x32_bf16 v[240:243], a[76:79], v[92:95], v[240:243]
    v_exp_f32 v245, v41
    s_waitcnt lgkmcnt(6)
    v_mfma_f32_16x16x32_bf16 v[48:51], a[60:63], v[160:163], v[64:67]
    v_exp_f32 v246, v42
    v_cvt_pk_bf16_f32 v84, v244, v245
    v_mfma_f32_16x16x32_bf16 v[48:51], a[64:67], v[164:167], v[48:51]
    v_exp_f32 v247, v43
    v_mfma_f32_16x16x32_bf16 v[48:51], a[68:71], v[168:171], v[48:51]
    v_exp_f32 v244, v44
    v_cvt_pk_bf16_f32 v85, v246, v247
    v_mfma_f32_16x16x32_bf16 v[48:51], a[72:75], v[172:175], v[48:51]
    v_exp_f32 v245, v45
    v_mfma_f32_16x16x32_bf16 v[56:59], a[60:63], v[176:179], v[68:71]
    ds_read_b64_tr_b16 a[60:61], v23 offset:16384
    ds_read_b64_tr_b16 a[62:63], v23 offset:20480
    v_mfma_f32_16x16x32_bf16 v[56:59], a[64:67], v[180:183], v[56:59]
    v_exp_f32 v246, v46
    v_cvt_pk_bf16_f32 v86, v244, v245
    v_mfma_f32_16x16x32_bf16 v[56:59], a[68:71], v[184:187], v[56:59]
    ds_read_b64_tr_b16 a[64:65], v24 offset:16384
    ds_read_b64_tr_b16 a[66:67], v24 offset:20480
    v_mfma_f32_16x16x32_bf16 v[56:59], a[72:75], v[188:191], v[56:59]
    v_exp_f32 v247, v47
    v_or3_b32 v14, v80, v81, v82
    v_mfma_f32_16x16x32_bf16 v[52:55], a[32:35], v[160:163], v[64:67]
    ds_read_b64_tr_b16 a[68:69], v25 offset:16384
    ds_read_b64_tr_b16 a[70:71], v25 offset:20480
    v_cvt_pk_bf16_f32 v87, v246, v247
    v_mfma_f32_16x16x32_bf16 v[52:55], a[36:39], v[164:167], v[52:55]
    v_or3_b32 v14, v14, v83, v84
    v_or3_b32 v14, v14, v85, v86
    v_bitop3_b32 v14, v14, v87, s72 bitop3:0xa8
    v_mfma_f32_16x16x32_bf16 v[52:55], a[40:43], v[168:171], v[52:55]
    ds_read_b64_tr_b16 a[72:73], v26 offset:16384
    ds_read_b64_tr_b16 a[74:75], v26 offset:20480
    s_add_u32 m0, s79, 98304
    s_nop 0
    buffer_load_dwordx4 v254, s[56:59], s82 offen offset:2048 lds
    v_mfma_f32_16x16x32_bf16 v[52:55], a[44:47], v[172:175], v[52:55]
    v_cmp_ne_u32 vcc, 0, v14
    v_mfma_f32_16x16x32_bf16 v[60:63], a[32:35], v[176:179], v[68:71]
    ds_read_b64_tr_b16 a[32:33], v27 offset:16384
    ds_read_b64_tr_b16 a[34:35], v27 offset:20480
    buffer_load_dwordx4 v255, s[56:59], s82 offen offset:3072 lds
    v_mfma_f32_16x16x32_bf16 v[60:63], a[36:39], v[180:183], v[60:63]
    s_add_u32 m0, s79, 114688
    s_add_u32 s82, s81, 32768
    s_and_b32 s82, s82, 0x7ffff
    buffer_load_dwordx4 v252, s[56:59], s82 offen lds
    v_mfma_f32_16x16x32_bf16 v[60:63], a[40:43], v[184:187], v[60:63]
    v_mfma_f32_16x16x32_bf16 v[60:63], a[44:47], v[188:191], v[60:63]
    s_cbranch_vccnz LB_r1_2
LB_b1_2:
    s_waitcnt vmcnt(19) lgkmcnt(0)
    s_barrier
    v_mfma_f32_16x16x32_bf16 v[96:99], a[48:51], v[80:83], v[96:99]
    ds_read_b128 a[36:39], v16 offset:32768
    ds_read_b128 a[40:43], v17 offset:32768
    ds_read_b128 a[44:47], v18 offset:32768
    s_add_u32 m0, s78, 81920
    s_mov_b32 s9, 49152
    buffer_load_dwordx4 v10, s[48:51], s9 offen nt lds
    v_mfma_f32_16x16x32_bf16 v[100:103], a[48:51], v[84:87], v[100:103]
    ds_read_b128 a[48:51], v19 offset:32768
    v_mfma_f32_16x16x32_bf16 v[104:107], a[52:55], v[80:83], v[104:107]
    buffer_load_dwordx4 v5, s[48:51], s9 offen offset:1024 nt lds
    v_exp_f32 v244, v48
    v_mfma_f32_16x16x32_bf16 v[108:111], a[52:55], v[84:87], v[108:111]
    ds_read_b128 a[52:55], v16 offset:36864
    v_exp_f32 v245, v49
    v_mfma_f32_16x16x32_bf16 v[112:115], a[56:59], v[80:83], v[112:115]
    s_add_u32 m0, s78, 24576
    s_mov_b32 s9, 65536
    buffer_load_dwordx4 v8, s[44:47], s9 offen nt lds
    v_mfma_f32_16x16x32_bf16 v[116:119], a[56:59], v[84:87], v[116:119]
    ds_read_b128 a[56:59], v17 offset:36864
    v_exp_f32 v246, v50
    v_mfma_f32_16x16x32_bf16 v[120:123], a[60:63], v[80:83], v[120:123]
    buffer_load_dwordx4 v9, s[44:47], s9 offen offset:1024 nt lds
    v_cvt_pk_bf16_f32 v88, v244, v245
    v_mfma_f32_16x16x32_bf16 v[124:127], a[60:63], v[84:87], v[124:127]
    ds_read_b128 a[60:63], v18 offset:36864
    v_exp_f32 v247, v51
    v_mfma_f32_16x16x32_bf16 v[128:131], a[64:67], v[80:83], v[128:131]
    v_exp_f32 v244, v52
    v_mfma_f32_16x16x32_bf16 v[132:135], a[64:67], v[84:87], v[132:135]
    ds_read_b128 a[64:67], v19 offset:36864
    v_cvt_pk_bf16_f32 v89, v246, v247
    v_mfma_f32_16x16x32_bf16 v[136:139], a[68:71], v[80:83], v[136:139]
    v_exp_f32 v245, v53
    v_mfma_f32_16x16x32_bf16 v[140:143], a[68:71], v[84:87], v[140:143]
    ds_read_b64_tr_b16 a[68:69], v20 offset:24576
    ds_read_b64_tr_b16 a[70:71], v20 offset:28672
    v_mfma_f32_16x16x32_bf16 v[144:147], a[72:75], v[80:83], v[144:147]
    v_exp_f32 v246, v54
    v_mfma_f32_16x16x32_bf16 v[148:151], a[72:75], v[84:87], v[148:151]
    ds_read_b64_tr_b16 a[72:73], v21 offset:24576
    ds_read_b64_tr_b16 a[74:75], v21 offset:28672
    v_mfma_f32_16x16x32_bf16 v[152:155], a[32:35], v[80:83], v[152:155]
    v_cvt_pk_bf16_f32 v90, v244, v245
    v_exp_f32 v247, v55
    v_mfma_f32_16x16x32_bf16 v[156:159], a[32:35], v[84:87], v[156:159]
    ds_read_b64_tr_b16 a[32:33], v22 offset:24576
    ds_read_b64_tr_b16 a[34:35], v22 offset:28672
    v_mfma_f32_16x16x32_bf16 v[76:79], a[76:79], v[80:83], v[76:79]
    v_exp_f32 v244, v56
    v_mfma_f32_16x16x32_bf16 v[240:243], a[76:79], v[84:87], v[240:243]
    v_cvt_pk_bf16_f32 v91, v246, v247
    v_exp_f32 v245, v57
    s_waitcnt lgkmcnt(6)
    v_mfma_f32_16x16x32_bf16 v[32:35], a[36:39], v[160:163], v[64:67]
    v_exp_f32 v246, v58
    v_mfma_f32_16x16x32_bf16 v[32:35], a[40:43], v[164:167], v[32:35]
    v_cvt_pk_bf16_f32 v92, v244, v245
    v_exp_f32 v247, v59
    v_mfma_f32_16x16x32_bf16 v[32:35], a[44:47], v[168:171], v[32:35]
    v_exp_f32 v244, v60
    v_mfma_f32_16x16x32_bf16 v[32:35], a[48:51], v[172:175], v[32:35]
    v_cvt_pk_bf16_f32 v93, v246, v247
    v_exp_f32 v245, v61
    v_mfma_f32_16x16x32_bf16 v[40:43], a[36:39], v[176:179], v[68:71]
    ds_read_b64_tr_b16 a[36:37], v23 offset:24576
    ds_read_b64_tr_b16 a[38:39], v23 offset:28672
    v_mfma_f32_16x16x32_bf16 v[40:43], a[40:43], v[180:183], v[40:43]
    v_exp_f32 v246, v62
    v_mfma_f32_16x16x32_bf16 v[40:43], a[44:47], v[184:187], v[40:43]
    ds_read_b64_tr_b16 a[40:41], v24 offset:24576
    ds_read_b64_tr_b16 a[42:43], v24 offset:28672
    v_mfma_f32_16x16x32_bf16 v[40:43], a[48:51], v[188:191], v[40:43]
    v_cvt_pk_bf16_f32 v94, v244, v245
    v_exp_f32 v247, v63
    v_mfma_f32_16x16x32_bf16 v[36:39], a[52:55], v[160:163], v[64:67]
    ds_read_b64_tr_b16 a[44:45], v25 offset:24576
    ds_read_b64_tr_b16 a[46:47], v25 offset:28672
    v_mfma_f32_16x16x32_bf16 v[36:39], a[56:59], v[164:167], v[36:39]
    v_or3_b32 v14, v88, v89, v90
    v_cvt_pk_bf16_f32 v95, v246, v247
    v_mfma_f32_16x16x32_bf16 v[36:39], a[60:63], v[168:171], v[36:39]
    ds_read_b64_tr_b16 a[48:49], v26 offset:24576
    ds_read_b64_tr_b16 a[50:51], v26 offset:28672
    s_add_u32 m0, s79, 114688
    s_nop 0
    buffer_load_dwordx4 v253, s[56:59], s82 offen offset:1024 lds
    v_mfma_f32_16x16x32_bf16 v[36:39], a[64:67], v[172:175], v[36:39]
    v_or3_b32 v14, v14, v91, v92
    v_or3_b32 v14, v14, v93, v94
    v_mfma_f32_16x16x32_bf16 v[44:47], a[52:55], v[176:179], v[68:71]
    ds_read_b64_tr_b16 a[52:53], v27 offset:24576
    ds_read_b64_tr_b16 a[54:55], v27 offset:28672
    buffer_load_dwordx4 v254, s[56:59], s82 offen offset:2048 lds
    v_mfma_f32_16x16x32_bf16 v[44:47], a[56:59], v[180:183], v[44:47]
    buffer_load_dwordx4 v255, s[56:59], s82 offen offset:3072 lds
    v_mfma_f32_16x16x32_bf16 v[44:47], a[60:63], v[184:187], v[44:47]
    v_bitop3_b32 v14, v14, v95, s72 bitop3:0xa8
    v_cmp_ne_u32 vcc, 0, v14
    v_mfma_f32_16x16x32_bf16 v[44:47], a[64:67], v[188:191], v[44:47]
    s_cbranch_vccnz LB_r1_3
LB_b1_3:
    s_waitcnt vmcnt(19) lgkmcnt(0)
    s_barrier
    buffer_load_dword v6, v248, s[64:67], 0 offen sc1
    v_mfma_f32_16x16x32_bf16 v[96:99], a[68:71], v[88:91], v[96:99]
    ds_read_b128 a[56:59], v16 offset:0
    ds_read_b128 a[60:63], v17 offset:0
    ds_read_b128 a[64:67], v18 offset:0
    s_add_u32 m0, s78, 90112
    s_mov_b32 s9, 57344
    buffer_load_dwordx4 v10, s[48:51], s9 offen nt lds
    v_mfma_f32_16x16x32_bf16 v[100:103], a[68:71], v[92:95], v[100:103]
    ds_read_b128 a[68:71], v19 offset:0
    v_mfma_f32_16x16x32_bf16 v[104:107], a[72:75], v[88:91], v[104:107]
    buffer_load_dwordx4 v5, s[48:51], s9 offen offset:1024 nt lds
    s_waitcnt vmcnt(19)
    ds_read_b64_tr_b16 a[80:81], v28 offset:49152
    v_mfma_f32_16x16x32_bf16 v[108:111], a[72:75], v[92:95], v[108:111]
    ds_read_b128 a[72:75], v16 offset:4096
    v_exp_f32 v244, v32
    v_mfma_f32_16x16x32_bf16 v[112:115], a[32:35], v[88:91], v[112:115]
    s_add_u32 m0, s78, 32768
    s_mov_b32 s9, 73728
    buffer_load_dwordx4 v8, s[44:47], s9 offen nt lds
    ds_read_b64_tr_b16 a[82:83], v28 offset:51200
    v_mfma_f32_16x16x32_bf16 v[116:119], a[32:35], v[92:95], v[116:119]
    ds_read_b128 a[32:35], v17 offset:4096
    v_exp_f32 v245, v33
    v_mfma_f32_16x16x32_bf16 v[120:123], a[36:39], v[88:91], v[120:123]
    buffer_load_dwordx4 v9, s[44:47], s9 offen offset:1024 nt lds
    ds_read_b64_tr_b16 a[84:85], v29 offset:49152
    ds_read_b64_tr_b16 a[86:87], v29 offset:51200
    v_mfma_f32_16x16x32_bf16 v[124:127], a[36:39], v[92:95], v[124:127]
    ds_read_b128 a[36:39], v18 offset:4096
    v_exp_f32 v246, v34
    v_mfma_f32_16x16x32_bf16 v[128:131], a[40:43], v[88:91], v[128:131]
    ds_read_b64_tr_b16 a[88:89], v30 offset:49152
    ds_read_b64_tr_b16 a[90:91], v30 offset:51200
    v_cvt_pk_bf16_f32 v80, v244, v245
    v_mfma_f32_16x16x32_bf16 v[132:135], a[40:43], v[92:95], v[132:135]
    ds_read_b128 a[40:43], v19 offset:4096
    v_exp_f32 v247, v35
    v_mfma_f32_16x16x32_bf16 v[136:139], a[44:47], v[88:91], v[136:139]
    ds_read_b64_tr_b16 a[92:93], v31 offset:49152
    ds_read_b64_tr_b16 a[94:95], v31 offset:51200
    v_mfma_f32_16x16x32_bf16 v[140:143], a[44:47], v[92:95], v[140:143]
    ds_read_b64_tr_b16 a[44:45], v20 offset:0
    ds_read_b64_tr_b16 a[46:47], v20 offset:4096
    v_mfma_f32_16x16x32_bf16 v[144:147], a[48:51], v[88:91], v[144:147]
    v_exp_f32 v244, v36
    v_cvt_pk_bf16_f32 v81, v246, v247
    v_mfma_f32_16x16x32_bf16 v[148:151], a[48:51], v[92:95], v[148:151]
    ds_read_b64_tr_b16 a[48:49], v21 offset:0
    ds_read_b64_tr_b16 a[50:51], v21 offset:4096
    v_mfma_f32_16x16x32_bf16 v[152:155], a[52:55], v[88:91], v[152:155]
    v_exp_f32 v245, v37
    v_mfma_f32_16x16x32_bf16 v[156:159], a[52:55], v[92:95], v[156:159]
    ds_read_b64_tr_b16 a[52:53], v22 offset:0
    ds_read_b64_tr_b16 a[54:55], v22 offset:4096
    v_mfma_f32_16x16x32_bf16 v[76:79], a[76:79], v[88:91], v[76:79]
    v_exp_f32 v246, v38
    v_cvt_pk_bf16_f32 v82, v244, v245
    v_mfma_f32_16x16x32_bf16 v[240:243], a[76:79], v[92:95], v[240:243]
    v_exp_f32 v247, v39
    s_waitcnt lgkmcnt(8)
    v_mfma_f32_16x16x32_bf16 v[48:51], a[56:59], v[160:163], v[64:67]
    v_exp_f32 v244, v40
    v_cvt_pk_bf16_f32 v83, v246, v247
    v_mfma_f32_16x16x32_bf16 v[48:51], a[60:63], v[164:167], v[48:51]
    v_exp_f32 v245, v41
    v_mfma_f32_16x16x32_bf16 v[48:51], a[64:67], v[168:171], v[48:51]
    v_exp_f32 v246, v42
    v_cvt_pk_bf16_f32 v84, v244, v245
    v_mfma_f32_16x16x32_bf16 v[48:51], a[68:71], v[172:175], v[48:51]
    v_exp_f32 v247, v43
    v_mfma_f32_16x16x32_bf16 v[56:59], a[56:59], v[176:179], v[68:71]
    ds_read_b64_tr_b16 a[56:57], v23 offset:0
    ds_read_b64_tr_b16 a[58:59], v23 offset:4096
    v_exp_f32 v244, v44
    v_mfma_f32_16x16x32_bf16 v[56:59], a[60:63], v[180:183], v[56:59]
    v_cvt_pk_bf16_f32 v85, v246, v247
    v_exp_f32 v245, v45
    v_mfma_f32_16x16x32_bf16 v[56:59], a[64:67], v[184:187], v[56:59]
    ds_read_b64_tr_b16 a[60:61], v24 offset:0
    ds_read_b64_tr_b16 a[62:63], v24 offset:4096
    v_mfma_f32_16x16x32_bf16 v[56:59], a[68:71], v[188:191], v[56:59]
    v_exp_f32 v246, v46
    v_cvt_pk_bf16_f32 v86, v244, v245
    v_mfma_f32_16x16x32_bf16 v[52:55], a[72:75], v[160:163], v[64:67]
    ds_read_b64_tr_b16 a[64:65], v25 offset:0
    ds_read_b64_tr_b16 a[66:67], v25 offset:4096
    v_exp_f32 v247, v47
    v_mfma_f32_16x16x32_bf16 v[52:55], a[32:35], v[164:167], v[52:55]
    v_or3_b32 v14, v80, v81, v82
    v_cvt_pk_bf16_f32 v87, v246, v247
    v_or3_b32 v14, v14, v83, v84
    v_mfma_f32_16x16x32_bf16 v[52:55], a[36:39], v[168:171], v[52:55]
    ds_read_b64_tr_b16 a[68:69], v26 offset:0
    ds_read_b64_tr_b16 a[70:71], v26 offset:4096
    s_add_u32 m0, s79, 131072
    s_add_u32 s82, s81, 40960
    s_and_b32 s82, s82, 0x7ffff
    buffer_load_dwordx4 v252, s[56:59], s82 offen lds
    v_mfma_f32_16x16x32_bf16 v[52:55], a[40:43], v[172:175], v[52:55]
    v_or3_b32 v14, v14, v85, v86
    v_bitop3_b32 v14, v14, v87, s72 bitop3:0xa8
    v_mfma_f32_16x16x32_bf16 v[60:63], a[72:75], v[176:179], v[68:71]
    ds_read_b64_tr_b16 a[72:73], v27 offset:0
    ds_read_b64_tr_b16 a[74:75], v27 offset:4096
    buffer_load_dwordx4 v253, s[56:59], s82 offen offset:1024 lds
    v_mfma_f32_16x16x32_bf16 v[60:63], a[32:35], v[180:183], v[60:63]
    buffer_load_dwordx4 v254, s[56:59], s82 offen offset:2048 lds
    v_mfma_f32_16x16x32_bf16 v[60:63], a[36:39], v[184:187], v[60:63]
    v_cmp_ne_u32 vcc, 0, v14
    v_mfma_f32_16x16x32_bf16 v[60:63], a[40:43], v[188:191], v[60:63]
    s_cbranch_vccnz LB_r1_4
LB_b1_4:
    s_waitcnt vmcnt(20) lgkmcnt(0)
    s_barrier
    v_mfma_f32_16x16x32_bf16 v[96:99], a[44:47], v[80:83], v[96:99]
    ds_read_b128 a[32:35], v16 offset:8192
    ds_read_b128 a[36:39], v17 offset:8192
    ds_read_b128 a[40:43], v18 offset:8192
    s_add_u32 m0, s78, 65536
    s_mov_b32 s9, 65536
    buffer_load_dwordx4 v10, s[48:51], s9 offen nt lds
    v_mfma_f32_16x16x32_bf16 v[100:103], a[44:47], v[84:87], v[100:103]
    ds_read_b128 a[44:47], v19 offset:8192
    v_mfma_f32_16x16x32_bf16 v[104:107], a[48:51], v[80:83], v[104:107]
    buffer_load_dwordx4 v5, s[48:51], s9 offen offset:1024 nt lds
    s_waitcnt vmcnt(18)
    v_add_u32 v28, 65536, v28
    v_add_u32 v29, 65536, v29
    v_add_u32 v30, 65536, v30
    v_add_u32 v31, 65536, v31
    ds_read_b64_tr_b16 a[96:97], v28 offset:32768
    v_mfma_f32_16x16x32_bf16 v[108:111], a[48:51], v[84:87], v[108:111]
    ds_read_b128 a[48:51], v16 offset:12288
    v_exp_f32 v244, v48
    v_mfma_f32_16x16x32_bf16 v[112:115], a[52:55], v[80:83], v[112:115]
    s_add_u32 m0, s78, 0
    s_mov_b32 s9, 81920
    buffer_load_dwordx4 v8, s[44:47], s9 offen nt lds
    ds_read_b64_tr_b16 a[98:99], v28 offset:34816
    v_mfma_f32_16x16x32_bf16 v[116:119], a[52:55], v[84:87], v[116:119]
    ds_read_b128 a[52:55], v17 offset:12288
    v_exp_f32 v245, v49
    v_mfma_f32_16x16x32_bf16 v[120:123], a[56:59], v[80:83], v[120:123]
    buffer_load_dwordx4 v9, s[44:47], s9 offen offset:1024 nt lds
    ds_read_b64_tr_b16 a[100:101], v29 offset:32768
    ds_read_b64_tr_b16 a[102:103], v29 offset:34816
    v_mfma_f32_16x16x32_bf16 v[124:127], a[56:59], v[84:87], v[124:127]
    ds_read_b128 a[56:59], v18 offset:12288
    v_exp_f32 v246, v50
    v_mfma_f32_16x16x32_bf16 v[128:131], a[60:63], v[80:83], v[128:131]
    ds_read_b64_tr_b16 a[104:105], v30 offset:32768
    ds_read_b64_tr_b16 a[106:107], v30 offset:34816
    v_cvt_pk_bf16_f32 v88, v244, v245
    v_mfma_f32_16x16x32_bf16 v[132:135], a[60:63], v[84:87], v[132:135]
    ds_read_b128 a[60:63], v19 offset:12288
    v_exp_f32 v247, v51
    v_mfma_f32_16x16x32_bf16 v[136:139], a[64:67], v[80:83], v[136:139]
    ds_read_b64_tr_b16 a[108:109], v31 offset:32768
    ds_read_b64_tr_b16 a[110:111], v31 offset:34816
    v_mfma_f32_16x16x32_bf16 v[140:143], a[64:67], v[84:87], v[140:143]
    ds_read_b64_tr_b16 a[64:65], v20 offset:8192
    ds_read_b64_tr_b16 a[66:67], v20 offset:12288
    v_mfma_f32_16x16x32_bf16 v[144:147], a[68:71], v[80:83], v[144:147]
    v_exp_f32 v244, v52
    v_cvt_pk_bf16_f32 v89, v246, v247
    v_mfma_f32_16x16x32_bf16 v[148:151], a[68:71], v[84:87], v[148:151]
    ds_read_b64_tr_b16 a[68:69], v21 offset:8192
    ds_read_b64_tr_b16 a[70:71], v21 offset:12288
    v_mfma_f32_16x16x32_bf16 v[152:155], a[72:75], v[80:83], v[152:155]
    v_exp_f32 v245, v53
    v_mfma_f32_16x16x32_bf16 v[156:159], a[72:75], v[84:87], v[156:159]
    ds_read_b64_tr_b16 a[72:73], v22 offset:8192
    ds_read_b64_tr_b16 a[74:75], v22 offset:12288
    v_mfma_f32_16x16x32_bf16 v[76:79], a[76:79], v[80:83], v[76:79]
    v_exp_f32 v246, v54
    v_cvt_pk_bf16_f32 v90, v244, v245
    v_mfma_f32_16x16x32_bf16 v[240:243], a[76:79], v[84:87], v[240:243]
    v_exp_f32 v247, v55
    s_waitcnt lgkmcnt(8)
    v_mfma_f32_16x16x32_bf16 v[32:35], a[32:35], v[160:163], v[64:67]
    v_exp_f32 v244, v56
    v_cvt_pk_bf16_f32 v91, v246, v247
    v_mfma_f32_16x16x32_bf16 v[32:35], a[36:39], v[164:167], v[32:35]
    v_exp_f32 v245, v57
    v_mfma_f32_16x16x32_bf16 v[32:35], a[40:43], v[168:171], v[32:35]
    v_exp_f32 v246, v58
    v_cvt_pk_bf16_f32 v92, v244, v245
    v_mfma_f32_16x16x32_bf16 v[32:35], a[44:47], v[172:175], v[32:35]
    v_exp_f32 v247, v59
    v_mfma_f32_16x16x32_bf16 v[40:43], a[32:35], v[176:179], v[68:71]
    ds_read_b64_tr_b16 a[32:33], v23 offset:8192
    ds_read_b64_tr_b16 a[34:35], v23 offset:12288
    v_exp_f32 v244, v60
    v_mfma_f32_16x16x32_bf16 v[40:43], a[36:39], v[180:183], v[40:43]
    v_cvt_pk_bf16_f32 v93, v246, v247
    v_exp_f32 v245, v61
    v_mfma_f32_16x16x32_bf16 v[40:43], a[40:43], v[184:187], v[40:43]
    ds_read_b64_tr_b16 a[36:37], v24 offset:8192
    ds_read_b64_tr_b16 a[38:39], v24 offset:12288
    v_mfma_f32_16x16x32_bf16 v[40:43], a[44:47], v[188:191], v[40:43]
    v_exp_f32 v246, v62
    v_cvt_pk_bf16_f32 v94, v244, v245
    v_mfma_f32_16x16x32_bf16 v[36:39], a[48:51], v[160:163], v[64:67]
    ds_read_b64_tr_b16 a[40:41], v25 offset:8192
    ds_read_b64_tr_b16 a[42:43], v25 offset:12288
    v_exp_f32 v247, v63
    v_mfma_f32_16x16x32_bf16 v[36:39], a[52:55], v[164:167], v[36:39]
    v_or3_b32 v14, v88, v89, v90
    v_cvt_pk_bf16_f32 v95, v246, v247
    v_or3_b32 v14, v14, v91, v92
    v_mfma_f32_16x16x32_bf16 v[36:39], a[56:59], v[168:171], v[36:39]
    ds_read_b64_tr_b16 a[44:45], v26 offset:8192
    ds_read_b64_tr_b16 a[46:47], v26 offset:12288
    s_add_u32 m0, s79, 131072
    s_nop 0
    buffer_load_dwordx4 v255, s[56:59], s82 offen offset:3072 lds
    v_mfma_f32_16x16x32_bf16 v[36:39], a[60:63], v[172:175], v[36:39]
    v_or3_b32 v14, v14, v93, v94
    v_bitop3_b32 v14, v14, v95, s72 bitop3:0xa8
    v_cmp_ne_u32 vcc, 0, v14
    v_mfma_f32_16x16x32_bf16 v[44:47], a[48:51], v[176:179], v[68:71]
    ds_read_b64_tr_b16 a[48:49], v27 offset:8192
    ds_read_b64_tr_b16 a[50:51], v27 offset:12288
    s_add_u32 m0, s79, 49152
    s_add_u32 s82, s81, 65536
    s_and_b32 s82, s82, 0x7ffff
    buffer_load_dwordx4 v252, s[56:59], s82 offen lds
    v_mfma_f32_16x16x32_bf16 v[44:47], a[52:55], v[180:183], v[44:47]
    buffer_load_dwordx4 v253, s[56:59], s82 offen offset:1024 lds
    v_mfma_f32_16x16x32_bf16 v[44:47], a[56:59], v[184:187], v[44:47]
    v_mfma_f32_16x16x32_bf16 v[44:47], a[60:63], v[188:191], v[44:47]
    s_cbranch_vccnz LB_r1_5
LB_b1_5:
    s_waitcnt vmcnt(20) lgkmcnt(0)
    s_barrier
    v_mfma_f32_16x16x32_bf16 v[96:99], a[64:67], v[88:91], v[96:99]
    ds_read_b128 a[52:55], v16 offset:16384
    ds_read_b128 a[56:59], v17 offset:16384
    ds_read_b128 a[60:63], v18 offset:16384
    s_add_u32 m0, s78, 73728
    s_mov_b32 s9, 73728
    buffer_load_dwordx4 v10, s[48:51], s9 offen nt lds
    v_mfma_f32_16x16x32_bf16 v[100:103], a[64:67], v[92:95], v[100:103]
    ds_read_b128 a[64:67], v19 offset:16384
    v_mfma_f32_16x16x32_bf16 v[104:107], a[68:71], v[88:91], v[104:107]
    buffer_load_dwordx4 v5, s[48:51], s9 offen offset:1024 nt lds
    s_waitcnt vmcnt(17)
    ds_read_b64_tr_b16 a[112:113], v28 offset:49152
    v_mfma_f32_16x16x32_bf16 v[108:111], a[68:71], v[92:95], v[108:111]
    ds_read_b128 a[68:71], v16 offset:20480
    v_exp_f32 v244, v32
    v_mfma_f32_16x16x32_bf16 v[112:115], a[72:75], v[88:91], v[112:115]
    s_add_u32 m0, s78, 8192
    s_mov_b32 s9, 90112
    buffer_load_dwordx4 v8, s[44:47], s9 offen nt lds
    ds_read_b64_tr_b16 a[114:115], v28 offset:51200
    v_mfma_f32_16x16x32_bf16 v[116:119], a[72:75], v[92:95], v[116:119]
    ds_read_b128 a[72:75], v17 offset:20480
    v_exp_f32 v245, v33
    v_mfma_f32_16x16x32_bf16 v[120:123], a[32:35], v[88:91], v[120:123]
    buffer_load_dwordx4 v9, s[44:47], s9 offen offset:1024 nt lds
    ds_read_b64_tr_b16 a[116:117], v29 offset:49152
    ds_read_b64_tr_b16 a[118:119], v29 offset:51200
    v_mfma_f32_16x16x32_bf16 v[124:127], a[32:35], v[92:95], v[124:127]
    ds_read_b128 a[32:35], v18 offset:20480
    v_exp_f32 v246, v34
    v_mfma_f32_16x16x32_bf16 v[128:131], a[36:39], v[88:91], v[128:131]
    ds_read_b64_tr_b16 a[120:121], v30 offset:49152
    ds_read_b64_tr_b16 a[122:123], v30 offset:51200
    v_cvt_pk_bf16_f32 v80, v244, v245
    v_mfma_f32_16x16x32_bf16 v[132:135], a[36:39], v[92:95], v[132:135]
    ds_read_b128 a[36:39], v19 offset:20480
    v_exp_f32 v247, v35
    v_mfma_f32_16x16x32_bf16 v[136:139], a[40:43], v[88:91], v[136:139]
    ds_read_b64_tr_b16 a[124:125], v31 offset:49152
    ds_read_b64_tr_b16 a[126:127], v31 offset:51200
    v_mfma_f32_16x16x32_bf16 v[140:143], a[40:43], v[92:95], v[140:143]
    ds_read_b64_tr_b16 a[40:41], v20 offset:16384
    ds_read_b64_tr_b16 a[42:43], v20 offset:20480
    v_mfma_f32_16x16x32_bf16 v[144:147], a[44:47], v[88:91], v[144:147]
    v_exp_f32 v244, v36
    v_cvt_pk_bf16_f32 v81, v246, v247
    v_mfma_f32_16x16x32_bf16 v[148:151], a[44:47], v[92:95], v[148:151]
    ds_read_b64_tr_b16 a[44:45], v21 offset:16384
    ds_read_b64_tr_b16 a[46:47], v21 offset:20480
    v_mfma_f32_16x16x32_bf16 v[152:155], a[48:51], v[88:91], v[152:155]
    v_exp_f32 v245, v37
    v_mfma_f32_16x16x32_bf16 v[156:159], a[48:51], v[92:95], v[156:159]
    ds_read_b64_tr_b16 a[48:49], v22 offset:16384
    ds_read_b64_tr_b16 a[50:51], v22 offset:20480
    v_mfma_f32_16x16x32_bf16 v[76:79], a[76:79], v[88:91], v[76:79]
    v_exp_f32 v246, v38
    v_cvt_pk_bf16_f32 v82, v244, v245
    v_mfma_f32_16x16x32_bf16 v[240:243], a[76:79], v[92:95], v[240:243]
    v_exp_f32 v247, v39
    s_waitcnt lgkmcnt(8)
    v_mfma_f32_16x16x32_bf16 v[48:51], a[52:55], v[160:163], v[64:67]
    v_exp_f32 v244, v40
    v_cvt_pk_bf16_f32 v83, v246, v247
    v_mfma_f32_16x16x32_bf16 v[48:51], a[56:59], v[164:167], v[48:51]
    v_exp_f32 v245, v41
    v_mfma_f32_16x16x32_bf16 v[48:51], a[60:63], v[168:171], v[48:51]
    v_exp_f32 v246, v42
    v_cvt_pk_bf16_f32 v84, v244, v245
    v_mfma_f32_16x16x32_bf16 v[48:51], a[64:67], v[172:175], v[48:51]
    v_exp_f32 v247, v43
    v_mfma_f32_16x16x32_bf16 v[56:59], a[52:55], v[176:179], v[68:71]
    ds_read_b64_tr_b16 a[52:53], v23 offset:16384
    ds_read_b64_tr_b16 a[54:55], v23 offset:20480
    v_exp_f32 v244, v44
    v_mfma_f32_16x16x32_bf16 v[56:59], a[56:59], v[180:183], v[56:59]
    v_cvt_pk_bf16_f32 v85, v246, v247
    v_exp_f32 v245, v45
    v_mfma_f32_16x16x32_bf16 v[56:59], a[60:63], v[184:187], v[56:59]
    ds_read_b64_tr_b16 a[56:57], v24 offset:16384
    ds_read_b64_tr_b16 a[58:59], v24 offset:20480
    v_mfma_f32_16x16x32_bf16 v[56:59], a[64:67], v[188:191], v[56:59]
    v_exp_f32 v246, v46
    v_cvt_pk_bf16_f32 v86, v244, v245
    v_mfma_f32_16x16x32_bf16 v[52:55], a[68:71], v[160:163], v[64:67]
    ds_read_b64_tr_b16 a[60:61], v25 offset:16384
    ds_read_b64_tr_b16 a[62:63], v25 offset:20480
    v_exp_f32 v247, v47
    v_mfma_f32_16x16x32_bf16 v[52:55], a[72:75], v[164:167], v[52:55]
    v_or3_b32 v14, v80, v81, v82
    v_cvt_pk_bf16_f32 v87, v246, v247
    v_or3_b32 v14, v14, v83, v84
    v_mfma_f32_16x16x32_bf16 v[52:55], a[32:35], v[168:171], v[52:55]
    ds_read_b64_tr_b16 a[64:65], v26 offset:16384
    ds_read_b64_tr_b16 a[66:67], v26 offset:20480
    s_add_u32 m0, s79, 49152
    s_nop 0
    buffer_load_dwordx4 v254, s[56:59], s82 offen offset:2048 lds
    v_mfma_f32_16x16x32_bf16 v[52:55], a[36:39], v[172:175], v[52:55]
    v_or3_b32 v14, v14, v85, v86
    v_bitop3_b32 v14, v14, v87, s72 bitop3:0xa8
    v_cmp_ne_u32 vcc, 0, v14
    v_mfma_f32_16x16x32_bf16 v[60:63], a[68:71], v[176:179], v[68:71]
    ds_read_b64_tr_b16 a[68:69], v27 offset:16384
    ds_read_b64_tr_b16 a[70:71], v27 offset:20480
    buffer_load_dwordx4 v255, s[56:59], s82 offen offset:3072 lds
    v_mfma_f32_16x16x32_bf16 v[60:63], a[72:75], v[180:183], v[60:63]
    s_add_u32 m0, s79, 98304
    s_add_u32 s82, s81, 73728
    s_and_b32 s82, s82, 0x7ffff
    buffer_load_dwordx4 v252, s[56:59], s82 offen lds
    v_mfma_f32_16x16x32_bf16 v[60:63], a[32:35], v[184:187], v[60:63]
    v_mfma_f32_16x16x32_bf16 v[60:63], a[36:39], v[188:191], v[60:63]
    s_cbranch_vccnz LB_r1_6
LB_b1_6:
    s_waitcnt vmcnt(19) lgkmcnt(0)
    s_barrier
    v_mfma_f32_16x16x32_bf16 v[96:99], a[40:43], v[80:83], v[96:99]
    ds_read_b128 a[72:75], v16 offset:24576
    ds_read_b128 a[32:35], v17 offset:24576
    ds_read_b128 a[36:39], v18 offset:24576
    s_add_u32 m0, s78, 81920
    s_mov_b32 s9, 81920
    buffer_load_dwordx4 v10, s[48:51], s9 offen nt lds
    v_mfma_f32_16x16x32_bf16 v[100:103], a[40:43], v[84:87], v[100:103]
    ds_read_b128 a[40:43], v19 offset:24576
    v_mfma_f32_16x16x32_bf16 v[104:107], a[44:47], v[80:83], v[104:107]
    buffer_load_dwordx4 v5, s[48:51], s9 offen offset:1024 nt lds
    v_exp_f32 v244, v48
    v_mfma_f32_16x16x32_bf16 v[108:111], a[44:47], v[84:87], v[108:111]
    ds_read_b128 a[44:47], v16 offset:28672
    v_exp_f32 v245, v49
    v_mfma_f32_16x16x32_bf16 v[112:115], a[48:51], v[80:83], v[112:115]
    s_add_u32 m0, s79, 98304
    s_nop 0
    buffer_load_dwordx4 v253, s[56:59], s82 offen offset:1024 lds
    v_mfma_f32_16x16x32_bf16 v[116:119], a[48:51], v[84:87], v[116:119]
    ds_read_b128 a[48:51], v17 offset:28672
    v_exp_f32 v246, v50
    v_mfma_f32_16x16x32_bf16 v[120:123], a[52:55], v[80:83], v[120:123]
    buffer_load_dwordx4 v254, s[56:59], s82 offen offset:2048 lds
    v_cvt_pk_bf16_f32 v88, v244, v245
    v_mfma_f32_16x16x32_bf16 v[124:127], a[52:55], v[84:87], v[124:127]
    ds_read_b128 a[52:55], v18 offset:28672
    v_exp_f32 v247, v51
    v_mfma_f32_16x16x32_bf16 v[128:131], a[56:59], v[80:83], v[128:131]
    v_exp_f32 v244, v52
    v_mfma_f32_16x16x32_bf16 v[132:135], a[56:59], v[84:87], v[132:135]
    ds_read_b128 a[56:59], v19 offset:28672
    v_cvt_pk_bf16_f32 v89, v246, v247
    v_mfma_f32_16x16x32_bf16 v[136:139], a[60:63], v[80:83], v[136:139]
    v_exp_f32 v245, v53
    v_mfma_f32_16x16x32_bf16 v[140:143], a[60:63], v[84:87], v[140:143]
    ds_read_b64_tr_b16 a[60:61], v20 offset:24576
    ds_read_b64_tr_b16 a[62:63], v20 offset:28672
    v_mfma_f32_16x16x32_bf16 v[144:147], a[64:67], v[80:83], v[144:147]
    v_exp_f32 v246, v54
    v_mfma_f32_16x16x32_bf16 v[148:151], a[64:67], v[84:87], v[148:151]
    ds_read_b64_tr_b16 a[64:65], v21 offset:24576
    ds_read_b64_tr_b16 a[66:67], v21 offset:28672
    v_mfma_f32_16x16x32_bf16 v[152:155], a[68:71], v[80:83], v[152:155]
    v_cvt_pk_bf16_f32 v90, v244, v245
    v_exp_f32 v247, v55
    v_mfma_f32_16x16x32_bf16 v[156:159], a[68:71], v[84:87], v[156:159]
    ds_read_b64_tr_b16 a[68:69], v22 offset:24576
    ds_read_b64_tr_b16 a[70:71], v22 offset:28672
    v_mfma_f32_16x16x32_bf16 v[76:79], a[76:79], v[80:83], v[76:79]
    v_exp_f32 v244, v56
    v_mfma_f32_16x16x32_bf16 v[240:243], a[76:79], v[84:87], v[240:243]
    v_cvt_pk_bf16_f32 v91, v246, v247
    v_exp_f32 v245, v57
    s_waitcnt lgkmcnt(6)
    v_mfma_f32_16x16x32_bf16 v[32:35], a[72:75], v[160:163], v[64:67]
    v_exp_f32 v246, v58
    v_mfma_f32_16x16x32_bf16 v[32:35], a[32:35], v[164:167], v[32:35]
    v_cvt_pk_bf16_f32 v92, v244, v245
    v_exp_f32 v247, v59
    v_mfma_f32_16x16x32_bf16 v[32:35], a[36:39], v[168:171], v[32:35]
    v_exp_f32 v244, v60
    v_mfma_f32_16x16x32_bf16 v[32:35], a[40:43], v[172:175], v[32:35]
    v_cvt_pk_bf16_f32 v93, v246, v247
    v_exp_f32 v245, v61
    v_mfma_f32_16x16x32_bf16 v[40:43], a[72:75], v[176:179], v[68:71]
    ds_read_b64_tr_b16 a[72:73], v23 offset:24576
    ds_read_b64_tr_b16 a[74:75], v23 offset:28672
    v_mfma_f32_16x16x32_bf16 v[40:43], a[32:35], v[180:183], v[40:43]
    v_exp_f32 v246, v62
    v_mfma_f32_16x16x32_bf16 v[40:43], a[36:39], v[184:187], v[40:43]
    ds_read_b64_tr_b16 a[32:33], v24 offset:24576
    ds_read_b64_tr_b16 a[34:35], v24 offset:28672
    v_mfma_f32_16x16x32_bf16 v[40:43], a[40:43], v[188:191], v[40:43]
    v_cvt_pk_bf16_f32 v94, v244, v245
    v_exp_f32 v247, v63
    v_mfma_f32_16x16x32_bf16 v[36:39], a[44:47], v[160:163], v[64:67]
    ds_read_b64_tr_b16 a[36:37], v25 offset:24576
    ds_read_b64_tr_b16 a[38:39], v25 offset:28672
    v_mfma_f32_16x16x32_bf16 v[36:39], a[48:51], v[164:167], v[36:39]
    v_or3_b32 v14, v88, v89, v90
    v_cvt_pk_bf16_f32 v95, v246, v247
    v_mfma_f32_16x16x32_bf16 v[36:39], a[52:55], v[168:171], v[36:39]
    ds_read_b64_tr_b16 a[40:41], v26 offset:24576
    ds_read_b64_tr_b16 a[42:43], v26 offset:28672
    v_mfma_f32_16x16x32_bf16 v[36:39], a[56:59], v[172:175], v[36:39]
    v_or3_b32 v14, v14, v91, v92
    v_or3_b32 v14, v14, v93, v94
    v_mfma_f32_16x16x32_bf16 v[44:47], a[44:47], v[176:179], v[68:71]
    ds_read_b64_tr_b16 a[44:45], v27 offset:24576
    ds_read_b64_tr_b16 a[46:47], v27 offset:28672
    buffer_load_dwordx4 v255, s[56:59], s82 offen offset:3072 lds
    v_mfma_f32_16x16x32_bf16 v[44:47], a[48:51], v[180:183], v[44:47]
    v_bitop3_b32 v14, v14, v95, s72 bitop3:0xa8
    v_mfma_f32_16x16x32_bf16 v[44:47], a[52:55], v[184:187], v[44:47]
    v_cmp_ne_u32 vcc, 0, v14
    v_mfma_f32_16x16x32_bf16 v[44:47], a[56:59], v[188:191], v[44:47]
    s_cbranch_vccnz LB_r1_7
LB_b1_7:
    s_waitcnt vmcnt(17) lgkmcnt(0)
    s_barrier
    v_mfma_f32_16x16x32_bf16 v[96:99], a[60:63], v[88:91], v[96:99]
    ds_read_b128 a[48:51], v16 offset:32768
    ds_read_b128 a[52:55], v17 offset:32768
    ds_read_b128 a[56:59], v18 offset:32768
    s_add_u32 m0, s78, 16384
    s_mov_b32 s9, 98304
    buffer_load_dwordx4 v8, s[44:47], s9 offen nt lds
    v_mfma_f32_16x16x32_bf16 v[100:103], a[60:63], v[92:95], v[100:103]
    ds_read_b128 a[60:63], v19 offset:32768
    v_mfma_f32_16x16x32_bf16 v[104:107], a[64:67], v[88:91], v[104:107]
    buffer_load_dwordx4 v9, s[44:47], s9 offen offset:1024 nt lds
    s_waitcnt vmcnt(16)
    v_add_u32 v28, 32768, v28
    v_add_u32 v29, 32768, v29
    v_add_u32 v30, 32768, v30
    v_add_u32 v31, 32768, v31
    ds_read_b64_tr_b16 a[128:129], v28 offset:32768
    v_mfma_f32_16x16x32_bf16 v[108:111], a[64:67], v[92:95], v[108:111]
    ds_read_b128 a[64:67], v16 offset:36864
    v_exp_f32 v244, v32
    v_mfma_f32_16x16x32_bf16 v[112:115], a[68:71], v[88:91], v[112:115]
    s_add_u32 m0, s78, 90112
    s_mov_b32 s9, 90112
    buffer_load_dwordx4 v10, s[48:51], s9 offen nt lds
    ds_read_b64_tr_b16 a[130:131], v28 offset:34816
    v_mfma_f32_16x16x32_bf16 v[116:119], a[68:71], v[92:95], v[116:119]
    ds_read_b128 a[68:71], v17 offset:36864
    v_exp_f32 v245, v33
    v_mfma_f32_16x16x32_bf16 v[120:123], a[72:75], v[88:91], v[120:123]
    buffer_load_dwordx4 v5, s[48:51], s9 offen offset:1024 nt lds
    ds_read_b64_tr_b16 a[132:133], v29 offset:32768
    ds_read_b64_tr_b16 a[134:135], v29 offset:34816
    v_mfma_f32_16x16x32_bf16 v[124:127], a[72:75], v[92:95], v[124:127]
    ds_read_b128 a[72:75], v18 offset:36864
    v_exp_f32 v246, v34
    v_mfma_f32_16x16x32_bf16 v[128:131], a[32:35], v[88:91], v[128:131]
    ds_read_b64_tr_b16 a[136:137], v30 offset:32768
    ds_read_b64_tr_b16 a[138:139], v30 offset:34816
    v_cvt_pk_bf16_f32 v80, v244, v245
    v_mfma_f32_16x16x32_bf16 v[132:135], a[32:35], v[92:95], v[132:135]
    ds_read_b128 a[32:35], v19 offset:36864
    v_exp_f32 v247, v35
    v_mfma_f32_16x16x32_bf16 v[136:139], a[36:39], v[88:91], v[136:139]
    ds_read_b64_tr_b16 a[140:141], v31 offset:32768
    ds_read_b64_tr_b16 a[142:143], v31 offset:34816
    v_mfma_f32_16x16x32_bf16 v[140:143], a[36:39], v[92:95], v[140:143]
    ds_read_b64_tr_b16 a[36:37], v20 offset:0
    ds_read_b64_tr_b16 a[38:39], v20 offset:4096
    v_mfma_f32_16x16x32_bf16 v[144:147], a[40:43], v[88:91], v[144:147]
    v_exp_f32 v244, v36
    v_cvt_pk_bf16_f32 v81, v246, v247
    v_mfma_f32_16x16x32_bf16 v[148:151], a[40:43], v[92:95], v[148:151]
    ds_read_b64_tr_b16 a[40:41], v21 offset:0
    ds_read_b64_tr_b16 a[42:43], v21 offset:4096
    v_mfma_f32_16x16x32_bf16 v[152:155], a[44:47], v[88:91], v[152:155]
    v_exp_f32 v245, v37
    v_mfma_f32_16x16x32_bf16 v[156:159], a[44:47], v[92:95], v[156:159]
    ds_read_b64_tr_b16 a[44:45], v22 offset:0
    ds_read_b64_tr_b16 a[46:47], v22 offset:4096
    v_mfma_f32_16x16x32_bf16 v[76:79], a[76:79], v[88:91], v[76:79]
    v_exp_f32 v246, v38
    v_cvt_pk_bf16_f32 v82, v244, v245
    v_mfma_f32_16x16x32_bf16 v[240:243], a[76:79], v[92:95], v[240:243]
    v_exp_f32 v247, v39
    s_waitcnt lgkmcnt(8)
    v_mfma_f32_16x16x32_bf16 v[48:51], a[48:51], v[160:163], v[64:67]
    v_exp_f32 v244, v40
    v_cvt_pk_bf16_f32 v83, v246, v247
    v_mfma_f32_16x16x32_bf16 v[48:51], a[52:55], v[164:167], v[48:51]
    v_exp_f32 v245, v41
    v_mfma_f32_16x16x32_bf16 v[48:51], a[56:59], v[168:171], v[48:51]
    v_exp_f32 v246, v42
    v_cvt_pk_bf16_f32 v84, v244, v245
    v_mfma_f32_16x16x32_bf16 v[48:51], a[60:63], v[172:175], v[48:51]
    v_exp_f32 v247, v43
    v_mfma_f32_16x16x32_bf16 v[56:59], a[48:51], v[176:179], v[68:71]
    ds_read_b64_tr_b16 a[48:49], v23 offset:0
    ds_read_b64_tr_b16 a[50:51], v23 offset:4096
    v_exp_f32 v244, v44
    v_mfma_f32_16x16x32_bf16 v[56:59], a[52:55], v[180:183], v[56:59]
    v_cvt_pk_bf16_f32 v85, v246, v247
    v_exp_f32 v245, v45
    v_mfma_f32_16x16x32_bf16 v[56:59], a[56:59], v[184:187], v[56:59]
    ds_read_b64_tr_b16 a[52:53], v24 offset:0
    ds_read_b64_tr_b16 a[54:55], v24 offset:4096
    v_mfma_f32_16x16x32_bf16 v[56:59], a[60:63], v[188:191], v[56:59]
    v_exp_f32 v246, v46
    v_cvt_pk_bf16_f32 v86, v244, v245
    v_mfma_f32_16x16x32_bf16 v[52:55], a[64:67], v[160:163], v[64:67]
    ds_read_b64_tr_b16 a[56:57], v25 offset:0
    ds_read_b64_tr_b16 a[58:59], v25 offset:4096
    v_exp_f32 v247, v47
    v_mfma_f32_16x16x32_bf16 v[52:55], a[68:71], v[164:167], v[52:55]
    v_or3_b32 v14, v80, v81, v82
    v_cvt_pk_bf16_f32 v87, v246, v247
    v_or3_b32 v14, v14, v83, v84
    v_mfma_f32_16x16x32_bf16 v[52:55], a[72:75], v[168:171], v[52:55]
    ds_read_b64_tr_b16 a[60:61], v26 offset:0
    ds_read_b64_tr_b16 a[62:63], v26 offset:4096
    s_add_u32 m0, s79, 114688
    s_add_u32 s82, s81, 98304
    s_and_b32 s82, s82, 0x7ffff
    buffer_load_dwordx4 v252, s[56:59], s82 offen lds
    v_mfma_f32_16x16x32_bf16 v[52:55], a[32:35], v[172:175], v[52:55]
    v_or3_b32 v14, v14, v85, v86
    v_bitop3_b32 v14, v14, v87, s72 bitop3:0xa8
    v_mfma_f32_16x16x32_bf16 v[60:63], a[64:67], v[176:179], v[68:71]
    ds_read_b64_tr_b16 a[64:65], v27 offset:0
    ds_read_b64_tr_b16 a[66:67], v27 offset:4096
    buffer_load_dwordx4 v253, s[56:59], s82 offen offset:1024 lds
    v_mfma_f32_16x16x32_bf16 v[60:63], a[68:71], v[180:183], v[60:63]
    buffer_load_dwordx4 v254, s[56:59], s82 offen offset:2048 lds
    v_mfma_f32_16x16x32_bf16 v[60:63], a[72:75], v[184:187], v[60:63]
    v_cmp_ne_u32 vcc, 0, v14
    v_mfma_f32_16x16x32_bf16 v[60:63], a[32:35], v[188:191], v[60:63]
    s_cbranch_vccnz LB_r1_8
LB_b1_8:
    s_waitcnt vmcnt(17) lgkmcnt(0)
    s_barrier
    v_mfma_f32_16x16x32_bf16 v[96:99], a[36:39], v[80:83], v[96:99]
    ds_read_b128 a[68:71], v16 offset:0
    ds_read_b128 a[72:75], v17 offset:0
    ds_read_b128 a[32:35], v18 offset:0
    s_add_u32 m0, s78, 24576
    s_mov_b32 s9, 106496
    buffer_load_dwordx4 v8, s[44:47], s9 offen nt lds
    v_mfma_f32_16x16x32_bf16 v[100:103], a[36:39], v[84:87], v[100:103]
    ds_read_b128 a[36:39], v19 offset:0
    v_mfma_f32_16x16x32_bf16 v[104:107], a[40:43], v[80:83], v[104:107]
    buffer_load_dwordx4 v9, s[44:47], s9 offen offset:1024 nt lds
    s_waitcnt vmcnt(15)
    v_subrev_u32 v28, 98304, v28
    v_subrev_u32 v29, 98304, v29
    v_subrev_u32 v30, 98304, v30
    v_subrev_u32 v31, 98304, v31
    ds_read_b64_tr_b16 a[144:145], v28 offset:49152
    v_mfma_f32_16x16x32_bf16 v[108:111], a[40:43], v[84:87], v[108:111]
    ds_read_b128 a[40:43], v16 offset:4096
    v_exp_f32 v244, v48
    v_mfma_f32_16x16x32_bf16 v[112:115], a[44:47], v[80:83], v[112:115]
    s_add_u32 m0, s78, 65536
    s_mov_b32 s9, 98304
    buffer_load_dwordx4 v10, s[48:51], s9 offen nt lds
    ds_read_b64_tr_b16 a[146:147], v28 offset:51200
    v_mfma_f32_16x16x32_bf16 v[116:119], a[44:47], v[84:87], v[116:119]
    ds_read_b128 a[44:47], v17 offset:4096
    v_exp_f32 v245, v49
    v_mfma_f32_16x16x32_bf16 v[120:123], a[48:51], v[80:83], v[120:123]
    buffer_load_dwordx4 v5, s[48:51], s9 offen offset:1024 nt lds
    ds_read_b64_tr_b16 a[148:149], v29 offset:49152
    ds_read_b64_tr_b16 a[150:151], v29 offset:51200
    v_mfma_f32_16x16x32_bf16 v[124:127], a[48:51], v[84:87], v[124:127]
    ds_read_b128 a[48:51], v18 offset:4096
    v_exp_f32 v246, v50
    v_mfma_f32_16x16x32_bf16 v[128:131], a[52:55], v[80:83], v[128:131]
    ds_read_b64_tr_b16 a[152:153], v30 offset:49152
    ds_read_b64_tr_b16 a[154:155], v30 offset:51200
    v_cvt_pk_bf16_f32 v88, v244, v245
    v_mfma_f32_16x16x32_bf16 v[132:135], a[52:55], v[84:87], v[132:135]
    ds_read_b128 a[52:55], v19 offset:4096
    v_exp_f32 v247, v51
    v_mfma_f32_16x16x32_bf16 v[136:139], a[56:59], v[80:83], v[136:139]
    ds_read_b64_tr_b16 a[156:157], v31 offset:49152
    ds_read_b64_tr_b16 a[158:159], v31 offset:51200
    v_mfma_f32_16x16x32_bf16 v[140:143], a[56:59], v[84:87], v[140:143]
    ds_read_b64_tr_b16 a[56:57], v20 offset:8192
    ds_read_b64_tr_b16 a[58:59], v20 offset:12288
    v_mfma_f32_16x16x32_bf16 v[144:147], a[60:63], v[80:83], v[144:147]
    v_exp_f32 v244, v52
    v_cvt_pk_bf16_f32 v89, v246, v247
    v_mfma_f32_16x16x32_bf16 v[148:151], a[60:63], v[84:87], v[148:151]
    ds_read_b64_tr_b16 a[60:61], v21 offset:8192
    ds_read_b64_tr_b16 a[62:63], v21 offset:12288
    v_mfma_f32_16x16x32_bf16 v[152:155], a[64:67], v[80:83], v[152:155]
    v_exp_f32 v245, v53
    v_mfma_f32_16x16x32_bf16 v[156:159], a[64:67], v[84:87], v[156:159]
    ds_read_b64_tr_b16 a[64:65], v22 offset:8192
    ds_read_b64_tr_b16 a[66:67], v22 offset:12288
    v_mfma_f32_16x16x32_bf16 v[76:79], a[76:79], v[80:83], v[76:79]
    v_exp_f32 v246, v54
    v_cvt_pk_bf16_f32 v90, v244, v245
    v_mfma_f32_16x16x32_bf16 v[240:243], a[76:79], v[84:87], v[240:243]
    v_exp_f32 v247, v55
    s_waitcnt lgkmcnt(8)
    v_mfma_f32_16x16x32_bf16 v[32:35], a[68:71], v[160:163], v[64:67]
    v_exp_f32 v244, v56
    v_cvt_pk_bf16_f32 v91, v246, v247
    v_mfma_f32_16x16x32_bf16 v[32:35], a[72:75], v[164:167], v[32:35]
    v_exp_f32 v245, v57
    v_mfma_f32_16x16x32_bf16 v[32:35], a[32:35], v[168:171], v[32:35]
    v_exp_f32 v246, v58
    v_cvt_pk_bf16_f32 v92, v244, v245
    v_mfma_f32_16x16x32_bf16 v[32:35], a[36:39], v[172:175], v[32:35]
    v_exp_f32 v247, v59
    v_mfma_f32_16x16x32_bf16 v[40:43], a[68:71], v[176:179], v[68:71]
    ds_read_b64_tr_b16 a[68:69], v23 offset:8192
    ds_read_b64_tr_b16 a[70:71], v23 offset:12288
    v_exp_f32 v244, v60
    v_mfma_f32_16x16x32_bf16 v[40:43], a[72:75], v[180:183], v[40:43]
    v_cvt_pk_bf16_f32 v93, v246, v247
    v_exp_f32 v245, v61
    v_mfma_f32_16x16x32_bf16 v[40:43], a[32:35], v[184:187], v[40:43]
    ds_read_b64_tr_b16 a[72:73], v24 offset:8192
    ds_read_b64_tr_b16 a[74:75], v24 offset:12288
    v_mfma_f32_16x16x32_bf16 v[40:43], a[36:39], v[188:191], v[40:43]
    v_exp_f32 v246, v62
    v_cvt_pk_bf16_f32 v94, v244, v245
    v_mfma_f32_16x16x32_bf16 v[36:39], a[40:43], v[160:163], v[64:67]
    ds_read_b64_tr_b16 a[32:33], v25 offset:8192
    ds_read_b64_tr_b16 a[34:35], v25 offset:12288
    v_exp_f32 v247, v63
    v_mfma_f32_16x16x32_bf16 v[36:39], a[44:47], v[164:167], v[36:39]
    v_or3_b32 v14, v88, v89, v90
    v_cvt_pk_bf16_f32 v95, v246, v247
    v_or3_b32 v14, v14, v91, v92
    v_mfma_f32_16x16x32_bf16 v[36:39], a[48:51], v[168:171], v[36:39]
    ds_read_b64_tr_b16 a[36:37], v26 offset:8192
    ds_read_b64_tr_b16 a[38:39], v26 offset:12288
    s_add_u32 m0, s79, 114688
    s_nop 0
    buffer_load_dwordx4 v255, s[56:59], s82 offen offset:3072 lds
    v_mfma_f32_16x16x32_bf16 v[36:39], a[52:55], v[172:175], v[36:39]
    v_or3_b32 v14, v14, v93, v94
    v_bitop3_b32 v14, v14, v95, s72 bitop3:0xa8
    v_cmp_ne_u32 vcc, 0, v14
    v_mfma_f32_16x16x32_bf16 v[44:47], a[40:43], v[176:179], v[68:71]
    ds_read_b64_tr_b16 a[40:41], v27 offset:8192
    ds_read_b64_tr_b16 a[42:43], v27 offset:12288
    s_add_u32 m0, s79, 32768
    s_add_u32 s82, s81, 106496
    s_and_b32 s82, s82, 0x7ffff
    buffer_load_dwordx4 v252, s[56:59], s82 offen lds
    v_mfma_f32_16x16x32_bf16 v[44:47], a[44:47], v[180:183], v[44:47]
    buffer_load_dwordx4 v253, s[56:59], s82 offen offset:1024 lds
    v_mfma_f32_16x16x32_bf16 v[44:47], a[48:51], v[184:187], v[44:47]
    v_mfma_f32_16x16x32_bf16 v[44:47], a[52:55], v[188:191], v[44:47]
    s_cbranch_vccnz LB_r1_9
LB_b1_9:
    s_waitcnt vmcnt(17) lgkmcnt(0)
    s_barrier
    v_mfma_f32_16x16x32_bf16 v[96:99], a[56:59], v[88:91], v[96:99]
    ds_read_b128 a[44:47], v16 offset:8192
    ds_read_b128 a[48:51], v17 offset:8192
    ds_read_b128 a[52:55], v18 offset:8192
    s_add_u32 m0, s78, 0
    s_mov_b32 s9, 114688
    buffer_load_dwordx4 v8, s[44:47], s9 offen nt lds
    v_mfma_f32_16x16x32_bf16 v[100:103], a[56:59], v[92:95], v[100:103]
    ds_read_b128 a[56:59], v19 offset:8192
    v_mfma_f32_16x16x32_bf16 v[104:107], a[60:63], v[88:91], v[104:107]
    buffer_load_dwordx4 v9, s[44:47], s9 offen offset:1024 nt lds
    s_waitcnt vmcnt(16)
    v_add_u32 v28, 65536, v28
    v_add_u32 v29, 65536, v29
    v_add_u32 v30, 65536, v30
    v_add_u32 v31, 65536, v31
    ds_read_b64_tr_b16 a[160:161], v28 offset:32768
    v_mfma_f32_16x16x32_bf16 v[108:111], a[60:63], v[92:95], v[108:111]
    ds_read_b128 a[60:63], v16 offset:12288
    v_exp_f32 v244, v32
    v_mfma_f32_16x16x32_bf16 v[112:115], a[64:67], v[88:91], v[112:115]
    s_add_u32 m0, s78, 73728
    s_mov_b32 s9, 106496
    buffer_load_dwordx4 v10, s[48:51], s9 offen nt lds
    ds_read_b64_tr_b16 a[162:163], v28 offset:34816
    v_mfma_f32_16x16x32_bf16 v[116:119], a[64:67], v[92:95], v[116:119]
    ds_read_b128 a[64:67], v17 offset:12288
    v_exp_f32 v245, v33
    v_mfma_f32_16x16x32_bf16 v[120:123], a[68:71], v[88:91], v[120:123]
    buffer_load_dwordx4 v5, s[48:51], s9 offen offset:1024 nt lds
    ds_read_b64_tr_b16 a[164:165], v29 offset:32768
    ds_read_b64_tr_b16 a[166:167], v29 offset:34816
    v_mfma_f32_16x16x32_bf16 v[124:127], a[68:71], v[92:95], v[124:127]
    ds_read_b128 a[68:71], v18 offset:12288
    v_exp_f32 v246, v34
    v_mfma_f32_16x16x32_bf16 v[128:131], a[72:75], v[88:91], v[128:131]
    ds_read_b64_tr_b16 a[168:169], v30 offset:32768
    ds_read_b64_tr_b16 a[170:171], v30 offset:34816
    v_cvt_pk_bf16_f32 v80, v244, v245
    v_mfma_f32_16x16x32_bf16 v[132:135], a[72:75], v[92:95], v[132:135]
    ds_read_b128 a[72:75], v19 offset:12288
    v_exp_f32 v247, v35
    v_mfma_f32_16x16x32_bf16 v[136:139], a[32:35], v[88:91], v[136:139]
    ds_read_b64_tr_b16 a[172:173], v31 offset:32768
    ds_read_b64_tr_b16 a[174:175], v31 offset:34816
    v_mfma_f32_16x16x32_bf16 v[140:143], a[32:35], v[92:95], v[140:143]
    ds_read_b64_tr_b16 a[32:33], v20 offset:16384
    ds_read_b64_tr_b16 a[34:35], v20 offset:20480
    v_mfma_f32_16x16x32_bf16 v[144:147], a[36:39], v[88:91], v[144:147]
    v_exp_f32 v244, v36
    v_cvt_pk_bf16_f32 v81, v246, v247
    v_mfma_f32_16x16x32_bf16 v[148:151], a[36:39], v[92:95], v[148:151]
    ds_read_b64_tr_b16 a[36:37], v21 offset:16384
    ds_read_b64_tr_b16 a[38:39], v21 offset:20480
    v_mfma_f32_16x16x32_bf16 v[152:155], a[40:43], v[88:91], v[152:155]
    v_exp_f32 v245, v37
    v_mfma_f32_16x16x32_bf16 v[156:159], a[40:43], v[92:95], v[156:159]
    ds_read_b64_tr_b16 a[40:41], v22 offset:16384
    ds_read_b64_tr_b16 a[42:43], v22 offset:20480
    v_mfma_f32_16x16x32_bf16 v[76:79], a[76:79], v[88:91], v[76:79]
    v_exp_f32 v246, v38
    v_cvt_pk_bf16_f32 v82, v244, v245
    v_mfma_f32_16x16x32_bf16 v[240:243], a[76:79], v[92:95], v[240:243]
    v_exp_f32 v247, v39
    s_waitcnt lgkmcnt(8)
    v_mfma_f32_16x16x32_bf16 v[48:51], a[44:47], v[160:163], v[64:67]
    v_exp_f32 v244, v40
    v_cvt_pk_bf16_f32 v83, v246, v247
    v_mfma_f32_16x16x32_bf16 v[48:51], a[48:51], v[164:167], v[48:51]
    v_exp_f32 v245, v41
    v_mfma_f32_16x16x32_bf16 v[48:51], a[52:55], v[168:171], v[48:51]
    v_exp_f32 v246, v42
    v_cvt_pk_bf16_f32 v84, v244, v245
    v_mfma_f32_16x16x32_bf16 v[48:51], a[56:59], v[172:175], v[48:51]
    v_exp_f32 v247, v43
    v_mfma_f32_16x16x32_bf16 v[56:59], a[44:47], v[176:179], v[68:71]
    ds_read_b64_tr_b16 a[44:45], v23 offset:16384
    ds_read_b64_tr_b16 a[46:47], v23 offset:20480
    v_exp_f32 v244, v44
    v_mfma_f32_16x16x32_bf16 v[56:59], a[48:51], v[180:183], v[56:59]
    v_cvt_pk_bf16_f32 v85, v246, v247
    v_exp_f32 v245, v45
    v_mfma_f32_16x16x32_bf16 v[56:59], a[52:55], v[184:187], v[56:59]
    ds_read_b64_tr_b16 a[48:49], v24 offset:16384
    ds_read_b64_tr_b16 a[50:51], v24 offset:20480
    v_mfma_f32_16x16x32_bf16 v[56:59], a[56:59], v[188:191], v[56:59]
    v_exp_f32 v246, v46
    v_cvt_pk_bf16_f32 v86, v244, v245
    v_mfma_f32_16x16x32_bf16 v[52:55], a[60:63], v[160:163], v[64:67]
    ds_read_b64_tr_b16 a[52:53], v25 offset:16384
    ds_read_b64_tr_b16 a[54:55], v25 offset:20480
    v_exp_f32 v247, v47
    v_mfma_f32_16x16x32_bf16 v[52:55], a[64:67], v[164:167], v[52:55]
    v_or3_b32 v14, v80, v81, v82
    v_cvt_pk_bf16_f32 v87, v246, v247
    v_or3_b32 v14, v14, v83, v84
    v_mfma_f32_16x16x32_bf16 v[52:55], a[68:71], v[168:171], v[52:55]
    ds_read_b64_tr_b16 a[56:57], v26 offset:16384
    ds_read_b64_tr_b16 a[58:59], v26 offset:20480
    s_add_u32 m0, s79, 32768
    s_nop 0
    buffer_load_dwordx4 v254, s[56:59], s82 offen offset:2048 lds
    v_mfma_f32_16x16x32_bf16 v[52:55], a[72:75], v[172:175], v[52:55]
    v_or3_b32 v14, v14, v85, v86
    v_bitop3_b32 v14, v14, v87, s72 bitop3:0xa8
    v_cmp_ne_u32 vcc, 0, v14
    v_mfma_f32_16x16x32_bf16 v[60:63], a[60:63], v[176:179], v[68:71]
    ds_read_b64_tr_b16 a[60:61], v27 offset:16384
    ds_read_b64_tr_b16 a[62:63], v27 offset:20480
    buffer_load_dwordx4 v255, s[56:59], s82 offen offset:3072 lds
    v_mfma_f32_16x16x32_bf16 v[60:63], a[64:67], v[180:183], v[60:63]
    s_add_u32 m0, s79, 49152
    s_add_u32 s82, s81, 131072
    s_and_b32 s82, s82, 0x7ffff
    buffer_load_dwordx4 v252, s[56:59], s82 offen lds
    v_mfma_f32_16x16x32_bf16 v[60:63], a[68:71], v[184:187], v[60:63]
    v_mfma_f32_16x16x32_bf16 v[60:63], a[72:75], v[188:191], v[60:63]
    s_cbranch_vccnz LB_r1_10
LB_b1_10:
    s_waitcnt vmcnt(17) lgkmcnt(0)
    s_barrier
    v_mfma_f32_16x16x32_bf16 v[96:99], a[32:35], v[80:83], v[96:99]
    ds_read_b128 a[64:67], v16 offset:16384
    ds_read_b128 a[68:71], v17 offset:16384
    ds_read_b128 a[72:75], v18 offset:16384
    s_add_u32 m0, s78, 8192
    s_mov_b32 s9, 122880
    buffer_load_dwordx4 v8, s[44:47], s9 offen nt lds
    v_mfma_f32_16x16x32_bf16 v[100:103], a[32:35], v[84:87], v[100:103]
    ds_read_b128 a[32:35], v19 offset:16384
    v_mfma_f32_16x16x32_bf16 v[104:107], a[36:39], v[80:83], v[104:107]
    buffer_load_dwordx4 v9, s[44:47], s9 offen offset:1024 nt lds
    v_exp_f32 v244, v48
    v_mfma_f32_16x16x32_bf16 v[108:111], a[36:39], v[84:87], v[108:111]
    ds_read_b128 a[36:39], v16 offset:20480
    v_exp_f32 v245, v49
    v_mfma_f32_16x16x32_bf16 v[112:115], a[40:43], v[80:83], v[112:115]
    s_add_u32 m0, s78, 81920
    s_mov_b32 s9, 114688
    buffer_load_dwordx4 v10, s[48:51], s9 offen nt lds
    v_mfma_f32_16x16x32_bf16 v[116:119], a[40:43], v[84:87], v[116:119]
    ds_read_b128 a[40:43], v17 offset:20480
    v_exp_f32 v246, v50
    v_mfma_f32_16x16x32_bf16 v[120:123], a[44:47], v[80:83], v[120:123]
    buffer_load_dwordx4 v5, s[48:51], s9 offen offset:1024 nt lds
    v_cvt_pk_bf16_f32 v88, v244, v245
    v_mfma_f32_16x16x32_bf16 v[124:127], a[44:47], v[84:87], v[124:127]
    ds_read_b128 a[44:47], v18 offset:20480
    v_exp_f32 v247, v51
    v_mfma_f32_16x16x32_bf16 v[128:131], a[48:51], v[80:83], v[128:131]
    v_exp_f32 v244, v52
    v_mfma_f32_16x16x32_bf16 v[132:135], a[48:51], v[84:87], v[132:135]
    ds_read_b128 a[48:51], v19 offset:20480
    v_cvt_pk_bf16_f32 v89, v246, v247
    v_mfma_f32_16x16x32_bf16 v[136:139], a[52:55], v[80:83], v[136:139]
    v_exp_f32 v245, v53
    v_mfma_f32_16x16x32_bf16 v[140:143], a[52:55], v[84:87], v[140:143]
    ds_read_b64_tr_b16 a[52:53], v20 offset:24576
    ds_read_b64_tr_b16 a[54:55], v20 offset:28672
    v_mfma_f32_16x16x32_bf16 v[144:147], a[56:59], v[80:83], v[144:147]
    v_exp_f32 v246, v54
    v_mfma_f32_16x16x32_bf16 v[148:151], a[56:59], v[84:87], v[148:151]
    ds_read_b64_tr_b16 a[56:57], v21 offset:24576
    ds_read_b64_tr_b16 a[58:59], v21 offset:28672
    v_mfma_f32_16x16x32_bf16 v[152:155], a[60:63], v[80:83], v[152:155]
    v_cvt_pk_bf16_f32 v90, v244, v245
    v_exp_f32 v247, v55
    v_mfma_f32_16x16x32_bf16 v[156:159], a[60:63], v[84:87], v[156:159]
    ds_read_b64_tr_b16 a[60:61], v22 offset:24576
    ds_read_b64_tr_b16 a[62:63], v22 offset:28672
    v_mfma_f32_16x16x32_bf16 v[76:79], a[76:79], v[80:83], v[76:79]
    v_exp_f32 v244, v56
    v_mfma_f32_16x16x32_bf16 v[240:243], a[76:79], v[84:87], v[240:243]
    v_cvt_pk_bf16_f32 v91, v246, v247
    v_exp_f32 v245, v57
    s_waitcnt lgkmcnt(6)
    v_mfma_f32_16x16x32_bf16 v[32:35], a[64:67], v[160:163], v[64:67]
    v_exp_f32 v246, v58
    v_mfma_f32_16x16x32_bf16 v[32:35], a[68:71], v[164:167], v[32:35]
    v_cvt_pk_bf16_f32 v92, v244, v245
    v_exp_f32 v247, v59
    v_mfma_f32_16x16x32_bf16 v[32:35], a[72:75], v[168:171], v[32:35]
    v_exp_f32 v244, v60
    v_mfma_f32_16x16x32_bf16 v[32:35], a[32:35], v[172:175], v[32:35]
    v_cvt_pk_bf16_f32 v93, v246, v247
    v_exp_f32 v245, v61
    v_mfma_f32_16x16x32_bf16 v[40:43], a[64:67], v[176:179], v[68:71]
    ds_read_b64_tr_b16 a[64:65], v23 offset:24576
    ds_read_b64_tr_b16 a[66:67], v23 offset:28672
    v_mfma_f32_16x16x32_bf16 v[40:43], a[68:71], v[180:183], v[40:43]
    v_exp_f32 v246, v62
    v_mfma_f32_16x16x32_bf16 v[40:43], a[72:75], v[184:187], v[40:43]
    ds_read_b64_tr_b16 a[68:69], v24 offset:24576
    ds_read_b64_tr_b16 a[70:71], v24 offset:28672
    v_mfma_f32_16x16x32_bf16 v[40:43], a[32:35], v[188:191], v[40:43]
    v_cvt_pk_bf16_f32 v94, v244, v245
    v_exp_f32 v247, v63
    v_mfma_f32_16x16x32_bf16 v[36:39], a[36:39], v[160:163], v[64:67]
    ds_read_b64_tr_b16 a[72:73], v25 offset:24576
    ds_read_b64_tr_b16 a[74:75], v25 offset:28672
    v_mfma_f32_16x16x32_bf16 v[36:39], a[40:43], v[164:167], v[36:39]
    v_or3_b32 v14, v88, v89, v90
    v_cvt_pk_bf16_f32 v95, v246, v247
    v_mfma_f32_16x16x32_bf16 v[36:39], a[44:47], v[168:171], v[36:39]
    ds_read_b64_tr_b16 a[32:33], v26 offset:24576
    ds_read_b64_tr_b16 a[34:35], v26 offset:28672
    s_add_u32 m0, s79, 49152
    s_nop 0
    buffer_load_dwordx4 v253, s[56:59], s82 offen offset:1024 lds
    v_mfma_f32_16x16x32_bf16 v[36:39], a[48:51], v[172:175], v[36:39]
    v_or3_b32 v14, v14, v91, v92
    v_or3_b32 v14, v14, v93, v94
    v_mfma_f32_16x16x32_bf16 v[44:47], a[36:39], v[176:179], v[68:71]
    ds_read_b64_tr_b16 a[36:37], v27 offset:24576
    ds_read_b64_tr_b16 a[38:39], v27 offset:28672
    buffer_load_dwordx4 v254, s[56:59], s82 offen offset:2048 lds
    v_mfma_f32_16x16x32_bf16 v[44:47], a[40:43], v[180:183], v[44:47]
    buffer_load_dwordx4 v255, s[56:59], s82 offen offset:3072 lds
    v_mfma_f32_16x16x32_bf16 v[44:47], a[44:47], v[184:187], v[44:47]
    v_bitop3_b32 v14, v14, v95, s72 bitop3:0xa8
    v_cmp_ne_u32 vcc, 0, v14
    v_mfma_f32_16x16x32_bf16 v[44:47], a[48:51], v[188:191], v[44:47]
    s_cbranch_vccnz LB_r1_11
LB_b1_11:
    s_waitcnt vmcnt(17) lgkmcnt(0)
    s_barrier
    v_mfma_f32_16x16x32_bf16 v[96:99], a[52:55], v[88:91], v[96:99]
    ds_read_b128 a[40:43], v16 offset:24576
    ds_read_b128 a[44:47], v17 offset:24576
    ds_read_b128 a[48:51], v18 offset:24576
    s_add_u32 m0, s78, 16384
    s_mov_b32 s9, 131072
    buffer_load_dwordx4 v8, s[44:47], s9 offen nt lds
    v_mfma_f32_16x16x32_bf16 v[100:103], a[52:55], v[92:95], v[100:103]
    ds_read_b128 a[52:55], v19 offset:24576
    v_mfma_f32_16x16x32_bf16 v[104:107], a[56:59], v[88:91], v[104:107]
    buffer_load_dwordx4 v9, s[44:47], s9 offen offset:1024 nt lds
    s_waitcnt vmcnt(18)
    ds_read_b64_tr_b16 a[176:177], v28 offset:49152
    v_mfma_f32_16x16x32_bf16 v[108:111], a[56:59], v[92:95], v[108:111]
    ds_read_b128 a[56:59], v16 offset:28672
    v_exp_f32 v244, v32
    v_mfma_f32_16x16x32_bf16 v[112:115], a[60:63], v[88:91], v[112:115]
    s_add_u32 m0, s78, 90112
    s_mov_b32 s9, 122880
    buffer_load_dwordx4 v10, s[48:51], s9 offen nt lds
    ds_read_b64_tr_b16 a[178:179], v28 offset:51200
    v_mfma_f32_16x16x32_bf16 v[116:119], a[60:63], v[92:95], v[116:119]
    ds_read_b128 a[60:63], v17 offset:28672
    v_exp_f32 v245, v33
    v_mfma_f32_16x16x32_bf16 v[120:123], a[64:67], v[88:91], v[120:123]
    buffer_load_dwordx4 v5, s[48:51], s9 offen offset:1024 nt lds
    ds_read_b64_tr_b16 a[180:181], v29 offset:49152
    ds_read_b64_tr_b16 a[182:183], v29 offset:51200
    v_mfma_f32_16x16x32_bf16 v[124:127], a[64:67], v[92:95], v[124:127]
    ds_read_b128 a[64:67], v18 offset:28672
    v_exp_f32 v246, v34
    v_mfma_f32_16x16x32_bf16 v[128:131], a[68:71], v[88:91], v[128:131]
    ds_read_b64_tr_b16 a[184:185], v30 offset:49152
    ds_read_b64_tr_b16 a[186:187], v30 offset:51200
    v_cvt_pk_bf16_f32 v80, v244, v245
    v_mfma_f32_16x16x32_bf16 v[132:135], a[68:71], v[92:95], v[132:135]
    ds_read_b128 a[68:71], v19 offset:28672
    v_exp_f32 v247, v35
    v_mfma_f32_16x16x32_bf16 v[136:139], a[72:75], v[88:91], v[136:139]
    ds_read_b64_tr_b16 a[188:189], v31 offset:49152
    ds_read_b64_tr_b16 a[190:191], v31 offset:51200
    v_mfma_f32_16x16x32_bf16 v[140:143], a[72:75], v[92:95], v[140:143]
    ds_read_b64_tr_b16 a[72:73], v20 offset:0
    ds_read_b64_tr_b16 a[74:75], v20 offset:4096
    v_mfma_f32_16x16x32_bf16 v[144:147], a[32:35], v[88:91], v[144:147]
    v_exp_f32 v244, v36
    v_cvt_pk_bf16_f32 v81, v246, v247
    v_mfma_f32_16x16x32_bf16 v[148:151], a[32:35], v[92:95], v[148:151]
    ds_read_b64_tr_b16 a[32:33], v21 offset:0
    ds_read_b64_tr_b16 a[34:35], v21 offset:4096
    v_mfma_f32_16x16x32_bf16 v[152:155], a[36:39], v[88:91], v[152:155]
    v_exp_f32 v245, v37
    v_mfma_f32_16x16x32_bf16 v[156:159], a[36:39], v[92:95], v[156:159]
    ds_read_b64_tr_b16 a[36:37], v22 offset:0
    ds_read_b64_tr_b16 a[38:39], v22 offset:4096
    v_mfma_f32_16x16x32_bf16 v[76:79], a[76:79], v[88:91], v[76:79]
    v_exp_f32 v246, v38
    v_cvt_pk_bf16_f32 v82, v244, v245
    v_mfma_f32_16x16x32_bf16 v[240:243], a[76:79], v[92:95], v[240:243]
    v_exp_f32 v247, v39
    s_waitcnt lgkmcnt(8)
    v_mfma_f32_16x16x32_bf16 v[48:51], a[40:43], v[160:163], v[64:67]
    v_exp_f32 v244, v40
    v_cvt_pk_bf16_f32 v83, v246, v247
    v_mfma_f32_16x16x32_bf16 v[48:51], a[44:47], v[164:167], v[48:51]
    v_exp_f32 v245, v41
    v_mfma_f32_16x16x32_bf16 v[48:51], a[48:51], v[168:171], v[48:51]
    v_exp_f32 v246, v42
    v_cvt_pk_bf16_f32 v84, v244, v245
    v_mfma_f32_16x16x32_bf16 v[48:51], a[52:55], v[172:175], v[48:51]
    v_exp_f32 v247, v43
    v_mfma_f32_16x16x32_bf16 v[56:59], a[40:43], v[176:179], v[68:71]
    ds_read_b64_tr_b16 a[40:41], v23 offset:0
    ds_read_b64_tr_b16 a[42:43], v23 offset:4096
    v_exp_f32 v244, v44
    v_mfma_f32_16x16x32_bf16 v[56:59], a[44:47], v[180:183], v[56:59]
    v_cvt_pk_bf16_f32 v85, v246, v247
    v_exp_f32 v245, v45
    v_mfma_f32_16x16x32_bf16 v[56:59], a[48:51], v[184:187], v[56:59]
    ds_read_b64_tr_b16 a[44:45], v24 offset:0
    ds_read_b64_tr_b16 a[46:47], v24 offset:4096
    v_mfma_f32_16x16x32_bf16 v[56:59], a[52:55], v[188:191], v[56:59]
    v_exp_f32 v246, v46
    v_cvt_pk_bf16_f32 v86, v244, v245
    v_mfma_f32_16x16x32_bf16 v[52:55], a[56:59], v[160:163], v[64:67]
    ds_read_b64_tr_b16 a[48:49], v25 offset:0
    ds_read_b64_tr_b16 a[50:51], v25 offset:4096
    v_exp_f32 v247, v47
    v_mfma_f32_16x16x32_bf16 v[52:55], a[60:63], v[164:167], v[52:55]
    v_or3_b32 v14, v80, v81, v82
    v_cvt_pk_bf16_f32 v87, v246, v247
    v_or3_b32 v14, v14, v83, v84
    v_mfma_f32_16x16x32_bf16 v[52:55], a[64:67], v[168:171], v[52:55]
    ds_read_b64_tr_b16 a[52:53], v26 offset:0
    ds_read_b64_tr_b16 a[54:55], v26 offset:4096
    s_add_u32 m0, s79, 98304
    s_add_u32 s82, s81, 139264
    s_and_b32 s82, s82, 0x7ffff
    buffer_load_dwordx4 v252, s[56:59], s82 offen lds
    v_mfma_f32_16x16x32_bf16 v[52:55], a[68:71], v[172:175], v[52:55]
    v_or3_b32 v14, v14, v85, v86
    v_bitop3_b32 v14, v14, v87, s72 bitop3:0xa8
    v_mfma_f32_16x16x32_bf16 v[60:63], a[56:59], v[176:179], v[68:71]
    ds_read_b64_tr_b16 a[56:57], v27 offset:0
    ds_read_b64_tr_b16 a[58:59], v27 offset:4096
    buffer_load_dwordx4 v253, s[56:59], s82 offen offset:1024 lds
    v_mfma_f32_16x16x32_bf16 v[60:63], a[60:63], v[180:183], v[60:63]
    buffer_load_dwordx4 v254, s[56:59], s82 offen offset:2048 lds
    v_mfma_f32_16x16x32_bf16 v[60:63], a[64:67], v[184:187], v[60:63]
    v_cmp_ne_u32 vcc, 0, v14
    v_mfma_f32_16x16x32_bf16 v[60:63], a[68:71], v[188:191], v[60:63]
    s_cbranch_vccnz LB_r1_12
LB_b1_12:
    s_waitcnt vmcnt(17) lgkmcnt(0)
    s_barrier
    v_mfma_f32_16x16x32_bf16 v[96:99], a[72:75], v[80:83], v[96:99]
    ds_read_b128 a[60:63], v16 offset:0
    ds_read_b128 a[64:67], v17 offset:0
    ds_read_b128 a[68:71], v18 offset:0
    s_add_u32 m0, s78, 24576
    s_mov_b32 s9, 139264
    buffer_load_dwordx4 v8, s[44:47], s9 offen nt lds
    v_mfma_f32_16x16x32_bf16 v[100:103], a[72:75], v[84:87], v[100:103]
    ds_read_b128 a[72:75], v19 offset:0
    v_mfma_f32_16x16x32_bf16 v[104:107], a[32:35], v[80:83], v[104:107]
    buffer_load_dwordx4 v9, s[44:47], s9 offen offset:1024 nt lds
    s_waitcnt vmcnt(17)
    v_subrev_u32 v28, 65536, v28
    v_subrev_u32 v29, 65536, v29
    v_subrev_u32 v30, 65536, v30
    v_subrev_u32 v31, 65536, v31
    ds_read_b64_tr_b16 a[192:193], v28 offset:32768
    v_mfma_f32_16x16x32_bf16 v[108:111], a[32:35], v[84:87], v[108:111]
    ds_read_b128 a[32:35], v16 offset:4096
    v_exp_f32 v244, v48
    v_mfma_f32_16x16x32_bf16 v[112:115], a[36:39], v[80:83], v[112:115]
    s_add_u32 m0, s78, 65536
    s_mov_b32 s9, 131072
    buffer_load_dwordx4 v10, s[48:51], s9 offen nt lds
    ds_read_b64_tr_b16 a[194:195], v28 offset:34816
    v_mfma_f32_16x16x32_bf16 v[116:119], a[36:39], v[84:87], v[116:119]
    ds_read_b128 a[36:39], v17 offset:4096
    v_exp_f32 v245, v49
    v_mfma_f32_16x16x32_bf16 v[120:123], a[40:43], v[80:83], v[120:123]
    buffer_load_dwordx4 v5, s[48:51], s9 offen offset:1024 nt lds
    ds_read_b64_tr_b16 a[196:197], v29 offset:32768
    ds_read_b64_tr_b16 a[198:199], v29 offset:34816
    v_mfma_f32_16x16x32_bf16 v[124:127], a[40:43], v[84:87], v[124:127]
    ds_read_b128 a[40:43], v18 offset:4096
    v_exp_f32 v246, v50
    v_mfma_f32_16x16x32_bf16 v[128:131], a[44:47], v[80:83], v[128:131]
    ds_read_b64_tr_b16 a[200:201], v30 offset:32768
    ds_read_b64_tr_b16 a[202:203], v30 offset:34816
    v_cvt_pk_bf16_f32 v88, v244, v245
    v_mfma_f32_16x16x32_bf16 v[132:135], a[44:47], v[84:87], v[132:135]
    ds_read_b128 a[44:47], v19 offset:4096
    v_exp_f32 v247, v51
    v_mfma_f32_16x16x32_bf16 v[136:139], a[48:51], v[80:83], v[136:139]
    ds_read_b64_tr_b16 a[204:205], v31 offset:32768
    ds_read_b64_tr_b16 a[206:207], v31 offset:34816
    v_mfma_f32_16x16x32_bf16 v[140:143], a[48:51], v[84:87], v[140:143]
    ds_read_b64_tr_b16 a[48:49], v20 offset:8192
    ds_read_b64_tr_b16 a[50:51], v20 offset:12288
    v_mfma_f32_16x16x32_bf16 v[144:147], a[52:55], v[80:83], v[144:147]
    v_exp_f32 v244, v52
    v_cvt_pk_bf16_f32 v89, v246, v247
    v_mfma_f32_16x16x32_bf16 v[148:151], a[52:55], v[84:87], v[148:151]
    ds_read_b64_tr_b16 a[52:53], v21 offset:8192
    ds_read_b64_tr_b16 a[54:55], v21 offset:12288
    v_mfma_f32_16x16x32_bf16 v[152:155], a[56:59], v[80:83], v[152:155]
    v_exp_f32 v245, v53
    v_mfma_f32_16x16x32_bf16 v[156:159], a[56:59], v[84:87], v[156:159]
    ds_read_b64_tr_b16 a[56:57], v22 offset:8192
    ds_read_b64_tr_b16 a[58:59], v22 offset:12288
    v_mfma_f32_16x16x32_bf16 v[76:79], a[76:79], v[80:83], v[76:79]
    v_exp_f32 v246, v54
    v_cvt_pk_bf16_f32 v90, v244, v245
    v_mfma_f32_16x16x32_bf16 v[240:243], a[76:79], v[84:87], v[240:243]
    v_exp_f32 v247, v55
    s_waitcnt lgkmcnt(8)
    v_mfma_f32_16x16x32_bf16 v[32:35], a[60:63], v[160:163], v[64:67]
    v_exp_f32 v244, v56
    v_cvt_pk_bf16_f32 v91, v246, v247
    v_mfma_f32_16x16x32_bf16 v[32:35], a[64:67], v[164:167], v[32:35]
    v_exp_f32 v245, v57
    v_mfma_f32_16x16x32_bf16 v[32:35], a[68:71], v[168:171], v[32:35]
    v_exp_f32 v246, v58
    v_cvt_pk_bf16_f32 v92, v244, v245
    v_mfma_f32_16x16x32_bf16 v[32:35], a[72:75], v[172:175], v[32:35]
    v_exp_f32 v247, v59
    v_mfma_f32_16x16x32_bf16 v[40:43], a[60:63], v[176:179], v[68:71]
    ds_read_b64_tr_b16 a[60:61], v23 offset:8192
    ds_read_b64_tr_b16 a[62:63], v23 offset:12288
    v_exp_f32 v244, v60
    v_mfma_f32_16x16x32_bf16 v[40:43], a[64:67], v[180:183], v[40:43]
    v_cvt_pk_bf16_f32 v93, v246, v247
    v_exp_f32 v245, v61
    v_mfma_f32_16x16x32_bf16 v[40:43], a[68:71], v[184:187], v[40:43]
    ds_read_b64_tr_b16 a[64:65], v24 offset:8192
    ds_read_b64_tr_b16 a[66:67], v24 offset:12288
    v_mfma_f32_16x16x32_bf16 v[40:43], a[72:75], v[188:191], v[40:43]
    v_exp_f32 v246, v62
    v_cvt_pk_bf16_f32 v94, v244, v245
    v_mfma_f32_16x16x32_bf16 v[36:39], a[32:35], v[160:163], v[64:67]
    ds_read_b64_tr_b16 a[68:69], v25 offset:8192
    ds_read_b64_tr_b16 a[70:71], v25 offset:12288
    v_exp_f32 v247, v63
    v_mfma_f32_16x16x32_bf16 v[36:39], a[36:39], v[164:167], v[36:39]
    v_or3_b32 v14, v88, v89, v90
    v_cvt_pk_bf16_f32 v95, v246, v247
    v_or3_b32 v14, v14, v91, v92
    v_mfma_f32_16x16x32_bf16 v[36:39], a[40:43], v[168:171], v[36:39]
    ds_read_b64_tr_b16 a[72:73], v26 offset:8192
    ds_read_b64_tr_b16 a[74:75], v26 offset:12288
    s_add_u32 m0, s79, 98304
    s_nop 0
    buffer_load_dwordx4 v255, s[56:59], s82 offen offset:3072 lds
    v_mfma_f32_16x16x32_bf16 v[36:39], a[44:47], v[172:175], v[36:39]
    v_or3_b32 v14, v14, v93, v94
    v_bitop3_b32 v14, v14, v95, s72 bitop3:0xa8
    v_cmp_ne_u32 vcc, 0, v14
    v_mfma_f32_16x16x32_bf16 v[44:47], a[32:35], v[176:179], v[68:71]
    ds_read_b64_tr_b16 a[32:33], v27 offset:8192
    ds_read_b64_tr_b16 a[34:35], v27 offset:12288
    s_add_u32 m0, s79, 114688
    s_add_u32 s82, s81, 163840
    s_and_b32 s82, s82, 0x7ffff
    buffer_load_dwordx4 v252, s[56:59], s82 offen lds
    v_mfma_f32_16x16x32_bf16 v[44:47], a[36:39], v[180:183], v[44:47]
    buffer_load_dwordx4 v253, s[56:59], s82 offen offset:1024 lds
    v_mfma_f32_16x16x32_bf16 v[44:47], a[40:43], v[184:187], v[44:47]
    v_mfma_f32_16x16x32_bf16 v[44:47], a[44:47], v[188:191], v[44:47]
    s_cbranch_vccnz LB_r1_13
LB_b1_13:
    s_waitcnt vmcnt(17) lgkmcnt(0)
    s_barrier
    v_mfma_f32_16x16x32_bf16 v[96:99], a[48:51], v[88:91], v[96:99]
    ds_read_b128 a[36:39], v16 offset:8192
    ds_read_b128 a[40:43], v17 offset:8192
    ds_read_b128 a[44:47], v18 offset:8192
    s_add_u32 m0, s78, 0
    s_mov_b32 s9, 147456
    buffer_load_dwordx4 v8, s[44:47], s9 offen nt lds
    v_mfma_f32_16x16x32_bf16 v[100:103], a[48:51], v[92:95], v[100:103]
    ds_read_b128 a[48:51], v19 offset:8192
    v_mfma_f32_16x16x32_bf16 v[104:107], a[52:55], v[88:91], v[104:107]
    buffer_load_dwordx4 v9, s[44:47], s9 offen offset:1024 nt lds
    s_waitcnt vmcnt(16)
    ds_read_b64_tr_b16 a[208:209], v28 offset:49152
    v_mfma_f32_16x16x32_bf16 v[108:111], a[52:55], v[92:95], v[108:111]
    ds_read_b128 a[52:55], v16 offset:12288
    v_exp_f32 v244, v32
    v_mfma_f32_16x16x32_bf16 v[112:115], a[56:59], v[88:91], v[112:115]
    s_add_u32 m0, s78, 73728
    s_mov_b32 s9, 139264
    buffer_load_dwordx4 v10, s[48:51], s9 offen nt lds
    ds_read_b64_tr_b16 a[210:211], v28 offset:51200
    v_mfma_f32_16x16x32_bf16 v[116:119], a[56:59], v[92:95], v[116:119]
    ds_read_b128 a[56:59], v17 offset:12288
    v_exp_f32 v245, v33
    v_mfma_f32_16x16x32_bf16 v[120:123], a[60:63], v[88:91], v[120:123]
    buffer_load_dwordx4 v5, s[48:51], s9 offen offset:1024 nt lds
    ds_read_b64_tr_b16 a[212:213], v29 offset:49152
    ds_read_b64_tr_b16 a[214:215], v29 offset:51200
    v_mfma_f32_16x16x32_bf16 v[124:127], a[60:63], v[92:95], v[124:127]
    ds_read_b128 a[60:63], v18 offset:12288
    v_exp_f32 v246, v34
    v_mfma_f32_16x16x32_bf16 v[128:131], a[64:67], v[88:91], v[128:131]
    ds_read_b64_tr_b16 a[216:217], v30 offset:49152
    ds_read_b64_tr_b16 a[218:219], v30 offset:51200
    v_cvt_pk_bf16_f32 v80, v244, v245
    v_mfma_f32_16x16x32_bf16 v[132:135], a[64:67], v[92:95], v[132:135]
    ds_read_b128 a[64:67], v19 offset:12288
    v_exp_f32 v247, v35
    v_mfma_f32_16x16x32_bf16 v[136:139], a[68:71], v[88:91], v[136:139]
    ds_read_b64_tr_b16 a[220:221], v31 offset:49152
    ds_read_b64_tr_b16 a[222:223], v31 offset:51200
    v_mfma_f32_16x16x32_bf16 v[140:143], a[68:71], v[92:95], v[140:143]
    ds_read_b64_tr_b16 a[68:69], v20 offset:16384
    ds_read_b64_tr_b16 a[70:71], v20 offset:20480
    v_mfma_f32_16x16x32_bf16 v[144:147], a[72:75], v[88:91], v[144:147]
    v_exp_f32 v244, v36
    v_cvt_pk_bf16_f32 v81, v246, v247
    v_mfma_f32_16x16x32_bf16 v[148:151], a[72:75], v[92:95], v[148:151]
    ds_read_b64_tr_b16 a[72:73], v21 offset:16384
    ds_read_b64_tr_b16 a[74:75], v21 offset:20480
    v_mfma_f32_16x16x32_bf16 v[152:155], a[32:35], v[88:91], v[152:155]
    v_exp_f32 v245, v37
    v_mfma_f32_16x16x32_bf16 v[156:159], a[32:35], v[92:95], v[156:159]
    ds_read_b64_tr_b16 a[32:33], v22 offset:16384
    ds_read_b64_tr_b16 a[34:35], v22 offset:20480
    v_mfma_f32_16x16x32_bf16 v[76:79], a[76:79], v[88:91], v[76:79]
    v_exp_f32 v246, v38
    v_cvt_pk_bf16_f32 v82, v244, v245
    v_mfma_f32_16x16x32_bf16 v[240:243], a[76:79], v[92:95], v[240:243]
    v_exp_f32 v247, v39
    s_waitcnt lgkmcnt(8)
    v_mfma_f32_16x16x32_bf16 v[48:51], a[36:39], v[160:163], v[64:67]
    v_exp_f32 v244, v40
    v_cvt_pk_bf16_f32 v83, v246, v247
    v_mfma_f32_16x16x32_bf16 v[48:51], a[40:43], v[164:167], v[48:51]
    v_exp_f32 v245, v41
    v_mfma_f32_16x16x32_bf16 v[48:51], a[44:47], v[168:171], v[48:51]
    v_exp_f32 v246, v42
    v_cvt_pk_bf16_f32 v84, v244, v245
    v_mfma_f32_16x16x32_bf16 v[48:51], a[48:51], v[172:175], v[48:51]
    v_exp_f32 v247, v43
    v_mfma_f32_16x16x32_bf16 v[56:59], a[36:39], v[176:179], v[68:71]
    ds_read_b64_tr_b16 a[36:37], v23 offset:16384
    ds_read_b64_tr_b16 a[38:39], v23 offset:20480
    v_exp_f32 v244, v44
    v_mfma_f32_16x16x32_bf16 v[56:59], a[40:43], v[180:183], v[56:59]
    v_cvt_pk_bf16_f32 v85, v246, v247
    v_exp_f32 v245, v45
    v_mfma_f32_16x16x32_bf16 v[56:59], a[44:47], v[184:187], v[56:59]
    ds_read_b64_tr_b16 a[40:41], v24 offset:16384
    ds_read_b64_tr_b16 a[42:43], v24 offset:20480
    v_mfma_f32_16x16x32_bf16 v[56:59], a[48:51], v[188:191], v[56:59]
    v_exp_f32 v246, v46
    v_cvt_pk_bf16_f32 v86, v244, v245
    v_mfma_f32_16x16x32_bf16 v[52:55], a[52:55], v[160:163], v[64:67]
    ds_read_b64_tr_b16 a[44:45], v25 offset:16384
    ds_read_b64_tr_b16 a[46:47], v25 offset:20480
    v_exp_f32 v247, v47
    v_mfma_f32_16x16x32_bf16 v[52:55], a[56:59], v[164:167], v[52:55]
    v_or3_b32 v14, v80, v81, v82
    v_cvt_pk_bf16_f32 v87, v246, v247
    v_or3_b32 v14, v14, v83, v84
    v_mfma_f32_16x16x32_bf16 v[52:55], a[60:63], v[168:171], v[52:55]
    ds_read_b64_tr_b16 a[48:49], v26 offset:16384
    ds_read_b64_tr_b16 a[50:51], v26 offset:20480
    s_add_u32 m0, s79, 114688
    s_nop 0
    buffer_load_dwordx4 v254, s[56:59], s82 offen offset:2048 lds
    v_mfma_f32_16x16x32_bf16 v[52:55], a[64:67], v[172:175], v[52:55]
    v_or3_b32 v14, v14, v85, v86
    v_bitop3_b32 v14, v14, v87, s72 bitop3:0xa8
    v_cmp_ne_u32 vcc, 0, v14
    v_mfma_f32_16x16x32_bf16 v[60:63], a[52:55], v[176:179], v[68:71]
    ds_read_b64_tr_b16 a[52:53], v27 offset:16384
    ds_read_b64_tr_b16 a[54:55], v27 offset:20480
    buffer_load_dwordx4 v255, s[56:59], s82 offen offset:3072 lds
    v_mfma_f32_16x16x32_bf16 v[60:63], a[56:59], v[180:183], v[60:63]
    s_add_u32 m0, s79, 32768
    s_add_u32 s82, s81, 172032
    s_and_b32 s82, s82, 0x7ffff
    buffer_load_dwordx4 v252, s[56:59], s82 offen lds
    v_mfma_f32_16x16x32_bf16 v[60:63], a[60:63], v[184:187], v[60:63]
    v_mfma_f32_16x16x32_bf16 v[60:63], a[64:67], v[188:191], v[60:63]
    s_cbranch_vccnz LB_r1_14
LB_b1_14:
    s_waitcnt vmcnt(17) lgkmcnt(0)
    s_barrier
    v_mfma_f32_16x16x32_bf16 v[96:99], a[68:71], v[80:83], v[96:99]
    ds_read_b128 a[56:59], v16 offset:16384
    ds_read_b128 a[60:63], v17 offset:16384
    ds_read_b128 a[64:67], v18 offset:16384
    s_add_u32 m0, s78, 8192
    s_mov_b32 s9, 155648
    buffer_load_dwordx4 v8, s[44:47], s9 offen nt lds
    v_mfma_f32_16x16x32_bf16 v[100:103], a[68:71], v[84:87], v[100:103]
    ds_read_b128 a[68:71], v19 offset:16384
    v_mfma_f32_16x16x32_bf16 v[104:107], a[72:75], v[80:83], v[104:107]
    buffer_load_dwordx4 v9, s[44:47], s9 offen offset:1024 nt lds
    v_exp_f32 v244, v48
    v_mfma_f32_16x16x32_bf16 v[108:111], a[72:75], v[84:87], v[108:111]
    ds_read_b128 a[72:75], v16 offset:20480
    v_exp_f32 v245, v49
    v_mfma_f32_16x16x32_bf16 v[112:115], a[32:35], v[80:83], v[112:115]
    s_add_u32 m0, s79, 32768
    s_nop 0
    buffer_load_dwordx4 v253, s[56:59], s82 offen offset:1024 lds
    v_mfma_f32_16x16x32_bf16 v[116:119], a[32:35], v[84:87], v[116:119]
    ds_read_b128 a[32:35], v17 offset:20480
    v_exp_f32 v246, v50
    v_mfma_f32_16x16x32_bf16 v[120:123], a[36:39], v[80:83], v[120:123]
    buffer_load_dwordx4 v254, s[56:59], s82 offen offset:2048 lds
    v_cvt_pk_bf16_f32 v88, v244, v245
    v_mfma_f32_16x16x32_bf16 v[124:127], a[36:39], v[84:87], v[124:127]
    ds_read_b128 a[36:39], v18 offset:20480
    v_exp_f32 v247, v51
    v_mfma_f32_16x16x32_bf16 v[128:131], a[40:43], v[80:83], v[128:131]
    v_exp_f32 v244, v52
    v_mfma_f32_16x16x32_bf16 v[132:135], a[40:43], v[84:87], v[132:135]
    ds_read_b128 a[40:43], v19 offset:20480
    v_cvt_pk_bf16_f32 v89, v246, v247
    v_mfma_f32_16x16x32_bf16 v[136:139], a[44:47], v[80:83], v[136:139]
    v_exp_f32 v245, v53
    v_mfma_f32_16x16x32_bf16 v[140:143], a[44:47], v[84:87], v[140:143]
    ds_read_b64_tr_b16 a[44:45], v20 offset:24576
    ds_read_b64_tr_b16 a[46:47], v20 offset:28672
    v_mfma_f32_16x16x32_bf16 v[144:147], a[48:51], v[80:83], v[144:147]
    v_exp_f32 v246, v54
    v_mfma_f32_16x16x32_bf16 v[148:151], a[48:51], v[84:87], v[148:151]
    ds_read_b64_tr_b16 a[48:49], v21 offset:24576
    ds_read_b64_tr_b16 a[50:51], v21 offset:28672
    v_mfma_f32_16x16x32_bf16 v[152:155], a[52:55], v[80:83], v[152:155]
    v_cvt_pk_bf16_f32 v90, v244, v245
    v_exp_f32 v247, v55
    v_mfma_f32_16x16x32_bf16 v[156:159], a[52:55], v[84:87], v[156:159]
    ds_read_b64_tr_b16 a[52:53], v22 offset:24576
    ds_read_b64_tr_b16 a[54:55], v22 offset:28672
    v_mfma_f32_16x16x32_bf16 v[76:79], a[76:79], v[80:83], v[76:79]
    v_exp_f32 v244, v56
    v_mfma_f32_16x16x32_bf16 v[240:243], a[76:79], v[84:87], v[240:243]
    v_cvt_pk_bf16_f32 v91, v246, v247
    v_exp_f32 v245, v57
    s_waitcnt lgkmcnt(6)
    v_mfma_f32_16x16x32_bf16 v[32:35], a[56:59], v[160:163], v[64:67]
    v_exp_f32 v246, v58
    v_mfma_f32_16x16x32_bf16 v[32:35], a[60:63], v[164:167], v[32:35]
    v_cvt_pk_bf16_f32 v92, v244, v245
    v_exp_f32 v247, v59
    v_mfma_f32_16x16x32_bf16 v[32:35], a[64:67], v[168:171], v[32:35]
    v_exp_f32 v244, v60
    v_mfma_f32_16x16x32_bf16 v[32:35], a[68:71], v[172:175], v[32:35]
    v_cvt_pk_bf16_f32 v93, v246, v247
    v_exp_f32 v245, v61
    v_mfma_f32_16x16x32_bf16 v[40:43], a[56:59], v[176:179], v[68:71]
    ds_read_b64_tr_b16 a[56:57], v23 offset:24576
    ds_read_b64_tr_b16 a[58:59], v23 offset:28672
    v_mfma_f32_16x16x32_bf16 v[40:43], a[60:63], v[180:183], v[40:43]
    v_exp_f32 v246, v62
    v_mfma_f32_16x16x32_bf16 v[40:43], a[64:67], v[184:187], v[40:43]
    ds_read_b64_tr_b16 a[60:61], v24 offset:24576
    ds_read_b64_tr_b16 a[62:63], v24 offset:28672
    v_mfma_f32_16x16x32_bf16 v[40:43], a[68:71], v[188:191], v[40:43]
    v_cvt_pk_bf16_f32 v94, v244, v245
    v_exp_f32 v247, v63
    v_mfma_f32_16x16x32_bf16 v[36:39], a[72:75], v[160:163], v[64:67]
    ds_read_b64_tr_b16 a[64:65], v25 offset:24576
    ds_read_b64_tr_b16 a[66:67], v25 offset:28672
    v_mfma_f32_16x16x32_bf16 v[36:39], a[32:35], v[164:167], v[36:39]
    v_or3_b32 v14, v88, v89, v90
    v_cvt_pk_bf16_f32 v95, v246, v247
    v_mfma_f32_16x16x32_bf16 v[36:39], a[36:39], v[168:171], v[36:39]
    ds_read_b64_tr_b16 a[68:69], v26 offset:24576
    ds_read_b64_tr_b16 a[70:71], v26 offset:28672
    v_mfma_f32_16x16x32_bf16 v[36:39], a[40:43], v[172:175], v[36:39]
    v_or3_b32 v14, v14, v91, v92
    v_or3_b32 v14, v14, v93, v94
    v_mfma_f32_16x16x32_bf16 v[44:47], a[72:75], v[176:179], v[68:71]
    ds_read_b64_tr_b16 a[72:73], v27 offset:24576
    ds_read_b64_tr_b16 a[74:75], v27 offset:28672
    buffer_load_dwordx4 v255, s[56:59], s82 offen offset:3072 lds
    v_mfma_f32_16x16x32_bf16 v[44:47], a[32:35], v[180:183], v[44:47]
    v_bitop3_b32 v14, v14, v95, s72 bitop3:0xa8
    v_mfma_f32_16x16x32_bf16 v[44:47], a[36:39], v[184:187], v[44:47]
    v_cmp_ne_u32 vcc, 0, v14
    v_mfma_f32_16x16x32_bf16 v[44:47], a[40:43], v[188:191], v[44:47]
    s_cbranch_vccnz LB_r1_15
LB_b1_15:
    s_waitcnt vmcnt(15) lgkmcnt(0)
    s_barrier
    v_mfma_f32_16x16x32_bf16 v[96:99], a[44:47], v[88:91], v[96:99]
    ds_read_b128 a[32:35], v16 offset:24576
    ds_read_b128 a[36:39], v17 offset:24576
    ds_read_b128 a[40:43], v18 offset:24576
    s_add_u32 m0, s78, 81920
    s_mov_b32 s9, 147456
    buffer_load_dwordx4 v10, s[48:51], s9 offen nt lds
    v_mfma_f32_16x16x32_bf16 v[100:103], a[44:47], v[92:95], v[100:103]
    ds_read_b128 a[44:47], v19 offset:24576
    v_mfma_f32_16x16x32_bf16 v[104:107], a[48:51], v[88:91], v[104:107]
    buffer_load_dwordx4 v5, s[48:51], s9 offen offset:1024 nt lds
    s_waitcnt vmcnt(16)
    v_add_u32 v28, 65536, v28
    v_add_u32 v29, 65536, v29
    v_add_u32 v30, 65536, v30
    v_add_u32 v31, 65536, v31
    ds_read_b64_tr_b16 a[224:225], v28 offset:32768
    v_mfma_f32_16x16x32_bf16 v[108:111], a[48:51], v[92:95], v[108:111]
    ds_read_b128 a[48:51], v16 offset:28672
    v_exp_f32 v244, v32
    v_mfma_f32_16x16x32_bf16 v[112:115], a[52:55], v[88:91], v[112:115]
    s_add_u32 m0, s78, 16384
    s_mov_b32 s9, 163840
    buffer_load_dwordx4 v8, s[44:47], s9 offen nt lds
    ds_read_b64_tr_b16 a[226:227], v28 offset:34816
    v_mfma_f32_16x16x32_bf16 v[116:119], a[52:55], v[92:95], v[116:119]
    ds_read_b128 a[52:55], v17 offset:28672
    v_exp_f32 v245, v33
    v_mfma_f32_16x16x32_bf16 v[120:123], a[56:59], v[88:91], v[120:123]
    buffer_load_dwordx4 v9, s[44:47], s9 offen offset:1024 nt lds
    ds_read_b64_tr_b16 a[228:229], v29 offset:32768
    ds_read_b64_tr_b16 a[230:231], v29 offset:34816
    v_mfma_f32_16x16x32_bf16 v[124:127], a[56:59], v[92:95], v[124:127]
    ds_read_b128 a[56:59], v18 offset:28672
    v_exp_f32 v246, v34
    v_mfma_f32_16x16x32_bf16 v[128:131], a[60:63], v[88:91], v[128:131]
    ds_read_b64_tr_b16 a[232:233], v30 offset:32768
    ds_read_b64_tr_b16 a[234:235], v30 offset:34816
    v_cvt_pk_bf16_f32 v80, v244, v245
    v_mfma_f32_16x16x32_bf16 v[132:135], a[60:63], v[92:95], v[132:135]
    ds_read_b128 a[60:63], v19 offset:28672
    v_exp_f32 v247, v35
    v_mfma_f32_16x16x32_bf16 v[136:139], a[64:67], v[88:91], v[136:139]
    ds_read_b64_tr_b16 a[236:237], v31 offset:32768
    ds_read_b64_tr_b16 a[238:239], v31 offset:34816
    v_mfma_f32_16x16x32_bf16 v[140:143], a[64:67], v[92:95], v[140:143]
    ds_read_b64_tr_b16 a[64:65], v20 offset:0
    ds_read_b64_tr_b16 a[66:67], v20 offset:4096
    v_mfma_f32_16x16x32_bf16 v[144:147], a[68:71], v[88:91], v[144:147]
    v_exp_f32 v244, v36
    v_cvt_pk_bf16_f32 v81, v246, v247
    v_mfma_f32_16x16x32_bf16 v[148:151], a[68:71], v[92:95], v[148:151]
    ds_read_b64_tr_b16 a[68:69], v21 offset:0
    ds_read_b64_tr_b16 a[70:71], v21 offset:4096
    v_mfma_f32_16x16x32_bf16 v[152:155], a[72:75], v[88:91], v[152:155]
    v_exp_f32 v245, v37
    v_mfma_f32_16x16x32_bf16 v[156:159], a[72:75], v[92:95], v[156:159]
    ds_read_b64_tr_b16 a[72:73], v22 offset:0
    ds_read_b64_tr_b16 a[74:75], v22 offset:4096
    v_mfma_f32_16x16x32_bf16 v[76:79], a[76:79], v[88:91], v[76:79]
    v_exp_f32 v246, v38
    v_cvt_pk_bf16_f32 v82, v244, v245
    v_mfma_f32_16x16x32_bf16 v[240:243], a[76:79], v[92:95], v[240:243]
    v_exp_f32 v247, v39
    s_waitcnt lgkmcnt(8)
    v_mfma_f32_16x16x32_bf16 v[48:51], a[32:35], v[160:163], v[64:67]
    v_exp_f32 v244, v40
    v_cvt_pk_bf16_f32 v83, v246, v247
    v_mfma_f32_16x16x32_bf16 v[48:51], a[36:39], v[164:167], v[48:51]
    v_exp_f32 v245, v41
    v_mfma_f32_16x16x32_bf16 v[48:51], a[40:43], v[168:171], v[48:51]
    v_exp_f32 v246, v42
    v_cvt_pk_bf16_f32 v84, v244, v245
    v_mfma_f32_16x16x32_bf16 v[48:51], a[44:47], v[172:175], v[48:51]
    v_exp_f32 v247, v43
    v_mfma_f32_16x16x32_bf16 v[56:59], a[32:35], v[176:179], v[68:71]
    ds_read_b64_tr_b16 a[32:33], v23 offset:0
    ds_read_b64_tr_b16 a[34:35], v23 offset:4096
    v_mfma_f32_16x16x32_bf16 v[56:59], a[36:39], v[180:183], v[56:59]
    v_exp_f32 v244, v44
    v_cvt_pk_bf16_f32 v85, v246, v247
    v_mfma_f32_16x16x32_bf16 v[56:59], a[40:43], v[184:187], v[56:59]
    ds_read_b64_tr_b16 a[36:37], v24 offset:0
    ds_read_b64_tr_b16 a[38:39], v24 offset:4096
    v_mfma_f32_16x16x32_bf16 v[56:59], a[44:47], v[188:191], v[56:59]
    v_exp_f32 v245, v45
    v_exp_f32 v246, v46
    v_mfma_f32_16x16x32_bf16 v[52:55], a[48:51], v[160:163], v[64:67]
    ds_read_b64_tr_b16 a[40:41], v25 offset:0
    ds_read_b64_tr_b16 a[42:43], v25 offset:4096
    v_cvt_pk_bf16_f32 v86, v244, v245
    v_mfma_f32_16x16x32_bf16 v[52:55], a[52:55], v[164:167], v[52:55]
    v_exp_f32 v247, v47
    v_or3_b32 v14, v80, v81, v82
    v_mfma_f32_16x16x32_bf16 v[52:55], a[56:59], v[168:171], v[52:55]
    ds_read_b64_tr_b16 a[44:45], v26 offset:0
    ds_read_b64_tr_b16 a[46:47], v26 offset:4096
    v_cvt_pk_bf16_f32 v87, v246, v247
    v_mfma_f32_16x16x32_bf16 v[52:55], a[60:63], v[172:175], v[52:55]
    v_or3_b32 v14, v14, v83, v84
    v_or3_b32 v14, v14, v85, v86
    v_bitop3_b32 v14, v14, v87, s72 bitop3:0xa8
    v_mfma_f32_16x16x32_bf16 v[60:63], a[48:51], v[176:179], v[68:71]
    ds_read_b64_tr_b16 a[48:49], v27 offset:0
    ds_read_b64_tr_b16 a[50:51], v27 offset:4096
    s_add_u32 m0, s79, 49152
    s_add_u32 s82, s81, 196608
    s_and_b32 s82, s82, 0x7ffff
    buffer_load_dwordx4 v252, s[56:59], s82 offen lds
    v_mfma_f32_16x16x32_bf16 v[60:63], a[52:55], v[180:183], v[60:63]
    buffer_load_dwordx4 v253, s[56:59], s82 offen offset:1024 lds
    v_mfma_f32_16x16x32_bf16 v[60:63], a[56:59], v[184:187], v[60:63]
    v_cmp_ne_u32 vcc, 0, v14
    v_mfma_f32_16x16x32_bf16 v[60:63], a[60:63], v[188:191], v[60:63]
    s_cbranch_vccnz LB_r1_16
LB_b1_16:
    s_waitcnt vmcnt(14) lgkmcnt(0)
    s_barrier
    v_mfma_f32_16x16x32_bf16 v[96:99], a[64:67], v[80:83], v[96:99]
    ds_read_b128 a[52:55], v16 offset:0
    ds_read_b128 a[56:59], v17 offset:0
    ds_read_b128 a[60:63], v18 offset:0
    s_add_u32 m0, s78, 65536
    s_mov_b32 s9, 155648
    buffer_load_dwordx4 v10, s[48:51], s9 offen nt lds
    v_mfma_f32_16x16x32_bf16 v[100:103], a[64:67], v[84:87], v[100:103]
    ds_read_b128 a[64:67], v19 offset:0
    v_mfma_f32_16x16x32_bf16 v[104:107], a[68:71], v[80:83], v[104:107]
    buffer_load_dwordx4 v5, s[48:51], s9 offen offset:1024 nt lds
    s_waitcnt vmcnt(14)
    ds_read_b64_tr_b16 a[240:241], v28 offset:49152
    v_mfma_f32_16x16x32_bf16 v[108:111], a[68:71], v[84:87], v[108:111]
    ds_read_b128 a[68:71], v16 offset:4096
    v_exp_f32 v244, v48
    v_mfma_f32_16x16x32_bf16 v[112:115], a[72:75], v[80:83], v[112:115]
    s_add_u32 m0, s78, 24576
    s_mov_b32 s9, 172032
    buffer_load_dwordx4 v8, s[44:47], s9 offen nt lds
    ds_read_b64_tr_b16 a[242:243], v28 offset:51200
    v_mfma_f32_16x16x32_bf16 v[116:119], a[72:75], v[84:87], v[116:119]
    ds_read_b128 a[72:75], v17 offset:4096
    v_exp_f32 v245, v49
    v_mfma_f32_16x16x32_bf16 v[120:123], a[32:35], v[80:83], v[120:123]
    buffer_load_dwordx4 v9, s[44:47], s9 offen offset:1024 nt lds
    ds_read_b64_tr_b16 a[244:245], v29 offset:49152
    ds_read_b64_tr_b16 a[246:247], v29 offset:51200
    v_mfma_f32_16x16x32_bf16 v[124:127], a[32:35], v[84:87], v[124:127]
    ds_read_b128 a[32:35], v18 offset:4096
    v_exp_f32 v246, v50
    v_mfma_f32_16x16x32_bf16 v[128:131], a[36:39], v[80:83], v[128:131]
    ds_read_b64_tr_b16 a[248:249], v30 offset:49152
    ds_read_b64_tr_b16 a[250:251], v30 offset:51200
    v_cvt_pk_bf16_f32 v88, v244, v245
    v_mfma_f32_16x16x32_bf16 v[132:135], a[36:39], v[84:87], v[132:135]
    ds_read_b128 a[36:39], v19 offset:4096
    v_exp_f32 v247, v51
    v_mfma_f32_16x16x32_bf16 v[136:139], a[40:43], v[80:83], v[136:139]
    ds_read_b64_tr_b16 a[252:253], v31 offset:49152
    ds_read_b64_tr_b16 a[254:255], v31 offset:51200
    v_mfma_f32_16x16x32_bf16 v[140:143], a[40:43], v[84:87], v[140:143]
    ds_read_b64_tr_b16 a[40:41], v20 offset:8192
    ds_read_b64_tr_b16 a[42:43], v20 offset:12288
    v_mfma_f32_16x16x32_bf16 v[144:147], a[44:47], v[80:83], v[144:147]
    v_exp_f32 v244, v52
    v_cvt_pk_bf16_f32 v89, v246, v247
    v_mfma_f32_16x16x32_bf16 v[148:151], a[44:47], v[84:87], v[148:151]
    ds_read_b64_tr_b16 a[44:45], v21 offset:8192
    ds_read_b64_tr_b16 a[46:47], v21 offset:12288
    v_mfma_f32_16x16x32_bf16 v[152:155], a[48:51], v[80:83], v[152:155]
    v_exp_f32 v245, v53
    v_mfma_f32_16x16x32_bf16 v[156:159], a[48:51], v[84:87], v[156:159]
    ds_read_b64_tr_b16 a[48:49], v22 offset:8192
    ds_read_b64_tr_b16 a[50:51], v22 offset:12288
    v_mfma_f32_16x16x32_bf16 v[76:79], a[76:79], v[80:83], v[76:79]
    v_exp_f32 v246, v54
    v_cvt_pk_bf16_f32 v90, v244, v245
    v_mfma_f32_16x16x32_bf16 v[240:243], a[76:79], v[84:87], v[240:243]
    v_exp_f32 v247, v55
    s_waitcnt lgkmcnt(8)
    v_mfma_f32_16x16x32_bf16 v[32:35], a[52:55], v[160:163], v[64:67]
    v_exp_f32 v244, v56
    v_cvt_pk_bf16_f32 v91, v246, v247
    v_mfma_f32_16x16x32_bf16 v[32:35], a[56:59], v[164:167], v[32:35]
    v_exp_f32 v245, v57
    v_mfma_f32_16x16x32_bf16 v[32:35], a[60:63], v[168:171], v[32:35]
    v_exp_f32 v246, v58
    v_cvt_pk_bf16_f32 v92, v244, v245
    v_mfma_f32_16x16x32_bf16 v[32:35], a[64:67], v[172:175], v[32:35]
    v_exp_f32 v247, v59
    v_mfma_f32_16x16x32_bf16 v[40:43], a[52:55], v[176:179], v[68:71]
    ds_read_b64_tr_b16 a[52:53], v23 offset:8192
    ds_read_b64_tr_b16 a[54:55], v23 offset:12288
    v_mfma_f32_16x16x32_bf16 v[40:43], a[56:59], v[180:183], v[40:43]
    v_exp_f32 v244, v60
    v_cvt_pk_bf16_f32 v93, v246, v247
    v_mfma_f32_16x16x32_bf16 v[40:43], a[60:63], v[184:187], v[40:43]
    ds_read_b64_tr_b16 a[56:57], v24 offset:8192
    ds_read_b64_tr_b16 a[58:59], v24 offset:12288
    v_mfma_f32_16x16x32_bf16 v[40:43], a[64:67], v[188:191], v[40:43]
    v_exp_f32 v245, v61
    v_mfma_f32_16x16x32_bf16 v[36:39], a[68:71], v[160:163], v[64:67]
    ds_read_b64_tr_b16 a[60:61], v25 offset:8192
    ds_read_b64_tr_b16 a[62:63], v25 offset:12288
    v_mfma_f32_16x16x32_bf16 v[36:39], a[72:75], v[164:167], v[36:39]
    v_exp_f32 v246, v62
    v_cvt_pk_bf16_f32 v94, v244, v245
    v_mfma_f32_16x16x32_bf16 v[36:39], a[32:35], v[168:171], v[36:39]
    ds_read_b64_tr_b16 a[64:65], v26 offset:8192
    ds_read_b64_tr_b16 a[66:67], v26 offset:12288
    v_exp_f32 v247, v63
    v_mfma_f32_16x16x32_bf16 v[36:39], a[36:39], v[172:175], v[36:39]
    v_or3_b32 v14, v88, v89, v90
    v_cvt_pk_bf16_f32 v95, v246, v247
    v_or3_b32 v14, v14, v91, v92
    v_mfma_f32_16x16x32_bf16 v[44:47], a[68:71], v[176:179], v[68:71]
    ds_read_b64_tr_b16 a[68:69], v27 offset:8192
    ds_read_b64_tr_b16 a[70:71], v27 offset:12288
    s_add_u32 m0, s79, 49152
    s_nop 0
    buffer_load_dwordx4 v254, s[56:59], s82 offen offset:2048 lds
    v_mfma_f32_16x16x32_bf16 v[44:47], a[72:75], v[180:183], v[44:47]
    buffer_load_dwordx4 v255, s[56:59], s82 offen offset:3072 lds
    v_or3_b32 v14, v14, v93, v94
    v_mfma_f32_16x16x32_bf16 v[44:47], a[32:35], v[184:187], v[44:47]
    v_bitop3_b32 v14, v14, v95, s72 bitop3:0xa8
    v_cmp_ne_u32 vcc, 0, v14
    v_mfma_f32_16x16x32_bf16 v[44:47], a[36:39], v[188:191], v[44:47]
    s_cbranch_vccnz LB_r1_17
LB_b1_17:
    s_waitcnt vmcnt(10) lgkmcnt(0)
    s_barrier
    v_mfma_f32_16x16x32_bf16 v[96:99], a[40:43], v[88:91], v[96:99]
    ds_read_b128 a[72:75], v16 offset:8192
    ds_read_b128 a[32:35], v17 offset:8192
    ds_read_b128 a[36:39], v18 offset:8192
    s_add_u32 m0, s78, 73728
    s_mov_b32 s9, 163840
    buffer_load_dwordx4 v10, s[48:51], s9 offen nt lds
    v_mfma_f32_16x16x32_bf16 v[100:103], a[40:43], v[92:95], v[100:103]
    ds_read_b128 a[40:43], v19 offset:8192
    v_mfma_f32_16x16x32_bf16 v[104:107], a[44:47], v[88:91], v[104:107]
    buffer_load_dwordx4 v5, s[48:51], s9 offen offset:1024 nt lds
    v_subrev_u32 v28, 65536, v28
    v_subrev_u32 v29, 65536, v29
    v_subrev_u32 v30, 65536, v30
    v_subrev_u32 v31, 65536, v31
    ds_read_b64_tr_b16 a[0:1], v28 offset:32768
    v_mfma_f32_16x16x32_bf16 v[108:111], a[44:47], v[92:95], v[108:111]
    ds_read_b128 a[44:47], v16 offset:12288
    v_exp_f32 v244, v32
    v_mfma_f32_16x16x32_bf16 v[112:115], a[48:51], v[88:91], v[112:115]
    s_add_u32 m0, s78, 0
    s_mov_b32 s9, 180224
    buffer_load_dwordx4 v8, s[44:47], s9 offen nt lds
    ds_read_b64_tr_b16 a[2:3], v28 offset:34816
    v_mfma_f32_16x16x32_bf16 v[116:119], a[48:51], v[92:95], v[116:119]
    ds_read_b128 a[48:51], v17 offset:12288
    v_exp_f32 v245, v33
    v_mfma_f32_16x16x32_bf16 v[120:123], a[52:55], v[88:91], v[120:123]
    buffer_load_dwordx4 v9, s[44:47], s9 offen offset:1024 nt lds
    ds_read_b64_tr_b16 a[4:5], v29 offset:32768
    ds_read_b64_tr_b16 a[6:7], v29 offset:34816
    v_mfma_f32_16x16x32_bf16 v[124:127], a[52:55], v[92:95], v[124:127]
    ds_read_b128 a[52:55], v18 offset:12288
    v_exp_f32 v246, v34
    v_mfma_f32_16x16x32_bf16 v[128:131], a[56:59], v[88:91], v[128:131]
    ds_read_b64_tr_b16 a[8:9], v30 offset:32768
    ds_read_b64_tr_b16 a[10:11], v30 offset:34816
    v_cvt_pk_bf16_f32 v80, v244, v245
    v_mfma_f32_16x16x32_bf16 v[132:135], a[56:59], v[92:95], v[132:135]
    ds_read_b128 a[56:59], v19 offset:12288
    v_exp_f32 v247, v35
    v_mfma_f32_16x16x32_bf16 v[136:139], a[60:63], v[88:91], v[136:139]
    ds_read_b64_tr_b16 a[12:13], v31 offset:32768
    ds_read_b64_tr_b16 a[14:15], v31 offset:34816
    v_mfma_f32_16x16x32_bf16 v[140:143], a[60:63], v[92:95], v[140:143]
    ds_read_b64_tr_b16 a[60:61], v20 offset:16384
    ds_read_b64_tr_b16 a[62:63], v20 offset:20480
    v_mfma_f32_16x16x32_bf16 v[144:147], a[64:67], v[88:91], v[144:147]
    v_exp_f32 v244, v36
    v_cvt_pk_bf16_f32 v81, v246, v247
    v_mfma_f32_16x16x32_bf16 v[148:151], a[64:67], v[92:95], v[148:151]
    ds_read_b64_tr_b16 a[64:65], v21 offset:16384
    ds_read_b64_tr_b16 a[66:67], v21 offset:20480
    v_mfma_f32_16x16x32_bf16 v[152:155], a[68:71], v[88:91], v[152:155]
    v_exp_f32 v245, v37
    v_mfma_f32_16x16x32_bf16 v[156:159], a[68:71], v[92:95], v[156:159]
    ds_read_b64_tr_b16 a[68:69], v22 offset:16384
    ds_read_b64_tr_b16 a[70:71], v22 offset:20480
    v_mfma_f32_16x16x32_bf16 v[76:79], a[76:79], v[88:91], v[76:79]
    v_exp_f32 v246, v38
    v_cvt_pk_bf16_f32 v82, v244, v245
    v_mfma_f32_16x16x32_bf16 v[240:243], a[76:79], v[92:95], v[240:243]
    v_exp_f32 v247, v39
    s_waitcnt lgkmcnt(8)
    v_mfma_f32_16x16x32_bf16 v[48:51], a[72:75], v[160:163], v[64:67]
    v_exp_f32 v244, v40
    v_cvt_pk_bf16_f32 v83, v246, v247
    v_mfma_f32_16x16x32_bf16 v[48:51], a[32:35], v[164:167], v[48:51]
    v_exp_f32 v245, v41
    v_mfma_f32_16x16x32_bf16 v[48:51], a[36:39], v[168:171], v[48:51]
    v_exp_f32 v246, v42
    v_cvt_pk_bf16_f32 v84, v244, v245
    v_mfma_f32_16x16x32_bf16 v[48:51], a[40:43], v[172:175], v[48:51]
    v_exp_f32 v247, v43
    v_mfma_f32_16x16x32_bf16 v[56:59], a[72:75], v[176:179], v[68:71]
    ds_read_b64_tr_b16 a[72:73], v23 offset:16384
    ds_read_b64_tr_b16 a[74:75], v23 offset:20480
    v_mfma_f32_16x16x32_bf16 v[56:59], a[32:35], v[180:183], v[56:59]
    v_exp_f32 v244, v44
    v_cvt_pk_bf16_f32 v85, v246, v247
    v_mfma_f32_16x16x32_bf16 v[56:59], a[36:39], v[184:187], v[56:59]
    ds_read_b64_tr_b16 a[32:33], v24 offset:16384
    ds_read_b64_tr_b16 a[34:35], v24 offset:20480
    v_mfma_f32_16x16x32_bf16 v[56:59], a[40:43], v[188:191], v[56:59]
    v_exp_f32 v245, v45
    v_exp_f32 v246, v46
    v_mfma_f32_16x16x32_bf16 v[52:55], a[44:47], v[160:163], v[64:67]
    ds_read_b64_tr_b16 a[36:37], v25 offset:16384
    ds_read_b64_tr_b16 a[38:39], v25 offset:20480
    v_cvt_pk_bf16_f32 v86, v244, v245
    v_mfma_f32_16x16x32_bf16 v[52:55], a[48:51], v[164:167], v[52:55]
    v_exp_f32 v247, v47
    v_or3_b32 v14, v80, v81, v82
    v_mfma_f32_16x16x32_bf16 v[52:55], a[52:55], v[168:171], v[52:55]
    ds_read_b64_tr_b16 a[40:41], v26 offset:16384
    ds_read_b64_tr_b16 a[42:43], v26 offset:20480
    v_cvt_pk_bf16_f32 v87, v246, v247
    v_mfma_f32_16x16x32_bf16 v[52:55], a[56:59], v[172:175], v[52:55]
    v_or3_b32 v14, v14, v83, v84
    v_or3_b32 v14, v14, v85, v86
    v_bitop3_b32 v14, v14, v87, s72 bitop3:0xa8
    v_mfma_f32_16x16x32_bf16 v[60:63], a[44:47], v[176:179], v[68:71]
    ds_read_b64_tr_b16 a[44:45], v27 offset:16384
    ds_read_b64_tr_b16 a[46:47], v27 offset:20480
    s_add_u32 m0, s79, 98304
    s_add_u32 s82, s81, 204800
    s_and_b32 s82, s82, 0x7ffff
    buffer_load_dwordx4 v252, s[56:59], s82 offen lds
    v_mfma_f32_16x16x32_bf16 v[60:63], a[48:51], v[180:183], v[60:63]
    buffer_load_dwordx4 v253, s[56:59], s82 offen offset:1024 lds
    v_mfma_f32_16x16x32_bf16 v[60:63], a[52:55], v[184:187], v[60:63]
    v_cmp_ne_u32 vcc, 0, v14
    v_mfma_f32_16x16x32_bf16 v[60:63], a[56:59], v[188:191], v[60:63]
    s_cbranch_vccnz LB_r1_18
LB_b1_18:
    s_waitcnt vmcnt(10) lgkmcnt(0)
    s_barrier
    v_mfma_f32_16x16x32_bf16 v[96:99], a[60:63], v[80:83], v[96:99]
    ds_read_b128 a[48:51], v16 offset:16384
    ds_read_b128 a[52:55], v17 offset:16384
    ds_read_b128 a[56:59], v18 offset:16384
    s_add_u32 m0, s78, 81920
    s_mov_b32 s9, 172032
    buffer_load_dwordx4 v10, s[48:51], s9 offen nt lds
    v_mfma_f32_16x16x32_bf16 v[100:103], a[60:63], v[84:87], v[100:103]
    ds_read_b128 a[60:63], v19 offset:16384
    v_mfma_f32_16x16x32_bf16 v[104:107], a[64:67], v[80:83], v[104:107]
    buffer_load_dwordx4 v5, s[48:51], s9 offen offset:1024 nt lds
    v_exp_f32 v244, v48
    v_mfma_f32_16x16x32_bf16 v[108:111], a[64:67], v[84:87], v[108:111]
    ds_read_b128 a[64:67], v16 offset:20480
    v_exp_f32 v245, v49
    v_mfma_f32_16x16x32_bf16 v[112:115], a[68:71], v[80:83], v[112:115]
    s_add_u32 m0, s78, 8192
    s_mov_b32 s9, 188416
    buffer_load_dwordx4 v8, s[44:47], s9 offen nt lds
    v_mfma_f32_16x16x32_bf16 v[116:119], a[68:71], v[84:87], v[116:119]
    ds_read_b128 a[68:71], v17 offset:20480
    v_exp_f32 v246, v50
    v_mfma_f32_16x16x32_bf16 v[120:123], a[72:75], v[80:83], v[120:123]
    buffer_load_dwordx4 v9, s[44:47], s9 offen offset:1024 nt lds
    v_cvt_pk_bf16_f32 v88, v244, v245
    v_mfma_f32_16x16x32_bf16 v[124:127], a[72:75], v[84:87], v[124:127]
    ds_read_b128 a[72:75], v18 offset:20480
    v_exp_f32 v247, v51
    v_mfma_f32_16x16x32_bf16 v[128:131], a[32:35], v[80:83], v[128:131]
    v_exp_f32 v244, v52
    v_mfma_f32_16x16x32_bf16 v[132:135], a[32:35], v[84:87], v[132:135]
    ds_read_b128 a[32:35], v19 offset:20480
    v_cvt_pk_bf16_f32 v89, v246, v247
    v_mfma_f32_16x16x32_bf16 v[136:139], a[36:39], v[80:83], v[136:139]
    v_exp_f32 v245, v53
    v_mfma_f32_16x16x32_bf16 v[140:143], a[36:39], v[84:87], v[140:143]
    ds_read_b64_tr_b16 a[36:37], v20 offset:0
    ds_read_b64_tr_b16 a[38:39], v20 offset:4096
    v_mfma_f32_16x16x32_bf16 v[144:147], a[40:43], v[80:83], v[144:147]
    v_exp_f32 v246, v54
    v_mfma_f32_16x16x32_bf16 v[148:151], a[40:43], v[84:87], v[148:151]
    ds_read_b64_tr_b16 a[40:41], v21 offset:0
    ds_read_b64_tr_b16 a[42:43], v21 offset:4096
    v_mfma_f32_16x16x32_bf16 v[152:155], a[44:47], v[80:83], v[152:155]
    v_cvt_pk_bf16_f32 v90, v244, v245
    v_exp_f32 v247, v55
    v_mfma_f32_16x16x32_bf16 v[156:159], a[44:47], v[84:87], v[156:159]
    ds_read_b64_tr_b16 a[44:45], v22 offset:0
    ds_read_b64_tr_b16 a[46:47], v22 offset:4096
    v_mfma_f32_16x16x32_bf16 v[76:79], a[76:79], v[80:83], v[76:79]
    v_exp_f32 v244, v56
    v_mfma_f32_16x16x32_bf16 v[240:243], a[76:79], v[84:87], v[240:243]
    v_cvt_pk_bf16_f32 v91, v246, v247
    v_exp_f32 v245, v57
    s_waitcnt lgkmcnt(6)
    v_mfma_f32_16x16x32_bf16 v[32:35], a[48:51], v[160:163], v[64:67]
    v_exp_f32 v246, v58
    v_mfma_f32_16x16x32_bf16 v[32:35], a[52:55], v[164:167], v[32:35]
    v_cvt_pk_bf16_f32 v92, v244, v245
    v_exp_f32 v247, v59
    v_mfma_f32_16x16x32_bf16 v[32:35], a[56:59], v[168:171], v[32:35]
    v_exp_f32 v244, v60
    v_mfma_f32_16x16x32_bf16 v[32:35], a[60:63], v[172:175], v[32:35]
    v_cvt_pk_bf16_f32 v93, v246, v247
    v_exp_f32 v245, v61
    v_mfma_f32_16x16x32_bf16 v[40:43], a[48:51], v[176:179], v[68:71]
    ds_read_b64_tr_b16 a[48:49], v23 offset:0
    ds_read_b64_tr_b16 a[50:51], v23 offset:4096
    v_mfma_f32_16x16x32_bf16 v[40:43], a[52:55], v[180:183], v[40:43]
    v_exp_f32 v246, v62
    v_mfma_f32_16x16x32_bf16 v[40:43], a[56:59], v[184:187], v[40:43]
    ds_read_b64_tr_b16 a[52:53], v24 offset:0
    ds_read_b64_tr_b16 a[54:55], v24 offset:4096
    v_mfma_f32_16x16x32_bf16 v[40:43], a[60:63], v[188:191], v[40:43]
    v_cvt_pk_bf16_f32 v94, v244, v245
    v_exp_f32 v247, v63
    v_mfma_f32_16x16x32_bf16 v[36:39], a[64:67], v[160:163], v[64:67]
    ds_read_b64_tr_b16 a[56:57], v25 offset:0
    ds_read_b64_tr_b16 a[58:59], v25 offset:4096
    v_mfma_f32_16x16x32_bf16 v[36:39], a[68:71], v[164:167], v[36:39]
    v_or3_b32 v14, v88, v89, v90
    v_cvt_pk_bf16_f32 v95, v246, v247
    v_mfma_f32_16x16x32_bf16 v[36:39], a[72:75], v[168:171], v[36:39]
    ds_read_b64_tr_b16 a[60:61], v26 offset:0
    ds_read_b64_tr_b16 a[62:63], v26 offset:4096
    v_mfma_f32_16x16x32_bf16 v[36:39], a[32:35], v[172:175], v[36:39]
    v_or3_b32 v14, v14, v91, v92
    v_or3_b32 v14, v14, v93, v94
    v_mfma_f32_16x16x32_bf16 v[44:47], a[64:67], v[176:179], v[68:71]
    ds_read_b64_tr_b16 a[64:65], v27 offset:0
    ds_read_b64_tr_b16 a[66:67], v27 offset:4096
    s_add_u32 m0, s79, 98304
    s_nop 0
    buffer_load_dwordx4 v254, s[56:59], s82 offen offset:2048 lds
    v_mfma_f32_16x16x32_bf16 v[44:47], a[68:71], v[180:183], v[44:47]
    buffer_load_dwordx4 v255, s[56:59], s82 offen offset:3072 lds
    v_mfma_f32_16x16x32_bf16 v[44:47], a[72:75], v[184:187], v[44:47]
    v_bitop3_b32 v14, v14, v95, s72 bitop3:0xa8
    v_cmp_ne_u32 vcc, 0, v14
    v_mfma_f32_16x16x32_bf16 v[44:47], a[32:35], v[188:191], v[44:47]
    s_cbranch_vccnz LB_r1_19
LB_b1_19:
    s_waitcnt vmcnt(10) lgkmcnt(0)
    s_barrier
    v_mfma_f32_16x16x32_bf16 v[96:99], a[36:39], v[88:91], v[96:99]
    ds_read_b128 a[68:71], v16 offset:24576
    ds_read_b128 a[72:75], v17 offset:24576
    ds_read_b128 a[32:35], v18 offset:24576
    s_add_u32 m0, s78, 65536
    s_mov_b32 s9, 180224
    buffer_load_dwordx4 v10, s[48:51], s9 offen nt lds
    v_mfma_f32_16x16x32_bf16 v[100:103], a[36:39], v[92:95], v[100:103]
    ds_read_b128 a[36:39], v19 offset:24576
    v_mfma_f32_16x16x32_bf16 v[104:107], a[40:43], v[88:91], v[104:107]
    buffer_load_dwordx4 v5, s[48:51], s9 offen offset:1024 nt lds
    ds_read_b64_tr_b16 a[16:17], v28 offset:49152
    v_mfma_f32_16x16x32_bf16 v[108:111], a[40:43], v[92:95], v[108:111]
    ds_read_b128 a[40:43], v16 offset:28672
    v_exp_f32 v244, v32
    v_mfma_f32_16x16x32_bf16 v[112:115], a[44:47], v[88:91], v[112:115]
    s_add_u32 m0, s78, 16384
    s_mov_b32 s9, 196608
    buffer_load_dwordx4 v8, s[44:47], s9 offen nt lds
    ds_read_b64_tr_b16 a[18:19], v28 offset:51200
    v_mfma_f32_16x16x32_bf16 v[116:119], a[44:47], v[92:95], v[116:119]
    ds_read_b128 a[44:47], v17 offset:28672
    v_exp_f32 v245, v33
    v_mfma_f32_16x16x32_bf16 v[120:123], a[48:51], v[88:91], v[120:123]
    buffer_load_dwordx4 v9, s[44:47], s9 offen offset:1024 nt lds
    ds_read_b64_tr_b16 a[20:21], v29 offset:49152
    ds_read_b64_tr_b16 a[22:23], v29 offset:51200
    v_mfma_f32_16x16x32_bf16 v[124:127], a[48:51], v[92:95], v[124:127]
    ds_read_b128 a[48:51], v18 offset:28672
    v_exp_f32 v246, v34
    v_mfma_f32_16x16x32_bf16 v[128:131], a[52:55], v[88:91], v[128:131]
    ds_read_b64_tr_b16 a[24:25], v30 offset:49152
    ds_read_b64_tr_b16 a[26:27], v30 offset:51200
    v_cvt_pk_bf16_f32 v80, v244, v245
    v_mfma_f32_16x16x32_bf16 v[132:135], a[52:55], v[92:95], v[132:135]
    ds_read_b128 a[52:55], v19 offset:28672
    v_exp_f32 v247, v35
    v_mfma_f32_16x16x32_bf16 v[136:139], a[56:59], v[88:91], v[136:139]
    ds_read_b64_tr_b16 a[28:29], v31 offset:49152
    ds_read_b64_tr_b16 a[30:31], v31 offset:51200
    v_mfma_f32_16x16x32_bf16 v[140:143], a[56:59], v[92:95], v[140:143]
    ds_read_b64_tr_b16 a[56:57], v20 offset:8192
    ds_read_b64_tr_b16 a[58:59], v20 offset:12288
    v_mfma_f32_16x16x32_bf16 v[144:147], a[60:63], v[88:91], v[144:147]
    v_exp_f32 v244, v36
    v_cvt_pk_bf16_f32 v81, v246, v247
    v_mfma_f32_16x16x32_bf16 v[148:151], a[60:63], v[92:95], v[148:151]
    ds_read_b64_tr_b16 a[60:61], v21 offset:8192
    ds_read_b64_tr_b16 a[62:63], v21 offset:12288
    v_mfma_f32_16x16x32_bf16 v[152:155], a[64:67], v[88:91], v[152:155]
    v_exp_f32 v245, v37
    v_mfma_f32_16x16x32_bf16 v[156:159], a[64:67], v[92:95], v[156:159]
    ds_read_b64_tr_b16 a[64:65], v22 offset:8192
    ds_read_b64_tr_b16 a[66:67], v22 offset:12288
    v_mfma_f32_16x16x32_bf16 v[76:79], a[76:79], v[88:91], v[76:79]
    v_exp_f32 v246, v38
    v_cvt_pk_bf16_f32 v82, v244, v245
    v_mfma_f32_16x16x32_bf16 v[240:243], a[76:79], v[92:95], v[240:243]
    v_exp_f32 v247, v39
    s_waitcnt lgkmcnt(8)
    v_mfma_f32_16x16x32_bf16 v[48:51], a[68:71], v[160:163], v[64:67]
    v_exp_f32 v244, v40
    v_cvt_pk_bf16_f32 v83, v246, v247
    v_mfma_f32_16x16x32_bf16 v[48:51], a[72:75], v[164:167], v[48:51]
    v_exp_f32 v245, v41
    v_mfma_f32_16x16x32_bf16 v[48:51], a[32:35], v[168:171], v[48:51]
    v_exp_f32 v246, v42
    v_cvt_pk_bf16_f32 v84, v244, v245
    v_mfma_f32_16x16x32_bf16 v[48:51], a[36:39], v[172:175], v[48:51]
    v_exp_f32 v247, v43
    v_mfma_f32_16x16x32_bf16 v[56:59], a[68:71], v[176:179], v[68:71]
    ds_read_b64_tr_b16 a[68:69], v23 offset:8192
    ds_read_b64_tr_b16 a[70:71], v23 offset:12288
    v_mfma_f32_16x16x32_bf16 v[56:59], a[72:75], v[180:183], v[56:59]
    v_exp_f32 v244, v44
    v_cvt_pk_bf16_f32 v85, v246, v247
    v_mfma_f32_16x16x32_bf16 v[56:59], a[32:35], v[184:187], v[56:59]
    ds_read_b64_tr_b16 a[72:73], v24 offset:8192
    ds_read_b64_tr_b16 a[74:75], v24 offset:12288
    v_mfma_f32_16x16x32_bf16 v[56:59], a[36:39], v[188:191], v[56:59]
    v_exp_f32 v245, v45
    v_exp_f32 v246, v46
    v_mfma_f32_16x16x32_bf16 v[52:55], a[40:43], v[160:163], v[64:67]
    ds_read_b64_tr_b16 a[32:33], v25 offset:8192
    ds_read_b64_tr_b16 a[34:35], v25 offset:12288
    v_cvt_pk_bf16_f32 v86, v244, v245
    v_mfma_f32_16x16x32_bf16 v[52:55], a[44:47], v[164:167], v[52:55]
    v_exp_f32 v247, v47
    v_or3_b32 v14, v80, v81, v82
    v_mfma_f32_16x16x32_bf16 v[52:55], a[48:51], v[168:171], v[52:55]
    ds_read_b64_tr_b16 a[36:37], v26 offset:8192
    ds_read_b64_tr_b16 a[38:39], v26 offset:12288
    v_cvt_pk_bf16_f32 v87, v246, v247
    v_mfma_f32_16x16x32_bf16 v[52:55], a[52:55], v[172:175], v[52:55]
    v_or3_b32 v14, v14, v83, v84
    v_or3_b32 v14, v14, v85, v86
    v_bitop3_b32 v14, v14, v87, s72 bitop3:0xa8
    v_mfma_f32_16x16x32_bf16 v[60:63], a[40:43], v[176:179], v[68:71]
    ds_read_b64_tr_b16 a[40:41], v27 offset:8192
    ds_read_b64_tr_b16 a[42:43], v27 offset:12288
    s_add_u32 m0, s79, 32768
    s_add_u32 s82, s81, 229376
    s_and_b32 s82, s82, 0x7ffff
    buffer_load_dwordx4 v252, s[56:59], s82 offen lds
    v_mfma_f32_16x16x32_bf16 v[60:63], a[44:47], v[180:183], v[60:63]
    buffer_load_dwordx4 v253, s[56:59], s82 offen offset:1024 lds
    v_mfma_f32_16x16x32_bf16 v[60:63], a[48:51], v[184:187], v[60:63]
    v_cmp_ne_u32 vcc, 0, v14
    v_mfma_f32_16x16x32_bf16 v[60:63], a[52:55], v[188:191], v[60:63]
    s_cbranch_vccnz LB_r1_20
LB_b1_20:
    s_waitcnt vmcnt(10) lgkmcnt(0)
    s_barrier
    v_mfma_f32_16x16x32_bf16 v[96:99], a[56:59], v[80:83], v[96:99]
    ds_read_b128 a[44:47], v16 offset:0
    ds_read_b128 a[48:51], v17 offset:0
    ds_read_b128 a[52:55], v18 offset:0
    s_add_u32 m0, s78, 73728
    s_mov_b32 s9, 188416
    buffer_load_dwordx4 v10, s[48:51], s9 offen nt lds
    v_mfma_f32_16x16x32_bf16 v[100:103], a[56:59], v[84:87], v[100:103]
    ds_read_b128 a[56:59], v19 offset:0
    v_mfma_f32_16x16x32_bf16 v[104:107], a[60:63], v[80:83], v[104:107]
    buffer_load_dwordx4 v5, s[48:51], s9 offen offset:1024 nt lds
    v_exp_f32 v244, v48
    v_mfma_f32_16x16x32_bf16 v[108:111], a[60:63], v[84:87], v[108:111]
    ds_read_b128 a[60:63], v16 offset:4096
    v_exp_f32 v245, v49
    v_mfma_f32_16x16x32_bf16 v[112:115], a[64:67], v[80:83], v[112:115]
    s_add_u32 m0, s78, 24576
    s_mov_b32 s9, 204800
    buffer_load_dwordx4 v8, s[44:47], s9 offen nt lds
    v_mfma_f32_16x16x32_bf16 v[116:119], a[64:67], v[84:87], v[116:119]
    ds_read_b128 a[64:67], v17 offset:4096
    v_exp_f32 v246, v50
    v_mfma_f32_16x16x32_bf16 v[120:123], a[68:71], v[80:83], v[120:123]
    buffer_load_dwordx4 v9, s[44:47], s9 offen offset:1024 nt lds
    v_cvt_pk_bf16_f32 v88, v244, v245
    v_mfma_f32_16x16x32_bf16 v[124:127], a[68:71], v[84:87], v[124:127]
    ds_read_b128 a[68:71], v18 offset:4096
    v_exp_f32 v247, v51
    v_mfma_f32_16x16x32_bf16 v[128:131], a[72:75], v[80:83], v[128:131]
    v_exp_f32 v244, v52
    v_mfma_f32_16x16x32_bf16 v[132:135], a[72:75], v[84:87], v[132:135]
    ds_read_b128 a[72:75], v19 offset:4096
    v_cvt_pk_bf16_f32 v89, v246, v247
    v_mfma_f32_16x16x32_bf16 v[136:139], a[32:35], v[80:83], v[136:139]
    v_exp_f32 v245, v53
    v_mfma_f32_16x16x32_bf16 v[140:143], a[32:35], v[84:87], v[140:143]
    ds_read_b64_tr_b16 a[32:33], v20 offset:16384
    ds_read_b64_tr_b16 a[34:35], v20 offset:20480
    v_mfma_f32_16x16x32_bf16 v[144:147], a[36:39], v[80:83], v[144:147]
    v_exp_f32 v246, v54
    v_mfma_f32_16x16x32_bf16 v[148:151], a[36:39], v[84:87], v[148:151]
    ds_read_b64_tr_b16 a[36:37], v21 offset:16384
    ds_read_b64_tr_b16 a[38:39], v21 offset:20480
    v_mfma_f32_16x16x32_bf16 v[152:155], a[40:43], v[80:83], v[152:155]
    v_cvt_pk_bf16_f32 v90, v244, v245
    v_exp_f32 v247, v55
    v_mfma_f32_16x16x32_bf16 v[156:159], a[40:43], v[84:87], v[156:159]
    ds_read_b64_tr_b16 a[40:41], v22 offset:16384
    ds_read_b64_tr_b16 a[42:43], v22 offset:20480
    v_mfma_f32_16x16x32_bf16 v[76:79], a[76:79], v[80:83], v[76:79]
    v_exp_f32 v244, v56
    v_mfma_f32_16x16x32_bf16 v[240:243], a[76:79], v[84:87], v[240:243]
    v_cvt_pk_bf16_f32 v91, v246, v247
    v_exp_f32 v245, v57
    s_waitcnt lgkmcnt(6)
    v_mfma_f32_16x16x32_bf16 v[32:35], a[44:47], v[160:163], v[64:67]
    v_exp_f32 v246, v58
    v_mfma_f32_16x16x32_bf16 v[32:35], a[48:51], v[164:167], v[32:35]
    v_cvt_pk_bf16_f32 v92, v244, v245
    v_exp_f32 v247, v59
    v_mfma_f32_16x16x32_bf16 v[32:35], a[52:55], v[168:171], v[32:35]
    v_exp_f32 v244, v60
    v_mfma_f32_16x16x32_bf16 v[32:35], a[56:59], v[172:175], v[32:35]
    v_cvt_pk_bf16_f32 v93, v246, v247
    v_exp_f32 v245, v61
    v_mfma_f32_16x16x32_bf16 v[40:43], a[44:47], v[176:179], v[68:71]
    ds_read_b64_tr_b16 a[44:45], v23 offset:16384
    ds_read_b64_tr_b16 a[46:47], v23 offset:20480
    v_mfma_f32_16x16x32_bf16 v[40:43], a[48:51], v[180:183], v[40:43]
    v_exp_f32 v246, v62
    v_mfma_f32_16x16x32_bf16 v[40:43], a[52:55], v[184:187], v[40:43]
    ds_read_b64_tr_b16 a[48:49], v24 offset:16384
    ds_read_b64_tr_b16 a[50:51], v24 offset:20480
    v_mfma_f32_16x16x32_bf16 v[40:43], a[56:59], v[188:191], v[40:43]
    v_cvt_pk_bf16_f32 v94, v244, v245
    v_exp_f32 v247, v63
    v_mfma_f32_16x16x32_bf16 v[36:39], a[60:63], v[160:163], v[64:67]
    ds_read_b64_tr_b16 a[52:53], v25 offset:16384
    ds_read_b64_tr_b16 a[54:55], v25 offset:20480
    v_mfma_f32_16x16x32_bf16 v[36:39], a[64:67], v[164:167], v[36:39]
    v_or3_b32 v14, v88, v89, v90
    v_cvt_pk_bf16_f32 v95, v246, v247
    v_mfma_f32_16x16x32_bf16 v[36:39], a[68:71], v[168:171], v[36:39]
    ds_read_b64_tr_b16 a[56:57], v26 offset:16384
    ds_read_b64_tr_b16 a[58:59], v26 offset:20480
    v_mfma_f32_16x16x32_bf16 v[36:39], a[72:75], v[172:175], v[36:39]
    v_or3_b32 v14, v14, v91, v92
    v_or3_b32 v14, v14, v93, v94
    v_mfma_f32_16x16x32_bf16 v[44:47], a[60:63], v[176:179], v[68:71]
    ds_read_b64_tr_b16 a[60:61], v27 offset:16384
    ds_read_b64_tr_b16 a[62:63], v27 offset:20480
    s_add_u32 m0, s79, 32768
    s_nop 0
    buffer_load_dwordx4 v254, s[56:59], s82 offen offset:2048 lds
    v_mfma_f32_16x16x32_bf16 v[44:47], a[64:67], v[180:183], v[44:47]
    buffer_load_dwordx4 v255, s[56:59], s82 offen offset:3072 lds
    v_mfma_f32_16x16x32_bf16 v[44:47], a[68:71], v[184:187], v[44:47]
    v_bitop3_b32 v14, v14, v95, s72 bitop3:0xa8
    v_cmp_ne_u32 vcc, 0, v14
    v_mfma_f32_16x16x32_bf16 v[44:47], a[72:75], v[188:191], v[44:47]
    s_cbranch_vccnz LB_r1_21
LB_b1_21:
    s_waitcnt vmcnt(10) lgkmcnt(0)
    s_barrier
    v_mfma_f32_16x16x32_bf16 v[96:99], a[32:35], v[88:91], v[96:99]
    ds_read_b128 a[64:67], v16 offset:8192
    ds_read_b128 a[68:71], v17 offset:8192
    ds_read_b128 a[72:75], v18 offset:8192
    s_add_u32 m0, s78, 81920
    s_mov_b32 s9, 196608
    buffer_load_dwordx4 v10, s[48:51], s9 offen nt lds
    v_mfma_f32_16x16x32_bf16 v[100:103], a[32:35], v[92:95], v[100:103]
    ds_read_b128 a[32:35], v19 offset:8192
    v_mfma_f32_16x16x32_bf16 v[104:107], a[36:39], v[88:91], v[104:107]
    buffer_load_dwordx4 v5, s[48:51], s9 offen offset:1024 nt lds
    v_add_u32 v28, 65536, v28
    v_add_u32 v29, 65536, v29
    v_add_u32 v30, 65536, v30
    v_add_u32 v31, 65536, v31
    ds_read_b64_tr_b16 v[192:193], v28 offset:32768
    v_mfma_f32_16x16x32_bf16 v[108:111], a[36:39], v[92:95], v[108:111]
    ds_read_b128 a[36:39], v16 offset:12288
    v_exp_f32 v244, v32
    v_mfma_f32_16x16x32_bf16 v[112:115], a[40:43], v[88:91], v[112:115]
    s_add_u32 m0, s79, 49152
    s_add_u32 s82, s81, 237568
    s_and_b32 s82, s82, 0x7ffff
    buffer_load_dwordx4 v252, s[56:59], s82 offen lds
    ds_read_b64_tr_b16 v[194:195], v28 offset:34816
    v_mfma_f32_16x16x32_bf16 v[116:119], a[40:43], v[92:95], v[116:119]
    ds_read_b128 a[40:43], v17 offset:12288
    v_exp_f32 v245, v33
    v_mfma_f32_16x16x32_bf16 v[120:123], a[44:47], v[88:91], v[120:123]
    buffer_load_dwordx4 v253, s[56:59], s82 offen offset:1024 lds
    ds_read_b64_tr_b16 v[196:197], v29 offset:32768
    ds_read_b64_tr_b16 v[198:199], v29 offset:34816
    v_mfma_f32_16x16x32_bf16 v[124:127], a[44:47], v[92:95], v[124:127]
    ds_read_b128 a[44:47], v18 offset:12288
    v_exp_f32 v246, v34
    v_mfma_f32_16x16x32_bf16 v[128:131], a[48:51], v[88:91], v[128:131]
    ds_read_b64_tr_b16 v[200:201], v30 offset:32768
    ds_read_b64_tr_b16 v[202:203], v30 offset:34816
    v_mfma_f32_16x16x32_bf16 v[132:135], a[48:51], v[92:95], v[132:135]
    ds_read_b128 a[48:51], v19 offset:12288
    v_cvt_pk_bf16_f32 v80, v244, v245
    v_mfma_f32_16x16x32_bf16 v[136:139], a[52:55], v[88:91], v[136:139]
    ds_read_b64_tr_b16 v[204:205], v31 offset:32768
    ds_read_b64_tr_b16 v[206:207], v31 offset:34816
    v_mfma_f32_16x16x32_bf16 v[140:143], a[52:55], v[92:95], v[140:143]
    ds_read_b64_tr_b16 a[52:53], v20 offset:0
    ds_read_b64_tr_b16 a[54:55], v20 offset:4096
    v_mfma_f32_16x16x32_bf16 v[144:147], a[56:59], v[88:91], v[144:147]
    v_exp_f32 v247, v35
    v_mfma_f32_16x16x32_bf16 v[148:151], a[56:59], v[92:95], v[148:151]
    ds_read_b64_tr_b16 a[56:57], v21 offset:0
    ds_read_b64_tr_b16 a[58:59], v21 offset:4096
    v_mfma_f32_16x16x32_bf16 v[152:155], a[60:63], v[88:91], v[152:155]
    v_exp_f32 v244, v36
    v_cvt_pk_bf16_f32 v81, v246, v247
    v_mfma_f32_16x16x32_bf16 v[156:159], a[60:63], v[92:95], v[156:159]
    ds_read_b64_tr_b16 a[60:61], v22 offset:0
    ds_read_b64_tr_b16 a[62:63], v22 offset:4096
    v_mfma_f32_16x16x32_bf16 v[76:79], a[76:79], v[88:91], v[76:79]
    v_exp_f32 v245, v37
    v_mfma_f32_16x16x32_bf16 v[240:243], a[76:79], v[92:95], v[240:243]
    v_exp_f32 v246, v38
    v_cvt_pk_bf16_f32 v82, v244, v245
    s_waitcnt lgkmcnt(8)
    v_mfma_f32_16x16x32_bf16 v[48:51], a[64:67], v[160:163], v[64:67]
    v_exp_f32 v247, v39
    v_mfma_f32_16x16x32_bf16 v[48:51], a[68:71], v[164:167], v[48:51]
    v_exp_f32 v244, v40
    v_cvt_pk_bf16_f32 v83, v246, v247
    v_mfma_f32_16x16x32_bf16 v[48:51], a[72:75], v[168:171], v[48:51]
    v_exp_f32 v245, v41
    v_mfma_f32_16x16x32_bf16 v[48:51], a[32:35], v[172:175], v[48:51]
    v_exp_f32 v246, v42
    v_cvt_pk_bf16_f32 v84, v244, v245
    v_mfma_f32_16x16x32_bf16 v[56:59], a[64:67], v[176:179], v[68:71]
    ds_read_b64_tr_b16 a[64:65], v23 offset:0
    ds_read_b64_tr_b16 a[66:67], v23 offset:4096
    v_mfma_f32_16x16x32_bf16 v[56:59], a[68:71], v[180:183], v[56:59]
    v_exp_f32 v247, v43
    v_mfma_f32_16x16x32_bf16 v[56:59], a[72:75], v[184:187], v[56:59]
    ds_read_b64_tr_b16 a[68:69], v24 offset:0
    ds_read_b64_tr_b16 a[70:71], v24 offset:4096
    v_mfma_f32_16x16x32_bf16 v[56:59], a[32:35], v[188:191], v[56:59]
    v_exp_f32 v244, v44
    v_cvt_pk_bf16_f32 v85, v246, v247
    v_mfma_f32_16x16x32_bf16 v[52:55], a[36:39], v[160:163], v[64:67]
    ds_read_b64_tr_b16 a[72:73], v25 offset:0
    ds_read_b64_tr_b16 a[74:75], v25 offset:4096
    v_mfma_f32_16x16x32_bf16 v[52:55], a[40:43], v[164:167], v[52:55]
    v_exp_f32 v245, v45
    v_mfma_f32_16x16x32_bf16 v[52:55], a[44:47], v[168:171], v[52:55]
    ds_read_b64_tr_b16 a[32:33], v26 offset:0
    ds_read_b64_tr_b16 a[34:35], v26 offset:4096
    v_exp_f32 v246, v46
    v_mfma_f32_16x16x32_bf16 v[52:55], a[48:51], v[172:175], v[52:55]
    v_cvt_pk_bf16_f32 v86, v244, v245
    v_exp_f32 v247, v47
    v_mfma_f32_16x16x32_bf16 v[60:63], a[36:39], v[176:179], v[68:71]
    ds_read_b64_tr_b16 a[36:37], v27 offset:0
    ds_read_b64_tr_b16 a[38:39], v27 offset:4096
    v_or3_b32 v14, v80, v81, v82
    v_mfma_f32_16x16x32_bf16 v[60:63], a[40:43], v[180:183], v[60:63]
    v_cvt_pk_bf16_f32 v87, v246, v247
    v_or3_b32 v14, v14, v83, v84
    v_or3_b32 v14, v14, v85, v86
    v_mfma_f32_16x16x32_bf16 v[60:63], a[44:47], v[184:187], v[60:63]
    v_bitop3_b32 v14, v14, v87, s72 bitop3:0xa8
    v_cmp_ne_u32 vcc, 0, v14
    v_mfma_f32_16x16x32_bf16 v[60:63], a[48:51], v[188:191], v[60:63]
    s_cbranch_vccnz LB_r1_22
LB_b1_22:
    s_waitcnt vmcnt(8) lgkmcnt(0)
    s_barrier
    v_mfma_f32_16x16x32_bf16 v[96:99], a[52:55], v[80:83], v[96:99]
    ds_read_b128 a[40:43], v16 offset:16384
    ds_read_b128 a[44:47], v17 offset:16384
    ds_read_b128 a[48:51], v18 offset:16384
    s_add_u32 m0, s78, 0
    s_mov_b32 s9, 212992
    buffer_load_dwordx4 v8, s[44:47], s9 offen nt lds
    v_mfma_f32_16x16x32_bf16 v[100:103], a[52:55], v[84:87], v[100:103]
    ds_read_b128 a[52:55], v19 offset:16384
    v_mfma_f32_16x16x32_bf16 v[104:107], a[56:59], v[80:83], v[104:107]
    buffer_load_dwordx4 v9, s[44:47], s9 offen offset:1024 nt lds
    v_exp_f32 v244, v48
    v_mfma_f32_16x16x32_bf16 v[108:111], a[56:59], v[84:87], v[108:111]
    ds_read_b128 a[56:59], v16 offset:20480
    v_exp_f32 v245, v49
    v_mfma_f32_16x16x32_bf16 v[112:115], a[60:63], v[80:83], v[112:115]
    s_add_u32 m0, s78, 65536
    s_mov_b32 s9, 204800
    buffer_load_dwordx4 v10, s[48:51], s9 offen nt lds
    v_mfma_f32_16x16x32_bf16 v[116:119], a[60:63], v[84:87], v[116:119]
    ds_read_b128 a[60:63], v17 offset:20480
    v_exp_f32 v246, v50
    v_mfma_f32_16x16x32_bf16 v[120:123], a[64:67], v[80:83], v[120:123]
    buffer_load_dwordx4 v5, s[48:51], s9 offen offset:1024 nt lds
    v_cvt_pk_bf16_f32 v88, v244, v245
    v_mfma_f32_16x16x32_bf16 v[124:127], a[64:67], v[84:87], v[124:127]
    ds_read_b128 a[64:67], v18 offset:20480
    v_exp_f32 v247, v51
    v_mfma_f32_16x16x32_bf16 v[128:131], a[68:71], v[80:83], v[128:131]
    v_exp_f32 v244, v52
    v_mfma_f32_16x16x32_bf16 v[132:135], a[68:71], v[84:87], v[132:135]
    ds_read_b128 a[68:71], v19 offset:20480
    v_cvt_pk_bf16_f32 v89, v246, v247
    v_mfma_f32_16x16x32_bf16 v[136:139], a[72:75], v[80:83], v[136:139]
    v_exp_f32 v245, v53
    v_mfma_f32_16x16x32_bf16 v[140:143], a[72:75], v[84:87], v[140:143]
    ds_read_b64_tr_b16 a[72:73], v20 offset:8192
    ds_read_b64_tr_b16 a[74:75], v20 offset:12288
    v_mfma_f32_16x16x32_bf16 v[144:147], a[32:35], v[80:83], v[144:147]
    v_exp_f32 v246, v54
    v_mfma_f32_16x16x32_bf16 v[148:151], a[32:35], v[84:87], v[148:151]
    ds_read_b64_tr_b16 a[32:33], v21 offset:8192
    ds_read_b64_tr_b16 a[34:35], v21 offset:12288
    v_mfma_f32_16x16x32_bf16 v[152:155], a[36:39], v[80:83], v[152:155]
    v_cvt_pk_bf16_f32 v90, v244, v245
    v_exp_f32 v247, v55
    v_mfma_f32_16x16x32_bf16 v[156:159], a[36:39], v[84:87], v[156:159]
    ds_read_b64_tr_b16 a[36:37], v22 offset:8192
    ds_read_b64_tr_b16 a[38:39], v22 offset:12288
    v_mfma_f32_16x16x32_bf16 v[76:79], a[76:79], v[80:83], v[76:79]
    v_exp_f32 v244, v56
    v_mfma_f32_16x16x32_bf16 v[240:243], a[76:79], v[84:87], v[240:243]
    v_cvt_pk_bf16_f32 v91, v246, v247
    v_exp_f32 v245, v57
    s_waitcnt lgkmcnt(6)
    v_mfma_f32_16x16x32_bf16 v[32:35], a[40:43], v[160:163], v[64:67]
    v_exp_f32 v246, v58
    v_mfma_f32_16x16x32_bf16 v[32:35], a[44:47], v[164:167], v[32:35]
    v_cvt_pk_bf16_f32 v92, v244, v245
    v_exp_f32 v247, v59
    v_mfma_f32_16x16x32_bf16 v[32:35], a[48:51], v[168:171], v[32:35]
    v_exp_f32 v244, v60
    v_mfma_f32_16x16x32_bf16 v[32:35], a[52:55], v[172:175], v[32:35]
    v_cvt_pk_bf16_f32 v93, v246, v247
    v_exp_f32 v245, v61
    v_mfma_f32_16x16x32_bf16 v[40:43], a[40:43], v[176:179], v[68:71]
    ds_read_b64_tr_b16 a[40:41], v23 offset:8192
    ds_read_b64_tr_b16 a[42:43], v23 offset:12288
    v_mfma_f32_16x16x32_bf16 v[40:43], a[44:47], v[180:183], v[40:43]
    v_exp_f32 v246, v62
    v_mfma_f32_16x16x32_bf16 v[40:43], a[48:51], v[184:187], v[40:43]
    ds_read_b64_tr_b16 a[44:45], v24 offset:8192
    ds_read_b64_tr_b16 a[46:47], v24 offset:12288
    v_mfma_f32_16x16x32_bf16 v[40:43], a[52:55], v[188:191], v[40:43]
    v_cvt_pk_bf16_f32 v94, v244, v245
    v_exp_f32 v247, v63
    v_mfma_f32_16x16x32_bf16 v[36:39], a[56:59], v[160:163], v[64:67]
    ds_read_b64_tr_b16 a[48:49], v25 offset:8192
    ds_read_b64_tr_b16 a[50:51], v25 offset:12288
    v_mfma_f32_16x16x32_bf16 v[36:39], a[60:63], v[164:167], v[36:39]
    v_or3_b32 v14, v88, v89, v90
    v_cvt_pk_bf16_f32 v95, v246, v247
    v_mfma_f32_16x16x32_bf16 v[36:39], a[64:67], v[168:171], v[36:39]
    ds_read_b64_tr_b16 a[52:53], v26 offset:8192
    ds_read_b64_tr_b16 a[54:55], v26 offset:12288
    v_mfma_f32_16x16x32_bf16 v[36:39], a[68:71], v[172:175], v[36:39]
    v_or3_b32 v14, v14, v91, v92
    v_or3_b32 v14, v14, v93, v94
    v_mfma_f32_16x16x32_bf16 v[44:47], a[56:59], v[176:179], v[68:71]
    ds_read_b64_tr_b16 a[56:57], v27 offset:8192
    ds_read_b64_tr_b16 a[58:59], v27 offset:12288
    s_add_u32 m0, s79, 49152
    s_nop 0
    buffer_load_dwordx4 v254, s[56:59], s82 offen offset:2048 lds
    v_mfma_f32_16x16x32_bf16 v[44:47], a[60:63], v[180:183], v[44:47]
    buffer_load_dwordx4 v255, s[56:59], s82 offen offset:3072 lds
    v_mfma_f32_16x16x32_bf16 v[44:47], a[64:67], v[184:187], v[44:47]
    v_bitop3_b32 v14, v14, v95, s72 bitop3:0xa8
    v_cmp_ne_u32 vcc, 0, v14
    v_mfma_f32_16x16x32_bf16 v[44:47], a[68:71], v[188:191], v[44:47]
    s_cbranch_vccnz LB_r1_23
LB_b1_23:
    s_waitcnt vmcnt(8) lgkmcnt(0)
    s_barrier
    v_mfma_f32_16x16x32_bf16 v[96:99], a[72:75], v[88:91], v[96:99]
    ds_read_b128 a[60:63], v16 offset:24576
    ds_read_b128 a[64:67], v17 offset:24576
    ds_read_b128 a[68:71], v18 offset:24576
    s_add_u32 m0, s78, 8192
    s_mov_b32 s9, 221184
    buffer_load_dwordx4 v8, s[44:47], s9 offen nt lds
    v_mfma_f32_16x16x32_bf16 v[100:103], a[72:75], v[92:95], v[100:103]
    ds_read_b128 a[72:75], v19 offset:24576
    v_mfma_f32_16x16x32_bf16 v[104:107], a[32:35], v[88:91], v[104:107]
    buffer_load_dwordx4 v9, s[44:47], s9 offen offset:1024 nt lds
    v_subrev_u32 v28, 65536, v28
    v_subrev_u32 v29, 65536, v29
    v_subrev_u32 v30, 65536, v30
    v_subrev_u32 v31, 65536, v31
    ds_read_b64_tr_b16 v[208:209], v28 offset:32768
    v_mfma_f32_16x16x32_bf16 v[108:111], a[32:35], v[92:95], v[108:111]
    ds_read_b128 a[32:35], v16 offset:28672
    v_exp_f32 v244, v32
    v_mfma_f32_16x16x32_bf16 v[112:115], a[36:39], v[88:91], v[112:115]
    s_add_u32 m0, s78, 73728
    s_mov_b32 s9, 212992
    buffer_load_dwordx4 v10, s[48:51], s9 offen nt lds
    ds_read_b64_tr_b16 v[210:211], v28 offset:34816
    v_mfma_f32_16x16x32_bf16 v[116:119], a[36:39], v[92:95], v[116:119]
    ds_read_b128 a[36:39], v17 offset:28672
    v_exp_f32 v245, v33
    v_mfma_f32_16x16x32_bf16 v[120:123], a[40:43], v[88:91], v[120:123]
    buffer_load_dwordx4 v5, s[48:51], s9 offen offset:1024 nt lds
    ds_read_b64_tr_b16 v[212:213], v29 offset:32768
    ds_read_b64_tr_b16 v[214:215], v29 offset:34816
    v_mfma_f32_16x16x32_bf16 v[124:127], a[40:43], v[92:95], v[124:127]
    ds_read_b128 a[40:43], v18 offset:28672
    v_exp_f32 v246, v34
    v_mfma_f32_16x16x32_bf16 v[128:131], a[44:47], v[88:91], v[128:131]
    ds_read_b64_tr_b16 v[216:217], v30 offset:32768
    ds_read_b64_tr_b16 v[218:219], v30 offset:34816
    v_cvt_pk_bf16_f32 v80, v244, v245
    v_mfma_f32_16x16x32_bf16 v[132:135], a[44:47], v[92:95], v[132:135]
    ds_read_b128 a[44:47], v19 offset:28672
    v_exp_f32 v247, v35
    v_mfma_f32_16x16x32_bf16 v[136:139], a[48:51], v[88:91], v[136:139]
    ds_read_b64_tr_b16 v[220:221], v31 offset:32768
    ds_read_b64_tr_b16 v[222:223], v31 offset:34816
    v_mfma_f32_16x16x32_bf16 v[140:143], a[48:51], v[92:95], v[140:143]
    ds_read_b64_tr_b16 a[48:49], v20 offset:16384
    ds_read_b64_tr_b16 a[50:51], v20 offset:20480
    v_mfma_f32_16x16x32_bf16 v[144:147], a[52:55], v[88:91], v[144:147]
    v_exp_f32 v244, v36
    v_cvt_pk_bf16_f32 v81, v246, v247
    v_mfma_f32_16x16x32_bf16 v[148:151], a[52:55], v[92:95], v[148:151]
    ds_read_b64_tr_b16 a[52:53], v21 offset:16384
    ds_read_b64_tr_b16 a[54:55], v21 offset:20480
    v_mfma_f32_16x16x32_bf16 v[152:155], a[56:59], v[88:91], v[152:155]
    v_exp_f32 v245, v37
    v_mfma_f32_16x16x32_bf16 v[156:159], a[56:59], v[92:95], v[156:159]
    ds_read_b64_tr_b16 a[56:57], v22 offset:16384
    ds_read_b64_tr_b16 a[58:59], v22 offset:20480
    v_mfma_f32_16x16x32_bf16 v[76:79], a[76:79], v[88:91], v[76:79]
    v_exp_f32 v246, v38
    v_cvt_pk_bf16_f32 v82, v244, v245
    v_mfma_f32_16x16x32_bf16 v[240:243], a[76:79], v[92:95], v[240:243]
    v_exp_f32 v247, v39
    s_waitcnt lgkmcnt(8)
    v_mfma_f32_16x16x32_bf16 v[48:51], a[60:63], v[160:163], v[64:67]
    v_exp_f32 v244, v40
    v_cvt_pk_bf16_f32 v83, v246, v247
    v_mfma_f32_16x16x32_bf16 v[48:51], a[64:67], v[164:167], v[48:51]
    v_exp_f32 v245, v41
    v_mfma_f32_16x16x32_bf16 v[48:51], a[68:71], v[168:171], v[48:51]
    v_exp_f32 v246, v42
    v_cvt_pk_bf16_f32 v84, v244, v245
    v_mfma_f32_16x16x32_bf16 v[48:51], a[72:75], v[172:175], v[48:51]
    v_exp_f32 v247, v43
    v_mfma_f32_16x16x32_bf16 v[56:59], a[60:63], v[176:179], v[68:71]
    ds_read_b64_tr_b16 a[60:61], v23 offset:16384
    ds_read_b64_tr_b16 a[62:63], v23 offset:20480
    v_mfma_f32_16x16x32_bf16 v[56:59], a[64:67], v[180:183], v[56:59]
    v_exp_f32 v244, v44
    v_cvt_pk_bf16_f32 v85, v246, v247
    v_mfma_f32_16x16x32_bf16 v[56:59], a[68:71], v[184:187], v[56:59]
    ds_read_b64_tr_b16 a[64:65], v24 offset:16384
    ds_read_b64_tr_b16 a[66:67], v24 offset:20480
    v_mfma_f32_16x16x32_bf16 v[56:59], a[72:75], v[188:191], v[56:59]
    v_exp_f32 v245, v45
    v_exp_f32 v246, v46
    v_mfma_f32_16x16x32_bf16 v[52:55], a[32:35], v[160:163], v[64:67]
    ds_read_b64_tr_b16 a[68:69], v25 offset:16384
    ds_read_b64_tr_b16 a[70:71], v25 offset:20480
    v_cvt_pk_bf16_f32 v86, v244, v245
    v_mfma_f32_16x16x32_bf16 v[52:55], a[36:39], v[164:167], v[52:55]
    v_exp_f32 v247, v47
    v_or3_b32 v14, v80, v81, v82
    v_mfma_f32_16x16x32_bf16 v[52:55], a[40:43], v[168:171], v[52:55]
    ds_read_b64_tr_b16 a[72:73], v26 offset:16384
    ds_read_b64_tr_b16 a[74:75], v26 offset:20480
    v_cvt_pk_bf16_f32 v87, v246, v247
    v_mfma_f32_16x16x32_bf16 v[52:55], a[44:47], v[172:175], v[52:55]
    v_or3_b32 v14, v14, v83, v84
    v_or3_b32 v14, v14, v85, v86
    v_bitop3_b32 v14, v14, v87, s72 bitop3:0xa8
    v_mfma_f32_16x16x32_bf16 v[60:63], a[32:35], v[176:179], v[68:71]
    ds_read_b64_tr_b16 a[32:33], v27 offset:16384
    ds_read_b64_tr_b16 a[34:35], v27 offset:20480
    s_add_u32 m0, s79, 98304
    s_add_u32 s82, s81, 262144
    s_and_b32 s82, s82, 0x7ffff
    buffer_load_dwordx4 v252, s[56:59], s82 offen lds
    v_mfma_f32_16x16x32_bf16 v[60:63], a[36:39], v[180:183], v[60:63]
    buffer_load_dwordx4 v253, s[56:59], s82 offen offset:1024 lds
    v_mfma_f32_16x16x32_bf16 v[60:63], a[40:43], v[184:187], v[60:63]
    v_cmp_ne_u32 vcc, 0, v14
    v_mfma_f32_16x16x32_bf16 v[60:63], a[44:47], v[188:191], v[60:63]
    s_cbranch_vccnz LB_r1_24
LB_b1_24:
    s_waitcnt vmcnt(8) lgkmcnt(0)
    s_barrier
    v_mfma_f32_16x16x32_bf16 v[96:99], a[48:51], v[80:83], v[96:99]
    ds_read_b128 a[36:39], v16 offset:0
    ds_read_b128 a[40:43], v17 offset:0
    ds_read_b128 a[44:47], v18 offset:0
    s_add_u32 m0, s78, 16384
    s_mov_b32 s9, 229376
    buffer_load_dwordx4 v8, s[44:47], s9 offen nt lds
    v_mfma_f32_16x16x32_bf16 v[100:103], a[48:51], v[84:87], v[100:103]
    ds_read_b128 a[48:51], v19 offset:0
    v_mfma_f32_16x16x32_bf16 v[104:107], a[52:55], v[80:83], v[104:107]
    buffer_load_dwordx4 v9, s[44:47], s9 offen offset:1024 nt lds
    v_exp_f32 v244, v48
    v_mfma_f32_16x16x32_bf16 v[108:111], a[52:55], v[84:87], v[108:111]
    ds_read_b128 a[52:55], v16 offset:4096
    v_exp_f32 v245, v49
    v_mfma_f32_16x16x32_bf16 v[112:115], a[56:59], v[80:83], v[112:115]
    s_add_u32 m0, s78, 81920
    s_mov_b32 s9, 221184
    buffer_load_dwordx4 v10, s[48:51], s9 offen nt lds
    v_mfma_f32_16x16x32_bf16 v[116:119], a[56:59], v[84:87], v[116:119]
    ds_read_b128 a[56:59], v17 offset:4096
    v_exp_f32 v246, v50
    v_mfma_f32_16x16x32_bf16 v[120:123], a[60:63], v[80:83], v[120:123]
    buffer_load_dwordx4 v5, s[48:51], s9 offen offset:1024 nt lds
    v_cvt_pk_bf16_f32 v88, v244, v245
    v_mfma_f32_16x16x32_bf16 v[124:127], a[60:63], v[84:87], v[124:127]
    ds_read_b128 a[60:63], v18 offset:4096
    v_exp_f32 v247, v51
    v_mfma_f32_16x16x32_bf16 v[128:131], a[64:67], v[80:83], v[128:131]
    v_exp_f32 v244, v52
    v_mfma_f32_16x16x32_bf16 v[132:135], a[64:67], v[84:87], v[132:135]
    ds_read_b128 a[64:67], v19 offset:4096
    v_cvt_pk_bf16_f32 v89, v246, v247
    v_mfma_f32_16x16x32_bf16 v[136:139], a[68:71], v[80:83], v[136:139]
    v_exp_f32 v245, v53
    v_mfma_f32_16x16x32_bf16 v[140:143], a[68:71], v[84:87], v[140:143]
    ds_read_b64_tr_b16 a[68:69], v20 offset:0
    ds_read_b64_tr_b16 a[70:71], v20 offset:4096
    v_mfma_f32_16x16x32_bf16 v[144:147], a[72:75], v[80:83], v[144:147]
    v_exp_f32 v246, v54
    v_mfma_f32_16x16x32_bf16 v[148:151], a[72:75], v[84:87], v[148:151]
    ds_read_b64_tr_b16 a[72:73], v21 offset:0
    ds_read_b64_tr_b16 a[74:75], v21 offset:4096
    v_mfma_f32_16x16x32_bf16 v[152:155], a[32:35], v[80:83], v[152:155]
    v_cvt_pk_bf16_f32 v90, v244, v245
    v_exp_f32 v247, v55
    v_mfma_f32_16x16x32_bf16 v[156:159], a[32:35], v[84:87], v[156:159]
    ds_read_b64_tr_b16 a[32:33], v22 offset:0
    ds_read_b64_tr_b16 a[34:35], v22 offset:4096
    v_mfma_f32_16x16x32_bf16 v[76:79], a[76:79], v[80:83], v[76:79]
    v_exp_f32 v244, v56
    v_mfma_f32_16x16x32_bf16 v[240:243], a[76:79], v[84:87], v[240:243]
    v_cvt_pk_bf16_f32 v91, v246, v247
    v_exp_f32 v245, v57
    s_waitcnt lgkmcnt(6)
    v_mfma_f32_16x16x32_bf16 v[32:35], a[36:39], v[160:163], v[64:67]
    v_exp_f32 v246, v58
    v_mfma_f32_16x16x32_bf16 v[32:35], a[40:43], v[164:167], v[32:35]
    v_cvt_pk_bf16_f32 v92, v244, v245
    v_exp_f32 v247, v59
    v_mfma_f32_16x16x32_bf16 v[32:35], a[44:47], v[168:171], v[32:35]
    v_exp_f32 v244, v60
    v_mfma_f32_16x16x32_bf16 v[32:35], a[48:51], v[172:175], v[32:35]
    v_cvt_pk_bf16_f32 v93, v246, v247
    v_exp_f32 v245, v61
    v_mfma_f32_16x16x32_bf16 v[40:43], a[36:39], v[176:179], v[68:71]
    ds_read_b64_tr_b16 a[36:37], v23 offset:0
    ds_read_b64_tr_b16 a[38:39], v23 offset:4096
    v_mfma_f32_16x16x32_bf16 v[40:43], a[40:43], v[180:183], v[40:43]
    v_exp_f32 v246, v62
    v_mfma_f32_16x16x32_bf16 v[40:43], a[44:47], v[184:187], v[40:43]
    ds_read_b64_tr_b16 a[40:41], v24 offset:0
    ds_read_b64_tr_b16 a[42:43], v24 offset:4096
    v_mfma_f32_16x16x32_bf16 v[40:43], a[48:51], v[188:191], v[40:43]
    v_cvt_pk_bf16_f32 v94, v244, v245
    v_exp_f32 v247, v63
    v_mfma_f32_16x16x32_bf16 v[36:39], a[52:55], v[160:163], v[64:67]
    ds_read_b64_tr_b16 a[44:45], v25 offset:0
    ds_read_b64_tr_b16 a[46:47], v25 offset:4096
    v_mfma_f32_16x16x32_bf16 v[36:39], a[56:59], v[164:167], v[36:39]
    v_or3_b32 v14, v88, v89, v90
    v_cvt_pk_bf16_f32 v95, v246, v247
    v_mfma_f32_16x16x32_bf16 v[36:39], a[60:63], v[168:171], v[36:39]
    ds_read_b64_tr_b16 a[48:49], v26 offset:0
    ds_read_b64_tr_b16 a[50:51], v26 offset:4096
    v_mfma_f32_16x16x32_bf16 v[36:39], a[64:67], v[172:175], v[36:39]
    v_or3_b32 v14, v14, v91, v92
    v_or3_b32 v14, v14, v93, v94
    v_mfma_f32_16x16x32_bf16 v[44:47], a[52:55], v[176:179], v[68:71]
    ds_read_b64_tr_b16 a[52:53], v27 offset:0
    ds_read_b64_tr_b16 a[54:55], v27 offset:4096
    s_add_u32 m0, s79, 98304
    s_nop 0
    buffer_load_dwordx4 v254, s[56:59], s82 offen offset:2048 lds
    v_mfma_f32_16x16x32_bf16 v[44:47], a[56:59], v[180:183], v[44:47]
    buffer_load_dwordx4 v255, s[56:59], s82 offen offset:3072 lds
    v_mfma_f32_16x16x32_bf16 v[44:47], a[60:63], v[184:187], v[44:47]
    v_bitop3_b32 v14, v14, v95, s72 bitop3:0xa8
    v_cmp_ne_u32 vcc, 0, v14
    v_mfma_f32_16x16x32_bf16 v[44:47], a[64:67], v[188:191], v[44:47]
    s_cbranch_vccnz LB_r1_25
LB_b1_25:
    s_waitcnt vmcnt(8) lgkmcnt(0)
    s_barrier
    v_mfma_f32_16x16x32_bf16 v[96:99], a[68:71], v[88:91], v[96:99]
    ds_read_b128 a[56:59], v16 offset:8192
    ds_read_b128 a[60:63], v17 offset:8192
    ds_read_b128 a[64:67], v18 offset:8192
    s_add_u32 m0, s78, 0
    s_mov_b32 s9, 237568
    buffer_load_dwordx4 v8, s[44:47], s9 offen nt lds
    v_mfma_f32_16x16x32_bf16 v[100:103], a[68:71], v[92:95], v[100:103]
    ds_read_b128 a[68:71], v19 offset:8192
    v_mfma_f32_16x16x32_bf16 v[104:107], a[72:75], v[88:91], v[104:107]
    buffer_load_dwordx4 v9, s[44:47], s9 offen offset:1024 nt lds
    ds_read_b64_tr_b16 v[224:225], v28 offset:49152
    v_mfma_f32_16x16x32_bf16 v[108:111], a[72:75], v[92:95], v[108:111]
    ds_read_b128 a[72:75], v16 offset:12288
    v_exp_f32 v244, v32
    v_mfma_f32_16x16x32_bf16 v[112:115], a[32:35], v[88:91], v[112:115]
    s_add_u32 m0, s78, 65536
    s_mov_b32 s9, 229376
    buffer_load_dwordx4 v10, s[48:51], s9 offen nt lds
    ds_read_b64_tr_b16 v[226:227], v28 offset:51200
    v_mfma_f32_16x16x32_bf16 v[116:119], a[32:35], v[92:95], v[116:119]
    ds_read_b128 a[32:35], v17 offset:12288
    v_exp_f32 v245, v33
    v_mfma_f32_16x16x32_bf16 v[120:123], a[36:39], v[88:91], v[120:123]
    buffer_load_dwordx4 v5, s[48:51], s9 offen offset:1024 nt lds
    ds_read_b64_tr_b16 v[228:229], v29 offset:49152
    ds_read_b64_tr_b16 v[230:231], v29 offset:51200
    v_mfma_f32_16x16x32_bf16 v[124:127], a[36:39], v[92:95], v[124:127]
    ds_read_b128 a[36:39], v18 offset:12288
    v_exp_f32 v246, v34
    v_mfma_f32_16x16x32_bf16 v[128:131], a[40:43], v[88:91], v[128:131]
    ds_read_b64_tr_b16 v[232:233], v30 offset:49152
    ds_read_b64_tr_b16 v[234:235], v30 offset:51200
    v_cvt_pk_bf16_f32 v80, v244, v245
    v_mfma_f32_16x16x32_bf16 v[132:135], a[40:43], v[92:95], v[132:135]
    ds_read_b128 a[40:43], v19 offset:12288
    v_exp_f32 v247, v35
    v_mfma_f32_16x16x32_bf16 v[136:139], a[44:47], v[88:91], v[136:139]
    ds_read_b64_tr_b16 v[236:237], v31 offset:49152
    ds_read_b64_tr_b16 v[238:239], v31 offset:51200
    v_mfma_f32_16x16x32_bf16 v[140:143], a[44:47], v[92:95], v[140:143]
    ds_read_b64_tr_b16 a[44:45], v20 offset:8192
    ds_read_b64_tr_b16 a[46:47], v20 offset:12288
    v_mfma_f32_16x16x32_bf16 v[144:147], a[48:51], v[88:91], v[144:147]
    v_exp_f32 v244, v36
    v_cvt_pk_bf16_f32 v81, v246, v247
    v_mfma_f32_16x16x32_bf16 v[148:151], a[48:51], v[92:95], v[148:151]
    ds_read_b64_tr_b16 a[48:49], v21 offset:8192
    ds_read_b64_tr_b16 a[50:51], v21 offset:12288
    v_mfma_f32_16x16x32_bf16 v[152:155], a[52:55], v[88:91], v[152:155]
    v_exp_f32 v245, v37
    v_mfma_f32_16x16x32_bf16 v[156:159], a[52:55], v[92:95], v[156:159]
    ds_read_b64_tr_b16 a[52:53], v22 offset:8192
    ds_read_b64_tr_b16 a[54:55], v22 offset:12288
    v_mfma_f32_16x16x32_bf16 v[76:79], a[76:79], v[88:91], v[76:79]
    v_exp_f32 v246, v38
    v_cvt_pk_bf16_f32 v82, v244, v245
    v_mfma_f32_16x16x32_bf16 v[240:243], a[76:79], v[92:95], v[240:243]
    v_exp_f32 v247, v39
    s_waitcnt lgkmcnt(8)
    v_mfma_f32_16x16x32_bf16 v[48:51], a[56:59], v[160:163], v[64:67]
    v_exp_f32 v244, v40
    v_cvt_pk_bf16_f32 v83, v246, v247
    v_mfma_f32_16x16x32_bf16 v[48:51], a[60:63], v[164:167], v[48:51]
    v_exp_f32 v245, v41
    v_mfma_f32_16x16x32_bf16 v[48:51], a[64:67], v[168:171], v[48:51]
    v_exp_f32 v246, v42
    v_cvt_pk_bf16_f32 v84, v244, v245
    v_mfma_f32_16x16x32_bf16 v[48:51], a[68:71], v[172:175], v[48:51]
    v_exp_f32 v247, v43
    v_mfma_f32_16x16x32_bf16 v[56:59], a[56:59], v[176:179], v[68:71]
    ds_read_b64_tr_b16 a[56:57], v23 offset:8192
    ds_read_b64_tr_b16 a[58:59], v23 offset:12288
    v_mfma_f32_16x16x32_bf16 v[56:59], a[60:63], v[180:183], v[56:59]
    v_exp_f32 v244, v44
    v_cvt_pk_bf16_f32 v85, v246, v247
    v_mfma_f32_16x16x32_bf16 v[56:59], a[64:67], v[184:187], v[56:59]
    ds_read_b64_tr_b16 a[60:61], v24 offset:8192
    ds_read_b64_tr_b16 a[62:63], v24 offset:12288
    v_mfma_f32_16x16x32_bf16 v[56:59], a[68:71], v[188:191], v[56:59]
    v_exp_f32 v245, v45
    v_exp_f32 v246, v46
    v_mfma_f32_16x16x32_bf16 v[52:55], a[72:75], v[160:163], v[64:67]
    ds_read_b64_tr_b16 a[64:65], v25 offset:8192
    ds_read_b64_tr_b16 a[66:67], v25 offset:12288
    v_cvt_pk_bf16_f32 v86, v244, v245
    v_mfma_f32_16x16x32_bf16 v[52:55], a[32:35], v[164:167], v[52:55]
    v_exp_f32 v247, v47
    v_or3_b32 v14, v80, v81, v82
    v_mfma_f32_16x16x32_bf16 v[52:55], a[36:39], v[168:171], v[52:55]
    ds_read_b64_tr_b16 a[68:69], v26 offset:8192
    ds_read_b64_tr_b16 a[70:71], v26 offset:12288
    v_cvt_pk_bf16_f32 v87, v246, v247
    v_mfma_f32_16x16x32_bf16 v[52:55], a[40:43], v[172:175], v[52:55]
    v_or3_b32 v14, v14, v83, v84
    v_or3_b32 v14, v14, v85, v86
    v_bitop3_b32 v14, v14, v87, s72 bitop3:0xa8
    v_mfma_f32_16x16x32_bf16 v[60:63], a[72:75], v[176:179], v[68:71]
    ds_read_b64_tr_b16 a[72:73], v27 offset:8192
    ds_read_b64_tr_b16 a[74:75], v27 offset:12288
    s_add_u32 m0, s79, 32768
    s_add_u32 s82, s81, 270336
    s_and_b32 s82, s82, 0x7ffff
    buffer_load_dwordx4 v252, s[56:59], s82 offen lds
    v_mfma_f32_16x16x32_bf16 v[60:63], a[32:35], v[180:183], v[60:63]
    buffer_load_dwordx4 v253, s[56:59], s82 offen offset:1024 lds
    v_mfma_f32_16x16x32_bf16 v[60:63], a[36:39], v[184:187], v[60:63]
    v_cmp_ne_u32 vcc, 0, v14
    v_mfma_f32_16x16x32_bf16 v[60:63], a[40:43], v[188:191], v[60:63]
    s_cbranch_vccnz LB_r1_26
LB_b1_26:
    s_waitcnt vmcnt(8) lgkmcnt(0)
    s_barrier
    v_mfma_f32_16x16x32_bf16 v[96:99], a[44:47], v[80:83], v[96:99]
    ds_read_b128 a[32:35], v16 offset:16384
    ds_read_b128 a[36:39], v17 offset:16384
    ds_read_b128 a[40:43], v18 offset:16384
    s_add_u32 m0, s78, 8192
    s_mov_b32 s9, 245760
    buffer_load_dwordx4 v8, s[44:47], s9 offen nt lds
    v_mfma_f32_16x16x32_bf16 v[100:103], a[44:47], v[84:87], v[100:103]
    ds_read_b128 a[44:47], v19 offset:16384
    v_mfma_f32_16x16x32_bf16 v[104:107], a[48:51], v[80:83], v[104:107]
    buffer_load_dwordx4 v9, s[44:47], s9 offen offset:1024 nt lds
    v_exp_f32 v244, v48
    v_mfma_f32_16x16x32_bf16 v[108:111], a[48:51], v[84:87], v[108:111]
    ds_read_b128 a[48:51], v16 offset:20480
    v_exp_f32 v245, v49
    v_mfma_f32_16x16x32_bf16 v[112:115], a[52:55], v[80:83], v[112:115]
    s_add_u32 m0, s78, 73728
    s_mov_b32 s9, 237568
    buffer_load_dwordx4 v10, s[48:51], s9 offen nt lds
    v_mfma_f32_16x16x32_bf16 v[116:119], a[52:55], v[84:87], v[116:119]
    ds_read_b128 a[52:55], v17 offset:20480
    v_exp_f32 v246, v50
    v_mfma_f32_16x16x32_bf16 v[120:123], a[56:59], v[80:83], v[120:123]
    buffer_load_dwordx4 v5, s[48:51], s9 offen offset:1024 nt lds
    v_cvt_pk_bf16_f32 v88, v244, v245
    v_mfma_f32_16x16x32_bf16 v[124:127], a[56:59], v[84:87], v[124:127]
    ds_read_b128 a[56:59], v18 offset:20480
    v_exp_f32 v247, v51
    v_mfma_f32_16x16x32_bf16 v[128:131], a[60:63], v[80:83], v[128:131]
    v_exp_f32 v244, v52
    v_mfma_f32_16x16x32_bf16 v[132:135], a[60:63], v[84:87], v[132:135]
    ds_read_b128 a[60:63], v19 offset:20480
    v_cvt_pk_bf16_f32 v89, v246, v247
    v_mfma_f32_16x16x32_bf16 v[136:139], a[64:67], v[80:83], v[136:139]
    v_exp_f32 v245, v53
    v_mfma_f32_16x16x32_bf16 v[140:143], a[64:67], v[84:87], v[140:143]
    ds_read_b64_tr_b16 a[64:65], v20 offset:16384
    ds_read_b64_tr_b16 a[66:67], v20 offset:20480
    v_mfma_f32_16x16x32_bf16 v[144:147], a[68:71], v[80:83], v[144:147]
    v_exp_f32 v246, v54
    v_mfma_f32_16x16x32_bf16 v[148:151], a[68:71], v[84:87], v[148:151]
    ds_read_b64_tr_b16 a[68:69], v21 offset:16384
    ds_read_b64_tr_b16 a[70:71], v21 offset:20480
    v_mfma_f32_16x16x32_bf16 v[152:155], a[72:75], v[80:83], v[152:155]
    v_cvt_pk_bf16_f32 v90, v244, v245
    v_exp_f32 v247, v55
    v_mfma_f32_16x16x32_bf16 v[156:159], a[72:75], v[84:87], v[156:159]
    ds_read_b64_tr_b16 a[72:73], v22 offset:16384
    ds_read_b64_tr_b16 a[74:75], v22 offset:20480
    v_mfma_f32_16x16x32_bf16 v[76:79], a[76:79], v[80:83], v[76:79]
    v_exp_f32 v244, v56
    v_mfma_f32_16x16x32_bf16 v[240:243], a[76:79], v[84:87], v[240:243]
    v_cvt_pk_bf16_f32 v91, v246, v247
    v_exp_f32 v245, v57
    s_waitcnt lgkmcnt(6)
    v_mfma_f32_16x16x32_bf16 v[32:35], a[32:35], v[160:163], v[64:67]
    v_exp_f32 v246, v58
    v_mfma_f32_16x16x32_bf16 v[32:35], a[36:39], v[164:167], v[32:35]
    v_cvt_pk_bf16_f32 v92, v244, v245
    v_exp_f32 v247, v59
    v_mfma_f32_16x16x32_bf16 v[32:35], a[40:43], v[168:171], v[32:35]
    v_exp_f32 v244, v60
    v_mfma_f32_16x16x32_bf16 v[32:35], a[44:47], v[172:175], v[32:35]
    v_cvt_pk_bf16_f32 v93, v246, v247
    v_exp_f32 v245, v61
    v_mfma_f32_16x16x32_bf16 v[40:43], a[32:35], v[176:179], v[68:71]
    ds_read_b64_tr_b16 a[32:33], v23 offset:16384
    ds_read_b64_tr_b16 a[34:35], v23 offset:20480
    v_mfma_f32_16x16x32_bf16 v[40:43], a[36:39], v[180:183], v[40:43]
    v_exp_f32 v246, v62
    v_mfma_f32_16x16x32_bf16 v[40:43], a[40:43], v[184:187], v[40:43]
    ds_read_b64_tr_b16 a[36:37], v24 offset:16384
    ds_read_b64_tr_b16 a[38:39], v24 offset:20480
    v_mfma_f32_16x16x32_bf16 v[40:43], a[44:47], v[188:191], v[40:43]
    v_cvt_pk_bf16_f32 v94, v244, v245
    v_exp_f32 v247, v63
    v_mfma_f32_16x16x32_bf16 v[36:39], a[48:51], v[160:163], v[64:67]
    ds_read_b64_tr_b16 a[40:41], v25 offset:16384
    ds_read_b64_tr_b16 a[42:43], v25 offset:20480
    v_mfma_f32_16x16x32_bf16 v[36:39], a[52:55], v[164:167], v[36:39]
    v_or3_b32 v14, v88, v89, v90
    v_cvt_pk_bf16_f32 v95, v246, v247
    v_mfma_f32_16x16x32_bf16 v[36:39], a[56:59], v[168:171], v[36:39]
    ds_read_b64_tr_b16 a[44:45], v26 offset:16384
    ds_read_b64_tr_b16 a[46:47], v26 offset:20480
    v_mfma_f32_16x16x32_bf16 v[36:39], a[60:63], v[172:175], v[36:39]
    v_or3_b32 v14, v14, v91, v92
    v_or3_b32 v14, v14, v93, v94
    v_mfma_f32_16x16x32_bf16 v[44:47], a[48:51], v[176:179], v[68:71]
    ds_read_b64_tr_b16 a[48:49], v27 offset:16384
    ds_read_b64_tr_b16 a[50:51], v27 offset:20480
    s_add_u32 m0, s79, 32768
    s_nop 0
    buffer_load_dwordx4 v254, s[56:59], s82 offen offset:2048 lds
    v_mfma_f32_16x16x32_bf16 v[44:47], a[52:55], v[180:183], v[44:47]
    buffer_load_dwordx4 v255, s[56:59], s82 offen offset:3072 lds
    v_mfma_f32_16x16x32_bf16 v[44:47], a[56:59], v[184:187], v[44:47]
    v_bitop3_b32 v14, v14, v95, s72 bitop3:0xa8
    v_cmp_ne_u32 vcc, 0, v14
    v_mfma_f32_16x16x32_bf16 v[44:47], a[60:63], v[188:191], v[44:47]
    s_cbranch_vccnz LB_r1_27
LB_b1_27:
    s_waitcnt vmcnt(8) lgkmcnt(0)
    s_barrier
    v_mfma_f32_16x16x32_bf16 v[96:99], a[64:67], v[88:91], v[96:99]
    ds_read_b128 a[52:55], v16 offset:0
    ds_read_b128 a[56:59], v17 offset:0
    ds_read_b128 a[60:63], v18 offset:0
    s_add_u32 m0, s78, 16384
    s_mov_b32 s9, 253952
    buffer_load_dwordx4 v8, s[44:47], s9 offen nt lds
    v_mfma_f32_16x16x32_bf16 v[100:103], a[64:67], v[92:95], v[100:103]
    ds_read_b128 a[64:67], v19 offset:0
    v_mfma_f32_16x16x32_bf16 v[104:107], a[68:71], v[88:91], v[104:107]
    buffer_load_dwordx4 v9, s[44:47], s9 offen offset:1024 nt lds
    v_exp_f32 v244, v32
    v_mfma_f32_16x16x32_bf16 v[108:111], a[68:71], v[92:95], v[108:111]
    ds_read_b128 a[68:71], v16 offset:4096
    v_exp_f32 v245, v33
    v_mfma_f32_16x16x32_bf16 v[112:115], a[72:75], v[88:91], v[112:115]
    s_add_u32 m0, s78, 81920
    s_mov_b32 s9, 245760
    buffer_load_dwordx4 v10, s[48:51], s9 offen nt lds
    v_mfma_f32_16x16x32_bf16 v[116:119], a[72:75], v[92:95], v[116:119]
    ds_read_b128 a[72:75], v17 offset:4096
    v_exp_f32 v246, v34
    v_mfma_f32_16x16x32_bf16 v[120:123], a[32:35], v[88:91], v[120:123]
    buffer_load_dwordx4 v5, s[48:51], s9 offen offset:1024 nt lds
    v_cvt_pk_bf16_f32 v80, v244, v245
    v_mfma_f32_16x16x32_bf16 v[124:127], a[32:35], v[92:95], v[124:127]
    ds_read_b128 a[32:35], v18 offset:4096
    v_exp_f32 v247, v35
    v_mfma_f32_16x16x32_bf16 v[128:131], a[36:39], v[88:91], v[128:131]
    v_exp_f32 v244, v36
    v_mfma_f32_16x16x32_bf16 v[132:135], a[36:39], v[92:95], v[132:135]
    ds_read_b128 a[36:39], v19 offset:4096
    v_cvt_pk_bf16_f32 v81, v246, v247
    v_mfma_f32_16x16x32_bf16 v[136:139], a[40:43], v[88:91], v[136:139]
    v_exp_f32 v245, v37
    v_mfma_f32_16x16x32_bf16 v[140:143], a[40:43], v[92:95], v[140:143]
    ds_read_b64_tr_b16 a[40:41], v20 offset:0
    ds_read_b64_tr_b16 a[42:43], v20 offset:4096
    v_mfma_f32_16x16x32_bf16 v[144:147], a[44:47], v[88:91], v[144:147]
    v_exp_f32 v246, v38
    v_cvt_pk_bf16_f32 v82, v244, v245
    v_mfma_f32_16x16x32_bf16 v[148:151], a[44:47], v[92:95], v[148:151]
    ds_read_b64_tr_b16 a[44:45], v21 offset:0
    ds_read_b64_tr_b16 a[46:47], v21 offset:4096
    v_mfma_f32_16x16x32_bf16 v[152:155], a[48:51], v[88:91], v[152:155]
    v_exp_f32 v247, v39
    v_mfma_f32_16x16x32_bf16 v[156:159], a[48:51], v[92:95], v[156:159]
    ds_read_b64_tr_b16 a[48:49], v22 offset:0
    ds_read_b64_tr_b16 a[50:51], v22 offset:4096
    v_mfma_f32_16x16x32_bf16 v[76:79], a[76:79], v[88:91], v[76:79]
    v_exp_f32 v244, v40
    v_cvt_pk_bf16_f32 v83, v246, v247
    v_mfma_f32_16x16x32_bf16 v[240:243], a[76:79], v[92:95], v[240:243]
    v_exp_f32 v245, v41
    s_waitcnt lgkmcnt(6)
    v_mfma_f32_16x16x32_bf16 v[48:51], a[52:55], v[160:163], v[64:67]
    v_exp_f32 v246, v42
    v_cvt_pk_bf16_f32 v84, v244, v245
    v_mfma_f32_16x16x32_bf16 v[48:51], a[56:59], v[164:167], v[48:51]
    v_exp_f32 v247, v43
    v_mfma_f32_16x16x32_bf16 v[48:51], a[60:63], v[168:171], v[48:51]
    v_exp_f32 v244, v44
    v_cvt_pk_bf16_f32 v85, v246, v247
    v_mfma_f32_16x16x32_bf16 v[48:51], a[64:67], v[172:175], v[48:51]
    v_exp_f32 v245, v45
    v_mfma_f32_16x16x32_bf16 v[56:59], a[52:55], v[176:179], v[68:71]
    ds_read_b64_tr_b16 a[52:53], v23 offset:0
    ds_read_b64_tr_b16 a[54:55], v23 offset:4096
    v_mfma_f32_16x16x32_bf16 v[56:59], a[56:59], v[180:183], v[56:59]
    v_exp_f32 v246, v46
    v_cvt_pk_bf16_f32 v86, v244, v245
    v_mfma_f32_16x16x32_bf16 v[56:59], a[60:63], v[184:187], v[56:59]
    ds_read_b64_tr_b16 a[56:57], v24 offset:0
    ds_read_b64_tr_b16 a[58:59], v24 offset:4096
    v_mfma_f32_16x16x32_bf16 v[56:59], a[64:67], v[188:191], v[56:59]
    v_exp_f32 v247, v47
    v_or3_b32 v14, v80, v81, v82
    v_mfma_f32_16x16x32_bf16 v[52:55], a[68:71], v[160:163], v[64:67]
    ds_read_b64_tr_b16 a[60:61], v25 offset:0
    ds_read_b64_tr_b16 a[62:63], v25 offset:4096
    s_add_u32 m0, s79, 49152
    s_add_u32 s82, s81, 294912
    s_and_b32 s82, s82, 0x7ffff
    buffer_load_dwordx4 v252, s[56:59], s82 offen lds
    v_mfma_f32_16x16x32_bf16 v[52:55], a[72:75], v[164:167], v[52:55]
    v_cvt_pk_bf16_f32 v87, v246, v247
    v_or3_b32 v14, v14, v83, v84
    v_mfma_f32_16x16x32_bf16 v[52:55], a[32:35], v[168:171], v[52:55]
    ds_read_b64_tr_b16 a[64:65], v26 offset:0
    ds_read_b64_tr_b16 a[66:67], v26 offset:4096
    buffer_load_dwordx4 v253, s[56:59], s82 offen offset:1024 lds
    v_mfma_f32_16x16x32_bf16 v[52:55], a[36:39], v[172:175], v[52:55]
    v_or3_b32 v14, v14, v85, v86
    v_bitop3_b32 v14, v14, v87, s72 bitop3:0xa8
    v_mfma_f32_16x16x32_bf16 v[60:63], a[68:71], v[176:179], v[68:71]
    ds_read_b64_tr_b16 a[68:69], v27 offset:0
    ds_read_b64_tr_b16 a[70:71], v27 offset:4096
    buffer_load_dwordx4 v254, s[56:59], s82 offen offset:2048 lds
    v_mfma_f32_16x16x32_bf16 v[60:63], a[72:75], v[180:183], v[60:63]
    buffer_load_dwordx4 v255, s[56:59], s82 offen offset:3072 lds
    v_mfma_f32_16x16x32_bf16 v[60:63], a[32:35], v[184:187], v[60:63]
    v_cmp_ne_u32 vcc, 0, v14
    v_mfma_f32_16x16x32_bf16 v[60:63], a[36:39], v[188:191], v[60:63]
    s_cbranch_vccnz LB_r1_28
LB_b1_28:
    s_waitcnt vmcnt(10) lgkmcnt(0)
    s_barrier
    v_mfma_f32_16x16x32_bf16 v[96:99], a[40:43], v[80:83], v[96:99]
    ds_read_b128 a[72:75], v16 offset:8192
    ds_read_b128 a[32:35], v17 offset:8192
    ds_read_b128 a[36:39], v18 offset:8192
    s_add_u32 m0, s78, 65536
    s_mov_b32 s9, 253952
    buffer_load_dwordx4 v10, s[48:51], s9 offen nt lds
    v_mfma_f32_16x16x32_bf16 v[100:103], a[40:43], v[84:87], v[100:103]
    ds_read_b128 a[40:43], v19 offset:8192
    v_mfma_f32_16x16x32_bf16 v[104:107], a[44:47], v[80:83], v[104:107]
    buffer_load_dwordx4 v5, s[48:51], s9 offen offset:1024 nt lds
    v_exp_f32 v244, v48
    v_mfma_f32_16x16x32_bf16 v[108:111], a[44:47], v[84:87], v[108:111]
    ds_read_b128 a[44:47], v16 offset:12288
    v_exp_f32 v245, v49
    v_mfma_f32_16x16x32_bf16 v[112:115], a[48:51], v[80:83], v[112:115]
    s_add_u32 m0, s79, 114688
    s_add_u32 s82, s81, 303104
    s_and_b32 s82, s82, 0x7ffff
    buffer_load_dwordx4 v252, s[56:59], s82 offen lds
    v_mfma_f32_16x16x32_bf16 v[116:119], a[48:51], v[84:87], v[116:119]
    ds_read_b128 a[48:51], v17 offset:12288
    v_exp_f32 v246, v50
    v_mfma_f32_16x16x32_bf16 v[120:123], a[52:55], v[80:83], v[120:123]
    buffer_load_dwordx4 v253, s[56:59], s82 offen offset:1024 lds
    v_cvt_pk_bf16_f32 v88, v244, v245
    v_mfma_f32_16x16x32_bf16 v[124:127], a[52:55], v[84:87], v[124:127]
    ds_read_b128 a[52:55], v18 offset:12288
    v_exp_f32 v247, v51
    v_mfma_f32_16x16x32_bf16 v[128:131], a[56:59], v[80:83], v[128:131]
    v_exp_f32 v244, v52
    v_mfma_f32_16x16x32_bf16 v[132:135], a[56:59], v[84:87], v[132:135]
    ds_read_b128 a[56:59], v19 offset:12288
    v_cvt_pk_bf16_f32 v89, v246, v247
    v_mfma_f32_16x16x32_bf16 v[136:139], a[60:63], v[80:83], v[136:139]
    v_exp_f32 v245, v53
    v_mfma_f32_16x16x32_bf16 v[140:143], a[60:63], v[84:87], v[140:143]
    ds_read_b64_tr_b16 a[60:61], v20 offset:8192
    ds_read_b64_tr_b16 a[62:63], v20 offset:12288
    v_mfma_f32_16x16x32_bf16 v[144:147], a[64:67], v[80:83], v[144:147]
    v_exp_f32 v246, v54
    v_mfma_f32_16x16x32_bf16 v[148:151], a[64:67], v[84:87], v[148:151]
    ds_read_b64_tr_b16 a[64:65], v21 offset:8192
    ds_read_b64_tr_b16 a[66:67], v21 offset:12288
    v_mfma_f32_16x16x32_bf16 v[152:155], a[68:71], v[80:83], v[152:155]
    v_cvt_pk_bf16_f32 v90, v244, v245
    v_exp_f32 v247, v55
    v_mfma_f32_16x16x32_bf16 v[156:159], a[68:71], v[84:87], v[156:159]
    ds_read_b64_tr_b16 a[68:69], v22 offset:8192
    ds_read_b64_tr_b16 a[70:71], v22 offset:12288
    v_mfma_f32_16x16x32_bf16 v[76:79], a[76:79], v[80:83], v[76:79]
    v_exp_f32 v244, v56
    v_mfma_f32_16x16x32_bf16 v[240:243], a[76:79], v[84:87], v[240:243]
    v_cvt_pk_bf16_f32 v91, v246, v247
    v_exp_f32 v245, v57
    s_waitcnt lgkmcnt(6)
    v_mfma_f32_16x16x32_bf16 v[32:35], a[72:75], v[160:163], v[64:67]
    v_exp_f32 v246, v58
    v_mfma_f32_16x16x32_bf16 v[32:35], a[32:35], v[164:167], v[32:35]
    v_cvt_pk_bf16_f32 v92, v244, v245
    v_exp_f32 v247, v59
    v_mfma_f32_16x16x32_bf16 v[32:35], a[36:39], v[168:171], v[32:35]
    v_exp_f32 v244, v60
    v_mfma_f32_16x16x32_bf16 v[32:35], a[40:43], v[172:175], v[32:35]
    v_cvt_pk_bf16_f32 v93, v246, v247
    v_exp_f32 v245, v61
    v_mfma_f32_16x16x32_bf16 v[40:43], a[72:75], v[176:179], v[68:71]
    ds_read_b64_tr_b16 a[72:73], v23 offset:8192
    ds_read_b64_tr_b16 a[74:75], v23 offset:12288
    v_mfma_f32_16x16x32_bf16 v[40:43], a[32:35], v[180:183], v[40:43]
    v_exp_f32 v246, v62
    v_mfma_f32_16x16x32_bf16 v[40:43], a[36:39], v[184:187], v[40:43]
    ds_read_b64_tr_b16 a[32:33], v24 offset:8192
    ds_read_b64_tr_b16 a[34:35], v24 offset:12288
    v_mfma_f32_16x16x32_bf16 v[40:43], a[40:43], v[188:191], v[40:43]
    v_cvt_pk_bf16_f32 v94, v244, v245
    v_exp_f32 v247, v63
    v_mfma_f32_16x16x32_bf16 v[36:39], a[44:47], v[160:163], v[64:67]
    ds_read_b64_tr_b16 a[36:37], v25 offset:8192
    ds_read_b64_tr_b16 a[38:39], v25 offset:12288
    v_mfma_f32_16x16x32_bf16 v[36:39], a[48:51], v[164:167], v[36:39]
    v_or3_b32 v14, v88, v89, v90
    v_cvt_pk_bf16_f32 v95, v246, v247
    v_mfma_f32_16x16x32_bf16 v[36:39], a[52:55], v[168:171], v[36:39]
    ds_read_b64_tr_b16 a[40:41], v26 offset:8192
    ds_read_b64_tr_b16 a[42:43], v26 offset:12288
    v_mfma_f32_16x16x32_bf16 v[36:39], a[56:59], v[172:175], v[36:39]
    v_or3_b32 v14, v14, v91, v92
    v_or3_b32 v14, v14, v93, v94
    v_mfma_f32_16x16x32_bf16 v[44:47], a[44:47], v[176:179], v[68:71]
    ds_read_b64_tr_b16 a[44:45], v27 offset:8192
    ds_read_b64_tr_b16 a[46:47], v27 offset:12288
    buffer_load_dwordx4 v254, s[56:59], s82 offen offset:2048 lds
    v_mfma_f32_16x16x32_bf16 v[44:47], a[48:51], v[180:183], v[44:47]
    buffer_load_dwordx4 v255, s[56:59], s82 offen offset:3072 lds
    v_mfma_f32_16x16x32_bf16 v[44:47], a[52:55], v[184:187], v[44:47]
    v_bitop3_b32 v14, v14, v95, s72 bitop3:0xa8
    v_cmp_ne_u32 vcc, 0, v14
    v_mfma_f32_16x16x32_bf16 v[44:47], a[56:59], v[188:191], v[44:47]
    s_cbranch_vccnz LB_r1_29
LB_b1_29:
    s_waitcnt vmcnt(12) lgkmcnt(0)
    s_barrier
    v_mfma_f32_16x16x32_bf16 v[96:99], a[60:63], v[88:91], v[96:99]
    ds_read_b128 a[48:51], v16 offset:16384
    ds_read_b128 a[52:55], v17 offset:16384
    ds_read_b128 a[56:59], v18 offset:16384
    s_add_u32 m0, s79, 131072
    s_add_u32 s82, s81, 327680
    s_and_b32 s82, s82, 0x7ffff
    buffer_load_dwordx4 v252, s[56:59], s82 offen lds
    v_mfma_f32_16x16x32_bf16 v[100:103], a[60:63], v[92:95], v[100:103]
    ds_read_b128 a[60:63], v19 offset:16384
    v_mfma_f32_16x16x32_bf16 v[104:107], a[64:67], v[88:91], v[104:107]
    buffer_load_dwordx4 v253, s[56:59], s82 offen offset:1024 lds
    v_mfma_f32_16x16x32_bf16 v[108:111], a[64:67], v[92:95], v[108:111]
    ds_read_b128 a[64:67], v16 offset:20480
    v_exp_f32 v244, v32
    v_mfma_f32_16x16x32_bf16 v[112:115], a[68:71], v[88:91], v[112:115]
    buffer_load_dwordx4 v254, s[56:59], s82 offen offset:2048 lds
    v_mfma_f32_16x16x32_bf16 v[116:119], a[68:71], v[92:95], v[116:119]
    ds_read_b128 a[68:71], v17 offset:20480
    v_exp_f32 v245, v33
    v_mfma_f32_16x16x32_bf16 v[120:123], a[72:75], v[88:91], v[120:123]
    buffer_load_dwordx4 v255, s[56:59], s82 offen offset:3072 lds
    v_mfma_f32_16x16x32_bf16 v[124:127], a[72:75], v[92:95], v[124:127]
    ds_read_b128 a[72:75], v18 offset:20480
    v_exp_f32 v246, v34
    v_mfma_f32_16x16x32_bf16 v[128:131], a[32:35], v[88:91], v[128:131]
    v_cvt_pk_bf16_f32 v80, v244, v245
    v_exp_f32 v247, v35
    v_mfma_f32_16x16x32_bf16 v[132:135], a[32:35], v[92:95], v[132:135]
    ds_read_b128 a[32:35], v19 offset:20480
    v_exp_f32 v244, v36
    v_mfma_f32_16x16x32_bf16 v[136:139], a[36:39], v[88:91], v[136:139]
    v_cvt_pk_bf16_f32 v81, v246, v247
    v_exp_f32 v245, v37
    v_mfma_f32_16x16x32_bf16 v[140:143], a[36:39], v[92:95], v[140:143]
    s_waitcnt vmcnt(14)
    s_barrier
    ds_read_b64_tr_b16 a[36:37], v20 offset:16384
    ds_read_b64_tr_b16 a[38:39], v20 offset:20480
    v_mfma_f32_16x16x32_bf16 v[144:147], a[40:43], v[88:91], v[144:147]
    v_exp_f32 v246, v38
    v_mfma_f32_16x16x32_bf16 v[148:151], a[40:43], v[92:95], v[148:151]
    ds_read_b64_tr_b16 a[40:41], v21 offset:16384
    ds_read_b64_tr_b16 a[42:43], v21 offset:20480
    v_mfma_f32_16x16x32_bf16 v[152:155], a[44:47], v[88:91], v[152:155]
    v_cvt_pk_bf16_f32 v82, v244, v245
    v_exp_f32 v247, v39
    v_mfma_f32_16x16x32_bf16 v[156:159], a[44:47], v[92:95], v[156:159]
    ds_read_b64_tr_b16 a[44:45], v22 offset:16384
    ds_read_b64_tr_b16 a[46:47], v22 offset:20480
    v_mfma_f32_16x16x32_bf16 v[76:79], a[76:79], v[88:91], v[76:79]
    v_exp_f32 v244, v40
    v_mfma_f32_16x16x32_bf16 v[240:243], a[76:79], v[92:95], v[240:243]
    v_cvt_pk_bf16_f32 v83, v246, v247
    v_exp_f32 v245, v41
    s_waitcnt lgkmcnt(6)
    v_mfma_f32_16x16x32_bf16 v[48:51], a[48:51], v[160:163], v[64:67]
    v_exp_f32 v246, v42
    v_mfma_f32_16x16x32_bf16 v[48:51], a[52:55], v[164:167], v[48:51]
    v_cvt_pk_bf16_f32 v84, v244, v245
    v_exp_f32 v247, v43
    v_mfma_f32_16x16x32_bf16 v[48:51], a[56:59], v[168:171], v[48:51]
    v_exp_f32 v244, v44
    v_mfma_f32_16x16x32_bf16 v[48:51], a[60:63], v[172:175], v[48:51]
    v_cvt_pk_bf16_f32 v85, v246, v247
    v_exp_f32 v245, v45
    v_mfma_f32_16x16x32_bf16 v[56:59], a[48:51], v[176:179], v[68:71]
    ds_read_b64_tr_b16 a[48:49], v23 offset:16384
    ds_read_b64_tr_b16 a[50:51], v23 offset:20480
    v_mfma_f32_16x16x32_bf16 v[56:59], a[52:55], v[180:183], v[56:59]
    v_exp_f32 v246, v46
    v_mfma_f32_16x16x32_bf16 v[56:59], a[56:59], v[184:187], v[56:59]
    ds_read_b64_tr_b16 a[52:53], v24 offset:16384
    ds_read_b64_tr_b16 a[54:55], v24 offset:20480
    v_mfma_f32_16x16x32_bf16 v[56:59], a[60:63], v[188:191], v[56:59]
    v_cvt_pk_bf16_f32 v86, v244, v245
    v_mfma_f32_16x16x32_bf16 v[52:55], a[64:67], v[160:163], v[64:67]
    ds_read_b64_tr_b16 a[56:57], v25 offset:16384
    ds_read_b64_tr_b16 a[58:59], v25 offset:20480
    v_mfma_f32_16x16x32_bf16 v[52:55], a[68:71], v[164:167], v[52:55]
    v_exp_f32 v247, v47
    v_mfma_f32_16x16x32_bf16 v[52:55], a[72:75], v[168:171], v[52:55]
    ds_read_b64_tr_b16 a[60:61], v26 offset:16384
    ds_read_b64_tr_b16 a[62:63], v26 offset:20480
    v_mfma_f32_16x16x32_bf16 v[52:55], a[32:35], v[172:175], v[52:55]
    v_or3_b32 v14, v80, v81, v82
    v_cvt_pk_bf16_f32 v87, v246, v247
    v_mfma_f32_16x16x32_bf16 v[60:63], a[64:67], v[176:179], v[68:71]
    ds_read_b64_tr_b16 a[64:65], v27 offset:16384
    ds_read_b64_tr_b16 a[66:67], v27 offset:20480
    v_mfma_f32_16x16x32_bf16 v[60:63], a[68:71], v[180:183], v[60:63]
    v_or3_b32 v14, v14, v83, v84
    v_or3_b32 v14, v14, v85, v86
    v_mfma_f32_16x16x32_bf16 v[60:63], a[72:75], v[184:187], v[60:63]
    v_bitop3_b32 v14, v14, v87, s72 bitop3:0xa8
    v_cmp_ne_u32 vcc, 0, v14
    v_mfma_f32_16x16x32_bf16 v[60:63], a[32:35], v[188:191], v[60:63]
    s_cbranch_vccnz LB_r1_30
LB_b1_30:
    s_waitcnt lgkmcnt(0)
    s_barrier
    v_mfma_f32_16x16x32_bf16 v[96:99], a[36:39], v[80:83], v[96:99]
    v_lshlrev_b32 v3, 4, v1
    v_and_b32 v2, 15, v1
    v_lshlrev_b32 v2, 4, v2
    v_lshrrev_b32 v4, 4, v1
    v_lshl_add_u32 v2, v4, 9, v2
    s_lshl_b32 s10, s3, 3
    s_lshl_b32 s11, s5, 1
    s_sub_u32 s10, s10, s11
    v_mfma_f32_16x16x32_bf16 v[100:103], a[36:39], v[84:87], v[100:103]
    s_add_u32 s11, s10, 0
    s_and_b32 s11, s11, 31
    s_lshl_b32 s11, s11, 10
    v_add_u32 v16, s11, v2
    v_mfma_f32_16x16x32_bf16 v[104:107], a[40:43], v[80:83], v[104:107]
    s_add_u32 s11, s10, 2
    s_and_b32 s11, s11, 31
    s_lshl_b32 s11, s11, 10
    v_add_u32 v17, s11, v2
    v_add_u32 v28, 65536, v28
    v_add_u32 v29, 65536, v29
    v_add_u32 v30, 65536, v30
    v_add_u32 v31, 65536, v31
    ds_read_b64_tr_b16 v[160:161], v28 offset:32768
    v_mfma_f32_16x16x32_bf16 v[108:111], a[40:43], v[84:87], v[108:111]
    s_add_u32 s11, s10, 4
    s_and_b32 s11, s11, 31
    s_lshl_b32 s11, s11, 10
    v_add_u32 v18, s11, v2
    v_mfma_f32_16x16x32_bf16 v[112:115], a[44:47], v[80:83], v[112:115]
    s_add_u32 s11, s10, 6
    s_and_b32 s11, s11, 31
    s_lshl_b32 s11, s11, 10
    v_add_u32 v19, s11, v2
    ds_read_b64_tr_b16 v[162:163], v28 offset:34816
    v_mfma_f32_16x16x32_bf16 v[116:119], a[44:47], v[84:87], v[116:119]
    v_exp_f32 v244, v48
    v_mfma_f32_16x16x32_bf16 v[120:123], a[48:51], v[80:83], v[120:123]
    ds_read_b64_tr_b16 v[164:165], v29 offset:32768
    ds_read_b64_tr_b16 v[166:167], v29 offset:34816
    v_mfma_f32_16x16x32_bf16 v[124:127], a[48:51], v[84:87], v[124:127]
    v_exp_f32 v245, v49
    v_mfma_f32_16x16x32_bf16 v[128:131], a[52:55], v[80:83], v[128:131]
    ds_read_b64_tr_b16 v[168:169], v30 offset:32768
    ds_read_b64_tr_b16 v[170:171], v30 offset:34816
    v_mfma_f32_16x16x32_bf16 v[132:135], a[52:55], v[84:87], v[132:135]
    v_exp_f32 v246, v50
    v_mfma_f32_16x16x32_bf16 v[136:139], a[56:59], v[80:83], v[136:139]
    ds_read_b64_tr_b16 v[172:173], v31 offset:32768
    ds_read_b64_tr_b16 v[174:175], v31 offset:34816
    v_mfma_f32_16x16x32_bf16 v[140:143], a[56:59], v[84:87], v[140:143]
    v_subrev_u32 v28, 65536, v28
    v_subrev_u32 v29, 65536, v29
    v_subrev_u32 v30, 65536, v30
    v_subrev_u32 v31, 65536, v31
    ds_read_b64_tr_b16 v[176:177], v28 offset:32768
    ds_read_b64_tr_b16 v[178:179], v28 offset:34816
    v_mfma_f32_16x16x32_bf16 v[144:147], a[60:63], v[80:83], v[144:147]
    ds_read_b64_tr_b16 v[180:181], v29 offset:32768
    ds_read_b64_tr_b16 v[182:183], v29 offset:34816
    v_mfma_f32_16x16x32_bf16 v[148:151], a[60:63], v[84:87], v[148:151]
    ds_read_b64_tr_b16 v[184:185], v30 offset:32768
    ds_read_b64_tr_b16 v[186:187], v30 offset:34816
    v_mfma_f32_16x16x32_bf16 v[152:155], a[64:67], v[80:83], v[152:155]
    ds_read_b64_tr_b16 v[188:189], v31 offset:32768
    ds_read_b64_tr_b16 v[190:191], v31 offset:34816
    v_mfma_f32_16x16x32_bf16 v[156:159], a[64:67], v[84:87], v[156:159]
    v_cvt_pk_bf16_f32 v88, v244, v245
    v_exp_f32 v247, v51
    v_mfma_f32_16x16x32_bf16 v[76:79], a[76:79], v[80:83], v[76:79]
    v_exp_f32 v244, v52
    v_mfma_f32_16x16x32_bf16 v[240:243], a[76:79], v[84:87], v[240:243]
    v_cvt_pk_bf16_f32 v89, v246, v247
    v_exp_f32 v245, v53
    v_exp_f32 v246, v54
    v_cvt_pk_bf16_f32 v90, v244, v245
    v_exp_f32 v247, v55
    v_exp_f32 v244, v56
    v_cvt_pk_bf16_f32 v91, v246, v247
    v_exp_f32 v245, v57
    v_exp_f32 v246, v58
    v_cvt_pk_bf16_f32 v92, v244, v245
    v_exp_f32 v247, v59
    v_exp_f32 v244, v60
    v_cvt_pk_bf16_f32 v93, v246, v247
    v_exp_f32 v245, v61
    v_exp_f32 v246, v62
    v_cvt_pk_bf16_f32 v94, v244, v245
    v_exp_f32 v247, v63
    v_or3_b32 v14, v88, v89, v90
    v_cvt_pk_bf16_f32 v95, v246, v247
    v_or3_b32 v14, v14, v91, v92
    v_or3_b32 v14, v14, v93, v94
    v_bitop3_b32 v14, v14, v95, s72 bitop3:0xa8
    v_cmp_ne_u32 vcc, 0, v14
    s_cbranch_vccnz LB_r1_31
LB_b1_31:
    v_mfma_f32_16x16x32_bf16 v[76:79], a[76:79], v[88:91], v[76:79]
    v_mfma_f32_16x16x32_bf16 v[240:243], a[76:79], v[92:95], v[240:243]
    s_waitcnt vmcnt(8)
    s_barrier
    ds_read_b64_tr_b16 a[56:57], v20 offset:0
    ds_read_b64_tr_b16 a[58:59], v20 offset:4096
    ds_read_b64_tr_b16 a[60:61], v21 offset:0
    ds_read_b64_tr_b16 a[62:63], v21 offset:4096
    ds_read_b64_tr_b16 a[64:65], v22 offset:0
    ds_read_b64_tr_b16 a[66:67], v22 offset:4096
    ds_read_b64_tr_b16 a[68:69], v23 offset:0
    ds_read_b64_tr_b16 a[70:71], v23 offset:4096
    ds_read_b64_tr_b16 a[72:73], v24 offset:0
    ds_read_b64_tr_b16 a[74:75], v24 offset:4096
    ds_read_b64_tr_b16 a[32:33], v25 offset:0
    ds_read_b64_tr_b16 a[34:35], v25 offset:4096
    ds_read_b64_tr_b16 a[36:37], v26 offset:0
    ds_read_b64_tr_b16 a[38:39], v26 offset:4096
    ds_read_b64_tr_b16 a[40:41], v27 offset:0
    ds_read_b64_tr_b16 a[42:43], v27 offset:4096
    v_rcp_f32 v74, v76
    v_rcp_f32 v14, v240
    v_mov_b32 v75, v74
    v_mov_b32 v15, v14
    s_waitcnt lgkmcnt(14)
    v_mfma_f32_16x16x32_bf16 v[96:99], a[56:59], v[88:91], v[96:99]
    v_add_u32 v20, 65536, v28
    v_add_u32 v21, 65536, v29
    v_mfma_f32_16x16x32_bf16 v[100:103], a[56:59], v[92:95], v[100:103]
    v_add_u32 v22, 65536, v30
    v_add_u32 v23, 65536, v31
    s_waitcnt lgkmcnt(12)
    v_mfma_f32_16x16x32_bf16 v[104:107], a[60:63], v[88:91], v[104:107]
    v_add_u32 v24, 98304, v28
    v_add_u32 v25, 98304, v29
    v_mfma_f32_16x16x32_bf16 v[108:111], a[60:63], v[92:95], v[108:111]
    v_add_u32 v26, 98304, v30
    v_add_u32 v27, 98304, v31
    s_waitcnt lgkmcnt(10)
    v_mfma_f32_16x16x32_bf16 v[112:115], a[64:67], v[88:91], v[112:115]
    s_lshl_b32 s10, s3, 4
    s_add_u32 s10, s10, s4
    v_mfma_f32_16x16x32_bf16 v[116:119], a[64:67], v[92:95], v[116:119]
    s_lshl_b32 s10, s10, 12
    s_add_u32 s10, s10, s75
    s_waitcnt lgkmcnt(8)
    v_mfma_f32_16x16x32_bf16 v[120:123], a[68:71], v[88:91], v[120:123]
    s_add_u32 s11, s10, 32768
    v_pk_mul_f32 v[96:97], v[96:97], v[74:75]
    v_pk_mul_f32 v[98:99], v[98:99], v[74:75]
    v_pk_mul_f32 v[104:105], v[104:105], v[74:75]
    v_pk_mul_f32 v[106:107], v[106:107], v[74:75]
    v_mfma_f32_16x16x32_bf16 v[124:127], a[68:71], v[92:95], v[124:127]
    v_cvt_pk_bf16_f32 v32, v96, v97
    v_cvt_pk_bf16_f32 v33, v98, v99
    v_cvt_pk_bf16_f32 v34, v104, v105
    v_cvt_pk_bf16_f32 v35, v106, v107
    s_waitcnt lgkmcnt(6)
    v_mfma_f32_16x16x32_bf16 v[128:131], a[72:75], v[88:91], v[128:131]
    ds_write_b128 v16, v[32:35] offset:0
    v_pk_mul_f32 v[100:101], v[100:101], v[14:15]
    v_pk_mul_f32 v[102:103], v[102:103], v[14:15]
    v_pk_mul_f32 v[108:109], v[108:109], v[14:15]
    v_mfma_f32_16x16x32_bf16 v[132:135], a[72:75], v[92:95], v[132:135]
    v_pk_mul_f32 v[110:111], v[110:111], v[14:15]
    v_cvt_pk_bf16_f32 v36, v100, v101
    v_cvt_pk_bf16_f32 v37, v102, v103
    v_cvt_pk_bf16_f32 v38, v108, v109
    s_waitcnt lgkmcnt(5)
    v_mfma_f32_16x16x32_bf16 v[136:139], a[32:35], v[88:91], v[136:139]
    v_cvt_pk_bf16_f32 v39, v110, v111
    ds_write_b128 v16, v[36:39] offset:256
    v_pk_mul_f32 v[112:113], v[112:113], v[74:75]
    v_pk_mul_f32 v[114:115], v[114:115], v[74:75]
    v_mfma_f32_16x16x32_bf16 v[140:143], a[32:35], v[92:95], v[140:143]
    v_pk_mul_f32 v[120:121], v[120:121], v[74:75]
    v_pk_mul_f32 v[122:123], v[122:123], v[74:75]
    v_cvt_pk_bf16_f32 v40, v112, v113
    v_cvt_pk_bf16_f32 v41, v114, v115
    s_waitcnt lgkmcnt(4)
    v_mfma_f32_16x16x32_bf16 v[144:147], a[36:39], v[88:91], v[144:147]
    v_cvt_pk_bf16_f32 v42, v120, v121
    v_cvt_pk_bf16_f32 v43, v122, v123
    ds_write_b128 v17, v[40:43] offset:0
    v_pk_mul_f32 v[116:117], v[116:117], v[14:15]
    v_mfma_f32_16x16x32_bf16 v[148:151], a[36:39], v[92:95], v[148:151]
    v_pk_mul_f32 v[118:119], v[118:119], v[14:15]
    v_pk_mul_f32 v[124:125], v[124:125], v[14:15]
    v_pk_mul_f32 v[126:127], v[126:127], v[14:15]
    v_cvt_pk_bf16_f32 v44, v116, v117
    s_waitcnt lgkmcnt(3)
    v_mfma_f32_16x16x32_bf16 v[152:155], a[40:43], v[88:91], v[152:155]
    v_cvt_pk_bf16_f32 v45, v118, v119
    v_cvt_pk_bf16_f32 v46, v124, v125
    v_cvt_pk_bf16_f32 v47, v126, v127
    ds_write_b128 v17, v[44:47] offset:256
    v_mfma_f32_16x16x32_bf16 v[156:159], a[40:43], v[92:95], v[156:159]
    v_pk_mul_f32 v[128:129], v[128:129], v[74:75]
    v_pk_mul_f32 v[130:131], v[130:131], v[74:75]
    v_pk_mul_f32 v[136:137], v[136:137], v[74:75]
    v_pk_mul_f32 v[138:139], v[138:139], v[74:75]
    v_cvt_pk_bf16_f32 v48, v128, v129
    v_cvt_pk_bf16_f32 v49, v130, v131
    v_cvt_pk_bf16_f32 v50, v136, v137
    v_cvt_pk_bf16_f32 v51, v138, v139
    ds_write_b128 v18, v[48:51] offset:0
    v_pk_mul_f32 v[132:133], v[132:133], v[14:15]
    v_pk_mul_f32 v[134:135], v[134:135], v[14:15]
    v_pk_mul_f32 v[140:141], v[140:141], v[14:15]
    v_pk_mul_f32 v[142:143], v[142:143], v[14:15]
    v_cvt_pk_bf16_f32 v52, v132, v133
    v_cvt_pk_bf16_f32 v53, v134, v135
    v_cvt_pk_bf16_f32 v54, v140, v141
    v_cvt_pk_bf16_f32 v55, v142, v143
    ds_write_b128 v18, v[52:55] offset:256
    v_pk_mul_f32 v[144:145], v[144:145], v[74:75]
    v_pk_mul_f32 v[146:147], v[146:147], v[74:75]
    v_pk_mul_f32 v[152:153], v[152:153], v[74:75]
    v_pk_mul_f32 v[154:155], v[154:155], v[74:75]
    v_cvt_pk_bf16_f32 v56, v144, v145
    v_cvt_pk_bf16_f32 v57, v146, v147
    v_cvt_pk_bf16_f32 v58, v152, v153
    v_cvt_pk_bf16_f32 v59, v154, v155
    ds_write_b128 v19, v[56:59] offset:0
    v_pk_mul_f32 v[148:149], v[148:149], v[14:15]
    v_pk_mul_f32 v[150:151], v[150:151], v[14:15]
    v_pk_mul_f32 v[156:157], v[156:157], v[14:15]
    v_pk_mul_f32 v[158:159], v[158:159], v[14:15]
    v_cvt_pk_bf16_f32 v60, v148, v149
    v_cvt_pk_bf16_f32 v61, v150, v151
    v_cvt_pk_bf16_f32 v62, v156, v157
    v_cvt_pk_bf16_f32 v63, v158, v159
    ds_write_b128 v19, v[60:63] offset:256
    s_waitcnt lgkmcnt(0)
    s_barrier
    ds_read_b128 v[96:99], v3 offset:0
    ds_read_b128 v[100:103], v3 offset:1024
    s_waitcnt lgkmcnt(1)
    v_mfma_f32_32x32x16_bf16 v[32:47], a[80:83], v[96:99], 0
    ds_read_b128 v[104:107], v3 offset:18432
    ds_read_b64_tr_b16 a[32:33], v28 offset:49152
    ds_read_b64_tr_b16 a[34:35], v28 offset:51200
    s_add_u32 m0, s79, 32768
    s_add_u32 s82, s81, 335872
    s_and_b32 s82, s82, 0x7ffff
    buffer_load_dwordx4 v252, s[56:59], s82 offen lds
    v_mfma_f32_32x32x16_bf16 v[48:63], a[84:87], v[96:99], 0
    ds_read_b64_tr_b16 a[36:37], v29 offset:49152
    ds_read_b64_tr_b16 a[38:39], v29 offset:51200
    v_mfma_f32_32x32x16_bf16 v[64:79], a[88:91], v[96:99], 0
    ds_read_b64_tr_b16 a[40:41], v30 offset:49152
    ds_read_b64_tr_b16 a[42:43], v30 offset:51200
    buffer_load_dwordx4 v253, s[56:59], s82 offen offset:1024 lds
    v_mfma_f32_32x32x16_bf16 v[80:95], a[92:95], v[96:99], 0
    ds_read_b64_tr_b16 a[44:45], v31 offset:49152
    ds_read_b64_tr_b16 a[46:47], v31 offset:51200
    s_waitcnt lgkmcnt(9)
    v_mfma_f32_32x32x16_bf16 v[32:47], a[96:99], v[100:103], v[32:47]
    ds_read_b128 v[108:111], v3 offset:19456
    s_waitcnt vmcnt(6)
    ds_read_b64_tr_b16 a[48:49], v20 offset:49152
    ds_read_b64_tr_b16 a[50:51], v20 offset:51200
    buffer_load_dwordx4 v254, s[56:59], s82 offen offset:2048 lds
    v_mfma_f32_32x32x16_bf16 v[48:63], a[100:103], v[100:103], v[48:63]
    ds_read_b64_tr_b16 a[52:53], v21 offset:49152
    ds_read_b64_tr_b16 a[54:55], v21 offset:51200
    v_mfma_f32_32x32x16_bf16 v[64:79], a[104:107], v[100:103], v[64:79]
    ds_read_b64_tr_b16 a[56:57], v22 offset:49152
    ds_read_b64_tr_b16 a[58:59], v22 offset:51200
    buffer_load_dwordx4 v255, s[56:59], s82 offen offset:3072 lds
    v_mfma_f32_32x32x16_bf16 v[80:95], a[108:111], v[100:103], v[80:95]
    ds_read_b64_tr_b16 a[60:61], v23 offset:49152
    ds_read_b64_tr_b16 a[62:63], v23 offset:51200
    s_waitcnt lgkmcnt(9)
    v_mfma_f32_32x32x16_bf16 v[32:47], a[32:35], v[104:107], v[32:47]
    ds_read_b128 v[112:115], v3 offset:20480
    s_waitcnt vmcnt(4)
    ds_read_b64_tr_b16 v[128:129], v24 offset:32768
    ds_read_b64_tr_b16 v[130:131], v24 offset:34816
    s_add_u32 m0, s79, 65536
    s_add_u32 s82, s81, 360448
    s_and_b32 s82, s82, 0x7ffff
    buffer_load_dwordx4 v252, s[56:59], s82 offen lds
    v_mfma_f32_32x32x16_bf16 v[48:63], a[36:39], v[104:107], v[48:63]
    ds_read_b64_tr_b16 v[132:133], v25 offset:32768
    ds_read_b64_tr_b16 v[134:135], v25 offset:34816
    v_mfma_f32_32x32x16_bf16 v[64:79], a[40:43], v[104:107], v[64:79]
    ds_read_b64_tr_b16 v[136:137], v26 offset:32768
    ds_read_b64_tr_b16 v[138:139], v26 offset:34816
    buffer_load_dwordx4 v253, s[56:59], s82 offen offset:1024 lds
    v_mfma_f32_32x32x16_bf16 v[80:95], a[44:47], v[104:107], v[80:95]
    ds_read_b64_tr_b16 v[140:141], v27 offset:32768
    ds_read_b64_tr_b16 v[142:143], v27 offset:34816
    s_waitcnt lgkmcnt(9)
    v_mfma_f32_32x32x16_bf16 v[32:47], a[48:51], v[108:111], v[32:47]
    ds_read_b128 v[116:119], v3 offset:2048
    buffer_load_dwordx4 v254, s[56:59], s82 offen offset:2048 lds
    v_mfma_f32_32x32x16_bf16 v[48:63], a[52:55], v[108:111], v[48:63]
    v_mfma_f32_32x32x16_bf16 v[64:79], a[56:59], v[108:111], v[64:79]
    buffer_load_dwordx4 v255, s[56:59], s82 offen offset:3072 lds
    v_mfma_f32_32x32x16_bf16 v[80:95], a[60:63], v[108:111], v[80:95]
    s_waitcnt lgkmcnt(1)
    v_mfma_f32_32x32x16_bf16 v[32:47], v[128:131], v[112:115], v[32:47]
    ds_read_b128 v[96:99], v3 offset:3072
    s_add_u32 m0, s79, 81920
    s_add_u32 s82, s81, 368640
    s_and_b32 s82, s82, 0x7ffff
    buffer_load_dwordx4 v252, s[56:59], s82 offen lds
    v_mfma_f32_32x32x16_bf16 v[48:63], v[132:135], v[112:115], v[48:63]
    v_mfma_f32_32x32x16_bf16 v[64:79], v[136:139], v[112:115], v[64:79]
    buffer_load_dwordx4 v253, s[56:59], s82 offen offset:1024 lds
    v_mfma_f32_32x32x16_bf16 v[80:95], v[140:143], v[112:115], v[80:95]
    s_waitcnt lgkmcnt(1)
    v_mfma_f32_32x32x16_bf16 v[32:47], a[112:115], v[116:119], v[32:47]
    ds_read_b128 v[100:103], v3 offset:21504
    s_waitcnt vmcnt(6)
    ds_read_b64_tr_b16 a[32:33], v28 offset:32768
    ds_read_b64_tr_b16 a[34:35], v28 offset:34816
    buffer_load_dwordx4 v254, s[56:59], s82 offen offset:2048 lds
    v_mfma_f32_32x32x16_bf16 v[48:63], a[116:119], v[116:119], v[48:63]
    ds_read_b64_tr_b16 a[36:37], v29 offset:32768
    ds_read_b64_tr_b16 a[38:39], v29 offset:34816
    v_mfma_f32_32x32x16_bf16 v[64:79], a[120:123], v[116:119], v[64:79]
    ds_read_b64_tr_b16 a[40:41], v30 offset:32768
    ds_read_b64_tr_b16 a[42:43], v30 offset:34816
    buffer_load_dwordx4 v255, s[56:59], s82 offen offset:3072 lds
    v_mfma_f32_32x32x16_bf16 v[80:95], a[124:127], v[116:119], v[80:95]
    ds_read_b64_tr_b16 a[44:45], v31 offset:32768
    ds_read_b64_tr_b16 a[46:47], v31 offset:34816
    s_waitcnt lgkmcnt(9)
    v_mfma_f32_32x32x16_bf16 v[32:47], a[128:131], v[96:99], v[32:47]
    ds_read_b128 v[104:107], v3 offset:4096
    s_add_u32 m0, s79, 98304
    s_add_u32 s82, s81, 393216
    s_and_b32 s82, s82, 0x7ffff
    buffer_load_dwordx4 v252, s[56:59], s82 offen lds
    v_mfma_f32_32x32x16_bf16 v[48:63], a[132:135], v[96:99], v[48:63]
    v_mfma_f32_32x32x16_bf16 v[64:79], a[136:139], v[96:99], v[64:79]
    buffer_load_dwordx4 v253, s[56:59], s82 offen offset:1024 lds
    v_mfma_f32_32x32x16_bf16 v[80:95], a[140:143], v[96:99], v[80:95]
    s_waitcnt lgkmcnt(1)
    v_mfma_f32_32x32x16_bf16 v[32:47], a[32:35], v[100:103], v[32:47]
    ds_read_b128 v[108:111], v3 offset:22528
    s_waitcnt vmcnt(6)
    ds_read_b64_tr_b16 a[48:49], v20 offset:0
    ds_read_b64_tr_b16 a[50:51], v20 offset:2048
    buffer_load_dwordx4 v254, s[56:59], s82 offen offset:2048 lds
    v_mfma_f32_32x32x16_bf16 v[48:63], a[36:39], v[100:103], v[48:63]
    ds_read_b64_tr_b16 a[52:53], v21 offset:0
    ds_read_b64_tr_b16 a[54:55], v21 offset:2048
    v_mfma_f32_32x32x16_bf16 v[64:79], a[40:43], v[100:103], v[64:79]
    ds_read_b64_tr_b16 a[56:57], v22 offset:0
    ds_read_b64_tr_b16 a[58:59], v22 offset:2048
    buffer_load_dwordx4 v255, s[56:59], s82 offen offset:3072 lds
    v_mfma_f32_32x32x16_bf16 v[80:95], a[44:47], v[100:103], v[80:95]
    ds_read_b64_tr_b16 a[60:61], v23 offset:0
    ds_read_b64_tr_b16 a[62:63], v23 offset:2048
    s_waitcnt lgkmcnt(9)
    v_mfma_f32_32x32x16_bf16 v[32:47], a[144:147], v[104:107], v[32:47]
    ds_read_b128 v[112:115], v3 offset:5120
    s_add_u32 m0, s79, 147456
    s_add_u32 s82, s81, 401408
    s_and_b32 s82, s82, 0x7ffff
    buffer_load_dwordx4 v252, s[56:59], s82 offen lds
    v_mfma_f32_32x32x16_bf16 v[48:63], a[148:151], v[104:107], v[48:63]
    v_mfma_f32_32x32x16_bf16 v[64:79], a[152:155], v[104:107], v[64:79]
    buffer_load_dwordx4 v253, s[56:59], s82 offen offset:1024 lds
    v_mfma_f32_32x32x16_bf16 v[80:95], a[156:159], v[104:107], v[80:95]
    s_waitcnt lgkmcnt(1)
    v_mfma_f32_32x32x16_bf16 v[32:47], a[48:51], v[108:111], v[32:47]
    ds_read_b128 v[116:119], v3 offset:23552
    s_waitcnt vmcnt(6)
    ds_read_b64_tr_b16 v[128:129], v20 offset:16384
    ds_read_b64_tr_b16 v[130:131], v20 offset:18432
    buffer_load_dwordx4 v254, s[56:59], s82 offen offset:2048 lds
    v_mfma_f32_32x32x16_bf16 v[48:63], a[52:55], v[108:111], v[48:63]
    ds_read_b64_tr_b16 v[132:133], v21 offset:16384
    ds_read_b64_tr_b16 v[134:135], v21 offset:18432
    v_mfma_f32_32x32x16_bf16 v[64:79], a[56:59], v[108:111], v[64:79]
    ds_read_b64_tr_b16 v[136:137], v22 offset:16384
    ds_read_b64_tr_b16 v[138:139], v22 offset:18432
    buffer_load_dwordx4 v255, s[56:59], s82 offen offset:3072 lds
    v_mfma_f32_32x32x16_bf16 v[80:95], a[60:63], v[108:111], v[80:95]
    ds_read_b64_tr_b16 v[140:141], v23 offset:16384
    ds_read_b64_tr_b16 v[142:143], v23 offset:18432
    s_waitcnt lgkmcnt(9)
    v_mfma_f32_32x32x16_bf16 v[32:47], a[160:163], v[112:115], v[32:47]
    ds_read_b128 v[96:99], v3 offset:6144
    s_add_u32 m0, s79, 49152
    s_add_u32 s82, s81, 425984
    s_and_b32 s82, s82, 0x7ffff
    buffer_load_dwordx4 v252, s[56:59], s82 offen lds
    v_mfma_f32_32x32x16_bf16 v[48:63], a[164:167], v[112:115], v[48:63]
    v_mfma_f32_32x32x16_bf16 v[64:79], a[168:171], v[112:115], v[64:79]
    buffer_load_dwordx4 v253, s[56:59], s82 offen offset:1024 lds
    v_mfma_f32_32x32x16_bf16 v[80:95], a[172:175], v[112:115], v[80:95]
    s_waitcnt lgkmcnt(1)
    v_mfma_f32_32x32x16_bf16 v[32:47], v[128:131], v[116:119], v[32:47]
    ds_read_b128 v[100:103], v3 offset:24576
    s_waitcnt vmcnt(6)
    ds_read_b64_tr_b16 a[32:33], v20 offset:32768
    ds_read_b64_tr_b16 a[34:35], v20 offset:34816
    buffer_load_dwordx4 v254, s[56:59], s82 offen offset:2048 lds
    v_mfma_f32_32x32x16_bf16 v[48:63], v[132:135], v[116:119], v[48:63]
    ds_read_b64_tr_b16 a[36:37], v21 offset:32768
    ds_read_b64_tr_b16 a[38:39], v21 offset:34816
    v_mfma_f32_32x32x16_bf16 v[64:79], v[136:139], v[116:119], v[64:79]
    ds_read_b64_tr_b16 a[40:41], v22 offset:32768
    ds_read_b64_tr_b16 a[42:43], v22 offset:34816
    buffer_load_dwordx4 v255, s[56:59], s82 offen offset:3072 lds
    v_mfma_f32_32x32x16_bf16 v[80:95], v[140:143], v[116:119], v[80:95]
    ds_read_b64_tr_b16 a[44:45], v23 offset:32768
    ds_read_b64_tr_b16 a[46:47], v23 offset:34816
    s_waitcnt lgkmcnt(9)
    v_mfma_f32_32x32x16_bf16 v[32:47], a[176:179], v[96:99], v[32:47]
    ds_read_b128 v[104:107], v3 offset:7168
    s_add_u32 m0, s79, 114688
    s_add_u32 s82, s81, 434176
    s_and_b32 s82, s82, 0x7ffff
    buffer_load_dwordx4 v252, s[56:59], s82 offen lds
    v_mfma_f32_32x32x16_bf16 v[48:63], a[180:183], v[96:99], v[48:63]
    v_mfma_f32_32x32x16_bf16 v[64:79], a[184:187], v[96:99], v[64:79]
    buffer_load_dwordx4 v253, s[56:59], s82 offen offset:1024 lds
    v_mfma_f32_32x32x16_bf16 v[80:95], a[188:191], v[96:99], v[80:95]
    s_waitcnt lgkmcnt(1)
    v_mfma_f32_32x32x16_bf16 v[32:47], a[32:35], v[100:103], v[32:47]
    ds_read_b128 v[108:111], v3 offset:25600
    s_waitcnt vmcnt(6)
    ds_read_b64_tr_b16 a[48:49], v24 offset:49152
    ds_read_b64_tr_b16 a[50:51], v24 offset:51200
    buffer_load_dwordx4 v254, s[56:59], s82 offen offset:2048 lds
    v_mfma_f32_32x32x16_bf16 v[48:63], a[36:39], v[100:103], v[48:63]
    ds_read_b64_tr_b16 a[52:53], v25 offset:49152
    ds_read_b64_tr_b16 a[54:55], v25 offset:51200
    v_mfma_f32_32x32x16_bf16 v[64:79], a[40:43], v[100:103], v[64:79]
    ds_read_b64_tr_b16 a[56:57], v26 offset:49152
    ds_read_b64_tr_b16 a[58:59], v26 offset:51200
    buffer_load_dwordx4 v255, s[56:59], s82 offen offset:3072 lds
    v_mfma_f32_32x32x16_bf16 v[80:95], a[44:47], v[100:103], v[80:95]
    ds_read_b64_tr_b16 a[60:61], v27 offset:49152
    ds_read_b64_tr_b16 a[62:63], v27 offset:51200
    s_waitcnt lgkmcnt(9)
    v_mfma_f32_32x32x16_bf16 v[32:47], a[192:195], v[104:107], v[32:47]
    ds_read_b128 v[112:115], v3 offset:8192
    s_add_u32 m0, s79, 131072
    s_add_u32 s82, s81, 458752
    s_and_b32 s82, s82, 0x7ffff
    buffer_load_dwordx4 v252, s[56:59], s82 offen lds
    v_mfma_f32_32x32x16_bf16 v[48:63], a[196:199], v[104:107], v[48:63]
    v_mfma_f32_32x32x16_bf16 v[64:79], a[200:203], v[104:107], v[64:79]
    buffer_load_dwordx4 v253, s[56:59], s82 offen offset:1024 lds
    v_mfma_f32_32x32x16_bf16 v[80:95], a[204:207], v[104:107], v[80:95]
    s_waitcnt lgkmcnt(1)
    v_mfma_f32_32x32x16_bf16 v[32:47], a[48:51], v[108:111], v[32:47]
    ds_read_b128 v[116:119], v3 offset:26624
    s_waitcnt vmcnt(6)
    ds_read_b64_tr_b16 v[128:129], v28 offset:49152
    ds_read_b64_tr_b16 v[130:131], v28 offset:51200
    buffer_load_dwordx4 v254, s[56:59], s82 offen offset:2048 lds
    v_mfma_f32_32x32x16_bf16 v[48:63], a[52:55], v[108:111], v[48:63]
    ds_read_b64_tr_b16 v[132:133], v29 offset:49152
    ds_read_b64_tr_b16 v[134:135], v29 offset:51200
    v_mfma_f32_32x32x16_bf16 v[64:79], a[56:59], v[108:111], v[64:79]
    ds_read_b64_tr_b16 v[136:137], v30 offset:49152
    ds_read_b64_tr_b16 v[138:139], v30 offset:51200
    buffer_load_dwordx4 v255, s[56:59], s82 offen offset:3072 lds
    v_mfma_f32_32x32x16_bf16 v[80:95], a[60:63], v[108:111], v[80:95]
    ds_read_b64_tr_b16 v[140:141], v31 offset:49152
    ds_read_b64_tr_b16 v[142:143], v31 offset:51200
    s_waitcnt lgkmcnt(9)
    v_mfma_f32_32x32x16_bf16 v[32:47], a[208:211], v[112:115], v[32:47]
    ds_read_b128 v[96:99], v3 offset:9216
    s_add_u32 m0, s79, 32768
    s_add_u32 s82, s81, 466944
    s_and_b32 s82, s82, 0x7ffff
    buffer_load_dwordx4 v252, s[56:59], s82 offen lds
    v_mfma_f32_32x32x16_bf16 v[48:63], a[212:215], v[112:115], v[48:63]
    v_mfma_f32_32x32x16_bf16 v[64:79], a[216:219], v[112:115], v[64:79]
    buffer_load_dwordx4 v253, s[56:59], s82 offen offset:1024 lds
    v_mfma_f32_32x32x16_bf16 v[80:95], a[220:223], v[112:115], v[80:95]
    s_waitcnt lgkmcnt(1)
    v_mfma_f32_32x32x16_bf16 v[32:47], v[128:131], v[116:119], v[32:47]
    ds_read_b128 v[100:103], v3 offset:27648
    s_waitcnt vmcnt(6)
    ds_read_b64_tr_b16 a[32:33], v20 offset:49152
    ds_read_b64_tr_b16 a[34:35], v20 offset:51200
    buffer_load_dwordx4 v254, s[56:59], s82 offen offset:2048 lds
    v_mfma_f32_32x32x16_bf16 v[48:63], v[132:135], v[116:119], v[48:63]
    ds_read_b64_tr_b16 a[36:37], v21 offset:49152
    ds_read_b64_tr_b16 a[38:39], v21 offset:51200
    v_mfma_f32_32x32x16_bf16 v[64:79], v[136:139], v[116:119], v[64:79]
    ds_read_b64_tr_b16 a[40:41], v22 offset:49152
    ds_read_b64_tr_b16 a[42:43], v22 offset:51200
    buffer_load_dwordx4 v255, s[56:59], s82 offen offset:3072 lds
    v_mfma_f32_32x32x16_bf16 v[80:95], v[140:143], v[116:119], v[80:95]
    ds_read_b64_tr_b16 a[44:45], v23 offset:49152
    ds_read_b64_tr_b16 a[46:47], v23 offset:51200
    s_waitcnt lgkmcnt(9)
    v_mfma_f32_32x32x16_bf16 v[32:47], a[224:227], v[96:99], v[32:47]
    ds_read_b128 v[104:107], v3 offset:10240
    s_add_u32 m0, s79, 65536
    s_add_u32 s82, s81, 491520
    s_and_b32 s82, s82, 0x7ffff
    buffer_load_dwordx4 v252, s[56:59], s82 offen lds
    v_mfma_f32_32x32x16_bf16 v[48:63], a[228:231], v[96:99], v[48:63]
    v_mfma_f32_32x32x16_bf16 v[64:79], a[232:235], v[96:99], v[64:79]
    buffer_load_dwordx4 v253, s[56:59], s82 offen offset:1024 lds
    v_mfma_f32_32x32x16_bf16 v[80:95], a[236:239], v[96:99], v[80:95]
    s_waitcnt lgkmcnt(1)
    v_mfma_f32_32x32x16_bf16 v[32:47], a[32:35], v[100:103], v[32:47]
    ds_read_b128 v[108:111], v3 offset:28672
    s_waitcnt vmcnt(6)
    ds_read_b64_tr_b16 a[48:49], v24 offset:32768
    ds_read_b64_tr_b16 a[50:51], v24 offset:34816
    buffer_load_dwordx4 v254, s[56:59], s82 offen offset:2048 lds
    v_mfma_f32_32x32x16_bf16 v[48:63], a[36:39], v[100:103], v[48:63]
    ds_read_b64_tr_b16 a[52:53], v25 offset:32768
    ds_read_b64_tr_b16 a[54:55], v25 offset:34816
    v_mfma_f32_32x32x16_bf16 v[64:79], a[40:43], v[100:103], v[64:79]
    ds_read_b64_tr_b16 a[56:57], v26 offset:32768
    ds_read_b64_tr_b16 a[58:59], v26 offset:34816
    buffer_load_dwordx4 v255, s[56:59], s82 offen offset:3072 lds
    v_mfma_f32_32x32x16_bf16 v[80:95], a[44:47], v[100:103], v[80:95]
    ds_read_b64_tr_b16 a[60:61], v27 offset:32768
    ds_read_b64_tr_b16 a[62:63], v27 offset:34816
    s_waitcnt lgkmcnt(9)
    v_mfma_f32_32x32x16_bf16 v[32:47], a[240:243], v[104:107], v[32:47]
    ds_read_b128 v[112:115], v3 offset:11264
    s_add_u32 m0, s79, 81920
    s_add_u32 s82, s81, 499712
    s_and_b32 s82, s82, 0x7ffff
    buffer_load_dwordx4 v252, s[56:59], s82 offen lds
    v_mfma_f32_32x32x16_bf16 v[48:63], a[244:247], v[104:107], v[48:63]
    v_mfma_f32_32x32x16_bf16 v[64:79], a[248:251], v[104:107], v[64:79]
    buffer_load_dwordx4 v253, s[56:59], s82 offen offset:1024 lds
    v_mfma_f32_32x32x16_bf16 v[80:95], a[252:255], v[104:107], v[80:95]
    s_waitcnt lgkmcnt(1)
    v_mfma_f32_32x32x16_bf16 v[32:47], a[48:51], v[108:111], v[32:47]
    ds_read_b128 v[116:119], v3 offset:29696
    s_waitcnt vmcnt(6)
    ds_read_b64_tr_b16 v[128:129], v28 offset:32768
    ds_read_b64_tr_b16 v[130:131], v28 offset:34816
    buffer_load_dwordx4 v254, s[56:59], s82 offen offset:2048 lds
    v_mfma_f32_32x32x16_bf16 v[48:63], a[52:55], v[108:111], v[48:63]
    ds_read_b64_tr_b16 v[132:133], v29 offset:32768
    ds_read_b64_tr_b16 v[134:135], v29 offset:34816
    v_mfma_f32_32x32x16_bf16 v[64:79], a[56:59], v[108:111], v[64:79]
    ds_read_b64_tr_b16 v[136:137], v30 offset:32768
    ds_read_b64_tr_b16 v[138:139], v30 offset:34816
    buffer_load_dwordx4 v255, s[56:59], s82 offen offset:3072 lds
    v_mfma_f32_32x32x16_bf16 v[80:95], a[60:63], v[108:111], v[80:95]
    ds_read_b64_tr_b16 v[140:141], v31 offset:32768
    ds_read_b64_tr_b16 v[142:143], v31 offset:34816
    s_waitcnt lgkmcnt(9)
    v_mfma_f32_32x32x16_bf16 v[32:47], a[0:3], v[112:115], v[32:47]
    ds_read_b128 v[96:99], v3 offset:12288
    v_mfma_f32_32x32x16_bf16 v[48:63], a[4:7], v[112:115], v[48:63]
    v_mfma_f32_32x32x16_bf16 v[64:79], a[8:11], v[112:115], v[64:79]
    v_mfma_f32_32x32x16_bf16 v[80:95], a[12:15], v[112:115], v[80:95]
    s_waitcnt lgkmcnt(1)
    v_mfma_f32_32x32x16_bf16 v[32:47], v[128:131], v[116:119], v[32:47]
    ds_read_b128 v[100:103], v3 offset:30720
    s_waitcnt vmcnt(4)
    ds_read_b64_tr_b16 a[32:33], v20 offset:0
    ds_read_b64_tr_b16 a[34:35], v20 offset:2048
    v_mfma_f32_32x32x16_bf16 v[48:63], v[132:135], v[116:119], v[48:63]
    ds_read_b64_tr_b16 a[36:37], v21 offset:0
    ds_read_b64_tr_b16 a[38:39], v21 offset:2048
    v_mfma_f32_32x32x16_bf16 v[64:79], v[136:139], v[116:119], v[64:79]
    ds_read_b64_tr_b16 a[40:41], v22 offset:0
    ds_read_b64_tr_b16 a[42:43], v22 offset:2048
    v_mfma_f32_32x32x16_bf16 v[80:95], v[140:143], v[116:119], v[80:95]
    ds_read_b64_tr_b16 a[44:45], v23 offset:0
    ds_read_b64_tr_b16 a[46:47], v23 offset:2048
    s_waitcnt lgkmcnt(9)
    v_mfma_f32_32x32x16_bf16 v[32:47], a[16:19], v[96:99], v[32:47]
    ds_read_b128 v[104:107], v3 offset:13312
    v_mfma_f32_32x32x16_bf16 v[48:63], a[20:23], v[96:99], v[48:63]
    v_mfma_f32_32x32x16_bf16 v[64:79], a[24:27], v[96:99], v[64:79]
    v_mfma_f32_32x32x16_bf16 v[80:95], a[28:31], v[96:99], v[80:95]
    s_waitcnt lgkmcnt(1)
    v_mfma_f32_32x32x16_bf16 v[32:47], a[32:35], v[100:103], v[32:47]
    ds_read_b128 v[108:111], v3 offset:31744
    s_waitcnt vmcnt(0)
    ds_read_b64_tr_b16 a[48:49], v20 offset:16384
    ds_read_b64_tr_b16 a[50:51], v20 offset:18432
    v_mfma_f32_32x32x16_bf16 v[48:63], a[36:39], v[100:103], v[48:63]
    ds_read_b64_tr_b16 a[52:53], v21 offset:16384
    ds_read_b64_tr_b16 a[54:55], v21 offset:18432
    v_mfma_f32_32x32x16_bf16 v[64:79], a[40:43], v[100:103], v[64:79]
    ds_read_b64_tr_b16 a[56:57], v22 offset:16384
    ds_read_b64_tr_b16 a[58:59], v22 offset:18432
    v_mfma_f32_32x32x16_bf16 v[80:95], a[44:47], v[100:103], v[80:95]
    ds_read_b64_tr_b16 a[60:61], v23 offset:16384
    ds_read_b64_tr_b16 a[62:63], v23 offset:18432
    s_waitcnt lgkmcnt(9)
    v_mfma_f32_32x32x16_bf16 v[32:47], v[192:195], v[104:107], v[32:47]
    ds_read_b128 v[112:115], v3 offset:14336
    v_mfma_f32_32x32x16_bf16 v[48:63], v[196:199], v[104:107], v[48:63]
    v_mfma_f32_32x32x16_bf16 v[64:79], v[200:203], v[104:107], v[64:79]
    v_mfma_f32_32x32x16_bf16 v[80:95], v[204:207], v[104:107], v[80:95]
    s_waitcnt lgkmcnt(1)
    v_mfma_f32_32x32x16_bf16 v[32:47], a[48:51], v[108:111], v[32:47]
    ds_read_b128 v[100:103], v3 offset:17408
    v_mfma_f32_32x32x16_bf16 v[48:63], a[52:55], v[108:111], v[48:63]
    ds_read_b128 v[96:99], v3 offset:16384
    v_mfma_f32_32x32x16_bf16 v[64:79], a[56:59], v[108:111], v[64:79]
    ds_read_b128 v[116:119], v3 offset:15360
    v_mfma_f32_32x32x16_bf16 v[80:95], a[60:63], v[108:111], v[80:95]
    s_waitcnt lgkmcnt(3)
    v_mfma_f32_32x32x16_bf16 v[32:47], v[208:211], v[112:115], v[32:47]
    v_mfma_f32_32x32x16_bf16 v[48:63], v[212:215], v[112:115], v[48:63]
    v_mfma_f32_32x32x16_bf16 v[64:79], v[216:219], v[112:115], v[64:79]
    v_mfma_f32_32x32x16_bf16 v[80:95], v[220:223], v[112:115], v[80:95]
    s_waitcnt lgkmcnt(0)
    v_mfma_f32_32x32x16_bf16 v[32:47], v[224:227], v[116:119], v[32:47]
    v_mfma_f32_32x32x16_bf16 v[32:47], v[160:163], v[96:99], v[32:47]
    v_mfma_f32_32x32x16_bf16 v[32:47], v[176:179], v[100:103], v[32:47]
    v_mfma_f32_32x32x16_bf16 v[48:63], v[228:231], v[116:119], v[48:63]
    v_mfma_f32_32x32x16_bf16 v[48:63], v[164:167], v[96:99], v[48:63]
    v_mfma_f32_32x32x16_bf16 v[48:63], v[180:183], v[100:103], v[48:63]
    s_nop 8
    v_cvt_pk_bf16_f32 v128, v32, v33
    v_cvt_pk_bf16_f32 v129, v34, v35
    v_cvt_pk_bf16_f32 v130, v36, v37
    v_cvt_pk_bf16_f32 v131, v38, v39
    buffer_store_dwordx4 v[128:131], v3, s[64:67], s10 offen sc1
    v_cvt_pk_bf16_f32 v132, v40, v41
    v_mfma_f32_32x32x16_bf16 v[64:79], v[232:235], v[116:119], v[64:79]
    v_cvt_pk_bf16_f32 v133, v42, v43
    v_cvt_pk_bf16_f32 v134, v44, v45
    v_cvt_pk_bf16_f32 v135, v46, v47
    buffer_store_dwordx4 v[132:135], v3, s[64:67], s10 offen offset:1024 sc1
    v_mfma_f32_32x32x16_bf16 v[64:79], v[168:171], v[96:99], v[64:79]
    v_mfma_f32_32x32x16_bf16 v[64:79], v[184:187], v[100:103], v[64:79]
    v_cvt_pk_bf16_f32 v136, v48, v49
    v_cvt_pk_bf16_f32 v137, v50, v51
    v_cvt_pk_bf16_f32 v138, v52, v53
    v_cvt_pk_bf16_f32 v139, v54, v55
    buffer_store_dwordx4 v[136:139], v3, s[64:67], s10 offen offset:2048 sc1
    v_cvt_pk_bf16_f32 v140, v56, v57
    v_mfma_f32_32x32x16_bf16 v[80:95], v[236:239], v[116:119], v[80:95]
    v_cvt_pk_bf16_f32 v141, v58, v59
    v_cvt_pk_bf16_f32 v142, v60, v61
    v_cvt_pk_bf16_f32 v143, v62, v63
    buffer_store_dwordx4 v[140:143], v3, s[64:67], s10 offen offset:3072 sc1
    v_mfma_f32_32x32x16_bf16 v[80:95], v[172:175], v[96:99], v[80:95]
    v_mfma_f32_32x32x16_bf16 v[80:95], v[188:191], v[100:103], v[80:95]
    v_cvt_pk_bf16_f32 v144, v64, v65
    v_cvt_pk_bf16_f32 v145, v66, v67
    v_cvt_pk_bf16_f32 v146, v68, v69
    v_cvt_pk_bf16_f32 v147, v70, v71
    buffer_store_dwordx4 v[144:147], v3, s[64:67], s11 offen sc1
    v_cvt_pk_bf16_f32 v148, v72, v73
    v_cvt_pk_bf16_f32 v149, v74, v75
    v_cvt_pk_bf16_f32 v150, v76, v77
    v_cvt_pk_bf16_f32 v151, v78, v79
    buffer_store_dwordx4 v[148:151], v3, s[64:67], s11 offen offset:1024 sc1
    s_nop 1
    v_cvt_pk_bf16_f32 v152, v80, v81
    v_cvt_pk_bf16_f32 v153, v82, v83
    v_cvt_pk_bf16_f32 v154, v84, v85
    v_cvt_pk_bf16_f32 v155, v86, v87
    buffer_store_dwordx4 v[152:155], v3, s[64:67], s11 offen offset:2048 sc1
    v_cvt_pk_bf16_f32 v156, v88, v89
    v_cvt_pk_bf16_f32 v157, v90, v91
    v_cvt_pk_bf16_f32 v158, v92, v93
    v_cvt_pk_bf16_f32 v159, v94, v95
    buffer_store_dwordx4 v[156:159], v3, s[64:67], s11 offen offset:3072 sc1
    s_mov_b32 s13, 0
    s_mov_b64 exec, 3
    s_waitcnt vmcnt(0)
    buffer_store_dword v250, v249, s[64:67], 0 offen sc1
    s_mov_b64 exec, -1
    buffer_load_dword v4, v248, s[64:67], 0 offen sc1
    s_waitcnt vmcnt(0)
    v_cmp_ne_u32 vcc, s42, v4
    s_cbranch_vccz LB_go
    buffer_load_dword v4, v248, s[64:67], 0 offen sc1
    s_sleep 5
LB_poll:
    buffer_load_dword v2, v248, s[64:67], 0 offen sc1
    s_add_u32 s13, s13, 1
    s_waitcnt vmcnt(1)
    v_cmp_ne_u32 vcc, s42, v4
    s_cbranch_vccz LB_go
    buffer_load_dword v4, v248, s[64:67], 0 offen sc1
    s_cmp_ge_u32 s13, 200000
    s_waitcnt vmcnt(1)
    v_cmp_ne_u32 vcc, s42, v2
    s_cbranch_scc1 LB_go
    s_cbranch_vccnz LB_poll
LB_go:
    s_mov_b32 s12, 0
    buffer_load_dwordx4 v[128:131], v12, s[64:67], s12 offen sc1
    s_mov_b32 s12, 4096
    buffer_load_dwordx4 v[132:135], v12, s[64:67], s12 offen sc1
    s_mov_b32 s12, 8192
    buffer_load_dwordx4 v[136:139], v12, s[64:67], s12 offen sc1
    s_mov_b32 s12, 12288
    buffer_load_dwordx4 v[140:143], v12, s[64:67], s12 offen sc1
    s_mov_b32 s12, 16384
    buffer_load_dwordx4 v[144:147], v12, s[64:67], s12 offen sc1
    s_mov_b32 s12, 20480
    buffer_load_dwordx4 v[148:151], v12, s[64:67], s12 offen sc1
    s_mov_b32 s12, 24576
    buffer_load_dwordx4 v[152:155], v12, s[64:67], s12 offen sc1
    s_mov_b32 s12, 28672
    buffer_load_dwordx4 v[156:159], v12, s[64:67], s12 offen sc1
    s_mov_b32 s13, 0
    s_waitcnt vmcnt(7)
    v_lshlrev_b32 v32, 16, v128
    v_and_b32 v33, 0xffff0000, v128
    v_lshlrev_b32 v34, 16, v129
    v_and_b32 v35, 0xffff0000, v129
    v_lshlrev_b32 v36, 16, v130
    v_and_b32 v37, 0xffff0000, v130
    v_lshlrev_b32 v38, 16, v131
    v_and_b32 v39, 0xffff0000, v131
    s_waitcnt vmcnt(6)
    v_lshlrev_b32 v44, 16, v132
    v_and_b32 v45, 0xffff0000, v132
    v_pk_add_f32 v[32:33], v[32:33], v[44:45]
    v_lshlrev_b32 v46, 16, v133
    v_and_b32 v47, 0xffff0000, v133
    v_pk_add_f32 v[34:35], v[34:35], v[46:47]
    v_lshlrev_b32 v44, 16, v134
    v_and_b32 v45, 0xffff0000, v134
    v_pk_add_f32 v[36:37], v[36:37], v[44:45]
    v_lshlrev_b32 v46, 16, v135
    v_and_b32 v47, 0xffff0000, v135
    v_pk_add_f32 v[38:39], v[38:39], v[46:47]
    s_waitcnt vmcnt(5)
    v_lshlrev_b32 v44, 16, v136
    v_and_b32 v45, 0xffff0000, v136
    v_pk_add_f32 v[32:33], v[32:33], v[44:45]
    v_lshlrev_b32 v46, 16, v137
    v_and_b32 v47, 0xffff0000, v137
    v_pk_add_f32 v[34:35], v[34:35], v[46:47]
    v_lshlrev_b32 v44, 16, v138
    v_and_b32 v45, 0xffff0000, v138
    v_pk_add_f32 v[36:37], v[36:37], v[44:45]
    v_lshlrev_b32 v46, 16, v139
    v_and_b32 v47, 0xffff0000, v139
    v_pk_add_f32 v[38:39], v[38:39], v[46:47]
    s_waitcnt vmcnt(4)
    v_lshlrev_b32 v44, 16, v140
    v_and_b32 v45, 0xffff0000, v140
    v_pk_add_f32 v[32:33], v[32:33], v[44:45]
    v_lshlrev_b32 v46, 16, v141
    v_and_b32 v47, 0xffff0000, v141
    v_pk_add_f32 v[34:35], v[34:35], v[46:47]
    v_lshlrev_b32 v44, 16, v142
    v_and_b32 v45, 0xffff0000, v142
    v_pk_add_f32 v[36:37], v[36:37], v[44:45]
    v_lshlrev_b32 v46, 16, v143
    v_and_b32 v47, 0xffff0000, v143
    v_pk_add_f32 v[38:39], v[38:39], v[46:47]
    s_waitcnt vmcnt(3)
    v_lshlrev_b32 v44, 16, v144
    v_and_b32 v45, 0xffff0000, v144
    v_pk_add_f32 v[32:33], v[32:33], v[44:45]
    v_lshlrev_b32 v46, 16, v145
    v_and_b32 v47, 0xffff0000, v145
    v_pk_add_f32 v[34:35], v[34:35], v[46:47]
    v_lshlrev_b32 v44, 16, v146
    v_and_b32 v45, 0xffff0000, v146
    v_pk_add_f32 v[36:37], v[36:37], v[44:45]
    v_lshlrev_b32 v46, 16, v147
    v_and_b32 v47, 0xffff0000, v147
    v_pk_add_f32 v[38:39], v[38:39], v[46:47]
    s_waitcnt vmcnt(2)
    v_lshlrev_b32 v44, 16, v148
    v_and_b32 v45, 0xffff0000, v148
    v_pk_add_f32 v[32:33], v[32:33], v[44:45]
    v_lshlrev_b32 v46, 16, v149
    v_and_b32 v47, 0xffff0000, v149
    v_pk_add_f32 v[34:35], v[34:35], v[46:47]
    v_lshlrev_b32 v44, 16, v150
    v_and_b32 v45, 0xffff0000, v150
    v_pk_add_f32 v[36:37], v[36:37], v[44:45]
    v_lshlrev_b32 v46, 16, v151
    v_and_b32 v47, 0xffff0000, v151
    v_pk_add_f32 v[38:39], v[38:39], v[46:47]
    s_waitcnt vmcnt(1)
    v_lshlrev_b32 v44, 16, v152
    v_and_b32 v45, 0xffff0000, v152
    v_pk_add_f32 v[32:33], v[32:33], v[44:45]
    v_lshlrev_b32 v46, 16, v153
    v_and_b32 v47, 0xffff0000, v153
    v_pk_add_f32 v[34:35], v[34:35], v[46:47]
    v_lshlrev_b32 v44, 16, v154
    v_and_b32 v45, 0xffff0000, v154
    v_pk_add_f32 v[36:37], v[36:37], v[44:45]
    v_lshlrev_b32 v46, 16, v155
    v_and_b32 v47, 0xffff0000, v155
    v_pk_add_f32 v[38:39], v[38:39], v[46:47]
    s_waitcnt vmcnt(0)
    v_lshlrev_b32 v44, 16, v156
    v_and_b32 v45, 0xffff0000, v156
    v_pk_add_f32 v[32:33], v[32:33], v[44:45]
    v_lshlrev_b32 v46, 16, v157
    v_and_b32 v47, 0xffff0000, v157
    v_pk_add_f32 v[34:35], v[34:35], v[46:47]
    v_lshlrev_b32 v44, 16, v158
    v_and_b32 v45, 0xffff0000, v158
    v_pk_add_f32 v[36:37], v[36:37], v[44:45]
    v_lshlrev_b32 v46, 16, v159
    v_and_b32 v47, 0xffff0000, v159
    v_pk_add_f32 v[38:39], v[38:39], v[46:47]
    v_cvt_pk_bf16_f32 v40, v32, v33
    v_cvt_pk_bf16_f32 v41, v34, v35
    v_cvt_pk_bf16_f32 v42, v36, v37
    v_cvt_pk_bf16_f32 v43, v38, v39
    s_nop 1
    v_permlane32_swap_b32 v40, v42
    v_permlane32_swap_b32 v41, v43
    buffer_store_dwordx4 v[40:43], v13, s[68:71], 0 offen
LB_end:
    s_endpgm
LB_nononce:
    v_mov_b32 v2, 0
    s_mov_b32 s10, 0
LB_nn_loop:
    buffer_load_dword v4, v2, s[92:95], 0 offen sc1
    s_add_u32 s10, s10, 1
    s_waitcnt vmcnt(0)
    v_readfirstlane_b32 s42, v4
    s_cmp_ge_u32 s10, 200000
    s_cbranch_scc1 LB_nonce
    s_sleep 4
    s_cmp_eq_u32 s42, 0
    s_cbranch_scc1 LB_nn_loop
    s_branch LB_nonce
LB_r1_1:
    s_call_b64 s[76:77], LB_rare1_1
    s_branch LB_b1_1
LB_r1_2:
    s_call_b64 s[76:77], LB_rare1_0
    s_branch LB_b1_2
LB_r1_3:
    s_call_b64 s[76:77], LB_rare1_1
    s_branch LB_b1_3
LB_r1_4:
    s_call_b64 s[76:77], LB_rare1_0
    s_branch LB_b1_4
LB_r1_5:
    s_call_b64 s[76:77], LB_rare1_1
    s_branch LB_b1_5
LB_r1_6:
    s_call_b64 s[76:77], LB_rare1_0
    s_branch LB_b1_6
LB_r1_7:
    s_call_b64 s[76:77], LB_rare1_1
    s_branch LB_b1_7
LB_r1_8:
    s_call_b64 s[76:77], LB_rare1_0
    s_branch LB_b1_8
LB_r1_9:
    s_call_b64 s[76:77], LB_rare1_1
    s_branch LB_b1_9
LB_r1_10:
    s_call_b64 s[76:77], LB_rare1_0
    s_branch LB_b1_10
LB_r1_11:
    s_call_b64 s[76:77], LB_rare1_1
    s_branch LB_b1_11
LB_r1_12:
    s_call_b64 s[76:77], LB_rare1_0
    s_branch LB_b1_12
LB_r1_13:
    s_call_b64 s[76:77], LB_rare1_1
    s_branch LB_b1_13
LB_r1_14:
    s_call_b64 s[76:77], LB_rare1_0
    s_branch LB_b1_14
LB_r1_15:
    s_call_b64 s[76:77], LB_rare1_1
    s_branch LB_b1_15
LB_r1_16:
    s_call_b64 s[76:77], LB_rare1_0
    s_branch LB_b1_16
LB_r1_17:
    s_call_b64 s[76:77], LB_rare1_1
    s_branch LB_b1_17
LB_r1_18:
    s_call_b64 s[76:77], LB_rare1_0
    s_branch LB_b1_18
LB_r1_19:
    s_call_b64 s[76:77], LB_rare1_1
    s_branch LB_b1_19
LB_r1_20:
    s_call_b64 s[76:77], LB_rare1_0
    s_branch LB_b1_20
LB_r1_21:
    s_call_b64 s[76:77], LB_rare1_1
    s_branch LB_b1_21
LB_r1_22:
    s_call_b64 s[76:77], LB_rare1_0
    s_branch LB_b1_22
LB_r1_23:
    s_call_b64 s[76:77], LB_rare1_1
    s_branch LB_b1_23
LB_r1_24:
    s_call_b64 s[76:77], LB_rare1_0
    s_branch LB_b1_24
LB_r1_25:
    s_call_b64 s[76:77], LB_rare1_1
    s_branch LB_b1_25
LB_r1_26:
    s_call_b64 s[76:77], LB_rare1_0
    s_branch LB_b1_26
LB_r1_27:
    s_call_b64 s[76:77], LB_rare1_1
    s_branch LB_b1_27
LB_r1_28:
    s_call_b64 s[76:77], LB_rare1_0
    s_branch LB_b1_28
LB_r1_29:
    s_call_b64 s[76:77], LB_rare1_1
    s_branch LB_b1_29
LB_r1_30:
    s_call_b64 s[76:77], LB_rare1_0
    s_branch LB_b1_30
LB_r1_31:
    s_call_b64 s[76:77], LB_rare1_1
    s_branch LB_b1_31
LB_rare1_0:
    s_nop 7
    v_max3_f32 v14, v32, v33, v34
    v_max3_f32 v14, v14, v35, v36
    v_max3_f32 v14, v14, v37, v38
    v_max_f32 v14, v14, v39
    v_max3_f32 v73, v40, v41, v42
    v_max3_f32 v73, v73, v43, v44
    v_max3_f32 v73, v73, v45, v46
    v_max_f32 v73, v73, v47
    v_mov_b32 v74, v14
    v_mov_b32 v75, v73
    s_nop 0
    v_permlane16_swap_b32 v74, v14
    v_permlane16_swap_b32 v75, v73
    v_max_f32 v14, v14, v74
    v_max_f32 v73, v73, v75
    v_mov_b32 v74, v14
    v_mov_b32 v75, v73
    s_nop 0
    v_permlane32_swap_b32 v74, v14
    v_permlane32_swap_b32 v75, v73
    v_max_f32 v14, v14, v74
    v_max_f32 v73, v73, v75
    v_add_f32 v14, 1088421888, v14
    v_add_f32 v73, 1088421888, v73
    v_max_f32 v14, 0, v14
    v_max_f32 v73, 0, v73
    v_exp_f32 v15, -v14
    v_exp_f32 v72, -v73
    v_sub_f32 v32, v32, v14
    v_sub_f32 v33, v33, v14
    v_sub_f32 v34, v34, v14
    v_sub_f32 v35, v35, v14
    v_sub_f32 v36, v36, v14
    v_sub_f32 v37, v37, v14
    v_sub_f32 v38, v38, v14
    v_sub_f32 v39, v39, v14
    v_sub_f32 v40, v40, v73
    v_sub_f32 v41, v41, v73
    v_sub_f32 v42, v42, v73
    v_sub_f32 v43, v43, v73
    v_sub_f32 v44, v44, v73
    v_sub_f32 v45, v45, v73
    v_sub_f32 v46, v46, v73
    v_sub_f32 v47, v47, v73
    v_sub_f32 v48, v48, v14
    v_sub_f32 v49, v49, v14
    v_sub_f32 v50, v50, v14
    v_sub_f32 v51, v51, v14
    v_sub_f32 v52, v52, v14
    v_sub_f32 v53, v53, v14
    v_sub_f32 v54, v54, v14
    v_sub_f32 v55, v55, v14
    v_sub_f32 v56, v56, v73
    v_sub_f32 v57, v57, v73
    v_sub_f32 v58, v58, v73
    v_sub_f32 v59, v59, v73
    v_sub_f32 v60, v60, v73
    v_sub_f32 v61, v61, v73
    v_sub_f32 v62, v62, v73
    v_sub_f32 v63, v63, v73
    v_sub_f32 v64, v64, v14
    v_sub_f32 v65, v65, v14
    v_sub_f32 v66, v66, v14
    v_sub_f32 v67, v67, v14
    v_sub_f32 v68, v68, v73
    v_sub_f32 v69, v69, v73
    v_sub_f32 v70, v70, v73
    v_sub_f32 v71, v71, v73
    v_mul_f32 v96, v96, v15
    v_mul_f32 v97, v97, v15
    v_mul_f32 v98, v98, v15
    v_mul_f32 v99, v99, v15
    v_mul_f32 v100, v100, v72
    v_mul_f32 v101, v101, v72
    v_mul_f32 v102, v102, v72
    v_mul_f32 v103, v103, v72
    v_mul_f32 v104, v104, v15
    v_mul_f32 v105, v105, v15
    v_mul_f32 v106, v106, v15
    v_mul_f32 v107, v107, v15
    v_mul_f32 v108, v108, v72
    v_mul_f32 v109, v109, v72
    v_mul_f32 v110, v110, v72
    v_mul_f32 v111, v111, v72
    v_mul_f32 v112, v112, v15
    v_mul_f32 v113, v113, v15
    v_mul_f32 v114, v114, v15
    v_mul_f32 v115, v115, v15
    v_mul_f32 v116, v116, v72
    v_mul_f32 v117, v117, v72
    v_mul_f32 v118, v118, v72
    v_mul_f32 v119, v119, v72
    v_mul_f32 v120, v120, v15
    v_mul_f32 v121, v121, v15
    v_mul_f32 v122, v122, v15
    v_mul_f32 v123, v123, v15
    v_mul_f32 v124, v124, v72
    v_mul_f32 v125, v125, v72
    v_mul_f32 v126, v126, v72
    v_mul_f32 v127, v127, v72
    v_mul_f32 v128, v128, v15
    v_mul_f32 v129, v129, v15
    v_mul_f32 v130, v130, v15
    v_mul_f32 v131, v131, v15
    v_mul_f32 v132, v132, v72
    v_mul_f32 v133, v133, v72
    v_mul_f32 v134, v134, v72
    v_mul_f32 v135, v135, v72
    v_mul_f32 v136, v136, v15
    v_mul_f32 v137, v137, v15
    v_mul_f32 v138, v138, v15
    v_mul_f32 v139, v139, v15
    v_mul_f32 v140, v140, v72
    v_mul_f32 v141, v141, v72
    v_mul_f32 v142, v142, v72
    v_mul_f32 v143, v143, v72
    v_mul_f32 v144, v144, v15
    v_mul_f32 v145, v145, v15
    v_mul_f32 v146, v146, v15
    v_mul_f32 v147, v147, v15
    v_mul_f32 v148, v148, v72
    v_mul_f32 v149, v149, v72
    v_mul_f32 v150, v150, v72
    v_mul_f32 v151, v151, v72
    v_mul_f32 v152, v152, v15
    v_mul_f32 v153, v153, v15
    v_mul_f32 v154, v154, v15
    v_mul_f32 v155, v155, v15
    v_mul_f32 v156, v156, v72
    v_mul_f32 v157, v157, v72
    v_mul_f32 v158, v158, v72
    v_mul_f32 v159, v159, v72
    v_mul_f32 v76, v76, v15
    v_mul_f32 v240, v240, v72
    v_mul_f32 v77, v77, v15
    v_mul_f32 v241, v241, v72
    v_mul_f32 v78, v78, v15
    v_mul_f32 v242, v242, v72
    v_mul_f32 v79, v79, v15
    v_mul_f32 v243, v243, v72
    v_exp_f32 v244, v32
    v_exp_f32 v245, v33
    v_exp_f32 v246, v34
    v_cvt_pk_bf16_f32 v80, v244, v245
    v_exp_f32 v247, v35
    v_exp_f32 v244, v36
    v_cvt_pk_bf16_f32 v81, v246, v247
    v_exp_f32 v245, v37
    v_exp_f32 v246, v38
    v_cvt_pk_bf16_f32 v82, v244, v245
    v_exp_f32 v247, v39
    v_exp_f32 v244, v40
    v_cvt_pk_bf16_f32 v83, v246, v247
    v_exp_f32 v245, v41
    v_exp_f32 v246, v42
    v_cvt_pk_bf16_f32 v84, v244, v245
    v_exp_f32 v247, v43
    v_exp_f32 v244, v44
    v_cvt_pk_bf16_f32 v85, v246, v247
    v_exp_f32 v245, v45
    v_exp_f32 v246, v46
    v_cvt_pk_bf16_f32 v86, v244, v245
    v_exp_f32 v247, v47
    s_nop 0
    v_cvt_pk_bf16_f32 v87, v246, v247
    s_nop 1
    s_setpc_b64 s[76:77]
LB_rare1_1:
    s_nop 7
    v_max3_f32 v14, v48, v49, v50
    v_max3_f32 v14, v14, v51, v52
    v_max3_f32 v14, v14, v53, v54
    v_max_f32 v14, v14, v55
    v_max3_f32 v73, v56, v57, v58
    v_max3_f32 v73, v73, v59, v60
    v_max3_f32 v73, v73, v61, v62
    v_max_f32 v73, v73, v63
    v_mov_b32 v74, v14
    v_mov_b32 v75, v73
    s_nop 0
    v_permlane16_swap_b32 v74, v14
    v_permlane16_swap_b32 v75, v73
    v_max_f32 v14, v14, v74
    v_max_f32 v73, v73, v75
    v_mov_b32 v74, v14
    v_mov_b32 v75, v73
    s_nop 0
    v_permlane32_swap_b32 v74, v14
    v_permlane32_swap_b32 v75, v73
    v_max_f32 v14, v14, v74
    v_max_f32 v73, v73, v75
    v_add_f32 v14, 1088421888, v14
    v_add_f32 v73, 1088421888, v73
    v_max_f32 v14, 0, v14
    v_max_f32 v73, 0, v73
    v_exp_f32 v15, -v14
    v_exp_f32 v72, -v73
    v_sub_f32 v48, v48, v14
    v_sub_f32 v49, v49, v14
    v_sub_f32 v50, v50, v14
    v_sub_f32 v51, v51, v14
    v_sub_f32 v52, v52, v14
    v_sub_f32 v53, v53, v14
    v_sub_f32 v54, v54, v14
    v_sub_f32 v55, v55, v14
    v_sub_f32 v56, v56, v73
    v_sub_f32 v57, v57, v73
    v_sub_f32 v58, v58, v73
    v_sub_f32 v59, v59, v73
    v_sub_f32 v60, v60, v73
    v_sub_f32 v61, v61, v73
    v_sub_f32 v62, v62, v73
    v_sub_f32 v63, v63, v73
    v_sub_f32 v32, v32, v14
    v_sub_f32 v33, v33, v14
    v_sub_f32 v34, v34, v14
    v_sub_f32 v35, v35, v14
    v_sub_f32 v36, v36, v14
    v_sub_f32 v37, v37, v14
    v_sub_f32 v38, v38, v14
    v_sub_f32 v39, v39, v14
    v_sub_f32 v40, v40, v73
    v_sub_f32 v41, v41, v73
    v_sub_f32 v42, v42, v73
    v_sub_f32 v43, v43, v73
    v_sub_f32 v44, v44, v73
    v_sub_f32 v45, v45, v73
    v_sub_f32 v46, v46, v73
    v_sub_f32 v47, v47, v73
    v_sub_f32 v64, v64, v14
    v_sub_f32 v65, v65, v14
    v_sub_f32 v66, v66, v14
    v_sub_f32 v67, v67, v14
    v_sub_f32 v68, v68, v73
    v_sub_f32 v69, v69, v73
    v_sub_f32 v70, v70, v73
    v_sub_f32 v71, v71, v73
    v_mul_f32 v96, v96, v15
    v_mul_f32 v97, v97, v15
    v_mul_f32 v98, v98, v15
    v_mul_f32 v99, v99, v15
    v_mul_f32 v100, v100, v72
    v_mul_f32 v101, v101, v72
    v_mul_f32 v102, v102, v72
    v_mul_f32 v103, v103, v72
    v_mul_f32 v104, v104, v15
    v_mul_f32 v105, v105, v15
    v_mul_f32 v106, v106, v15
    v_mul_f32 v107, v107, v15
    v_mul_f32 v108, v108, v72
    v_mul_f32 v109, v109, v72
    v_mul_f32 v110, v110, v72
    v_mul_f32 v111, v111, v72
    v_mul_f32 v112, v112, v15
    v_mul_f32 v113, v113, v15
    v_mul_f32 v114, v114, v15
    v_mul_f32 v115, v115, v15
    v_mul_f32 v116, v116, v72
    v_mul_f32 v117, v117, v72
    v_mul_f32 v118, v118, v72
    v_mul_f32 v119, v119, v72
    v_mul_f32 v120, v120, v15
    v_mul_f32 v121, v121, v15
    v_mul_f32 v122, v122, v15
    v_mul_f32 v123, v123, v15
    v_mul_f32 v124, v124, v72
    v_mul_f32 v125, v125, v72
    v_mul_f32 v126, v126, v72
    v_mul_f32 v127, v127, v72
    v_mul_f32 v128, v128, v15
    v_mul_f32 v129, v129, v15
    v_mul_f32 v130, v130, v15
    v_mul_f32 v131, v131, v15
    v_mul_f32 v132, v132, v72
    v_mul_f32 v133, v133, v72
    v_mul_f32 v134, v134, v72
    v_mul_f32 v135, v135, v72
    v_mul_f32 v136, v136, v15
    v_mul_f32 v137, v137, v15
    v_mul_f32 v138, v138, v15
    v_mul_f32 v139, v139, v15
    v_mul_f32 v140, v140, v72
    v_mul_f32 v141, v141, v72
    v_mul_f32 v142, v142, v72
    v_mul_f32 v143, v143, v72
    v_mul_f32 v144, v144, v15
    v_mul_f32 v145, v145, v15
    v_mul_f32 v146, v146, v15
    v_mul_f32 v147, v147, v15
    v_mul_f32 v148, v148, v72
    v_mul_f32 v149, v149, v72
    v_mul_f32 v150, v150, v72
    v_mul_f32 v151, v151, v72
    v_mul_f32 v152, v152, v15
    v_mul_f32 v153, v153, v15
    v_mul_f32 v154, v154, v15
    v_mul_f32 v155, v155, v15
    v_mul_f32 v156, v156, v72
    v_mul_f32 v157, v157, v72
    v_mul_f32 v158, v158, v72
    v_mul_f32 v159, v159, v72
    v_mul_f32 v76, v76, v15
    v_mul_f32 v240, v240, v72
    v_mul_f32 v77, v77, v15
    v_mul_f32 v241, v241, v72
    v_mul_f32 v78, v78, v15
    v_mul_f32 v242, v242, v72
    v_mul_f32 v79, v79, v15
    v_mul_f32 v243, v243, v72
    v_exp_f32 v244, v48
    v_exp_f32 v245, v49
    v_exp_f32 v246, v50
    v_cvt_pk_bf16_f32 v88, v244, v245
    v_exp_f32 v247, v51
    v_exp_f32 v244, v52
    v_cvt_pk_bf16_f32 v89, v246, v247
    v_exp_f32 v245, v53
    v_exp_f32 v246, v54
    v_cvt_pk_bf16_f32 v90, v244, v245
    v_exp_f32 v247, v55
    v_exp_f32 v244, v56
    v_cvt_pk_bf16_f32 v91, v246, v247
    v_exp_f32 v245, v57
    v_exp_f32 v246, v58
    v_cvt_pk_bf16_f32 v92, v244, v245
    v_exp_f32 v247, v59
    v_exp_f32 v244, v60
    v_cvt_pk_bf16_f32 v93, v246, v247
    v_exp_f32 v245, v61
    v_exp_f32 v246, v62
    v_cvt_pk_bf16_f32 v94, v244, v245
    v_exp_f32 v247, v63
    s_nop 0
    v_cvt_pk_bf16_f32 v95, v246, v247
    s_nop 1
    s_setpc_b64 s[76:77]
LB_code_end:
.section .rodata,"a"
.p2align 6
.amdhsa_kernel concat_heads__gqa_block_cached__gqa_block_cached__near_ridge_kernel
  .amdhsa_next_free_vgpr 512
  .amdhsa_next_free_sgpr 102
  .amdhsa_accum_offset 256
  .amdhsa_group_segment_fixed_size 0
  .amdhsa_kernarg_size 104
  .amdhsa_user_sgpr_count 2
  .amdhsa_user_sgpr_kernarg_segment_ptr 1
  .amdhsa_system_sgpr_workgroup_id_x 1
.end_amdhsa_kernel
```
